```python
import torch

def _softmax(x, axis=-1):
    return torch.softmax(x, dim=axis)

def _gelu(x):
    return torch.nn.functional.gelu(x, approximate='tanh')

def _silu(x):
    return torch.nn.functional.silu(x)

def _sigmoid(x):
    return torch.sigmoid(x)

def _layernorm(x, axis=-1, eps=1e-05):
    m = x.mean(dim=axis, keepdim=True)
    v = x.var(dim=axis, keepdim=True, unbiased=False)
    return (x - m) / torch.sqrt(v + eps)

def _scatter_add(tgt, idx, src, axis=0):
    return tgt.clone().index_add_(axis, idx, src)

def _segment_sum(src, seg, n):
    out = torch.zeros((n,) + src.shape[1:], dtype=src.dtype)
    return out.index_add_(0, seg, src)

def _pad(x, pw):
    flat = tuple((v for pair in reversed(pw) for v in pair))
    return torch.nn.functional.pad(x, flat)
kernel_name = 'adaLN_cond__memory_aug_recurrent_mem_tr__dense_activation_silu__prompt'

def setup_inputs():

    _w = lambda a: (lambda t: t.to(torch.bfloat16) if t.is_floating_point() else t)(torch.as_tensor(a))

    def _A_setup():
        B, S, Dm = (1, 2048, 640)
        H, Dh = (32, 128)
        M, seg = (8, 32)
        seg = min(seg, S)
        S = S // seg * seg
        return {'x': _w((lambda *s: torch.randn(*s, dtype=torch.bfloat16) * 0.05)(B, S, Dm)), 'mem0': _w((lambda *s: torch.randn(*s, dtype=torch.bfloat16) * 0.8)(B, M, Dm)), 'Wq': _w((lambda *s: torch.randn(*s, dtype=torch.bfloat16) * 1.6)(Dm, H, Dh) * Dm ** (-0.5)), 'Wk': _w((lambda *s: torch.randn(*s, dtype=torch.bfloat16) * 1.6)(Dm, H, Dh) * Dm ** (-0.5)), 'Wv': _w((lambda *s: torch.randn(*s, dtype=torch.bfloat16) * 0.8)(Dm, H, Dh) * Dm ** (-0.5)), 'Wo': _w((lambda *s: torch.randn(*s, dtype=torch.bfloat16) * 0.8)(H, Dh, Dm) * (H * Dh) ** (-0.5)), 'seg_len': seg}
    _A_in = _A_setup()

    def _B_setup():
        B, S, D, F = (1, 2048, 640, 1728)
        return {'x': _w((lambda *s: torch.randn(*s, dtype=torch.bfloat16) * 0.05)(B, S, D)), 'w1': _w((lambda *s: torch.randn(*s, dtype=torch.bfloat16) * 3.2)(D, F) * D ** (-0.5)), 'w2': _w((lambda *s: torch.randn(*s, dtype=torch.bfloat16) * 0.2)(F, D) * F ** (-0.5))}
    _B_in = _B_setup()
    return {'A_x': _A_in['x'], 'A_mem0': _A_in['mem0'], 'A_Wq': _A_in['Wq'], 'A_Wk': _A_in['Wk'], 'A_Wv': _A_in['Wv'], 'A_Wo': _A_in['Wo'], 'A_seg_len': _A_in['seg_len'], 'B_x': _B_in['x'], 'B_w1': _B_in['w1'], 'B_w2': _B_in['w2'], 'c': _w((lambda *s: torch.randn(*s, dtype=torch.bfloat16) * 0.1)(1, 640) * 8.0), 'w_mod': _w((lambda *s: torch.randn(*s, dtype=torch.bfloat16) * 0.1)(640, 6 * 640) * 640 ** (-0.5) * 8.0)}

def reference(A_x, A_mem0, A_Wq, A_Wk, A_Wv, A_Wo, A_seg_len, B_x, B_w1, B_w2, c, w_mod):

    def _A_ref(x, mem0, Wq, Wk, Wv, Wo, seg_len):
        B, S, Dm = x.shape
        H, Dh = (Wq.shape[1], Wq.shape[2])
        M = mem0.shape[1]
        scale = Dh ** (-0.5)
        n_seg = S // seg_len
        L = M + seg_len
        idx = torch.arange(L)
        mask = (idx[:, None] < M) | (idx[:, None] >= idx[None, :])
        mem = mem0
        outs = []
        for s in range(n_seg):
            xs = x[:, s * seg_len:(s + 1) * seg_len, :].clone()
            h = torch.concatenate([mem, xs], axis=1)
            q = torch.einsum('btd,dhe->bhte', h, Wq)
            k = torch.einsum('btd,dhe->bhte', h, Wk)
            v = torch.einsum('btd,dhe->bhte', h, Wv)
            scores = torch.einsum('bhqe,bhke->bhqk', q, k) * scale
            scores = torch.where(mask[None, None], scores, -1000000000.0)
            p = _softmax(scores, axis=-1)
            o = torch.einsum('bhqk,bhke->bhqe', p, v)
            o = torch.einsum('bhte,hed->btd', o, Wo)
            mem = o[:, :M, :].clone()
            outs.append(o[:, M:, :])
        return torch.concatenate(outs, axis=1)

    def _B_ref(x, w1, w2):
        h = torch.einsum('bsd,df->bsf', x, w1)
        h = _silu(h)
        out = torch.einsum('bsf,fd->bsd', h, w2)
        return out
    x = A_x
    mod = (_silu(c) @ w_mod).reshape(c.shape[0], 6, 1, -1)
    sa, ca, ga, sb, cb, gb = (mod[:, 0].clone(), mod[:, 1].clone(), mod[:, 2].clone(), mod[:, 3].clone(), mod[:, 4].clone(), mod[:, 5].clone())
    h = _layernorm(x, axis=-1) * (1 + ca) + sa
    x = x + ga * _A_ref(h, A_mem0, A_Wq, A_Wk, A_Wv, A_Wo, A_seg_len)
    h = _layernorm(x, axis=-1) * (1 + cb) + sb
    x = x + gb * _B_ref(h, B_w1, B_w2)
    return x
```

```asm
; @launch grid=(256,1,1) block=(256,1,1) lds=163840
.amdgcn_target "amdgcn-amd-amdhsa--gfx950"
.text
.globl adaLN_cond__memory_aug_recurrent_mem_tr__dense_activation_silu__prompt_kernel
.p2align 8
.type adaLN_cond__memory_aug_recurrent_mem_tr__dense_activation_silu__prompt_kernel,@function
adaLN_cond__memory_aug_recurrent_mem_tr__dense_activation_silu__prompt_kernel:
    s_lshr_b32 s98, s2, 3
    s_and_b32 s98, s98, 31
    s_lshl_b32 s98, s98, 12
    v_cmp_gt_u32 vcc, 64, v0
    s_nop 0
    s_cbranch_vccz main_nocw
    s_getpc_b64 s[96:97]
pc_1:
    v_lshlrev_b32 v4, 6, v0
    v_add_u32 v4, s98, v4
    v_min_u32 v4, main_end - main_nocw, v4
    v_add_u32 v4, main_nocw - pc_1, v4
    v_mov_b32 v5, s97
    v_add_co_u32 v4, vcc, s96, v4
    s_nop 1
    v_addc_co_u32 v5, vcc, 0, v5, vcc
    global_load_dword v6, v[4:5], off
main_nocw:
    s_cmp_ge_u32 s2, 256
    s_cbranch_scc1 main_end0
    s_load_dwordx2 s[8:9], s[0:1], 112
    s_load_dwordx2 s[12:13], s[0:1], 16
    s_load_dwordx2 s[16:17], s[0:1], 24
    s_load_dwordx2 s[20:21], s[0:1], 32
    s_load_dwordx2 s[24:25], s[0:1], 40
    s_load_dwordx2 s[28:29], s[0:1], 8
    s_load_dwordx2 s[32:33], s[0:1], 104
    v_lshrrev_b32 v1, 6, v0
    v_and_b32 v0, 63, v0
    v_readfirstlane_b32 s36, v1
    s_getreg_b32 s54, hwreg(HW_REG_XCC_ID, 0, 4)
    s_and_b32 s54, s54, 7
    s_waitcnt lgkmcnt(0)
    s_and_b32 s9, s9, 0xffff
    s_mov_b32 s10, 268435456
    s_mov_b32 s11, 0x20000
    s_and_b32 s13, s13, 0xffff
    s_mov_b32 s14, 5242880
    s_mov_b32 s15, 0x20000
    s_and_b32 s17, s17, 0xffff
    s_mov_b32 s18, 5242880
    s_mov_b32 s19, 0x20000
    s_and_b32 s21, s21, 0xffff
    s_mov_b32 s22, 5242880
    s_mov_b32 s23, 0x20000
    s_and_b32 s25, s25, 0xffff
    s_mov_b32 s26, 5242880
    s_mov_b32 s27, 0x20000
    s_and_b32 s29, s29, 0xffff
    s_mov_b32 s30, 10240
    s_mov_b32 s31, 0x20000
    s_and_b32 s33, s33, 0xffff
    s_mov_b32 s34, 256
    s_mov_b32 s35, 0x20000
    s_cmp_eq_u32 s36, 1
    s_cbranch_scc1 role_cal_5
    s_cmp_lg_u32 s36, 0
    s_cbranch_scc1 role_wait_2
    s_mov_b32 s38, s54
    s_mov_b32 s55, 1
    s_mov_b64 exec, 1
role_try_3:
    v_mov_b32 v2, 1
    s_lshl_b32 s56, s38, 4
    s_cmp_lt_u32 s38, 2
    s_cselect_b32 s57, 0, 96
    s_add_u32 s56, s56, s57
    v_mov_b32 v3, s56
    buffer_atomic_add v2, v3, s[32:35], 0 offen sc0
    s_waitcnt vmcnt(0)
    v_readfirstlane_b32 s37, v2
    s_nop 0
    s_cmp_lt_u32 s37, 32
    s_cbranch_scc1 role_got_4
    s_add_u32 s55, s55, 1
    s_and_b32 s38, s55, 7
    s_cmp_lt_u32 s55, 10
    s_cbranch_scc1 role_try_3
    s_mov_b32 s38, 8
role_got_4:
    s_lshl_b32 s56, s38, 8
    s_or_b32 s56, s56, s37
    v_mov_b32 v2, s56
    v_mov_b32 v3, 0
    ds_write_b32 v3, v2
    s_mov_b64 exec, -1
    s_waitcnt lgkmcnt(0)
    s_branch role_wait_2
role_cal_5:
    s_cmp_lg_u32 s54, 0
    s_cbranch_scc1 role_wait_2
    s_lshr_b32 s55, s2, 3
    s_and_b32 s55, s55, 31
    s_lshl_b32 s55, s55, 6
    s_add_u32 s55, s55, 3020800
    s_add_u32 s56, s55, 8192
    v_mov_b32 v3, 0
    v_mov_b32 v2, -1
    s_mov_b64 exec, 1
    buffer_store_dword v2, v3, s[8:11], s55 offen sc1
    buffer_store_dword v2, v3, s[8:11], s56 offen sc1
    s_waitcnt vmcnt(0)
    s_memtime s[70:71]
    buffer_store_dword v2, v3, s[8:11], s55 offen sc1
    s_waitcnt vmcnt(0)
    s_memtime s[72:73]
    buffer_store_dword v2, v3, s[8:11], s56 offen sc1
    s_waitcnt vmcnt(0)
    s_memtime s[74:75]
    s_waitcnt lgkmcnt(0)
    s_sub_u32 s70, s72, s70
    s_sub_u32 s72, s74, s72
    s_cmp_lt_u32 s72, s70
    s_cselect_b32 s55, 1, 0
    v_mov_b32 v2, s55
    ds_write_b32 v3, v2 offset:4
    s_mov_b64 exec, -1
    s_waitcnt lgkmcnt(0)
role_wait_2:
    s_barrier
    v_mov_b32 v3, 0
    ds_read_b64 v[4:5], v3
    s_waitcnt lgkmcnt(0)
    v_readfirstlane_b32 s56, v4
    v_readfirstlane_b32 s6, v5
    s_nop 0
    s_and_b32 s6, s6, 1
    s_lshr_b32 s38, s56, 8
    s_and_b32 s37, s56, 31
    s_cmp_lg_u32 s38, s54
    s_cselect_b32 s39, 1, 0
    s_barrier
    s_cmp_ge_u32 s38, 8
    s_cbranch_scc1 main_end0
    s_cmp_ge_u32 s38, 2
    s_cbranch_scc1 main_worker
    v_mov_b32 v20, v0
    v_lshlrev_b32 v0, 4, v20
    v_xor_b32 v1, 128, v0
    s_mov_b32 s60, 0x00ff00ff
    s_mov_b32 s61, 0x00ff00ff
    s_mov_b64 s[64:65], 0xffffffff
    s_not_b64 s[66:67], s[64:65]
    s_not_b64 s[62:63], s[60:61]
    s_bitcmp1_b32 s36, 0
    s_cselect_b64 s[62:63], s[62:63], s[60:61]
    v_mov_b32 v21, 0xeeee
    v_mov_b32 v22, 0x4444
    v_cndmask_b32 v2, v21, v22, s[60:61]
    v_bfe_u32 v23, v20, 3, 1
    v_lshlrev_b32 v3, 9, v23
    v_bfe_u32 v23, v20, 4, 1
    v_lshl_add_u32 v3, v23, 8, v3
    v_bfe_u32 v23, v20, 2, 1
    v_lshl_add_u32 v3, v23, 7, v3
    v_bfe_u32 v23, v20, 5, 1
    v_lshl_add_u32 v3, v23, 6, v3
    v_bfe_u32 v23, v20, 0, 2
    v_lshl_add_u32 v3, v23, 4, v3
    v_bfe_u32 v23, v20, 3, 1
    v_lshlrev_b32 v4, 2, v23
    v_bfe_u32 v23, v20, 4, 2
    v_lshl_add_u32 v4, v23, 0, v4
    s_lshl_b32 s54, s36, 3
    v_add_u32 v4, s54, v4
    v_mul_u32_u24 v4, 4608, v4
    v_bfe_u32 v23, v20, 0, 3
    v_lshl_add_u32 v4, v23, 4, v4
    v_lshrrev_b32 v5, 4, v20
    s_lshl_b32 s54, s36, 2
    s_add_u32 s54, s54, 32
    v_add_u32 v5, s54, v5
    v_mul_u32_u24 v5, 4608, v5
    v_bfe_u32 v23, v20, 0, 4
    v_lshl_add_u32 v5, v23, 3, v5
    v_bfe_u32 v23, v20, 0, 4
    v_lshlrev_b32 v6, 4, v23
    v_bfe_u32 v23, v20, 4, 1
    v_lshl_add_u32 v6, v23, 3, v6
    v_bfe_u32 v23, v20, 5, 1
    v_lshl_add_u32 v6, v23, 8, v6
    s_lshl_b32 s54, s36, 9
    v_add_u32 v6, s54, v6
    v_bfe_u32 v23, v20, 2, 4
    v_lshlrev_b32 v7, 4, v23
    v_bfe_u32 v23, v20, 0, 1
    v_lshl_add_u32 v7, v23, 3, v7
    v_bfe_u32 v23, v20, 0, 4
    v_lshlrev_b32 v8, 4, v23
    v_bfe_u32 v23, v20, 4, 2
    v_lshl_add_u32 v8, v23, 2, v8
    s_lshl_b32 s54, s36, 11
    v_add_u32 v9, s54, v0
    v_add_u32 v10, 0x10000, v9
    v_add_u32 v11, 0x20000, v9
    s_mov_b32 s58, 0x3e0293ee
    s_mov_b32 s59, 0x3e0293ee
    s_mov_b32 s53, 0x40000
    s_lshr_b32 s50, s36, 1
    s_lshl_b32 s50, s50, 11
    s_mov_b32 s68, s37
    s_cmp_eq_u32 s36, 0
    s_cbranch_scc1 ci_6
    s_add_u32 s68, s37, 32
    s_cmp_lg_u32 s36, 2
    s_cbranch_scc1 ci_7
    s_cmp_lt_u32 s37, 16
    s_cbranch_scc1 ci_6
ci_7:
    s_mov_b32 s68, -1
ci_6:
    s_lshl_b32 s54, s38, 5
    s_add_u32 s54, s54, s37
    s_lshl_b32 s54, s54, 2
    s_add_u32 s54, s54, s36
    s_lshl_b32 s69, s54, 13
    s_add_u32 s69, s69, 5242880
    s_lshl_b32 s54, s54, 12
    s_add_u32 s52, s54, 3145728
    s_lshl_b32 s54, s37, 8
    s_lshl_b32 s94, s38, 21
    s_xor_b32 s95, s94, 0x200000
    s_add_u32 s94, s94, s54
    s_add_u32 s95, s95, s54
    s_lshl_b32 s54, s38, 13
    s_add_u32 s54, s54, 3014656
    s_lshl_b32 s55, s36, 11
    s_add_u32 s96, s54, s55
    s_sub_u32 s96, s96, 2048
    s_lshl_b32 s55, s68, 7
    s_add_u32 s98, s54, s55
    s_lshl_b32 s54, s38, 12
    s_add_u32 s54, s54, 3031040
    s_add_u32 s99, s54, s55
    s_xor_b32 s54, s54, 4096
    s_lshl_b32 s55, s36, 10
    s_add_u32 s97, s54, s55
    s_cmp_lg_u32 s36, 0
    s_cbranch_scc1 reg_8
    s_lshl_b32 s54, s39, 16
    s_add_u32 s54, s54, 1
    s_lshl_b32 s55, s6, 8
    s_cmp_eq_u32 s38, 0
    s_cselect_b32 s55, s55, 0
    s_add_u32 s54, s54, s55
    v_mov_b32 v30, s54
    v_mov_b32 v31, 64
    s_mov_b64 exec, 1
    buffer_atomic_add v30, v31, s[32:35], 0 offen
    s_mov_b64 exec, -1
reg_8:
    s_cmp_eq_u32 s68, -1
    s_cbranch_scc1 nocons_9
    v_bfe_u32 v23, v20, 4, 1
    v_lshlrev_b32 v21, 2, v23
    v_bfe_u32 v23, v20, 5, 1
    v_lshl_add_u32 v21, v23, 1, v21
    v_bfe_u32 v22, v20, 2, 1
    v_and_b32 v23, 3, v20
    s_and_b32 s54, s68, 1
    s_lshl_b32 s54, s54, 2
    v_add_u32 v23, s54, v23
    v_mul_u32_u24 v23, 1280, v23
    s_and_b32 s56, s68, 2
    s_lshl_b32 s56, s56, 3
    s_cmp_ge_u32 s68, 32
    s_cbranch_scc1 shr_10
    s_lshr_b32 s54, s68, 3
    s_lshl_b32 s54, s54, 6
    s_and_b32 s55, s68, 4
    s_lshl_b32 s55, s55, 1
    s_add_u32 s54, s54, s55
    s_lshl_b32 s55, s38, 8
    s_add_u32 s54, s54, s55
    s_add_u32 s54, s54, s56
    v_lshl_add_u32 v24, v22, 5, v21
    v_add_u32 v24, s54, v24
    v_add_u32 v25, 1, v24
    s_branch cont_11
shr_10:
    s_sub_u32 s54, s68, 32
    s_lshr_b32 s54, s54, 2
    s_lshl_b32 s54, s54, 5
    s_add_u32 s54, s54, 512
    s_add_u32 s54, s54, s56
    v_lshl_add_u32 v24, v21, 1, v22
    v_add_u32 v24, s54, v24
    v_add_u32 v25, 2, v24
cont_11:
    v_lshl_add_u32 v24, v24, 1, v23
    v_lshl_add_u32 v25, v25, 1, v23
    buffer_load_ushort v32, v24, s[28:31], 0 offen
    buffer_load_ushort v33, v25, s[28:31], 0 offen
nocons_9:
    s_lshl_b32 s54, s36, 4
    v_lshrrev_b32 v21, 4, v20
    v_add_u32 v21, s54, v21
    v_lshlrev_b32 v24, 13, v21
    v_bfe_u32 v23, v20, 0, 4
    v_lshl_add_u32 v24, v23, 4, v24
    v_mul_u32_u24 v26, 1280, v21
    v_mov_b32 v25, v26
    v_bfe_u32 v23, v20, 2, 2
    v_lshl_add_u32 v25, v23, 7, v25
    v_bfe_u32 v23, v20, 0, 2
    v_lshl_add_u32 v25, v23, 4, v25
    v_bfe_u32 v23, v20, 0, 4
    v_lshl_add_u32 v26, v23, 4, v26
    v_bfe_u32 v23, v20, 0, 2
    v_lshlrev_b32 v27, 3, v23
    v_bfe_u32 v23, v20, 3, 1
    v_lshl_add_u32 v27, v23, 5, v27
    v_bfe_u32 v23, v20, 2, 1
    v_lshl_add_u32 v27, v23, 8, v27
    v_bfe_u32 v23, v20, 3, 1
    v_lshl_add_u32 v27, v23, 11, v27
    v_bfe_u32 v23, v20, 4, 1
    v_lshl_add_u32 v27, v23, 9, v27
    v_bfe_u32 v23, v20, 5, 1
    v_lshl_add_u32 v27, v23, 12, v27
    s_lshl_b32 s54, s36, 6
    v_add_u32 v27, s54, v27
    v_bfe_u32 v23, v20, 0, 2
    v_lshlrev_b32 v28, 3, v23
    v_bfe_u32 v23, v20, 3, 1
    v_lshl_add_u32 v28, v23, 5, v28
    v_bfe_u32 v23, v20, 2, 1
    v_lshl_add_u32 v28, v23, 9, v28
    v_bfe_u32 v23, v20, 3, 1
    v_lshl_add_u32 v28, v23, 13, v28
    v_bfe_u32 v23, v20, 4, 1
    v_lshl_add_u32 v28, v23, 10, v28
    v_bfe_u32 v23, v20, 5, 1
    v_lshl_add_u32 v28, v23, 12, v28
    s_lshl_b32 s54, s36, 6
    v_add_u32 v28, s54, v28
    v_bfe_u32 v23, v20, 0, 2
    v_lshlrev_b32 v29, 3, v23
    v_bfe_u32 v23, v20, 3, 1
    v_lshl_add_u32 v29, v23, 5, v29
    v_bfe_u32 v23, v20, 2, 1
    v_lshl_add_u32 v29, v23, 8, v29
    v_bfe_u32 v23, v20, 3, 1
    v_lshl_add_u32 v29, v23, 13, v29
    v_bfe_u32 v23, v20, 4, 1
    v_lshl_add_u32 v29, v23, 12, v29
    v_bfe_u32 v23, v20, 5, 1
    v_lshl_add_u32 v29, v23, 10, v29
    s_lshl_b32 s54, s36, 6
    v_add_u32 v29, s54, v29
    s_mul_i32 s42, s37, 163840
    s_lshl_b32 s54, s38, 9
    s_add_u32 s41, s42, s54
    s_add_u32 s42, s42, 1024
    s_lshl_b32 s43, s37, 8
    s_add_u32 s43, s43, 4194304
    s_lshl_b32 s44, s36, 12
    s_lshl_b32 s54, s37, 14
    s_lshl_b32 s55, s36, 12
    s_add_u32 s54, s54, s55
    s_lshl_b32 s55, s37, 8
    s_sub_u32 s54, s54, s55
    v_lshlrev_b32 v38, 6, v20
    v_add_u32 v38, s54, v38
    s_add_u32 s54, s95, 1572864
    s_add_u32 m0, s44, 65536
    s_nop 0
    buffer_load_dwordx4 v24, s[16:19], s54 offen lds
    s_add_u32 s54, s95, 1605632
    s_add_u32 m0, s44, 66560
    s_nop 0
    buffer_load_dwordx4 v24, s[16:19], s54 offen lds
    s_add_u32 s54, s95, 1638400
    s_add_u32 m0, s44, 67584
    s_nop 0
    buffer_load_dwordx4 v24, s[16:19], s54 offen lds
    s_add_u32 s54, s95, 1671168
    s_add_u32 m0, s44, 68608
    s_nop 0
    buffer_load_dwordx4 v24, s[16:19], s54 offen lds
    s_add_u32 s54, s94, 0
    s_add_u32 m0, s44, 81920
    s_nop 0
    buffer_load_dwordx4 v24, s[12:15], s54 offen lds
    s_add_u32 s54, s94, 32768
    s_add_u32 m0, s44, 82944
    s_nop 0
    buffer_load_dwordx4 v24, s[12:15], s54 offen lds
    s_add_u32 s54, s94, 65536
    s_add_u32 m0, s44, 83968
    s_nop 0
    buffer_load_dwordx4 v24, s[12:15], s54 offen lds
    s_add_u32 s54, s94, 98304
    s_add_u32 m0, s44, 84992
    s_nop 0
    buffer_load_dwordx4 v24, s[12:15], s54 offen lds
    s_add_u32 s54, s94, 524288
    s_add_u32 m0, s44, 98304
    s_nop 0
    buffer_load_dwordx4 v24, s[12:15], s54 offen lds
    s_add_u32 s54, s94, 557056
    s_add_u32 m0, s44, 99328
    s_nop 0
    buffer_load_dwordx4 v24, s[12:15], s54 offen lds
    s_add_u32 s54, s94, 589824
    s_add_u32 m0, s44, 100352
    s_nop 0
    buffer_load_dwordx4 v24, s[12:15], s54 offen lds
    s_add_u32 s54, s94, 622592
    s_add_u32 m0, s44, 101376
    s_nop 0
    buffer_load_dwordx4 v24, s[12:15], s54 offen lds
    s_add_u32 s54, s94, 1048576
    s_add_u32 m0, s44, 114688
    s_nop 0
    buffer_load_dwordx4 v24, s[12:15], s54 offen lds
    s_add_u32 s54, s94, 1081344
    s_add_u32 m0, s44, 115712
    s_nop 0
    buffer_load_dwordx4 v24, s[12:15], s54 offen lds
    s_add_u32 s54, s94, 1114112
    s_add_u32 m0, s44, 116736
    s_nop 0
    buffer_load_dwordx4 v24, s[12:15], s54 offen lds
    s_add_u32 s54, s94, 1146880
    s_add_u32 m0, s44, 117760
    s_nop 0
    buffer_load_dwordx4 v24, s[12:15], s54 offen lds
    s_add_u32 s54, s94, 1572864
    s_add_u32 m0, s44, 131072
    s_nop 0
    buffer_load_dwordx4 v24, s[12:15], s54 offen lds
    s_add_u32 s54, s94, 1605632
    s_add_u32 m0, s44, 132096
    s_nop 0
    buffer_load_dwordx4 v24, s[12:15], s54 offen lds
    s_add_u32 s54, s94, 1638400
    s_add_u32 m0, s44, 133120
    s_nop 0
    buffer_load_dwordx4 v24, s[12:15], s54 offen lds
    s_add_u32 s54, s94, 1671168
    s_add_u32 m0, s44, 134144
    s_nop 0
    buffer_load_dwordx4 v24, s[12:15], s54 offen lds
    s_add_u32 s54, s43, 0
    s_add_u32 m0, s44, 147456
    s_nop 0
    buffer_load_dwordx4 v24, s[12:15], s54 offen lds
    s_add_u32 s54, s43, 32768
    s_add_u32 m0, s44, 148480
    s_nop 0
    buffer_load_dwordx4 v24, s[12:15], s54 offen lds
    s_add_u32 s54, s43, 65536
    s_add_u32 m0, s44, 149504
    s_nop 0
    buffer_load_dwordx4 v24, s[12:15], s54 offen lds
    s_add_u32 s54, s43, 98304
    s_add_u32 m0, s44, 150528
    s_nop 0
    buffer_load_dwordx4 v24, s[12:15], s54 offen lds
    s_add_u32 s54, s43, 524288
    s_add_u32 m0, s44, 0
    s_nop 0
    buffer_load_dwordx4 v24, s[12:15], s54 offen lds
    s_add_u32 s54, s43, 557056
    s_add_u32 m0, s44, 1024
    s_nop 0
    buffer_load_dwordx4 v24, s[12:15], s54 offen lds
    s_add_u32 s54, s43, 589824
    s_add_u32 m0, s44, 2048
    s_nop 0
    buffer_load_dwordx4 v24, s[12:15], s54 offen lds
    s_add_u32 s54, s43, 622592
    s_add_u32 m0, s44, 3072
    s_nop 0
    buffer_load_dwordx4 v24, s[12:15], s54 offen lds
    s_add_u32 s54, s95, 0
    s_add_u32 m0, s44, 16384
    s_nop 0
    buffer_load_dwordx4 v24, s[12:15], s54 offen lds
    s_add_u32 s54, s95, 32768
    s_add_u32 m0, s44, 17408
    s_nop 0
    buffer_load_dwordx4 v24, s[12:15], s54 offen lds
    s_add_u32 s54, s95, 65536
    s_add_u32 m0, s44, 18432
    s_nop 0
    buffer_load_dwordx4 v24, s[12:15], s54 offen lds
    s_add_u32 s54, s95, 98304
    s_add_u32 m0, s44, 19456
    s_nop 0
    buffer_load_dwordx4 v24, s[12:15], s54 offen lds
    s_waitcnt vmcnt(28) lgkmcnt(0)
    s_barrier
    v_add_u32 v30, 65536, v27
    v_xor_b32 v31, 2048, v30
    ds_read_b64_tr_b16 v[44:45], v30 offset:0
    ds_read_b64_tr_b16 v[46:47], v30 offset:1024
    ds_read_b64_tr_b16 v[48:49], v30 offset:8192
    ds_read_b64_tr_b16 v[50:51], v30 offset:9216
    ds_read_b64_tr_b16 v[52:53], v31 offset:0
    ds_read_b64_tr_b16 v[54:55], v31 offset:1024
    ds_read_b64_tr_b16 v[56:57], v31 offset:8192
    ds_read_b64_tr_b16 v[58:59], v31 offset:9216
    s_waitcnt lgkmcnt(0)
    buffer_store_dwordx4 v[44:47], v0, s[8:11], s52 offen offset:0
    buffer_store_dwordx4 v[48:51], v0, s[8:11], s52 offen offset:1024
    buffer_store_dwordx4 v[52:55], v0, s[8:11], s52 offen offset:2048
    buffer_store_dwordx4 v[56:59], v0, s[8:11], s52 offen offset:3072
    s_add_u32 s54, s95, 524288
    s_add_u32 m0, s44, 32768
    s_nop 0
    buffer_load_dwordx4 v24, s[12:15], s54 offen lds
    s_add_u32 s54, s95, 557056
    s_add_u32 m0, s44, 33792
    s_nop 0
    buffer_load_dwordx4 v24, s[12:15], s54 offen lds
    s_add_u32 s54, s95, 589824
    s_add_u32 m0, s44, 34816
    s_nop 0
    buffer_load_dwordx4 v24, s[12:15], s54 offen lds
    s_add_u32 s54, s95, 622592
    s_add_u32 m0, s44, 35840
    s_nop 0
    buffer_load_dwordx4 v24, s[12:15], s54 offen lds
    s_waitcnt vmcnt(32) lgkmcnt(0)
    s_barrier
    v_add_u32 v30, 81920, v27
    v_xor_b32 v31, 2048, v30
    ds_read_b64_tr_b16 a[0:1], v30 offset:0
    ds_read_b64_tr_b16 a[2:3], v30 offset:1024
    ds_read_b64_tr_b16 a[4:5], v30 offset:8192
    ds_read_b64_tr_b16 a[6:7], v30 offset:9216
    ds_read_b64_tr_b16 a[8:9], v31 offset:0
    ds_read_b64_tr_b16 a[10:11], v31 offset:1024
    ds_read_b64_tr_b16 a[12:13], v31 offset:8192
    ds_read_b64_tr_b16 a[14:15], v31 offset:9216
    s_add_u32 s54, s95, 1048576
    s_add_u32 m0, s44, 49152
    s_nop 0
    buffer_load_dwordx4 v24, s[12:15], s54 offen lds
    s_add_u32 s54, s95, 1081344
    s_add_u32 m0, s44, 50176
    s_nop 0
    buffer_load_dwordx4 v24, s[12:15], s54 offen lds
    s_add_u32 s54, s95, 1114112
    s_add_u32 m0, s44, 51200
    s_nop 0
    buffer_load_dwordx4 v24, s[12:15], s54 offen lds
    s_add_u32 s54, s95, 1146880
    s_add_u32 m0, s44, 52224
    s_nop 0
    buffer_load_dwordx4 v24, s[12:15], s54 offen lds
    s_waitcnt vmcnt(32) lgkmcnt(0)
    s_barrier
    v_add_u32 v30, 98304, v27
    v_xor_b32 v31, 2048, v30
    ds_read_b64_tr_b16 a[16:17], v30 offset:0
    ds_read_b64_tr_b16 a[18:19], v30 offset:1024
    ds_read_b64_tr_b16 a[20:21], v30 offset:8192
    ds_read_b64_tr_b16 a[22:23], v30 offset:9216
    ds_read_b64_tr_b16 a[24:25], v31 offset:0
    ds_read_b64_tr_b16 a[26:27], v31 offset:1024
    ds_read_b64_tr_b16 a[28:29], v31 offset:8192
    ds_read_b64_tr_b16 a[30:31], v31 offset:9216
    s_add_u32 s54, s95, 1572864
    s_add_u32 m0, s44, 65536
    s_nop 0
    buffer_load_dwordx4 v24, s[12:15], s54 offen lds
    s_add_u32 s54, s95, 1605632
    s_add_u32 m0, s44, 66560
    s_nop 0
    buffer_load_dwordx4 v24, s[12:15], s54 offen lds
    s_add_u32 s54, s95, 1638400
    s_add_u32 m0, s44, 67584
    s_nop 0
    buffer_load_dwordx4 v24, s[12:15], s54 offen lds
    s_add_u32 s54, s95, 1671168
    s_add_u32 m0, s44, 68608
    s_nop 0
    buffer_load_dwordx4 v24, s[12:15], s54 offen lds
    s_waitcnt vmcnt(32) lgkmcnt(0)
    s_barrier
    v_add_u32 v30, 114688, v27
    v_xor_b32 v31, 2048, v30
    ds_read_b64_tr_b16 a[32:33], v30 offset:0
    ds_read_b64_tr_b16 a[34:35], v30 offset:1024
    ds_read_b64_tr_b16 a[36:37], v30 offset:8192
    ds_read_b64_tr_b16 a[38:39], v30 offset:9216
    ds_read_b64_tr_b16 a[40:41], v31 offset:0
    ds_read_b64_tr_b16 a[42:43], v31 offset:1024
    ds_read_b64_tr_b16 a[44:45], v31 offset:8192
    ds_read_b64_tr_b16 a[46:47], v31 offset:9216
    s_add_u32 s54, s94, 0
    s_add_u32 m0, s44, 81920
    s_nop 0
    buffer_load_dwordx4 v24, s[16:19], s54 offen lds
    s_add_u32 s54, s94, 32768
    s_add_u32 m0, s44, 82944
    s_nop 0
    buffer_load_dwordx4 v24, s[16:19], s54 offen lds
    s_add_u32 s54, s94, 65536
    s_add_u32 m0, s44, 83968
    s_nop 0
    buffer_load_dwordx4 v24, s[16:19], s54 offen lds
    s_add_u32 s54, s94, 98304
    s_add_u32 m0, s44, 84992
    s_nop 0
    buffer_load_dwordx4 v24, s[16:19], s54 offen lds
    s_waitcnt vmcnt(32) lgkmcnt(0)
    s_barrier
    v_add_u32 v30, 131072, v27
    v_xor_b32 v31, 2048, v30
    ds_read_b64_tr_b16 a[48:49], v30 offset:0
    ds_read_b64_tr_b16 a[50:51], v30 offset:1024
    ds_read_b64_tr_b16 a[52:53], v30 offset:8192
    ds_read_b64_tr_b16 a[54:55], v30 offset:9216
    ds_read_b64_tr_b16 a[56:57], v31 offset:0
    ds_read_b64_tr_b16 a[58:59], v31 offset:1024
    ds_read_b64_tr_b16 a[60:61], v31 offset:8192
    ds_read_b64_tr_b16 a[62:63], v31 offset:9216
    s_add_u32 s54, s94, 524288
    s_add_u32 m0, s44, 98304
    s_nop 0
    buffer_load_dwordx4 v24, s[16:19], s54 offen lds
    s_add_u32 s54, s94, 557056
    s_add_u32 m0, s44, 99328
    s_nop 0
    buffer_load_dwordx4 v24, s[16:19], s54 offen lds
    s_add_u32 s54, s94, 589824
    s_add_u32 m0, s44, 100352
    s_nop 0
    buffer_load_dwordx4 v24, s[16:19], s54 offen lds
    s_add_u32 s54, s94, 622592
    s_add_u32 m0, s44, 101376
    s_nop 0
    buffer_load_dwordx4 v24, s[16:19], s54 offen lds
    s_waitcnt vmcnt(32) lgkmcnt(0)
    s_barrier
    v_add_u32 v30, 147456, v28
    v_xor_b32 v31, 8192, v30
    ds_read_b64_tr_b16 a[64:65], v30 offset:0
    ds_read_b64_tr_b16 a[66:67], v30 offset:2048
    ds_read_b64_tr_b16 a[68:69], v30 offset:256
    ds_read_b64_tr_b16 a[70:71], v30 offset:2304
    ds_read_b64_tr_b16 a[72:73], v31 offset:0
    ds_read_b64_tr_b16 a[74:75], v31 offset:2048
    ds_read_b64_tr_b16 a[76:77], v31 offset:256
    ds_read_b64_tr_b16 a[78:79], v31 offset:2304
    s_add_u32 s54, s94, 1048576
    s_add_u32 m0, s44, 114688
    s_nop 0
    buffer_load_dwordx4 v24, s[16:19], s54 offen lds
    s_add_u32 s54, s94, 1081344
    s_add_u32 m0, s44, 115712
    s_nop 0
    buffer_load_dwordx4 v24, s[16:19], s54 offen lds
    s_add_u32 s54, s94, 1114112
    s_add_u32 m0, s44, 116736
    s_nop 0
    buffer_load_dwordx4 v24, s[16:19], s54 offen lds
    s_add_u32 s54, s94, 1146880
    s_add_u32 m0, s44, 117760
    s_nop 0
    buffer_load_dwordx4 v24, s[16:19], s54 offen lds
    s_waitcnt vmcnt(32) lgkmcnt(0)
    s_barrier
    v_add_u32 v30, 0, v28
    v_xor_b32 v31, 8192, v30
    ds_read_b64_tr_b16 a[80:81], v30 offset:0
    ds_read_b64_tr_b16 a[82:83], v30 offset:2048
    ds_read_b64_tr_b16 a[84:85], v30 offset:256
    ds_read_b64_tr_b16 a[86:87], v30 offset:2304
    ds_read_b64_tr_b16 a[88:89], v31 offset:0
    ds_read_b64_tr_b16 a[90:91], v31 offset:2048
    ds_read_b64_tr_b16 a[92:93], v31 offset:256
    ds_read_b64_tr_b16 a[94:95], v31 offset:2304
    s_add_u32 s54, s94, 1572864
    s_add_u32 m0, s44, 131072
    s_nop 0
    buffer_load_dwordx4 v24, s[16:19], s54 offen lds
    s_add_u32 s54, s94, 1605632
    s_add_u32 m0, s44, 132096
    s_nop 0
    buffer_load_dwordx4 v24, s[16:19], s54 offen lds
    s_add_u32 s54, s94, 1638400
    s_add_u32 m0, s44, 133120
    s_nop 0
    buffer_load_dwordx4 v24, s[16:19], s54 offen lds
    s_add_u32 s54, s94, 1671168
    s_add_u32 m0, s44, 134144
    s_nop 0
    buffer_load_dwordx4 v24, s[16:19], s54 offen lds
    s_waitcnt vmcnt(32) lgkmcnt(0)
    s_barrier
    v_add_u32 v30, 16384, v27
    v_xor_b32 v31, 2048, v30
    ds_read_b64_tr_b16 a[96:97], v30 offset:0
    ds_read_b64_tr_b16 a[98:99], v30 offset:1024
    ds_read_b64_tr_b16 a[100:101], v30 offset:8192
    ds_read_b64_tr_b16 a[102:103], v30 offset:9216
    ds_read_b64_tr_b16 a[104:105], v31 offset:0
    ds_read_b64_tr_b16 a[106:107], v31 offset:1024
    ds_read_b64_tr_b16 a[108:109], v31 offset:8192
    ds_read_b64_tr_b16 a[110:111], v31 offset:9216
    s_add_u32 s54, s43, 0
    s_add_u32 m0, s44, 147456
    s_nop 0
    buffer_load_dwordx4 v24, s[16:19], s54 offen lds
    s_add_u32 s54, s43, 32768
    s_add_u32 m0, s44, 148480
    s_nop 0
    buffer_load_dwordx4 v24, s[16:19], s54 offen lds
    s_add_u32 s54, s43, 65536
    s_add_u32 m0, s44, 149504
    s_nop 0
    buffer_load_dwordx4 v24, s[16:19], s54 offen lds
    s_add_u32 s54, s43, 98304
    s_add_u32 m0, s44, 150528
    s_nop 0
    buffer_load_dwordx4 v24, s[16:19], s54 offen lds
    s_waitcnt vmcnt(28) lgkmcnt(0)
    s_barrier
    v_add_u32 v30, 32768, v27
    v_xor_b32 v31, 2048, v30
    ds_read_b64_tr_b16 a[112:113], v30 offset:0
    ds_read_b64_tr_b16 a[114:115], v30 offset:1024
    ds_read_b64_tr_b16 a[116:117], v30 offset:8192
    ds_read_b64_tr_b16 a[118:119], v30 offset:9216
    ds_read_b64_tr_b16 a[120:121], v31 offset:0
    ds_read_b64_tr_b16 a[122:123], v31 offset:1024
    ds_read_b64_tr_b16 a[124:125], v31 offset:8192
    ds_read_b64_tr_b16 a[126:127], v31 offset:9216
    s_add_u32 s54, s43, 524288
    s_add_u32 m0, s44, 0
    s_nop 0
    buffer_load_dwordx4 v24, s[16:19], s54 offen lds
    s_add_u32 s54, s43, 557056
    s_add_u32 m0, s44, 1024
    s_nop 0
    buffer_load_dwordx4 v24, s[16:19], s54 offen lds
    s_add_u32 s54, s43, 589824
    s_add_u32 m0, s44, 2048
    s_nop 0
    buffer_load_dwordx4 v24, s[16:19], s54 offen lds
    s_add_u32 s54, s43, 622592
    s_add_u32 m0, s44, 3072
    s_nop 0
    buffer_load_dwordx4 v24, s[16:19], s54 offen lds
    s_waitcnt vmcnt(28) lgkmcnt(0)
    s_barrier
    v_add_u32 v30, 49152, v27
    v_xor_b32 v31, 2048, v30
    ds_read_b64_tr_b16 a[128:129], v30 offset:0
    ds_read_b64_tr_b16 a[130:131], v30 offset:1024
    ds_read_b64_tr_b16 a[132:133], v30 offset:8192
    ds_read_b64_tr_b16 a[134:135], v30 offset:9216
    ds_read_b64_tr_b16 a[136:137], v31 offset:0
    ds_read_b64_tr_b16 a[138:139], v31 offset:1024
    ds_read_b64_tr_b16 a[140:141], v31 offset:8192
    ds_read_b64_tr_b16 a[142:143], v31 offset:9216
    s_add_u32 s54, s95, 0
    s_add_u32 m0, s44, 16384
    s_nop 0
    buffer_load_dwordx4 v24, s[16:19], s54 offen lds
    s_add_u32 s54, s95, 32768
    s_add_u32 m0, s44, 17408
    s_nop 0
    buffer_load_dwordx4 v24, s[16:19], s54 offen lds
    s_add_u32 s54, s95, 65536
    s_add_u32 m0, s44, 18432
    s_nop 0
    buffer_load_dwordx4 v24, s[16:19], s54 offen lds
    s_add_u32 s54, s95, 98304
    s_add_u32 m0, s44, 19456
    s_nop 0
    buffer_load_dwordx4 v24, s[16:19], s54 offen lds
    s_waitcnt vmcnt(28) lgkmcnt(0)
    s_barrier
    v_add_u32 v30, 65536, v27
    v_xor_b32 v31, 2048, v30
    ds_read_b64_tr_b16 a[144:145], v30 offset:0
    ds_read_b64_tr_b16 a[146:147], v30 offset:1024
    ds_read_b64_tr_b16 a[148:149], v30 offset:8192
    ds_read_b64_tr_b16 a[150:151], v30 offset:9216
    ds_read_b64_tr_b16 a[152:153], v31 offset:0
    ds_read_b64_tr_b16 a[154:155], v31 offset:1024
    ds_read_b64_tr_b16 a[156:157], v31 offset:8192
    ds_read_b64_tr_b16 a[158:159], v31 offset:9216
    s_add_u32 s54, s95, 524288
    s_add_u32 m0, s44, 32768
    s_nop 0
    buffer_load_dwordx4 v24, s[16:19], s54 offen lds
    s_add_u32 s54, s95, 557056
    s_add_u32 m0, s44, 33792
    s_nop 0
    buffer_load_dwordx4 v24, s[16:19], s54 offen lds
    s_add_u32 s54, s95, 589824
    s_add_u32 m0, s44, 34816
    s_nop 0
    buffer_load_dwordx4 v24, s[16:19], s54 offen lds
    s_add_u32 s54, s95, 622592
    s_add_u32 m0, s44, 35840
    s_nop 0
    buffer_load_dwordx4 v24, s[16:19], s54 offen lds
    s_waitcnt vmcnt(28) lgkmcnt(0)
    s_barrier
    v_add_u32 v30, 81920, v27
    v_xor_b32 v31, 2048, v30
    ds_read_b64_tr_b16 a[160:161], v30 offset:0
    ds_read_b64_tr_b16 a[162:163], v30 offset:1024
    ds_read_b64_tr_b16 a[164:165], v30 offset:8192
    ds_read_b64_tr_b16 a[166:167], v30 offset:9216
    ds_read_b64_tr_b16 a[168:169], v31 offset:0
    ds_read_b64_tr_b16 a[170:171], v31 offset:1024
    ds_read_b64_tr_b16 a[172:173], v31 offset:8192
    ds_read_b64_tr_b16 a[174:175], v31 offset:9216
    s_add_u32 s54, s95, 1048576
    s_add_u32 m0, s44, 49152
    s_nop 0
    buffer_load_dwordx4 v24, s[16:19], s54 offen lds
    s_add_u32 s54, s95, 1081344
    s_add_u32 m0, s44, 50176
    s_nop 0
    buffer_load_dwordx4 v24, s[16:19], s54 offen lds
    s_add_u32 s54, s95, 1114112
    s_add_u32 m0, s44, 51200
    s_nop 0
    buffer_load_dwordx4 v24, s[16:19], s54 offen lds
    s_add_u32 s54, s95, 1146880
    s_add_u32 m0, s44, 52224
    s_nop 0
    buffer_load_dwordx4 v24, s[16:19], s54 offen lds
    s_waitcnt vmcnt(28) lgkmcnt(0)
    s_barrier
    v_add_u32 v30, 98304, v27
    v_xor_b32 v31, 2048, v30
    ds_read_b64_tr_b16 a[176:177], v30 offset:0
    ds_read_b64_tr_b16 a[178:179], v30 offset:1024
    ds_read_b64_tr_b16 a[180:181], v30 offset:8192
    ds_read_b64_tr_b16 a[182:183], v30 offset:9216
    ds_read_b64_tr_b16 a[184:185], v31 offset:0
    ds_read_b64_tr_b16 a[186:187], v31 offset:1024
    ds_read_b64_tr_b16 a[188:189], v31 offset:8192
    ds_read_b64_tr_b16 a[190:191], v31 offset:9216
    s_add_u32 s54, s43, 524288
    s_add_u32 m0, s44, 65536
    s_nop 0
    buffer_load_dwordx4 v24, s[20:23], s54 offen lds
    s_add_u32 s54, s43, 557056
    s_add_u32 m0, s44, 66560
    s_nop 0
    buffer_load_dwordx4 v24, s[20:23], s54 offen lds
    s_add_u32 s54, s43, 589824
    s_add_u32 m0, s44, 67584
    s_nop 0
    buffer_load_dwordx4 v24, s[20:23], s54 offen lds
    s_add_u32 s54, s43, 622592
    s_add_u32 m0, s44, 68608
    s_nop 0
    buffer_load_dwordx4 v24, s[20:23], s54 offen lds
    s_waitcnt vmcnt(28) lgkmcnt(0)
    s_barrier
    v_add_u32 v30, 114688, v27
    v_xor_b32 v31, 2048, v30
    ds_read_b64_tr_b16 a[192:193], v30 offset:0
    ds_read_b64_tr_b16 a[194:195], v30 offset:1024
    ds_read_b64_tr_b16 a[196:197], v30 offset:8192
    ds_read_b64_tr_b16 a[198:199], v30 offset:9216
    ds_read_b64_tr_b16 a[200:201], v31 offset:0
    ds_read_b64_tr_b16 a[202:203], v31 offset:1024
    ds_read_b64_tr_b16 a[204:205], v31 offset:8192
    ds_read_b64_tr_b16 a[206:207], v31 offset:9216
    s_add_u32 s54, s95, 0
    s_add_u32 m0, s44, 81920
    s_nop 0
    buffer_load_dwordx4 v24, s[20:23], s54 offen lds
    s_add_u32 s54, s95, 32768
    s_add_u32 m0, s44, 82944
    s_nop 0
    buffer_load_dwordx4 v24, s[20:23], s54 offen lds
    s_add_u32 s54, s95, 65536
    s_add_u32 m0, s44, 83968
    s_nop 0
    buffer_load_dwordx4 v24, s[20:23], s54 offen lds
    s_add_u32 s54, s95, 98304
    s_add_u32 m0, s44, 84992
    s_nop 0
    buffer_load_dwordx4 v24, s[20:23], s54 offen lds
    s_waitcnt vmcnt(28) lgkmcnt(0)
    s_barrier
    v_add_u32 v30, 131072, v27
    v_xor_b32 v31, 2048, v30
    ds_read_b64_tr_b16 a[208:209], v30 offset:0
    ds_read_b64_tr_b16 a[210:211], v30 offset:1024
    ds_read_b64_tr_b16 a[212:213], v30 offset:8192
    ds_read_b64_tr_b16 a[214:215], v30 offset:9216
    ds_read_b64_tr_b16 a[216:217], v31 offset:0
    ds_read_b64_tr_b16 a[218:219], v31 offset:1024
    ds_read_b64_tr_b16 a[220:221], v31 offset:8192
    ds_read_b64_tr_b16 a[222:223], v31 offset:9216
    s_add_u32 s54, s95, 524288
    s_add_u32 m0, s44, 98304
    s_nop 0
    buffer_load_dwordx4 v24, s[20:23], s54 offen lds
    s_add_u32 s54, s95, 557056
    s_add_u32 m0, s44, 99328
    s_nop 0
    buffer_load_dwordx4 v24, s[20:23], s54 offen lds
    s_add_u32 s54, s95, 589824
    s_add_u32 m0, s44, 100352
    s_nop 0
    buffer_load_dwordx4 v24, s[20:23], s54 offen lds
    s_add_u32 s54, s95, 622592
    s_add_u32 m0, s44, 101376
    s_nop 0
    buffer_load_dwordx4 v24, s[20:23], s54 offen lds
    s_waitcnt vmcnt(28) lgkmcnt(0)
    s_barrier
    v_add_u32 v30, 147456, v28
    v_xor_b32 v31, 8192, v30
    ds_read_b64_tr_b16 a[224:225], v30 offset:0
    ds_read_b64_tr_b16 a[226:227], v30 offset:2048
    ds_read_b64_tr_b16 a[228:229], v30 offset:256
    ds_read_b64_tr_b16 a[230:231], v30 offset:2304
    ds_read_b64_tr_b16 a[232:233], v31 offset:0
    ds_read_b64_tr_b16 a[234:235], v31 offset:2048
    ds_read_b64_tr_b16 a[236:237], v31 offset:256
    ds_read_b64_tr_b16 a[238:239], v31 offset:2304
    s_add_u32 s54, s95, 1048576
    s_add_u32 m0, s44, 114688
    s_nop 0
    buffer_load_dwordx4 v24, s[20:23], s54 offen lds
    s_add_u32 s54, s95, 1081344
    s_add_u32 m0, s44, 115712
    s_nop 0
    buffer_load_dwordx4 v24, s[20:23], s54 offen lds
    s_add_u32 s54, s95, 1114112
    s_add_u32 m0, s44, 116736
    s_nop 0
    buffer_load_dwordx4 v24, s[20:23], s54 offen lds
    s_add_u32 s54, s95, 1146880
    s_add_u32 m0, s44, 117760
    s_nop 0
    buffer_load_dwordx4 v24, s[20:23], s54 offen lds
    s_waitcnt vmcnt(28) lgkmcnt(0)
    s_barrier
    v_add_u32 v30, 0, v28
    v_xor_b32 v31, 8192, v30
    ds_read_b64_tr_b16 a[240:241], v30 offset:0
    ds_read_b64_tr_b16 a[242:243], v30 offset:2048
    ds_read_b64_tr_b16 a[244:245], v30 offset:256
    ds_read_b64_tr_b16 a[246:247], v30 offset:2304
    ds_read_b64_tr_b16 a[248:249], v31 offset:0
    ds_read_b64_tr_b16 a[250:251], v31 offset:2048
    ds_read_b64_tr_b16 a[252:253], v31 offset:256
    ds_read_b64_tr_b16 a[254:255], v31 offset:2304
    s_add_u32 s54, s95, 1572864
    s_add_u32 m0, s44, 131072
    s_nop 0
    buffer_load_dwordx4 v24, s[20:23], s54 offen lds
    s_add_u32 s54, s95, 1605632
    s_add_u32 m0, s44, 132096
    s_nop 0
    buffer_load_dwordx4 v24, s[20:23], s54 offen lds
    s_add_u32 s54, s95, 1638400
    s_add_u32 m0, s44, 133120
    s_nop 0
    buffer_load_dwordx4 v24, s[20:23], s54 offen lds
    s_add_u32 s54, s95, 1671168
    s_add_u32 m0, s44, 134144
    s_nop 0
    buffer_load_dwordx4 v24, s[20:23], s54 offen lds
    s_waitcnt vmcnt(28) lgkmcnt(0)
    s_barrier
    v_add_u32 v30, 16384, v27
    v_xor_b32 v31, 2048, v30
    ds_read_b64_tr_b16 v[80:81], v30 offset:0
    ds_read_b64_tr_b16 v[82:83], v30 offset:1024
    ds_read_b64_tr_b16 v[84:85], v30 offset:8192
    ds_read_b64_tr_b16 v[86:87], v30 offset:9216
    ds_read_b64_tr_b16 v[88:89], v31 offset:0
    ds_read_b64_tr_b16 v[90:91], v31 offset:1024
    ds_read_b64_tr_b16 v[92:93], v31 offset:8192
    ds_read_b64_tr_b16 v[94:95], v31 offset:9216
    s_add_u32 s54, s41, 64
    s_add_u32 m0, s44, 147456
    s_nop 0
    buffer_load_dwordx4 v25, s[24:27], s54 offen lds
    s_add_u32 s54, s41, 5184
    s_add_u32 m0, s44, 148480
    s_nop 0
    buffer_load_dwordx4 v25, s[24:27], s54 offen lds
    s_add_u32 s54, s41, 10304
    s_add_u32 m0, s44, 149504
    s_nop 0
    buffer_load_dwordx4 v25, s[24:27], s54 offen lds
    s_add_u32 s54, s41, 15424
    s_add_u32 m0, s44, 150528
    s_nop 0
    buffer_load_dwordx4 v25, s[24:27], s54 offen lds
    buffer_load_dword v34, off, s[32:35], 0 offset:64 sc1
    buffer_load_dword v35, off, s[32:35], 0 offset:96 sc1
    s_waitcnt vmcnt(30) lgkmcnt(0)
    s_barrier
    v_add_u32 v30, 32768, v27
    v_xor_b32 v31, 2048, v30
    ds_read_b64_tr_b16 v[96:97], v30 offset:0
    ds_read_b64_tr_b16 v[98:99], v30 offset:1024
    ds_read_b64_tr_b16 v[100:101], v30 offset:8192
    ds_read_b64_tr_b16 v[102:103], v30 offset:9216
    ds_read_b64_tr_b16 v[104:105], v31 offset:0
    ds_read_b64_tr_b16 v[106:107], v31 offset:1024
    ds_read_b64_tr_b16 v[108:109], v31 offset:8192
    ds_read_b64_tr_b16 v[110:111], v31 offset:9216
    s_add_u32 s54, s42, 0
    s_add_u32 m0, s44, 0
    s_nop 0
    buffer_load_dwordx4 v26, s[24:27], s54 offen lds
    s_add_u32 s54, s42, 5120
    s_add_u32 m0, s44, 1024
    s_nop 0
    buffer_load_dwordx4 v26, s[24:27], s54 offen lds
    s_add_u32 s54, s42, 10240
    s_add_u32 m0, s44, 2048
    s_nop 0
    buffer_load_dwordx4 v26, s[24:27], s54 offen lds
    s_add_u32 s54, s42, 15360
    s_add_u32 m0, s44, 3072
    s_nop 0
    buffer_load_dwordx4 v26, s[24:27], s54 offen lds
    s_waitcnt vmcnt(30) lgkmcnt(0)
    s_barrier
    v_add_u32 v30, 49152, v27
    v_xor_b32 v31, 2048, v30
    ds_read_b64_tr_b16 v[112:113], v30 offset:0
    ds_read_b64_tr_b16 v[114:115], v30 offset:1024
    ds_read_b64_tr_b16 v[116:117], v30 offset:8192
    ds_read_b64_tr_b16 v[118:119], v30 offset:9216
    ds_read_b64_tr_b16 v[120:121], v31 offset:0
    ds_read_b64_tr_b16 v[122:123], v31 offset:1024
    ds_read_b64_tr_b16 v[124:125], v31 offset:8192
    ds_read_b64_tr_b16 v[126:127], v31 offset:9216
    s_add_u32 s54, s41, 81984
    s_add_u32 m0, s44, 16384
    s_nop 0
    buffer_load_dwordx4 v25, s[24:27], s54 offen lds
    s_add_u32 s54, s41, 87104
    s_add_u32 m0, s44, 17408
    s_nop 0
    buffer_load_dwordx4 v25, s[24:27], s54 offen lds
    s_add_u32 s54, s41, 92224
    s_add_u32 m0, s44, 18432
    s_nop 0
    buffer_load_dwordx4 v25, s[24:27], s54 offen lds
    s_add_u32 s54, s41, 97344
    s_add_u32 m0, s44, 19456
    s_nop 0
    buffer_load_dwordx4 v25, s[24:27], s54 offen lds
    s_waitcnt vmcnt(30) lgkmcnt(0)
    s_barrier
    v_add_u32 v30, 65536, v28
    v_xor_b32 v31, 8192, v30
    ds_read_b64_tr_b16 v[128:129], v30 offset:0
    ds_read_b64_tr_b16 v[130:131], v30 offset:2048
    ds_read_b64_tr_b16 v[132:133], v30 offset:256
    ds_read_b64_tr_b16 v[134:135], v30 offset:2304
    ds_read_b64_tr_b16 v[136:137], v31 offset:0
    ds_read_b64_tr_b16 v[138:139], v31 offset:2048
    ds_read_b64_tr_b16 v[140:141], v31 offset:256
    ds_read_b64_tr_b16 v[142:143], v31 offset:2304
    s_add_u32 s54, s94, 0
    s_add_u32 m0, s44, 32768
    s_nop 0
    buffer_load_dwordx4 v24, s[20:23], s54 offen lds
    s_add_u32 s54, s94, 32768
    s_add_u32 m0, s44, 33792
    s_nop 0
    buffer_load_dwordx4 v24, s[20:23], s54 offen lds
    s_add_u32 s54, s94, 65536
    s_add_u32 m0, s44, 34816
    s_nop 0
    buffer_load_dwordx4 v24, s[20:23], s54 offen lds
    s_add_u32 s54, s94, 98304
    s_add_u32 m0, s44, 35840
    s_nop 0
    buffer_load_dwordx4 v24, s[20:23], s54 offen lds
    s_waitcnt vmcnt(30) lgkmcnt(0)
    s_barrier
    v_add_u32 v30, 81920, v27
    v_xor_b32 v31, 2048, v30
    ds_read_b64_tr_b16 v[144:145], v30 offset:0
    ds_read_b64_tr_b16 v[146:147], v30 offset:1024
    ds_read_b64_tr_b16 v[148:149], v30 offset:8192
    ds_read_b64_tr_b16 v[150:151], v30 offset:9216
    ds_read_b64_tr_b16 v[152:153], v31 offset:0
    ds_read_b64_tr_b16 v[154:155], v31 offset:1024
    ds_read_b64_tr_b16 v[156:157], v31 offset:8192
    ds_read_b64_tr_b16 v[158:159], v31 offset:9216
    s_add_u32 s54, s94, 524288
    s_add_u32 m0, s44, 49152
    s_nop 0
    buffer_load_dwordx4 v24, s[20:23], s54 offen lds
    s_add_u32 s54, s94, 557056
    s_add_u32 m0, s44, 50176
    s_nop 0
    buffer_load_dwordx4 v24, s[20:23], s54 offen lds
    s_add_u32 s54, s94, 589824
    s_add_u32 m0, s44, 51200
    s_nop 0
    buffer_load_dwordx4 v24, s[20:23], s54 offen lds
    s_add_u32 s54, s94, 622592
    s_add_u32 m0, s44, 52224
    s_nop 0
    buffer_load_dwordx4 v24, s[20:23], s54 offen lds
    s_waitcnt vmcnt(30) lgkmcnt(0)
    s_barrier
    v_add_u32 v30, 98304, v27
    v_xor_b32 v31, 2048, v30
    ds_read_b64_tr_b16 v[160:161], v30 offset:0
    ds_read_b64_tr_b16 v[162:163], v30 offset:1024
    ds_read_b64_tr_b16 v[164:165], v30 offset:8192
    ds_read_b64_tr_b16 v[166:167], v30 offset:9216
    ds_read_b64_tr_b16 v[168:169], v31 offset:0
    ds_read_b64_tr_b16 v[170:171], v31 offset:1024
    ds_read_b64_tr_b16 v[172:173], v31 offset:8192
    ds_read_b64_tr_b16 v[174:175], v31 offset:9216
    s_add_u32 s54, s94, 1048576
    s_add_u32 m0, s44, 65536
    s_nop 0
    buffer_load_dwordx4 v24, s[20:23], s54 offen lds
    s_add_u32 s54, s94, 1081344
    s_add_u32 m0, s44, 66560
    s_nop 0
    buffer_load_dwordx4 v24, s[20:23], s54 offen lds
    s_add_u32 s54, s94, 1114112
    s_add_u32 m0, s44, 67584
    s_nop 0
    buffer_load_dwordx4 v24, s[20:23], s54 offen lds
    s_add_u32 s54, s94, 1146880
    s_add_u32 m0, s44, 68608
    s_nop 0
    buffer_load_dwordx4 v24, s[20:23], s54 offen lds
    s_waitcnt vmcnt(30) lgkmcnt(0)
    s_barrier
    v_add_u32 v30, 114688, v27
    v_xor_b32 v31, 2048, v30
    ds_read_b64_tr_b16 v[176:177], v30 offset:0
    ds_read_b64_tr_b16 v[178:179], v30 offset:1024
    ds_read_b64_tr_b16 v[180:181], v30 offset:8192
    ds_read_b64_tr_b16 v[182:183], v30 offset:9216
    ds_read_b64_tr_b16 v[184:185], v31 offset:0
    ds_read_b64_tr_b16 v[186:187], v31 offset:1024
    ds_read_b64_tr_b16 v[188:189], v31 offset:8192
    ds_read_b64_tr_b16 v[190:191], v31 offset:9216
    s_add_u32 s54, s94, 1572864
    s_add_u32 m0, s44, 81920
    s_nop 0
    buffer_load_dwordx4 v24, s[20:23], s54 offen lds
    s_add_u32 s54, s94, 1605632
    s_add_u32 m0, s44, 82944
    s_nop 0
    buffer_load_dwordx4 v24, s[20:23], s54 offen lds
    s_add_u32 s54, s94, 1638400
    s_add_u32 m0, s44, 83968
    s_nop 0
    buffer_load_dwordx4 v24, s[20:23], s54 offen lds
    s_add_u32 s54, s94, 1671168
    s_add_u32 m0, s44, 84992
    s_nop 0
    buffer_load_dwordx4 v24, s[20:23], s54 offen lds
    s_waitcnt vmcnt(30) lgkmcnt(0)
    s_barrier
    v_add_u32 v30, 131072, v27
    v_xor_b32 v31, 2048, v30
    ds_read_b64_tr_b16 v[192:193], v30 offset:0
    ds_read_b64_tr_b16 v[194:195], v30 offset:1024
    ds_read_b64_tr_b16 v[196:197], v30 offset:8192
    ds_read_b64_tr_b16 v[198:199], v30 offset:9216
    ds_read_b64_tr_b16 v[200:201], v31 offset:0
    ds_read_b64_tr_b16 v[202:203], v31 offset:1024
    ds_read_b64_tr_b16 v[204:205], v31 offset:8192
    ds_read_b64_tr_b16 v[206:207], v31 offset:9216
    s_add_u32 s54, s43, 0
    s_add_u32 m0, s44, 98304
    s_nop 0
    buffer_load_dwordx4 v24, s[20:23], s54 offen lds
    s_add_u32 s54, s43, 32768
    s_add_u32 m0, s44, 99328
    s_nop 0
    buffer_load_dwordx4 v24, s[20:23], s54 offen lds
    s_add_u32 s54, s43, 65536
    s_add_u32 m0, s44, 100352
    s_nop 0
    buffer_load_dwordx4 v24, s[20:23], s54 offen lds
    s_add_u32 s54, s43, 98304
    s_add_u32 m0, s44, 101376
    s_nop 0
    buffer_load_dwordx4 v24, s[20:23], s54 offen lds
    s_waitcnt vmcnt(30) lgkmcnt(0)
    s_barrier
    v_add_u32 v30, 147456, v29
    v_xor_b32 v31, 8192, v30
    ds_read_b64_tr_b16 v[208:209], v30 offset:0
    ds_read_b64_tr_b16 v[210:211], v30 offset:512
    ds_read_b64_tr_b16 v[212:213], v30 offset:2048
    ds_read_b64_tr_b16 v[214:215], v30 offset:2560
    ds_read_b64_tr_b16 v[216:217], v31 offset:0
    ds_read_b64_tr_b16 v[218:219], v31 offset:512
    ds_read_b64_tr_b16 v[220:221], v31 offset:2048
    ds_read_b64_tr_b16 v[222:223], v31 offset:2560
    s_add_u32 s54, s41, 0
    s_add_u32 m0, s44, 114688
    s_nop 0
    buffer_load_dwordx4 v25, s[24:27], s54 offen lds
    s_add_u32 s54, s41, 5120
    s_add_u32 m0, s44, 115712
    s_nop 0
    buffer_load_dwordx4 v25, s[24:27], s54 offen lds
    s_add_u32 s54, s41, 10240
    s_add_u32 m0, s44, 116736
    s_nop 0
    buffer_load_dwordx4 v25, s[24:27], s54 offen lds
    s_add_u32 s54, s41, 15360
    s_add_u32 m0, s44, 117760
    s_nop 0
    buffer_load_dwordx4 v25, s[24:27], s54 offen lds
    s_waitcnt vmcnt(28) lgkmcnt(0)
    s_barrier
    v_add_u32 v30, 0, v29
    v_xor_b32 v31, 8192, v30
    ds_read_b64_tr_b16 v[224:225], v30 offset:0
    ds_read_b64_tr_b16 v[226:227], v30 offset:512
    ds_read_b64_tr_b16 v[228:229], v30 offset:2048
    ds_read_b64_tr_b16 v[230:231], v30 offset:2560
    ds_read_b64_tr_b16 v[232:233], v31 offset:0
    ds_read_b64_tr_b16 v[234:235], v31 offset:512
    ds_read_b64_tr_b16 v[236:237], v31 offset:2048
    ds_read_b64_tr_b16 v[238:239], v31 offset:2560
    s_add_u32 s54, s41, 81920
    s_add_u32 m0, s44, 131072
    s_nop 0
    buffer_load_dwordx4 v25, s[24:27], s54 offen lds
    s_add_u32 s54, s41, 87040
    s_add_u32 m0, s44, 132096
    s_nop 0
    buffer_load_dwordx4 v25, s[24:27], s54 offen lds
    s_add_u32 s54, s41, 92160
    s_add_u32 m0, s44, 133120
    s_nop 0
    buffer_load_dwordx4 v25, s[24:27], s54 offen lds
    s_add_u32 s54, s41, 97280
    s_add_u32 m0, s44, 134144
    s_nop 0
    buffer_load_dwordx4 v25, s[24:27], s54 offen lds
    s_waitcnt vmcnt(28) lgkmcnt(0)
    s_barrier
    v_add_u32 v30, 16384, v29
    v_xor_b32 v31, 8192, v30
    ds_read_b64_tr_b16 v[240:241], v30 offset:0
    ds_read_b64_tr_b16 v[242:243], v30 offset:512
    ds_read_b64_tr_b16 v[244:245], v30 offset:2048
    ds_read_b64_tr_b16 v[246:247], v30 offset:2560
    ds_read_b64_tr_b16 v[248:249], v31 offset:0
    ds_read_b64_tr_b16 v[250:251], v31 offset:512
    ds_read_b64_tr_b16 v[252:253], v31 offset:2048
    ds_read_b64_tr_b16 v[254:255], v31 offset:2560
    s_add_u32 s54, s42, 81920
    s_add_u32 m0, s44, 147456
    s_nop 0
    buffer_load_dwordx4 v26, s[24:27], s54 offen lds
    s_add_u32 s54, s42, 87040
    s_add_u32 m0, s44, 148480
    s_nop 0
    buffer_load_dwordx4 v26, s[24:27], s54 offen lds
    s_add_u32 s54, s42, 92160
    s_add_u32 m0, s44, 149504
    s_nop 0
    buffer_load_dwordx4 v26, s[24:27], s54 offen lds
    s_add_u32 s54, s42, 97280
    s_add_u32 m0, s44, 150528
    s_nop 0
    buffer_load_dwordx4 v26, s[24:27], s54 offen lds
    v_readfirstlane_b32 s57, v34
    v_readfirstlane_b32 s4, v35
    s_mov_b32 s54, 2359296
    buffer_load_dword v36, off, s[8:11], s54 sc1
    s_waitcnt vmcnt(29) lgkmcnt(0)
    s_barrier
    v_add_u32 v30, 32768, v27
    v_xor_b32 v31, 2048, v30
    ds_read_b64_tr_b16 v[44:45], v30 offset:0
    ds_read_b64_tr_b16 v[46:47], v30 offset:1024
    ds_read_b64_tr_b16 v[48:49], v30 offset:8192
    ds_read_b64_tr_b16 v[50:51], v30 offset:9216
    ds_read_b64_tr_b16 v[52:53], v31 offset:0
    ds_read_b64_tr_b16 v[54:55], v31 offset:1024
    ds_read_b64_tr_b16 v[56:57], v31 offset:8192
    ds_read_b64_tr_b16 v[58:59], v31 offset:9216
    s_waitcnt vmcnt(25) lgkmcnt(0)
    s_barrier
    ds_write_b128 v9, v[44:47] offset:32768
    ds_write_b128 v9, v[48:51] offset:33792
    ds_write_b128 v9, v[52:55] offset:40960
    ds_write_b128 v9, v[56:59] offset:41984
    v_add_u32 v30, 49152, v27
    v_xor_b32 v31, 2048, v30
    ds_read_b64_tr_b16 v[60:61], v30 offset:0
    ds_read_b64_tr_b16 v[62:63], v30 offset:1024
    ds_read_b64_tr_b16 v[64:65], v30 offset:8192
    ds_read_b64_tr_b16 v[66:67], v30 offset:9216
    ds_read_b64_tr_b16 v[68:69], v31 offset:0
    ds_read_b64_tr_b16 v[70:71], v31 offset:1024
    ds_read_b64_tr_b16 v[72:73], v31 offset:8192
    ds_read_b64_tr_b16 v[74:75], v31 offset:9216
    s_waitcnt vmcnt(21) lgkmcnt(0)
    s_barrier
    ds_write_b128 v9, v[60:63] offset:49152
    ds_write_b128 v9, v[64:67] offset:50176
    ds_write_b128 v9, v[68:71] offset:57344
    ds_write_b128 v9, v[72:75] offset:58368
    v_add_u32 v30, 65536, v27
    v_xor_b32 v31, 2048, v30
    ds_read_b64_tr_b16 v[44:45], v30 offset:0
    ds_read_b64_tr_b16 v[46:47], v30 offset:1024
    ds_read_b64_tr_b16 v[48:49], v30 offset:8192
    ds_read_b64_tr_b16 v[50:51], v30 offset:9216
    ds_read_b64_tr_b16 v[52:53], v31 offset:0
    ds_read_b64_tr_b16 v[54:55], v31 offset:1024
    ds_read_b64_tr_b16 v[56:57], v31 offset:8192
    ds_read_b64_tr_b16 v[58:59], v31 offset:9216
    s_waitcnt vmcnt(17) lgkmcnt(0)
    s_barrier
    ds_write_b128 v10, v[44:47] offset:0
    ds_write_b128 v10, v[48:51] offset:1024
    ds_write_b128 v10, v[52:55] offset:8192
    ds_write_b128 v10, v[56:59] offset:9216
    v_add_u32 v30, 81920, v27
    v_xor_b32 v31, 2048, v30
    ds_read_b64_tr_b16 v[60:61], v30 offset:0
    ds_read_b64_tr_b16 v[62:63], v30 offset:1024
    ds_read_b64_tr_b16 v[64:65], v30 offset:8192
    ds_read_b64_tr_b16 v[66:67], v30 offset:9216
    ds_read_b64_tr_b16 v[68:69], v31 offset:0
    ds_read_b64_tr_b16 v[70:71], v31 offset:1024
    ds_read_b64_tr_b16 v[72:73], v31 offset:8192
    ds_read_b64_tr_b16 v[74:75], v31 offset:9216
    s_waitcnt vmcnt(13) lgkmcnt(0)
    s_barrier
    ds_write_b128 v10, v[60:63] offset:16384
    ds_write_b128 v10, v[64:67] offset:17408
    ds_write_b128 v10, v[68:71] offset:24576
    ds_write_b128 v10, v[72:75] offset:25600
    v_add_u32 v30, 98304, v28
    v_xor_b32 v31, 8192, v30
    ds_read_b64_tr_b16 v[44:45], v30 offset:0
    ds_read_b64_tr_b16 v[46:47], v30 offset:2048
    ds_read_b64_tr_b16 v[48:49], v30 offset:256
    ds_read_b64_tr_b16 v[50:51], v30 offset:2304
    ds_read_b64_tr_b16 v[52:53], v31 offset:0
    ds_read_b64_tr_b16 v[54:55], v31 offset:2048
    ds_read_b64_tr_b16 v[56:57], v31 offset:256
    ds_read_b64_tr_b16 v[58:59], v31 offset:2304
    s_waitcnt vmcnt(9) lgkmcnt(0)
    s_barrier
    ds_write_b128 v10, v[44:47] offset:32768
    ds_write_b128 v10, v[48:51] offset:33792
    ds_write_b128 v10, v[52:55] offset:40960
    ds_write_b128 v10, v[56:59] offset:41984
    v_add_u32 v30, 114688, v29
    v_xor_b32 v31, 8192, v30
    ds_read_b64_tr_b16 v[60:61], v30 offset:0
    ds_read_b64_tr_b16 v[62:63], v30 offset:512
    ds_read_b64_tr_b16 v[64:65], v30 offset:2048
    ds_read_b64_tr_b16 v[66:67], v30 offset:2560
    ds_read_b64_tr_b16 v[68:69], v31 offset:0
    ds_read_b64_tr_b16 v[70:71], v31 offset:512
    ds_read_b64_tr_b16 v[72:73], v31 offset:2048
    ds_read_b64_tr_b16 v[74:75], v31 offset:2560
    s_waitcnt vmcnt(5) lgkmcnt(0)
    s_barrier
    ds_write_b128 v10, v[60:63] offset:49152
    ds_write_b128 v10, v[64:67] offset:50176
    ds_write_b128 v10, v[68:71] offset:57344
    ds_write_b128 v10, v[72:75] offset:58368
    v_add_u32 v30, 131072, v29
    v_xor_b32 v31, 8192, v30
    ds_read_b64_tr_b16 v[44:45], v30 offset:0
    ds_read_b64_tr_b16 v[46:47], v30 offset:512
    ds_read_b64_tr_b16 v[48:49], v30 offset:2048
    ds_read_b64_tr_b16 v[50:51], v30 offset:2560
    ds_read_b64_tr_b16 v[52:53], v31 offset:0
    ds_read_b64_tr_b16 v[54:55], v31 offset:512
    ds_read_b64_tr_b16 v[56:57], v31 offset:2048
    ds_read_b64_tr_b16 v[58:59], v31 offset:2560
    s_waitcnt vmcnt(1) lgkmcnt(0)
    s_barrier
    ds_write_b128 v11, v[44:47] offset:0
    ds_write_b128 v11, v[48:51] offset:1024
    ds_write_b128 v11, v[52:55] offset:8192
    ds_write_b128 v11, v[56:59] offset:9216
    v_add_u32 v30, 147456, v29
    v_xor_b32 v31, 8192, v30
    ds_read_b64_tr_b16 v[60:61], v30 offset:0
    ds_read_b64_tr_b16 v[62:63], v30 offset:512
    ds_read_b64_tr_b16 v[64:65], v30 offset:2048
    ds_read_b64_tr_b16 v[66:67], v30 offset:2560
    ds_read_b64_tr_b16 v[68:69], v31 offset:0
    ds_read_b64_tr_b16 v[70:71], v31 offset:512
    ds_read_b64_tr_b16 v[72:73], v31 offset:2048
    ds_read_b64_tr_b16 v[74:75], v31 offset:2560
    s_waitcnt vmcnt(0) lgkmcnt(0)
    s_barrier
    ds_write_b128 v11, v[60:63] offset:16384
    ds_write_b128 v11, v[64:67] offset:17408
    ds_write_b128 v11, v[68:71] offset:24576
    ds_write_b128 v11, v[72:75] offset:25600
    s_waitcnt lgkmcnt(0)
team_after_loader:
mode_13:
    s_and_b32 s55, s57, 0xff
    s_cmp_ge_u32 s55, 64
    s_cbranch_scc1 modeok_14
    buffer_load_dword v34, off, s[32:35], 0 offset:64 sc1
    s_waitcnt vmcnt(0)
    v_readfirstlane_b32 s57, v34
    s_sub_u32 s53, s53, 1
    s_cbranch_scc0 mode_13
    s_mov_b32 s53, 0
modeok_14:
    v_readfirstlane_b32 s5, v36
    s_cmp_eq_u32 s4, 1
    s_cselect_b32 s5, s5, 0
    s_cmp_eq_u32 s5, 64
    s_cbranch_scc1 fast_15
    s_mov_b32 s54, 96
    v_min_u32 v28, 0, v20
    v_mul_u32_u24 v28, 0, v28
wt_16:
    buffer_load_dword v29, v28, s[32:35], s54 offen sc1
    s_waitcnt vmcnt(0)
    v_cmp_gt_u32 vcc, 1, v29
    s_nop 0
    s_cbranch_vccz wd_17
    s_sleep 2
    s_sub_u32 s53, s53, 1
    s_cbranch_scc0 wt_16
    s_mov_b32 s53, 0
wd_17:
    s_mov_b32 s54, 2359296
    v_min_u32 v28, 0, v20
    v_mul_u32_u24 v28, 0, v28
wt_18:
    buffer_load_dword v29, v28, s[8:11], s54 offen sc1
    s_waitcnt vmcnt(0)
    v_cmp_gt_u32 vcc, 64, v29
    s_nop 0
    s_cbranch_vccz wd_19
    s_sleep 2
    s_sub_u32 s53, s53, 1
    s_cbranch_scc0 wt_18
    s_mov_b32 s53, 0
wd_19:
fast_15:
    s_barrier
    s_bfe_u32 s55, s57, 0x80008
    s_cmp_gt_u32 s55, 16
    s_cselect_b32 s55, 8192, 0
    s_add_u32 s97, s97, s55
    s_add_u32 s99, s99, s55
    s_mov_b32 s40, -1
    v_lshrrev_b32 v20, 4, v0
    v_bfe_u32 v23, v20, 0, 1
    v_lshlrev_b32 v21, 4, v23
    v_mov_b32 v22, 0x3f80
    v_lshlrev_b32 v21, v21, v22
    v_bfe_u32 v22, v20, 1, 3
    v_cmp_eq_u32 vcc, 0, v22
    s_nop 1
    v_cndmask_b32 v24, 0, v21, vcc
    v_cmp_eq_u32 vcc, 1, v22
    s_nop 1
    v_cndmask_b32 v25, 0, v21, vcc
    v_cmp_eq_u32 vcc, 2, v22
    s_nop 1
    v_cndmask_b32 v26, 0, v21, vcc
    v_cmp_eq_u32 vcc, 3, v22
    s_nop 1
    v_cndmask_b32 v27, 0, v21, vcc
    ds_write_b128 v0, v[24:27] offset:0
    v_mov_b32 v12, 0x3f803f80
    v_mov_b32 v13, 0x3f803f80
    v_mov_b32 v14, 0x3f803f80
    v_mov_b32 v15, 0x3f803f80
    s_mov_b32 s92, 1400897536
    s_mul_i32 s54, s38, 262144
    s_add_u32 s54, s54, 2490368
    s_lshl_b32 s55, s37, 7
    s_add_u32 s41, s54, s55
    s_mul_i32 s55, s68, 4608
    s_add_u32 s42, s54, s55
    s_and_b32 s4, s40, 1
    s_sub_u32 s5, 0, s4
    s_add_u32 s54, s40, 1
    s_and_b32 s54, s54, 3
    s_lshl_b32 s54, s54, 15
    s_add_u32 s43, s54, s96
    s_add_u32 s44, s54, s97
    s_add_u32 s45, s54, s98
    s_add_u32 s46, s54, s99
    s_xor_b32 s47, s45, 0x10000
    s_xor_b32 s48, s46, 0x10000
    s_mul_i32 s49, s37, 1064960
    s_lshl_b32 s54, s36, 11
    s_add_u32 s49, s49, s54
    s_add_u32 s49, s49, 50331648
    s_add_u32 s93, s54, 16384
    s_mul_i32 s54, s37, 266240
    s_add_u32 s54, s54, 88080384
    s_lshl_b32 s55, s36, 10
    s_add_u32 s54, s54, s55
    s_lshl_b32 s55, s38, 30
    s_or_b32 s51, s54, s55
    s_mov_b32 s101, 0
    s_lshl_b32 s54, s38, 10
    s_add_u32 s54, s54, 2627584
    s_lshl_b32 s55, s37, 2
    s_add_u32 s88, s54, s55
    s_and_b32 s55, s37, 3
    s_lshl_b32 s55, s55, 8
    s_add_u32 s89, s54, s55
    s_mov_b32 s88, 0
    s_mov_b32 s89, 0
    s_mov_b32 s59, 0x40000000
    s_mov_b32 s94, 0x00010001
    s_mov_b32 s95, 0x00010001
    v_lshl_or_b32 v26, v33, 16, v32
    s_lshl_b32 s3, s37, 7
    s_add_u32 s3, s3, 2363392
    v_lshrrev_b32 v28, 2, v0
    v_min_u32 v28, 64, v28
kvf_20:
    buffer_load_dword v29, v28, s[8:11], s3 offen sc1
    s_waitcnt vmcnt(0)
    v_cmp_gt_u32 vcc, 2, v29
    s_nop 0
    s_ff1_i32_b64 s7, vcc
    s_lshl_b32 s7, s7, 2
    s_cmp_eq_u32 s7, 64
    s_cselect_b32 s7, 128, s7
    s_add_u32 s54, s40, 2
    s_cmp_lt_u32 s54, s7
    s_cbranch_scc1 kvd_21
    s_sleep 2
    s_sub_u32 s53, s53, 1
    s_cbranch_scc0 kvf_20
    s_mov_b32 s53, 0
    s_mov_b32 s7, 128
kvd_21:
    v_bfe_u32 v23, v20, 0, 5
    v_lshlrev_b32 v28, 6, v23
    v_bfe_u32 v23, v20, 5, 1
    v_lshl_add_u32 v28, v23, 13, v28
    ds_write_b32 v0, v28 offset:1024
    s_add_u32 s100, s49, 16384
    s_mov_b32 m0, s93
    s_nop 0
    buffer_load_dwordx4 v0, s[8:11], s49 offen offset:0 sc1 lds
    buffer_load_dwordx4 v0, s[8:11], s49 offen offset:1024 sc1 lds
    s_add_u32 m0, s93, 8192
    s_add_u32 s55, s49, 8192
    buffer_load_dwordx4 v0, s[8:11], s55 offen offset:0 sc1 lds
    buffer_load_dwordx4 v0, s[8:11], s55 offen offset:1024 sc1 lds
    s_mov_b32 m0, 13312
    s_nop 0
    buffer_load_dword v28, s[8:11], s100 offen sc1 lds
    s_waitcnt lgkmcnt(0)
    s_lshr_b32 s57, s57, 16
    s_cmp_lg_u32 s57, 0
    s_cbranch_scc1 globmode_12
    s_cmp_eq_u32 s36, 0
    s_cbranch_scc1 rec_entry_El
    s_cmp_lg_u32 s68, -1
    s_cbranch_scc1 rec_entry_Sl
rec_entry_Pl:
.p2align 3
rec_top_Pl:
    s_add_u32 s40, s40, 1
    ds_read_b128 v[52:55], v9 offset:32768
    ds_read_b128 v[56:59], v9 offset:33792
    ds_read_b128 v[60:63], v9 offset:40960
    ds_read_b128 v[64:67], v9 offset:41984
    ds_read_b128 v[68:71], v9 offset:49152
    ds_read_b128 v[72:75], v9 offset:50176
    v_mov_b64 v[16:17], 0
    v_mov_b64 v[18:19], 0
    v_mov_b64 v[20:21], 0
    v_mov_b64 v[22:23], 0
    v_mov_b64 v[24:25], 0
    v_mov_b64 v[26:27], 0
    s_add_u32 s54, s40, 2
    s_cmp_ge_u32 s54, s7
    s_cbranch_scc1 kv_stub_22
kv_cont_23:
    s_barrier
    s_sleep 3
    buffer_load_dwordx4 v[44:47], v3, s[8:11], s43 offen offset:0 sc1
    buffer_load_dwordx4 v[48:51], v3, s[8:11], s43 offen offset:1024 sc1
    s_sleep 2
    buffer_load_dwordx4 v[44:47], v3, s[8:11], s43 offen offset:0 sc1
    buffer_load_dwordx4 v[48:51], v3, s[8:11], s43 offen offset:1024 sc1
pl_check_24:
    s_waitcnt vmcnt(2)
    v_max3_u32 v40, v44, v45, v46
    v_max3_u32 v40, v40, v47, v48
    v_max3_u32 v40, v40, v49, v50
    v_max_u32_e64 v40, v40, v51
    ds_write_b128 v9, v[44:47] offset:0
    ds_write_b128 v9, v[48:51] offset:1024
    v_cmp_eq_u32 vcc, -1, v40
    s_nop 0
    s_cbranch_vccnz pl_stub_25
pl_cont_26:
    s_waitcnt lgkmcnt(0)
    s_barrier
    ds_read_b128 v[28:31], v0 offset:2048
    ds_read_b128 v[32:35], v1 offset:2048
    ds_read_b128 v[36:39], v0 offset:3072
    ds_read_b128 v[40:43], v1 offset:3072
    s_add_u32 m0, s93, -8192
    s_nop 0
    buffer_load_dwordx4 v3, s[8:11], s44 offen sc1 lds
    s_waitcnt lgkmcnt(3)
    v_smfmac_f32_16x16x64_bf16 v[16:19], v[28:31], a[0:7], v2
    v_smfmac_f32_16x16x64_bf16 v[20:23], v[28:31], a[160:167], v2
    buffer_load_dwordx4 v[44:47], v0, s[8:11], s52 offen offset:0
    v_smfmac_f32_16x16x64_bf16 v[24:27], v[28:31], v[52:59], v2
    ds_read_b128 v[52:55], v9 offset:57344
    s_waitcnt lgkmcnt(3)
    v_smfmac_f32_16x16x64_bf16 v[16:19], v[32:35], a[8:15], v2
    ds_read_b128 v[56:59], v9 offset:58368
    v_smfmac_f32_16x16x64_bf16 v[20:23], v[32:35], a[168:175], v2
    ds_read_b128 v[28:31], v0 offset:4096
    buffer_load_dwordx4 v[48:51], v0, s[8:11], s52 offen offset:1024
    v_smfmac_f32_16x16x64_bf16 v[24:27], v[32:35], v[60:67], v2
    ds_read_b128 v[60:63], v10 offset:0
    s_waitcnt lgkmcnt(5)
    v_smfmac_f32_16x16x64_bf16 v[16:19], v[36:39], a[16:23], v2
    ds_read_b128 v[64:67], v10 offset:1024
    v_smfmac_f32_16x16x64_bf16 v[20:23], v[36:39], a[176:183], v2
    ds_read_b128 v[32:35], v1 offset:4096
    v_smfmac_f32_16x16x64_bf16 v[24:27], v[36:39], v[68:75], v2
    ds_read_b128 v[68:71], v10 offset:8192
    s_waitcnt lgkmcnt(7)
    v_smfmac_f32_16x16x64_bf16 v[16:19], v[40:43], a[24:31], v2
    ds_read_b128 v[72:75], v10 offset:9216
    v_smfmac_f32_16x16x64_bf16 v[20:23], v[40:43], a[184:191], v2
    ds_read_b128 v[36:39], v0 offset:5120
    s_waitcnt lgkmcnt(7)
    v_smfmac_f32_16x16x64_bf16 v[24:27], v[40:43], v[52:59], v2
    ds_read_b128 v[52:55], v10 offset:16384
    s_waitcnt lgkmcnt(7)
    v_smfmac_f32_16x16x64_bf16 v[16:19], v[28:31], a[32:39], v2
    ds_read_b128 v[56:59], v10 offset:17408
    v_smfmac_f32_16x16x64_bf16 v[20:23], v[28:31], a[192:199], v2
    ds_read_b128 v[40:43], v1 offset:5120
    s_waitcnt lgkmcnt(7)
    v_smfmac_f32_16x16x64_bf16 v[24:27], v[28:31], v[60:67], v2
    ds_read_b128 v[60:63], v10 offset:24576
    s_waitcnt lgkmcnt(7)
    v_smfmac_f32_16x16x64_bf16 v[16:19], v[32:35], a[40:47], v2
    ds_read_b128 v[64:67], v10 offset:25600
    v_smfmac_f32_16x16x64_bf16 v[20:23], v[32:35], a[200:207], v2
    ds_read_b128 v[28:31], v0 offset:6144
    s_waitcnt lgkmcnt(7)
    v_smfmac_f32_16x16x64_bf16 v[24:27], v[32:35], v[68:75], v2
    ds_read_b128 v[68:71], v10 offset:32768
    s_waitcnt lgkmcnt(7)
    v_smfmac_f32_16x16x64_bf16 v[16:19], v[36:39], a[48:55], v2
    ds_read_b128 v[72:75], v10 offset:33792
    v_smfmac_f32_16x16x64_bf16 v[20:23], v[36:39], a[208:215], v2
    ds_read_b128 v[32:35], v1 offset:6144
    s_waitcnt lgkmcnt(7)
    v_smfmac_f32_16x16x64_bf16 v[24:27], v[36:39], v[52:59], v2
    s_waitcnt vmcnt(2)
    ds_read_b128 v[52:55], v9 offset:8192
    s_waitcnt lgkmcnt(7)
    v_smfmac_f32_16x16x64_bf16 v[16:19], v[40:43], a[56:63], v2
    buffer_load_dwordx4 v[56:59], v0, s[8:11], s52 offen offset:3072
    v_smfmac_f32_16x16x64_bf16 v[20:23], v[40:43], a[216:223], v2
    ds_read_b128 v[36:39], v0 offset:7168
    s_waitcnt lgkmcnt(6)
    v_smfmac_f32_16x16x64_bf16 v[24:27], v[40:43], v[60:67], v2
    ds_read_b128 v[60:63], v10 offset:40960
    s_waitcnt lgkmcnt(6)
    v_smfmac_f32_16x16x64_bf16 v[16:19], v[28:31], a[64:71], v2
    ds_read_b128 v[64:67], v10 offset:41984
    s_waitcnt lgkmcnt(3)
    v_max3_u32 v52, v52, v53, v54
    v_smfmac_f32_16x16x64_bf16 v[20:23], v[28:31], a[224:231], v2
    ds_read_b128 v[40:43], v1 offset:7168
    v_max_u32_e64 v52, v52, v55
    v_smfmac_f32_16x16x64_bf16 v[24:27], v[28:31], v[68:75], v2
    v_cmp_eq_u32_e64 vcc, -1, v52
    v_smfmac_f32_16x16x64_bf16 v[16:19], v[32:35], a[72:79], v2
    s_cbranch_vccnz rem_stub_27
rem_cont_28:
    v_smfmac_f32_16x16x64_bf16 v[20:23], v[32:35], a[232:239], v2
    buffer_load_dwordx4 v[52:55], v0, s[8:11], s52 offen offset:2048
    s_waitcnt lgkmcnt(1)
    v_smfmac_f32_16x16x64_bf16 v[24:27], v[32:35], v[60:67], v2
    s_barrier
    ds_read_b128 v[60:63], v0 offset:8192
    v_smfmac_f32_16x16x64_bf16 v[16:19], v[36:39], a[80:87], v2
    buffer_store_dwordx4 v[76:79], v0, s[8:11], s59 offen sc1
    s_mov_b32 s59, s51
    ds_read_b128 v[64:67], v1 offset:8192
    v_smfmac_f32_16x16x64_bf16 v[20:23], v[36:39], a[240:247], v2
    s_add_u32 s100, s49, s93
    s_add_u32 s100, s100, 16384
    ds_read_b128 v[68:71], v0 offset:10240
    v_smfmac_f32_16x16x64_bf16 v[24:27], v[36:39], v[128:135], v2
    v_lshlrev_b32 v76, 3, v0
    s_mov_b32 m0, 13312
    ds_read_b128 v[72:75], v1 offset:10240
    s_waitcnt lgkmcnt(4)
    v_smfmac_f32_16x16x64_bf16 v[16:19], v[40:43], a[88:95], v2
    s_mov_b64 exec, s[64:65]
    buffer_load_dword v76, s[8:11], s100 offen sc1 lds
    s_mov_b64 exec, -1
    ds_read_b128 v[28:31], v0 offset:12288
    v_smfmac_f32_16x16x64_bf16 v[20:23], v[40:43], a[248:255], v2
    ds_read_b128 v[32:35], v1 offset:12288
    v_smfmac_f32_16x16x64_bf16 v[24:27], v[40:43], v[136:143], v2
    ds_read_b128 v[36:39], v0 offset:14336
    s_waitcnt lgkmcnt(6)
    v_smfmac_f32_16x16x64_bf16 v[16:19], v[60:63], a[96:103], v2
    s_add_u32 s100, s49, 32768
    ds_read_b128 v[40:43], v1 offset:14336
    s_waitcnt lgkmcnt(6)
    v_smfmac_f32_16x16x64_bf16 v[16:19], v[64:67], a[104:111], v2
    s_mov_b32 m0, 13312
    s_waitcnt lgkmcnt(5)
    v_smfmac_f32_16x16x64_bf16 v[16:19], v[68:71], a[112:119], v2
    s_and_b32 s4, s40, 1
    s_waitcnt lgkmcnt(4)
    v_smfmac_f32_16x16x64_bf16 v[16:19], v[72:75], a[120:127], v2
    s_sub_u32 s5, 0, s4
    s_waitcnt lgkmcnt(3)
    v_smfmac_f32_16x16x64_bf16 v[16:19], v[28:31], a[128:135], v2
    s_add_u32 s54, s40, 1
    s_waitcnt lgkmcnt(2)
    v_smfmac_f32_16x16x64_bf16 v[16:19], v[32:35], a[136:143], v2
    s_and_b32 s54, s54, 3
    s_waitcnt lgkmcnt(1)
    v_smfmac_f32_16x16x64_bf16 v[16:19], v[36:39], a[144:151], v2
    s_lshl_b32 s54, s54, 15
    s_waitcnt lgkmcnt(0)
    v_smfmac_f32_16x16x64_bf16 v[16:19], v[40:43], a[152:159], v2
    s_add_u32 s43, s54, s96
    v_smfmac_f32_16x16x64_bf16 v[20:23], v[60:63], v[80:87], v2
    s_add_u32 s44, s54, s97
    v_smfmac_f32_16x16x64_bf16 v[20:23], v[64:67], v[88:95], v2
    s_add_u32 s45, s54, s98
    v_mul_f32 v16, s58, v16
    v_smfmac_f32_16x16x64_bf16 v[20:23], v[68:71], v[96:103], v2
    s_add_u32 s46, s54, s99
    v_mul_f32 v17, s58, v17
    v_smfmac_f32_16x16x64_bf16 v[20:23], v[72:75], v[104:111], v2
    s_xor_b32 s47, s45, 0x10000
    v_mul_f32_e64 v18, s58, v18
    v_smfmac_f32_16x16x64_bf16 v[20:23], v[28:31], v[112:119], v2
    s_xor_b32 s48, s46, 0x10000
    v_mul_f32_e64 v19, s58, v19
    v_smfmac_f32_16x16x64_bf16 v[20:23], v[32:35], v[120:127], v2
    s_add_u32 s49, s49, 16384
    v_cvt_pk_bf16_f32 v76, v16, v17
    s_waitcnt vmcnt(2)
    v_smfmac_f32_16x16x64_bf16 v[20:23], v[36:39], v[44:51], v2
    v_cvt_pk_bf16_f32 v77, v18, v19
    v_smfmac_f32_16x16x64_bf16 v[20:23], v[40:43], v[52:59], v2
    ds_write_b64 v6, v[76:77] offset:2048
    v_smfmac_f32_16x16x64_bf16 v[24:27], v[60:63], v[144:151], v2
    v_smfmac_f32_16x16x64_bf16 v[24:27], v[64:67], v[152:159], v2
    v_cvt_pk_bf16_f32 v78, v20, v21
    v_cvt_pk_bf16_f32 v79, v22, v23
    ds_write_b64 v6, v[78:79] offset:4096
    v_smfmac_f32_16x16x64_bf16 v[24:27], v[68:71], v[160:167], v2
    ds_read_b128 v[60:63], v0 offset:16384
    v_smfmac_f32_16x16x64_bf16 v[24:27], v[72:75], v[168:175], v2
    ds_read_b128 v[64:67], v0 offset:17408
    v_smfmac_f32_16x16x64_bf16 v[24:27], v[28:31], v[176:183], v2
    ds_read_b128 v[68:71], v0 offset:18432
    v_smfmac_f32_16x16x64_bf16 v[24:27], v[32:35], v[184:191], v2
    ds_read_b128 v[72:75], v0 offset:19456
    s_waitcnt lgkmcnt(4)
    s_barrier
    ds_read_b64_tr_b16 v[44:45], v7 offset:2048
    ds_read_b64_tr_b16 v[46:47], v7 offset:2304
    ds_read_b64_tr_b16 v[48:49], v7 offset:2560
    ds_read_b64_tr_b16 v[50:51], v7 offset:2816
    ds_read_b64_tr_b16 v[52:53], v7 offset:3072
    ds_read_b64_tr_b16 v[54:55], v7 offset:3328
    v_smfmac_f32_16x16x64_bf16 v[24:27], v[36:39], v[192:199], v2
    ds_read_b64_tr_b16 v[56:57], v7 offset:3584
    ds_read_b64_tr_b16 v[58:59], v7 offset:3840
    v_smfmac_f32_16x16x64_bf16 v[24:27], v[40:43], v[200:207], v2
    s_waitcnt lgkmcnt(4)
    v_mfma_f32_16x16x32_bf16 v[16:19], v[60:63], v[44:47], 0
    ds_read_b128 v[28:31], v0 offset:20480
    ds_read_b128 v[32:35], v0 offset:21504
    v_mfma_f32_16x16x32_bf16 v[16:19], v[64:67], v[48:51], v[16:19]
    ds_read_b128 v[36:39], v0 offset:22528
    ds_read_b128 v[40:43], v0 offset:23552
    s_waitcnt lgkmcnt(4)
    v_mfma_f32_16x16x32_bf16 v[16:19], v[68:71], v[52:55], v[16:19]
    ds_read_b64_tr_b16 v[60:61], v7 offset:4096
    ds_read_b64_tr_b16 v[62:63], v7 offset:4352
    v_mfma_f32_16x16x32_bf16 v[16:19], v[72:75], v[56:59], v[16:19]
    ds_read_b64_tr_b16 v[64:65], v7 offset:4608
    ds_read_b64_tr_b16 v[66:67], v7 offset:4864
    s_waitcnt lgkmcnt(6)
    v_mfma_f32_16x16x32_bf16 v[20:23], v[28:31], v[44:47], 0
    ds_read_b64_tr_b16 v[68:69], v7 offset:5120
    ds_read_b64_tr_b16 v[70:71], v7 offset:5376
    v_mfma_f32_16x16x32_bf16 v[20:23], v[32:35], v[48:51], v[20:23]
    ds_read_b64_tr_b16 v[72:73], v7 offset:5632
    ds_read_b64_tr_b16 v[74:75], v7 offset:5888
    s_waitcnt lgkmcnt(8)
    v_mfma_f32_16x16x32_bf16 v[20:23], v[36:39], v[52:55], v[20:23]
    v_cvt_pk_bf16_f32 v76, v24, v25
    v_cvt_pk_bf16_f32 v77, v26, v27
    v_mfma_f32_16x16x32_bf16 v[20:23], v[40:43], v[56:59], v[20:23]
    ds_read_b128 v[28:31], v9 offset:24576
    ds_read_b128 v[32:35], v9 offset:25600
    s_waitcnt lgkmcnt(6)
    v_mfma_f32_16x16x32_bf16 v[40:43], v[60:63], v[44:47], 0
    v_exp_f32_e64 v16, v16
    v_mfma_f32_16x16x32_bf16 v[40:43], v[64:67], v[48:51], v[40:43]
    v_exp_f32 v17, v17
    s_waitcnt lgkmcnt(2)
    v_mfma_f32_16x16x32_bf16 v[40:43], v[68:71], v[52:55], v[40:43]
    v_exp_f32_e64 v18, v18
    v_mfma_f32_16x16x32_bf16 v[40:43], v[72:75], v[56:59], v[40:43]
    v_exp_f32 v19, v19
    v_exp_f32 v20, v20
    v_exp_f32 v21, v21
    v_exp_f32 v22, v22
    v_exp_f32_e64 v23, v23
    v_cvt_pk_bf16_f32 v16, v16, v17
    v_cvt_pk_bf16_f32 v17, v18, v19
    v_cvt_pk_bf16_f32 v18, v20, v21
    v_cvt_pk_bf16_f32 v19, v22, v23
    v_exp_f32 v40, v40
    s_waitcnt lgkmcnt(0)
    v_mfma_f32_16x16x32_bf16 v[60:63], v[28:31], v[16:19], 0
    v_exp_f32_e64 v41, v41
    v_mfma_f32_16x16x32_bf16 v[64:67], v[32:35], v[16:19], 0
    v_exp_f32_e64 v42, v42
    v_mfma_f32_16x16x32_bf16 v[68:71], v[12:15], v[16:19], 0
    v_exp_f32_e64 v43, v43
    v_cndmask_b32 v24, 0, v76, s[64:65]
    v_cvt_pk_bf16_f32 v40, v40, v41
    v_cvt_pk_bf16_f32 v41, v42, v43
sm_back_30:
    v_cndmask_b32 v42, 0, v40, s[64:65]
    v_cndmask_b32 v43, 0, v41, s[64:65]
    v_cndmask_b32 v25, 0, v77, s[64:65]
    v_cndmask_b32 v26, 0, v76, s[66:67]
    v_mfma_f32_16x16x16_bf16 v[68:71], v[12:13], v[42:43], v[68:71]
    v_cndmask_b32 v27, 0, v77, s[66:67]
    v_mfma_f32_16x16x16_bf16 v[60:63], v[24:25], v[40:41], v[60:63]
    v_add_u32_e64 v20, s50, v0
    v_mfma_f32_16x16x16_bf16 v[64:67], v[26:27], v[40:41], v[64:67]
    v_mov_b64 v[16:17], 0
    v_mov_b64 v[18:19], 0
    v_mov_b64 v[22:23], 0
    s_nop 0
    v_rcp_f32 v70, v68
    s_nop 0
    v_max_f32_e64 v69, v68, v70
    v_pk_mul_f32 v[60:61], v[60:61], v[70:71] op_sel_hi:[1,0]
    v_pk_mul_f32 v[62:63], v[62:63], v[70:71] op_sel_hi:[1,0]
    v_pk_mul_f32 v[64:65], v[64:65], v[70:71] op_sel_hi:[1,0]
    v_pk_mul_f32 v[66:67], v[66:67], v[70:71] op_sel_hi:[1,0]
    v_cvt_pk_bf16_f32 v36, v60, v61
    v_cvt_pk_bf16_f32 v37, v62, v63
    v_cvt_pk_bf16_f32 v38, v64, v65
    v_cvt_pk_bf16_f32 v39, v66, v67
    v_cmp_nge_f32 vcc, s92, v69
    s_mov_b64 exec, s[62:63]
    ds_write_b128 v20, v[36:39] offset:9216
    s_mov_b64 exec, -1
    s_cbranch_vccnz sm_slow_29
sm_ok_31:
    s_cmp_eq_u32 s40, 63
    s_cbranch_scc1 fin_32
    s_add_u32 m0, s93, 8192
    s_add_u32 s55, s49, 8192
    buffer_load_dwordx4 v0, s[8:11], s55 offen offset:0 sc1 lds
    buffer_load_dwordx4 v0, s[8:11], s55 offen offset:1024 sc1 lds
    ds_read_b128 v[44:47], v10 offset:49152
    ds_read_b128 v[48:51], v10 offset:50176
    s_waitcnt lgkmcnt(2)
    s_barrier
    ds_read_b128 v[28:31], v0 offset:9216
    ds_read_b128 v[32:35], v1 offset:9216
    ds_read_b128 v[36:39], v0 offset:11264
    ds_read_b128 v[40:43], v1 offset:11264
    ds_read_b128 v[52:55], v10 offset:57344
    ds_read_b128 v[56:59], v10 offset:58368
    v_mov_b64 v[20:21], 0
    s_mov_b32 m0, s93
    s_nop 0
    buffer_load_dwordx4 v0, s[8:11], s49 offen offset:0 sc1 lds
    buffer_load_dwordx4 v0, s[8:11], s49 offen offset:1024 sc1 lds
    s_add_u32 s51, s51, 4096
    s_xor_b32 s51, s51, 0x40000000
    s_mov_b32 s101, 0
    s_waitcnt lgkmcnt(5)
    v_smfmac_f32_16x16x64_bf16 v[16:19], v[28:31], v[44:51], v2
    ds_read_b128 v[60:63], v11 offset:0
    v_smfmac_f32_16x16x64_bf16 v[20:23], v[28:31], v[208:215], v2
    ds_read_b128 v[64:67], v11 offset:1024
    s_waitcnt lgkmcnt(6)
    v_smfmac_f32_16x16x64_bf16 v[20:23], v[32:35], v[216:223], v2
    ds_read_b128 v[68:71], v11 offset:8192
    s_waitcnt lgkmcnt(3)
    v_smfmac_f32_16x16x64_bf16 v[16:19], v[32:35], v[52:59], v2
    ds_read_b128 v[72:75], v11 offset:9216
    v_smfmac_f32_16x16x64_bf16 v[20:23], v[36:39], v[240:247], v2
    ds_read_b128 v[44:47], v11 offset:16384
    v_mov_b64 v[24:25], 0
    v_smfmac_f32_16x16x64_bf16 v[20:23], v[40:43], v[248:255], v2
    ds_read_b128 v[48:51], v11 offset:17408
    v_mov_b64 v[26:27], 0
    s_waitcnt lgkmcnt(4)
    v_smfmac_f32_16x16x64_bf16 v[16:19], v[36:39], v[60:67], v2
    ds_read_b128 v[52:55], v11 offset:24576
    s_waitcnt lgkmcnt(3)
    v_smfmac_f32_16x16x64_bf16 v[16:19], v[40:43], v[68:75], v2
    ds_read_b128 v[56:59], v11 offset:25600
    v_smfmac_f32_16x16x64_bf16 v[24:27], v[28:31], v[224:231], v2
    v_cvt_pk_bf16_f32 v20, v20, v21
    v_smfmac_f32_16x16x64_bf16 v[24:27], v[32:35], v[232:239], v2
    v_cvt_pk_bf16_f32 v21, v22, v23
    s_waitcnt lgkmcnt(2)
    v_smfmac_f32_16x16x64_bf16 v[24:27], v[36:39], v[44:51], v2
    v_cvt_pk_bf16_f32 v19, v18, v19
    s_waitcnt lgkmcnt(0)
    v_smfmac_f32_16x16x64_bf16 v[24:27], v[40:43], v[52:59], v2
    v_cvt_pk_bf16_f32 v18, v16, v17
    v_and_or_b32 v20, v20, -2, s4
    v_and_or_b32 v18, v18, -2, s4
    buffer_store_dwordx4 v[18:21], v4, s[8:11], s41 offen
    s_nop 1
    v_cvt_pk_bf16_f32 v24, v24, v25
    v_cvt_pk_bf16_f32 v25, v26, v27
    v_and_or_b32 v24, v24, -2, s4
    buffer_store_dwordx2 v[24:25], v5, s[8:11], s41 offen
    s_branch rec_top_Pl
kv_stub_22:
    v_lshrrev_b32 v46, 2, v0
    v_min_u32 v46, 64, v46
kvf_33:
    buffer_load_dword v47, v46, s[8:11], s3 offen sc1
    s_waitcnt vmcnt(0)
    v_cmp_gt_u32 vcc, 2, v47
    s_nop 0
    s_ff1_i32_b64 s7, vcc
    s_lshl_b32 s7, s7, 2
    s_cmp_eq_u32 s7, 64
    s_cselect_b32 s7, 128, s7
    s_add_u32 s54, s40, 2
    s_cmp_lt_u32 s54, s7
    s_cbranch_scc1 kvd_34
    s_sleep 2
    s_sub_u32 s53, s53, 1
    s_cbranch_scc0 kvf_33
    s_mov_b32 s53, 0
    s_mov_b32 s7, 128
kvd_34:
    s_branch kv_cont_23
pl_stub_25:
    s_mov_b32 s89, 1
    s_sub_u32 s53, s53, 1
    s_cbranch_scc1 giveup_35
    s_mov_b64 exec, vcc
    buffer_load_dwordx4 v[44:47], v3, s[8:11], s43 offen offset:0 sc1
    buffer_load_dwordx4 v[48:51], v3, s[8:11], s43 offen offset:1024 sc1
    s_mov_b64 exec, -1
    s_branch pl_check_24
giveup_35:
    s_mov_b32 s53, 0
    s_branch pl_cont_26
rem_stub_27:
    s_sub_u32 s53, s53, 1
    s_cbranch_scc1 rem_give_37
    s_sleep 3
    buffer_load_dwordx4 v[52:55], v3, s[8:11], s44 offen sc1
    s_waitcnt vmcnt(0)
    ds_write_b128 v9, v[52:55] offset:8192
    s_waitcnt lgkmcnt(0)
    v_max3_u32 v52, v52, v53, v54
    v_max_u32 v52, v52, v55
    v_cmp_eq_u32 vcc, -1, v52
    s_nop 0
    s_cbranch_vccnz rem_stub_27
    s_branch rem_cont_28
rem_give_37:
    s_mov_b32 s53, 0
    s_branch rem_cont_28
sm_slow_29:
    s_cmp_lg_u32 s101, 0
    s_cbranch_scc1 sm_ok_31
    s_mov_b32 s101, 1
    s_waitcnt lgkmcnt(0)
    ds_read_b128 v[68:71], v0 offset:16384
    s_waitcnt lgkmcnt(0)
    v_mfma_f32_16x16x32_bf16 v[16:19], v[68:71], v[44:47], 0
    s_nop 3
    ds_read_b128 v[68:71], v0 offset:17408
    s_waitcnt lgkmcnt(0)
    v_mfma_f32_16x16x32_bf16 v[16:19], v[68:71], v[48:51], v[16:19]
    s_nop 3
    ds_read_b128 v[68:71], v0 offset:18432
    s_waitcnt lgkmcnt(0)
    v_mfma_f32_16x16x32_bf16 v[16:19], v[68:71], v[52:55], v[16:19]
    s_nop 3
    ds_read_b128 v[68:71], v0 offset:19456
    s_waitcnt lgkmcnt(0)
    v_mfma_f32_16x16x32_bf16 v[16:19], v[68:71], v[56:59], v[16:19]
    s_nop 3
    ds_read_b128 v[68:71], v0 offset:20480
    s_waitcnt lgkmcnt(0)
    v_mfma_f32_16x16x32_bf16 v[20:23], v[68:71], v[44:47], 0
    s_nop 3
    ds_read_b128 v[68:71], v0 offset:21504
    s_waitcnt lgkmcnt(0)
    v_mfma_f32_16x16x32_bf16 v[20:23], v[68:71], v[48:51], v[20:23]
    s_nop 3
    ds_read_b128 v[68:71], v0 offset:22528
    s_waitcnt lgkmcnt(0)
    v_mfma_f32_16x16x32_bf16 v[20:23], v[68:71], v[52:55], v[20:23]
    s_nop 3
    ds_read_b128 v[68:71], v0 offset:23552
    s_waitcnt lgkmcnt(0)
    v_mfma_f32_16x16x32_bf16 v[20:23], v[68:71], v[56:59], v[20:23]
    s_nop 3
    ds_read_b64_tr_b16 v[68:69], v7 offset:4096
    ds_read_b64_tr_b16 v[70:71], v7 offset:4352
    s_waitcnt lgkmcnt(0)
    v_mfma_f32_16x16x32_bf16 v[40:43], v[68:71], v[44:47], 0
    s_nop 3
    ds_read_b64_tr_b16 v[68:69], v7 offset:4608
    ds_read_b64_tr_b16 v[70:71], v7 offset:4864
    s_waitcnt lgkmcnt(0)
    v_mfma_f32_16x16x32_bf16 v[40:43], v[68:71], v[48:51], v[40:43]
    s_nop 3
    ds_read_b64_tr_b16 v[68:69], v7 offset:5120
    ds_read_b64_tr_b16 v[70:71], v7 offset:5376
    s_waitcnt lgkmcnt(0)
    v_mfma_f32_16x16x32_bf16 v[40:43], v[68:71], v[52:55], v[40:43]
    s_nop 3
    ds_read_b64_tr_b16 v[68:69], v7 offset:5632
    ds_read_b64_tr_b16 v[70:71], v7 offset:5888
    s_waitcnt lgkmcnt(0)
    v_mfma_f32_16x16x32_bf16 v[40:43], v[68:71], v[56:59], v[40:43]
    s_nop 3
    v_max3_f32 v68, v16, v17, v18
    v_max3_f32 v68, v68, v19, v20
    v_max3_f32 v68, v68, v21, v22
    s_nop 0
    v_max3_f32 v68, v68, v23, v40
    v_max3_f32 v68, v68, v41, v42
    v_max_f32 v68, v68, v43
    v_mov_b32 v69, v68
    s_nop 1
    v_permlane16_swap_b32 v68, v69
    v_max_f32 v68, v68, v69
    v_mov_b32 v69, v68
    s_nop 1
    v_permlane32_swap_b32 v68, v69
    v_max_f32 v68, v68, v69
    v_sub_f32 v16, v16, v68
    v_sub_f32 v17, v17, v68
    v_sub_f32 v18, v18, v68
    v_sub_f32 v19, v19, v68
    v_sub_f32 v20, v20, v68
    v_sub_f32 v21, v21, v68
    v_sub_f32 v22, v22, v68
    v_sub_f32 v23, v23, v68
    v_sub_f32 v40, v40, v68
    v_sub_f32 v41, v41, v68
    v_sub_f32 v42, v42, v68
    v_sub_f32 v43, v43, v68
    v_exp_f32 v16, v16
    v_exp_f32 v17, v17
    v_exp_f32 v18, v18
    v_exp_f32 v19, v19
    v_exp_f32 v20, v20
    v_exp_f32 v21, v21
    v_exp_f32 v22, v22
    v_exp_f32 v23, v23
    v_exp_f32 v40, v40
    v_exp_f32 v41, v41
    v_exp_f32 v42, v42
    v_exp_f32 v43, v43
    v_cvt_pk_bf16_f32 v16, v16, v17
    v_cvt_pk_bf16_f32 v17, v18, v19
    v_cvt_pk_bf16_f32 v18, v20, v21
    v_cvt_pk_bf16_f32 v19, v22, v23
    v_cvt_pk_bf16_f32 v40, v40, v41
    v_cvt_pk_bf16_f32 v41, v42, v43
    v_mfma_f32_16x16x32_bf16 v[60:63], v[28:31], v[16:19], 0
    v_mfma_f32_16x16x32_bf16 v[64:67], v[32:35], v[16:19], 0
    v_mfma_f32_16x16x32_bf16 v[68:71], v[12:15], v[16:19], 0
    s_nop 7
    s_branch sm_back_30
fin_32:
    buffer_store_dwordx4 v[76:79], v0, s[8:11], s51 offen sc1
    s_branch main_end0
rec_entry_El:
    v_mov_b32 v20, v26
    s_mov_b64 exec, s[60:61]
    buffer_store_dword v20, v8, s[8:11], s45 offen
    buffer_store_dword v20, v8, s[8:11], s46 offen sc1
    s_mov_b64 exec, -1
.p2align 3
rec_top_El:
    s_add_u32 s40, s40, 1
    s_barrier
    ds_read_b128 v[52:55], v9 offset:32768
    ds_read_b128 v[56:59], v9 offset:33792
    ds_read_b128 v[60:63], v9 offset:40960
    ds_read_b128 v[64:67], v9 offset:41984
    ds_read_b128 v[68:71], v9 offset:49152
    ds_read_b128 v[72:75], v9 offset:50176
    v_mov_b64 v[24:25], -1
    v_mov_b64 v[26:27], -1
    s_mov_b64 exec, 0xff
    buffer_store_dwordx4 v[24:27], v0, s[8:11], s47 offen
    s_mov_b64 exec, -1
    s_nop 0
    v_mov_b64 v[24:25], 0
    v_mov_b64 v[26:27], 0
    s_waitcnt vmcnt(3)
    v_mov_b32 v44, -1
    v_mov_b64 v[16:17], 0
    v_mov_b64 v[18:19], 0
    v_mov_b64 v[20:21], 0
    v_mov_b64 v[22:23], 0
    s_add_u32 s54, s40, 2
    s_cmp_ge_u32 s54, s7
    s_cbranch_scc1 kv_stub_38
kv_cont_39:
    s_waitcnt lgkmcnt(0)
    s_barrier
    ds_read_b128 v[28:31], v0 offset:2048
    ds_read_b128 v[32:35], v1 offset:2048
    ds_read_b128 v[36:39], v0 offset:3072
    ds_read_b128 v[40:43], v1 offset:3072
    s_add_u32 m0, s93, -8192
    s_nop 0
    buffer_load_dwordx4 v3, s[8:11], s44 offen sc1 lds
    s_waitcnt lgkmcnt(3)
    v_smfmac_f32_16x16x64_bf16 v[16:19], v[28:31], a[0:7], v2
    s_mov_b64 exec, s[60:61]
    buffer_store_dword v44, v8, s[8:11], s48 offen sc1
    s_mov_b64 exec, -1
    v_smfmac_f32_16x16x64_bf16 v[20:23], v[28:31], a[160:167], v2
    buffer_load_dwordx4 v[44:47], v0, s[8:11], s52 offen offset:0
    v_smfmac_f32_16x16x64_bf16 v[24:27], v[28:31], v[52:59], v2
    ds_read_b128 v[52:55], v9 offset:57344
    s_waitcnt lgkmcnt(3)
    v_smfmac_f32_16x16x64_bf16 v[16:19], v[32:35], a[8:15], v2
    ds_read_b128 v[56:59], v9 offset:58368
    v_smfmac_f32_16x16x64_bf16 v[20:23], v[32:35], a[168:175], v2
    ds_read_b128 v[28:31], v0 offset:4096
    buffer_load_dwordx4 v[48:51], v0, s[8:11], s52 offen offset:1024
    v_smfmac_f32_16x16x64_bf16 v[24:27], v[32:35], v[60:67], v2
    ds_read_b128 v[60:63], v10 offset:0
    s_waitcnt lgkmcnt(5)
    v_smfmac_f32_16x16x64_bf16 v[16:19], v[36:39], a[16:23], v2
    ds_read_b128 v[64:67], v10 offset:1024
    v_smfmac_f32_16x16x64_bf16 v[20:23], v[36:39], a[176:183], v2
    ds_read_b128 v[32:35], v1 offset:4096
    v_smfmac_f32_16x16x64_bf16 v[24:27], v[36:39], v[68:75], v2
    ds_read_b128 v[68:71], v10 offset:8192
    s_waitcnt lgkmcnt(7)
    v_smfmac_f32_16x16x64_bf16 v[16:19], v[40:43], a[24:31], v2
    ds_read_b128 v[72:75], v10 offset:9216
    v_smfmac_f32_16x16x64_bf16 v[20:23], v[40:43], a[184:191], v2
    ds_read_b128 v[36:39], v0 offset:5120
    s_waitcnt lgkmcnt(7)
    v_smfmac_f32_16x16x64_bf16 v[24:27], v[40:43], v[52:59], v2
    ds_read_b128 v[52:55], v10 offset:16384
    s_waitcnt lgkmcnt(7)
    v_smfmac_f32_16x16x64_bf16 v[16:19], v[28:31], a[32:39], v2
    ds_read_b128 v[56:59], v10 offset:17408
    v_smfmac_f32_16x16x64_bf16 v[20:23], v[28:31], a[192:199], v2
    ds_read_b128 v[40:43], v1 offset:5120
    s_waitcnt lgkmcnt(7)
    v_smfmac_f32_16x16x64_bf16 v[24:27], v[28:31], v[60:67], v2
    ds_read_b128 v[60:63], v10 offset:24576
    s_waitcnt lgkmcnt(7)
    v_smfmac_f32_16x16x64_bf16 v[16:19], v[32:35], a[40:47], v2
    ds_read_b128 v[64:67], v10 offset:25600
    v_smfmac_f32_16x16x64_bf16 v[20:23], v[32:35], a[200:207], v2
    ds_read_b128 v[28:31], v0 offset:6144
    s_waitcnt lgkmcnt(7)
    v_smfmac_f32_16x16x64_bf16 v[24:27], v[32:35], v[68:75], v2
    ds_read_b128 v[68:71], v10 offset:32768
    s_waitcnt lgkmcnt(7)
    v_smfmac_f32_16x16x64_bf16 v[16:19], v[36:39], a[48:55], v2
    ds_read_b128 v[72:75], v10 offset:33792
    v_smfmac_f32_16x16x64_bf16 v[20:23], v[36:39], a[208:215], v2
    ds_read_b128 v[32:35], v1 offset:6144
    s_waitcnt lgkmcnt(7)
    v_smfmac_f32_16x16x64_bf16 v[24:27], v[36:39], v[52:59], v2
    s_waitcnt vmcnt(3)
    ds_read_b128 v[52:55], v9 offset:8192
    s_waitcnt lgkmcnt(7)
    v_smfmac_f32_16x16x64_bf16 v[16:19], v[40:43], a[56:63], v2
    buffer_load_dwordx4 v[56:59], v0, s[8:11], s52 offen offset:3072
    v_smfmac_f32_16x16x64_bf16 v[20:23], v[40:43], a[216:223], v2
    ds_read_b128 v[36:39], v0 offset:7168
    s_waitcnt lgkmcnt(6)
    v_smfmac_f32_16x16x64_bf16 v[24:27], v[40:43], v[60:67], v2
    ds_read_b128 v[60:63], v10 offset:40960
    s_waitcnt lgkmcnt(6)
    v_smfmac_f32_16x16x64_bf16 v[16:19], v[28:31], a[64:71], v2
    ds_read_b128 v[64:67], v10 offset:41984
    s_waitcnt lgkmcnt(3)
    v_max3_u32 v52, v52, v53, v54
    v_smfmac_f32_16x16x64_bf16 v[20:23], v[28:31], a[224:231], v2
    ds_read_b128 v[40:43], v1 offset:7168
    v_max_u32_e64 v52, v52, v55
    v_smfmac_f32_16x16x64_bf16 v[24:27], v[28:31], v[68:75], v2
    v_cmp_eq_u32_e64 vcc, -1, v52
    v_smfmac_f32_16x16x64_bf16 v[16:19], v[32:35], a[72:79], v2
    s_cbranch_vccnz rem_stub_40
rem_cont_41:
    v_smfmac_f32_16x16x64_bf16 v[20:23], v[32:35], a[232:239], v2
    buffer_load_dwordx4 v[52:55], v0, s[8:11], s52 offen offset:2048
    s_waitcnt lgkmcnt(1)
    v_smfmac_f32_16x16x64_bf16 v[24:27], v[32:35], v[60:67], v2
    s_barrier
    ds_read_b128 v[60:63], v0 offset:8192
    v_smfmac_f32_16x16x64_bf16 v[16:19], v[36:39], a[80:87], v2
    buffer_store_dwordx4 v[76:79], v0, s[8:11], s59 offen sc1
    s_mov_b32 s59, s51
    ds_read_b128 v[64:67], v1 offset:8192
    v_smfmac_f32_16x16x64_bf16 v[20:23], v[36:39], a[240:247], v2
    s_add_u32 s100, s49, s93
    s_add_u32 s100, s100, 16384
    ds_read_b128 v[68:71], v0 offset:10240
    v_smfmac_f32_16x16x64_bf16 v[24:27], v[36:39], v[128:135], v2
    v_lshlrev_b32 v76, 3, v0
    s_mov_b32 m0, 13312
    ds_read_b128 v[72:75], v1 offset:10240
    s_waitcnt lgkmcnt(4)
    v_smfmac_f32_16x16x64_bf16 v[16:19], v[40:43], a[88:95], v2
    s_mov_b64 exec, s[64:65]
    buffer_load_dword v76, s[8:11], s100 offen sc1 lds
    s_mov_b64 exec, -1
    ds_read_b128 v[28:31], v0 offset:12288
    v_smfmac_f32_16x16x64_bf16 v[20:23], v[40:43], a[248:255], v2
    ds_read_b128 v[32:35], v1 offset:12288
    v_smfmac_f32_16x16x64_bf16 v[24:27], v[40:43], v[136:143], v2
    ds_read_b128 v[36:39], v0 offset:14336
    s_waitcnt lgkmcnt(6)
    v_smfmac_f32_16x16x64_bf16 v[16:19], v[60:63], a[96:103], v2
    s_add_u32 s100, s49, 32768
    ds_read_b128 v[40:43], v1 offset:14336
    s_waitcnt lgkmcnt(6)
    v_smfmac_f32_16x16x64_bf16 v[16:19], v[64:67], a[104:111], v2
    s_mov_b32 m0, 13312
    s_waitcnt lgkmcnt(5)
    v_smfmac_f32_16x16x64_bf16 v[16:19], v[68:71], a[112:119], v2
    s_and_b32 s4, s40, 1
    s_waitcnt lgkmcnt(4)
    v_smfmac_f32_16x16x64_bf16 v[16:19], v[72:75], a[120:127], v2
    s_sub_u32 s5, 0, s4
    s_waitcnt lgkmcnt(3)
    v_smfmac_f32_16x16x64_bf16 v[16:19], v[28:31], a[128:135], v2
    s_add_u32 s54, s40, 1
    s_waitcnt lgkmcnt(2)
    v_smfmac_f32_16x16x64_bf16 v[16:19], v[32:35], a[136:143], v2
    s_and_b32 s54, s54, 3
    s_waitcnt lgkmcnt(1)
    v_smfmac_f32_16x16x64_bf16 v[16:19], v[36:39], a[144:151], v2
    s_lshl_b32 s54, s54, 15
    s_waitcnt lgkmcnt(0)
    v_smfmac_f32_16x16x64_bf16 v[16:19], v[40:43], a[152:159], v2
    s_add_u32 s43, s54, s96
    v_smfmac_f32_16x16x64_bf16 v[20:23], v[60:63], v[80:87], v2
    s_add_u32 s44, s54, s97
    v_smfmac_f32_16x16x64_bf16 v[20:23], v[64:67], v[88:95], v2
    s_add_u32 s45, s54, s98
    v_mul_f32 v16, s58, v16
    v_smfmac_f32_16x16x64_bf16 v[20:23], v[68:71], v[96:103], v2
    s_add_u32 s46, s54, s99
    v_mul_f32 v17, s58, v17
    v_smfmac_f32_16x16x64_bf16 v[20:23], v[72:75], v[104:111], v2
    s_xor_b32 s47, s45, 0x10000
    v_mul_f32_e64 v18, s58, v18
    v_smfmac_f32_16x16x64_bf16 v[20:23], v[28:31], v[112:119], v2
    s_xor_b32 s48, s46, 0x10000
    v_mul_f32_e64 v19, s58, v19
    v_smfmac_f32_16x16x64_bf16 v[20:23], v[32:35], v[120:127], v2
    s_add_u32 s49, s49, 16384
    v_cvt_pk_bf16_f32 v76, v16, v17
    s_waitcnt vmcnt(2)
    v_smfmac_f32_16x16x64_bf16 v[20:23], v[36:39], v[44:51], v2
    v_cvt_pk_bf16_f32 v77, v18, v19
    v_smfmac_f32_16x16x64_bf16 v[20:23], v[40:43], v[52:59], v2
    ds_write_b64 v6, v[76:77] offset:2048
    v_smfmac_f32_16x16x64_bf16 v[24:27], v[60:63], v[144:151], v2
    v_smfmac_f32_16x16x64_bf16 v[24:27], v[64:67], v[152:159], v2
    v_cvt_pk_bf16_f32 v78, v20, v21
    v_cvt_pk_bf16_f32 v79, v22, v23
    ds_write_b64 v6, v[78:79] offset:4096
    v_smfmac_f32_16x16x64_bf16 v[24:27], v[68:71], v[160:167], v2
    ds_read_b128 v[60:63], v0 offset:16384
    v_smfmac_f32_16x16x64_bf16 v[24:27], v[72:75], v[168:175], v2
    ds_read_b128 v[64:67], v0 offset:17408
    v_smfmac_f32_16x16x64_bf16 v[24:27], v[28:31], v[176:183], v2
    ds_read_b128 v[68:71], v0 offset:18432
    v_smfmac_f32_16x16x64_bf16 v[24:27], v[32:35], v[184:191], v2
    ds_read_b128 v[72:75], v0 offset:19456
    s_waitcnt lgkmcnt(4)
    s_barrier
    ds_read_b64_tr_b16 v[44:45], v7 offset:2048
    ds_read_b64_tr_b16 v[46:47], v7 offset:2304
    ds_read_b64_tr_b16 v[48:49], v7 offset:2560
    ds_read_b64_tr_b16 v[50:51], v7 offset:2816
    ds_read_b64_tr_b16 v[52:53], v7 offset:3072
    ds_read_b64_tr_b16 v[54:55], v7 offset:3328
    v_smfmac_f32_16x16x64_bf16 v[24:27], v[36:39], v[192:199], v2
    ds_read_b64_tr_b16 v[56:57], v7 offset:3584
    ds_read_b64_tr_b16 v[58:59], v7 offset:3840
    v_smfmac_f32_16x16x64_bf16 v[24:27], v[40:43], v[200:207], v2
    s_waitcnt lgkmcnt(4)
    v_mfma_f32_16x16x32_bf16 v[16:19], v[60:63], v[44:47], 0
    ds_read_b128 v[28:31], v0 offset:20480
    ds_read_b128 v[32:35], v0 offset:21504
    v_mfma_f32_16x16x32_bf16 v[16:19], v[64:67], v[48:51], v[16:19]
    ds_read_b128 v[36:39], v0 offset:22528
    ds_read_b128 v[40:43], v0 offset:23552
    s_waitcnt lgkmcnt(4)
    v_mfma_f32_16x16x32_bf16 v[16:19], v[68:71], v[52:55], v[16:19]
    ds_read_b64_tr_b16 v[60:61], v7 offset:4096
    ds_read_b64_tr_b16 v[62:63], v7 offset:4352
    v_mfma_f32_16x16x32_bf16 v[16:19], v[72:75], v[56:59], v[16:19]
    ds_read_b64_tr_b16 v[64:65], v7 offset:4608
    ds_read_b64_tr_b16 v[66:67], v7 offset:4864
    s_waitcnt lgkmcnt(6)
    v_mfma_f32_16x16x32_bf16 v[20:23], v[28:31], v[44:47], 0
    ds_read_b64_tr_b16 v[68:69], v7 offset:5120
    ds_read_b64_tr_b16 v[70:71], v7 offset:5376
    v_mfma_f32_16x16x32_bf16 v[20:23], v[32:35], v[48:51], v[20:23]
    ds_read_b64_tr_b16 v[72:73], v7 offset:5632
    ds_read_b64_tr_b16 v[74:75], v7 offset:5888
    s_waitcnt lgkmcnt(8)
    v_mfma_f32_16x16x32_bf16 v[20:23], v[36:39], v[52:55], v[20:23]
    v_cvt_pk_bf16_f32 v76, v24, v25
    v_cvt_pk_bf16_f32 v77, v26, v27
    v_mfma_f32_16x16x32_bf16 v[20:23], v[40:43], v[56:59], v[20:23]
    ds_read_b128 v[28:31], v9 offset:24576
    ds_read_b128 v[32:35], v9 offset:25600
    s_waitcnt lgkmcnt(6)
    v_mfma_f32_16x16x32_bf16 v[40:43], v[60:63], v[44:47], 0
    v_exp_f32_e64 v16, v16
    v_mfma_f32_16x16x32_bf16 v[40:43], v[64:67], v[48:51], v[40:43]
    v_exp_f32 v17, v17
    s_waitcnt lgkmcnt(2)
    v_mfma_f32_16x16x32_bf16 v[40:43], v[68:71], v[52:55], v[40:43]
    v_exp_f32_e64 v18, v18
    v_mfma_f32_16x16x32_bf16 v[40:43], v[72:75], v[56:59], v[40:43]
    v_exp_f32 v19, v19
    v_exp_f32 v20, v20
    v_exp_f32 v21, v21
    v_exp_f32 v22, v22
    v_exp_f32_e64 v23, v23
    v_cvt_pk_bf16_f32 v16, v16, v17
    v_cvt_pk_bf16_f32 v17, v18, v19
    v_cvt_pk_bf16_f32 v18, v20, v21
    v_cvt_pk_bf16_f32 v19, v22, v23
    v_exp_f32 v40, v40
    s_waitcnt lgkmcnt(0)
    v_mfma_f32_16x16x32_bf16 v[60:63], v[28:31], v[16:19], 0
    v_exp_f32_e64 v41, v41
    v_mfma_f32_16x16x32_bf16 v[64:67], v[32:35], v[16:19], 0
    v_exp_f32_e64 v42, v42
    v_mfma_f32_16x16x32_bf16 v[68:71], v[12:15], v[16:19], 0
    v_exp_f32_e64 v43, v43
    v_cndmask_b32 v24, 0, v76, s[64:65]
    v_cvt_pk_bf16_f32 v40, v40, v41
    v_cvt_pk_bf16_f32 v41, v42, v43
sm_back_43:
    v_cndmask_b32 v42, 0, v40, s[64:65]
    v_cndmask_b32 v43, 0, v41, s[64:65]
    v_cndmask_b32 v25, 0, v77, s[64:65]
    v_cndmask_b32 v26, 0, v76, s[66:67]
    v_mfma_f32_16x16x16_bf16 v[68:71], v[12:13], v[42:43], v[68:71]
    v_cndmask_b32 v27, 0, v77, s[66:67]
    v_mfma_f32_16x16x16_bf16 v[60:63], v[24:25], v[40:41], v[60:63]
    v_add_u32_e64 v20, s50, v0
    v_mfma_f32_16x16x16_bf16 v[64:67], v[26:27], v[40:41], v[64:67]
    v_mov_b64 v[16:17], 0
    v_mov_b64 v[18:19], 0
    v_mov_b64 v[22:23], 0
    s_nop 0
    v_rcp_f32 v70, v68
    s_nop 0
    v_max_f32_e64 v69, v68, v70
    v_pk_mul_f32 v[60:61], v[60:61], v[70:71] op_sel_hi:[1,0]
    v_pk_mul_f32 v[62:63], v[62:63], v[70:71] op_sel_hi:[1,0]
    v_pk_mul_f32 v[64:65], v[64:65], v[70:71] op_sel_hi:[1,0]
    v_pk_mul_f32 v[66:67], v[66:67], v[70:71] op_sel_hi:[1,0]
    v_cvt_pk_bf16_f32 v36, v60, v61
    v_cvt_pk_bf16_f32 v37, v62, v63
    v_cvt_pk_bf16_f32 v38, v64, v65
    v_cvt_pk_bf16_f32 v39, v66, v67
    v_cmp_nge_f32 vcc, s92, v69
    s_mov_b64 exec, s[62:63]
    ds_write_b128 v20, v[36:39] offset:9216
    s_mov_b64 exec, -1
    s_cbranch_vccnz sm_slow_42
sm_ok_44:
    s_cmp_eq_u32 s40, 63
    s_cbranch_scc1 fin_45
    s_add_u32 m0, s93, 8192
    s_add_u32 s55, s49, 8192
    buffer_load_dwordx4 v0, s[8:11], s55 offen offset:0 sc1 lds
    buffer_load_dwordx4 v0, s[8:11], s55 offen offset:1024 sc1 lds
    ds_read_b128 v[44:47], v10 offset:49152
    ds_read_b128 v[48:51], v10 offset:50176
    s_waitcnt lgkmcnt(2)
    s_barrier
    ds_read_b128 v[28:31], v0 offset:9216
    ds_read_b128 v[32:35], v1 offset:9216
    ds_read_b128 v[36:39], v0 offset:11264
    ds_read_b128 v[40:43], v1 offset:11264
    ds_read_b128 v[52:55], v10 offset:57344
    ds_read_b128 v[56:59], v10 offset:58368
    v_mov_b64 v[20:21], 0
    s_mov_b32 m0, s93
    s_nop 0
    buffer_load_dwordx4 v0, s[8:11], s49 offen offset:0 sc1 lds
    buffer_load_dwordx4 v0, s[8:11], s49 offen offset:1024 sc1 lds
    s_add_u32 s51, s51, 4096
    s_xor_b32 s51, s51, 0x40000000
    s_mov_b32 s101, 0
    s_waitcnt lgkmcnt(5)
    v_smfmac_f32_16x16x64_bf16 v[16:19], v[28:31], v[44:51], v2
    ds_read_b128 v[60:63], v11 offset:0
    v_smfmac_f32_16x16x64_bf16 v[20:23], v[28:31], v[208:215], v2
    ds_read_b128 v[64:67], v11 offset:1024
    s_waitcnt lgkmcnt(6)
    v_smfmac_f32_16x16x64_bf16 v[20:23], v[32:35], v[216:223], v2
    ds_read_b128 v[68:71], v11 offset:8192
    s_waitcnt lgkmcnt(3)
    v_smfmac_f32_16x16x64_bf16 v[16:19], v[32:35], v[52:59], v2
    ds_read_b128 v[72:75], v11 offset:9216
    v_smfmac_f32_16x16x64_bf16 v[20:23], v[36:39], v[240:247], v2
    ds_read_b128 v[44:47], v11 offset:16384
    v_mov_b64 v[24:25], 0
    v_smfmac_f32_16x16x64_bf16 v[20:23], v[40:43], v[248:255], v2
    ds_read_b128 v[48:51], v11 offset:17408
    v_mov_b64 v[26:27], 0
    s_waitcnt lgkmcnt(4)
    v_smfmac_f32_16x16x64_bf16 v[16:19], v[36:39], v[60:67], v2
    ds_read_b128 v[52:55], v11 offset:24576
    s_waitcnt lgkmcnt(3)
    v_smfmac_f32_16x16x64_bf16 v[16:19], v[40:43], v[68:75], v2
    ds_read_b128 v[56:59], v11 offset:25600
    v_smfmac_f32_16x16x64_bf16 v[24:27], v[28:31], v[224:231], v2
    v_cvt_pk_bf16_f32 v20, v20, v21
    v_smfmac_f32_16x16x64_bf16 v[24:27], v[32:35], v[232:239], v2
    v_cvt_pk_bf16_f32 v21, v22, v23
    s_waitcnt lgkmcnt(2)
    v_smfmac_f32_16x16x64_bf16 v[24:27], v[36:39], v[44:51], v2
    v_cvt_pk_bf16_f32 v19, v18, v19
    s_waitcnt lgkmcnt(0)
    v_smfmac_f32_16x16x64_bf16 v[24:27], v[40:43], v[52:59], v2
    v_cvt_pk_bf16_f32 v18, v16, v17
    v_and_or_b32 v20, v20, -2, s4
    v_and_or_b32 v18, v18, -2, s4
    buffer_store_dwordx4 v[18:21], v4, s[8:11], s41 offen
    s_nop 1
    v_cvt_pk_bf16_f32 v24, v24, v25
    v_cvt_pk_bf16_f32 v25, v26, v27
    v_and_or_b32 v24, v24, -2, s4
    buffer_store_dwordx2 v[24:25], v5, s[8:11], s41 offen
    ds_read_b128 v[60:63], v0 offset:0
    s_sleep 4
    buffer_load_dwordx4 v[28:31], v0, s[8:11], s42 offen offset:0 sc1
    buffer_load_dwordx4 v[32:35], v0, s[8:11], s42 offen offset:1024 sc1
    buffer_load_dwordx4 v[36:39], v0, s[8:11], s42 offen offset:2048 sc1
    buffer_load_dwordx4 v[40:43], v0, s[8:11], s42 offen offset:3072 sc1
    s_sleep 2
    buffer_load_dwordx4 v[28:31], v0, s[8:11], s42 offen offset:0 sc1
    buffer_load_dwordx4 v[32:35], v0, s[8:11], s42 offen offset:1024 sc1
    buffer_load_dwordx4 v[36:39], v0, s[8:11], s42 offen offset:2048 sc1
    buffer_load_dwordx4 v[40:43], v0, s[8:11], s42 offen offset:3072 sc1
    s_waitcnt lgkmcnt(0)
ra_check_46:
    s_waitcnt vmcnt(7)
    v_bitop3_b32 v16, v28, v30, s5 bitop3:0x7e
    v_mfma_f32_16x16x32_bf16 v[68:71], v[28:31], v[60:63], 0
    s_waitcnt vmcnt(6)
    v_bitop3_b32 v17, v32, v34, s5 bitop3:0x7e
    v_or_b32_e64 v16, v16, v17
    v_mfma_f32_16x16x32_bf16 v[68:71], v[32:35], v[60:63], v[68:71]
    s_waitcnt vmcnt(5)
    v_bitop3_b32 v17, v36, v38, s5 bitop3:0x7e
    v_or_b32 v16, v16, v17
    v_lshlrev_b32_e64 v16, 31, v16
    v_mfma_f32_16x16x32_bf16 v[68:71], v[36:39], v[60:63], v[68:71]
    s_waitcnt vmcnt(4)
    v_bitop3_b32 v17, v40, v42, s5 bitop3:0x7e
    v_lshl_or_b32 v16, v17, 31, v16
    v_mfma_f32_16x16x32_bf16 v[68:71], v[40:43], v[60:63], v[68:71]
    v_cmp_gt_i32 vcc, 0, v16
    s_nop 0
    s_cbranch_vccnz ra_stub_47
ra_cont_48:
    s_nop 0
    v_permlane32_swap_b32 v68, v70
    v_permlane32_swap_b32 v69, v71
    v_pk_add_f32 v[68:69], v[68:69], v[70:71]
    v_cvt_pk_bf16_f32 v20, v68, v69
    s_mov_b64 exec, s[60:61]
    buffer_store_dword v20, v8, s[8:11], s45 offen
    buffer_store_dword v20, v8, s[8:11], s46 offen sc1
    s_mov_b64 exec, -1
    s_branch rec_top_El
kv_stub_38:
    v_lshrrev_b32 v46, 2, v0
    v_min_u32 v46, 64, v46
kvf_49:
    buffer_load_dword v47, v46, s[8:11], s3 offen sc1
    s_waitcnt vmcnt(0)
    v_cmp_gt_u32 vcc, 2, v47
    s_nop 0
    s_ff1_i32_b64 s7, vcc
    s_lshl_b32 s7, s7, 2
    s_cmp_eq_u32 s7, 64
    s_cselect_b32 s7, 128, s7
    s_add_u32 s54, s40, 2
    s_cmp_lt_u32 s54, s7
    s_cbranch_scc1 kvd_50
    s_sleep 2
    s_sub_u32 s53, s53, 1
    s_cbranch_scc0 kvf_49
    s_mov_b32 s53, 0
    s_mov_b32 s7, 128
kvd_50:
    s_branch kv_cont_39
rem_stub_40:
    s_sub_u32 s53, s53, 1
    s_cbranch_scc1 rem_give_52
    s_sleep 3
    buffer_load_dwordx4 v[52:55], v3, s[8:11], s44 offen sc1
    s_waitcnt vmcnt(0)
    ds_write_b128 v9, v[52:55] offset:8192
    s_waitcnt lgkmcnt(0)
    v_max3_u32 v52, v52, v53, v54
    v_max_u32 v52, v52, v55
    v_cmp_eq_u32 vcc, -1, v52
    s_nop 0
    s_cbranch_vccnz rem_stub_40
    s_branch rem_cont_41
rem_give_52:
    s_mov_b32 s53, 0
    s_branch rem_cont_41
sm_slow_42:
    s_cmp_lg_u32 s101, 0
    s_cbranch_scc1 sm_ok_44
    s_mov_b32 s101, 1
    s_waitcnt lgkmcnt(0)
    ds_read_b128 v[68:71], v0 offset:16384
    s_waitcnt lgkmcnt(0)
    v_mfma_f32_16x16x32_bf16 v[16:19], v[68:71], v[44:47], 0
    s_nop 3
    ds_read_b128 v[68:71], v0 offset:17408
    s_waitcnt lgkmcnt(0)
    v_mfma_f32_16x16x32_bf16 v[16:19], v[68:71], v[48:51], v[16:19]
    s_nop 3
    ds_read_b128 v[68:71], v0 offset:18432
    s_waitcnt lgkmcnt(0)
    v_mfma_f32_16x16x32_bf16 v[16:19], v[68:71], v[52:55], v[16:19]
    s_nop 3
    ds_read_b128 v[68:71], v0 offset:19456
    s_waitcnt lgkmcnt(0)
    v_mfma_f32_16x16x32_bf16 v[16:19], v[68:71], v[56:59], v[16:19]
    s_nop 3
    ds_read_b128 v[68:71], v0 offset:20480
    s_waitcnt lgkmcnt(0)
    v_mfma_f32_16x16x32_bf16 v[20:23], v[68:71], v[44:47], 0
    s_nop 3
    ds_read_b128 v[68:71], v0 offset:21504
    s_waitcnt lgkmcnt(0)
    v_mfma_f32_16x16x32_bf16 v[20:23], v[68:71], v[48:51], v[20:23]
    s_nop 3
    ds_read_b128 v[68:71], v0 offset:22528
    s_waitcnt lgkmcnt(0)
    v_mfma_f32_16x16x32_bf16 v[20:23], v[68:71], v[52:55], v[20:23]
    s_nop 3
    ds_read_b128 v[68:71], v0 offset:23552
    s_waitcnt lgkmcnt(0)
    v_mfma_f32_16x16x32_bf16 v[20:23], v[68:71], v[56:59], v[20:23]
    s_nop 3
    ds_read_b64_tr_b16 v[68:69], v7 offset:4096
    ds_read_b64_tr_b16 v[70:71], v7 offset:4352
    s_waitcnt lgkmcnt(0)
    v_mfma_f32_16x16x32_bf16 v[40:43], v[68:71], v[44:47], 0
    s_nop 3
    ds_read_b64_tr_b16 v[68:69], v7 offset:4608
    ds_read_b64_tr_b16 v[70:71], v7 offset:4864
    s_waitcnt lgkmcnt(0)
    v_mfma_f32_16x16x32_bf16 v[40:43], v[68:71], v[48:51], v[40:43]
    s_nop 3
    ds_read_b64_tr_b16 v[68:69], v7 offset:5120
    ds_read_b64_tr_b16 v[70:71], v7 offset:5376
    s_waitcnt lgkmcnt(0)
    v_mfma_f32_16x16x32_bf16 v[40:43], v[68:71], v[52:55], v[40:43]
    s_nop 3
    ds_read_b64_tr_b16 v[68:69], v7 offset:5632
    ds_read_b64_tr_b16 v[70:71], v7 offset:5888
    s_waitcnt lgkmcnt(0)
    v_mfma_f32_16x16x32_bf16 v[40:43], v[68:71], v[56:59], v[40:43]
    s_nop 3
    v_max3_f32 v68, v16, v17, v18
    v_max3_f32 v68, v68, v19, v20
    v_max3_f32 v68, v68, v21, v22
    s_nop 0
    v_max3_f32 v68, v68, v23, v40
    v_max3_f32 v68, v68, v41, v42
    v_max_f32 v68, v68, v43
    v_mov_b32 v69, v68
    s_nop 1
    v_permlane16_swap_b32 v68, v69
    v_max_f32 v68, v68, v69
    v_mov_b32 v69, v68
    s_nop 1
    v_permlane32_swap_b32 v68, v69
    v_max_f32 v68, v68, v69
    v_sub_f32 v16, v16, v68
    v_sub_f32 v17, v17, v68
    v_sub_f32 v18, v18, v68
    v_sub_f32 v19, v19, v68
    v_sub_f32 v20, v20, v68
    v_sub_f32 v21, v21, v68
    v_sub_f32 v22, v22, v68
    v_sub_f32 v23, v23, v68
    v_sub_f32 v40, v40, v68
    v_sub_f32 v41, v41, v68
    v_sub_f32 v42, v42, v68
    v_sub_f32 v43, v43, v68
    v_exp_f32 v16, v16
    v_exp_f32 v17, v17
    v_exp_f32 v18, v18
    v_exp_f32 v19, v19
    v_exp_f32 v20, v20
    v_exp_f32 v21, v21
    v_exp_f32 v22, v22
    v_exp_f32 v23, v23
    v_exp_f32 v40, v40
    v_exp_f32 v41, v41
    v_exp_f32 v42, v42
    v_exp_f32 v43, v43
    v_cvt_pk_bf16_f32 v16, v16, v17
    v_cvt_pk_bf16_f32 v17, v18, v19
    v_cvt_pk_bf16_f32 v18, v20, v21
    v_cvt_pk_bf16_f32 v19, v22, v23
    v_cvt_pk_bf16_f32 v40, v40, v41
    v_cvt_pk_bf16_f32 v41, v42, v43
    v_mfma_f32_16x16x32_bf16 v[60:63], v[28:31], v[16:19], 0
    v_mfma_f32_16x16x32_bf16 v[64:67], v[32:35], v[16:19], 0
    v_mfma_f32_16x16x32_bf16 v[68:71], v[12:15], v[16:19], 0
    s_nop 7
    s_branch sm_back_43
fin_45:
    buffer_store_dwordx4 v[76:79], v0, s[8:11], s51 offen sc1
    s_branch main_end0
ra_stub_47:
    s_mov_b32 s88, 1
    s_sub_u32 s53, s53, 1
    s_cbranch_scc1 giveup_53
    s_mov_b64 exec, vcc
    buffer_load_dwordx4 v[28:31], v0, s[8:11], s42 offen offset:0 sc1
    buffer_load_dwordx4 v[32:35], v0, s[8:11], s42 offen offset:1024 sc1
    buffer_load_dwordx4 v[36:39], v0, s[8:11], s42 offen offset:2048 sc1
    buffer_load_dwordx4 v[40:43], v0, s[8:11], s42 offen offset:3072 sc1
    s_mov_b64 exec, -1
    s_branch ra_check_46
giveup_53:
    s_mov_b32 s53, 0
    s_branch ra_cont_48
rec_entry_Sl:
    v_mov_b32 v20, v26
    s_mov_b64 exec, s[60:61]
    buffer_store_dword v20, v8, s[8:11], s45 offen
    s_mov_b64 exec, -1
.p2align 3
rec_top_Sl:
    s_add_u32 s40, s40, 1
    s_barrier
    ds_read_b128 v[52:55], v9 offset:32768
    ds_read_b128 v[56:59], v9 offset:33792
    ds_read_b128 v[60:63], v9 offset:40960
    ds_read_b128 v[64:67], v9 offset:41984
    ds_read_b128 v[68:71], v9 offset:49152
    ds_read_b128 v[72:75], v9 offset:50176
    v_mov_b64 v[24:25], -1
    v_mov_b64 v[26:27], -1
    v_mov_b64 v[16:17], 0
    v_mov_b64 v[18:19], 0
    v_mov_b64 v[20:21], 0
    v_mov_b64 v[22:23], 0
    s_add_u32 s54, s40, 2
    s_cmp_ge_u32 s54, s7
    s_cbranch_scc1 kv_stub_54
kv_cont_55:
    s_sleep 2
    buffer_load_dwordx4 v[44:47], v3, s[8:11], s43 offen offset:0 sc1
    buffer_load_dwordx4 v[48:51], v3, s[8:11], s43 offen offset:1024 sc1
    s_mov_b64 exec, 0xff
    buffer_store_dwordx4 v[24:27], v0, s[8:11], s47 offen
    s_mov_b64 exec, -1
    s_nop 0
    v_mov_b64 v[24:25], 0
    v_mov_b64 v[26:27], 0
    s_sleep 2
    buffer_load_dwordx4 v[44:47], v3, s[8:11], s43 offen offset:0 sc1
    buffer_load_dwordx4 v[48:51], v3, s[8:11], s43 offen offset:1024 sc1
pl_check_56:
    s_waitcnt vmcnt(2)
    v_max3_u32 v40, v44, v45, v46
    v_max3_u32 v40, v40, v47, v48
    v_max3_u32 v40, v40, v49, v50
    v_max_u32_e64 v40, v40, v51
    ds_write_b128 v9, v[44:47] offset:0
    ds_write_b128 v9, v[48:51] offset:1024
    v_cmp_eq_u32 vcc, -1, v40
    s_nop 0
    s_cbranch_vccnz pl_stub_57
pl_cont_58:
    s_waitcnt lgkmcnt(0)
    s_barrier
    ds_read_b128 v[28:31], v0 offset:2048
    ds_read_b128 v[32:35], v1 offset:2048
    ds_read_b128 v[36:39], v0 offset:3072
    ds_read_b128 v[40:43], v1 offset:3072
    s_add_u32 m0, s93, -8192
    s_nop 0
    buffer_load_dwordx4 v3, s[8:11], s44 offen sc1 lds
    s_waitcnt lgkmcnt(3)
    v_smfmac_f32_16x16x64_bf16 v[16:19], v[28:31], a[0:7], v2
    v_smfmac_f32_16x16x64_bf16 v[20:23], v[28:31], a[160:167], v2
    buffer_load_dwordx4 v[44:47], v0, s[8:11], s52 offen offset:0
    v_smfmac_f32_16x16x64_bf16 v[24:27], v[28:31], v[52:59], v2
    ds_read_b128 v[52:55], v9 offset:57344
    s_waitcnt lgkmcnt(3)
    v_smfmac_f32_16x16x64_bf16 v[16:19], v[32:35], a[8:15], v2
    ds_read_b128 v[56:59], v9 offset:58368
    v_smfmac_f32_16x16x64_bf16 v[20:23], v[32:35], a[168:175], v2
    ds_read_b128 v[28:31], v0 offset:4096
    buffer_load_dwordx4 v[48:51], v0, s[8:11], s52 offen offset:1024
    v_smfmac_f32_16x16x64_bf16 v[24:27], v[32:35], v[60:67], v2
    ds_read_b128 v[60:63], v10 offset:0
    s_waitcnt lgkmcnt(5)
    v_smfmac_f32_16x16x64_bf16 v[16:19], v[36:39], a[16:23], v2
    ds_read_b128 v[64:67], v10 offset:1024
    v_smfmac_f32_16x16x64_bf16 v[20:23], v[36:39], a[176:183], v2
    ds_read_b128 v[32:35], v1 offset:4096
    v_smfmac_f32_16x16x64_bf16 v[24:27], v[36:39], v[68:75], v2
    ds_read_b128 v[68:71], v10 offset:8192
    s_waitcnt lgkmcnt(7)
    v_smfmac_f32_16x16x64_bf16 v[16:19], v[40:43], a[24:31], v2
    ds_read_b128 v[72:75], v10 offset:9216
    v_smfmac_f32_16x16x64_bf16 v[20:23], v[40:43], a[184:191], v2
    ds_read_b128 v[36:39], v0 offset:5120
    s_waitcnt lgkmcnt(7)
    v_smfmac_f32_16x16x64_bf16 v[24:27], v[40:43], v[52:59], v2
    ds_read_b128 v[52:55], v10 offset:16384
    s_waitcnt lgkmcnt(7)
    v_smfmac_f32_16x16x64_bf16 v[16:19], v[28:31], a[32:39], v2
    ds_read_b128 v[56:59], v10 offset:17408
    v_smfmac_f32_16x16x64_bf16 v[20:23], v[28:31], a[192:199], v2
    ds_read_b128 v[40:43], v1 offset:5120
    s_waitcnt lgkmcnt(7)
    v_smfmac_f32_16x16x64_bf16 v[24:27], v[28:31], v[60:67], v2
    ds_read_b128 v[60:63], v10 offset:24576
    s_waitcnt lgkmcnt(7)
    v_smfmac_f32_16x16x64_bf16 v[16:19], v[32:35], a[40:47], v2
    ds_read_b128 v[64:67], v10 offset:25600
    v_smfmac_f32_16x16x64_bf16 v[20:23], v[32:35], a[200:207], v2
    ds_read_b128 v[28:31], v0 offset:6144
    s_waitcnt lgkmcnt(7)
    v_smfmac_f32_16x16x64_bf16 v[24:27], v[32:35], v[68:75], v2
    ds_read_b128 v[68:71], v10 offset:32768
    s_waitcnt lgkmcnt(7)
    v_smfmac_f32_16x16x64_bf16 v[16:19], v[36:39], a[48:55], v2
    ds_read_b128 v[72:75], v10 offset:33792
    v_smfmac_f32_16x16x64_bf16 v[20:23], v[36:39], a[208:215], v2
    ds_read_b128 v[32:35], v1 offset:6144
    s_waitcnt lgkmcnt(7)
    v_smfmac_f32_16x16x64_bf16 v[24:27], v[36:39], v[52:59], v2
    s_waitcnt vmcnt(2)
    ds_read_b128 v[52:55], v9 offset:8192
    s_waitcnt lgkmcnt(7)
    v_smfmac_f32_16x16x64_bf16 v[16:19], v[40:43], a[56:63], v2
    buffer_load_dwordx4 v[56:59], v0, s[8:11], s52 offen offset:3072
    v_smfmac_f32_16x16x64_bf16 v[20:23], v[40:43], a[216:223], v2
    ds_read_b128 v[36:39], v0 offset:7168
    s_waitcnt lgkmcnt(6)
    v_smfmac_f32_16x16x64_bf16 v[24:27], v[40:43], v[60:67], v2
    ds_read_b128 v[60:63], v10 offset:40960
    s_waitcnt lgkmcnt(6)
    v_smfmac_f32_16x16x64_bf16 v[16:19], v[28:31], a[64:71], v2
    ds_read_b128 v[64:67], v10 offset:41984
    s_waitcnt lgkmcnt(3)
    v_max3_u32 v52, v52, v53, v54
    v_smfmac_f32_16x16x64_bf16 v[20:23], v[28:31], a[224:231], v2
    ds_read_b128 v[40:43], v1 offset:7168
    v_max_u32_e64 v52, v52, v55
    v_smfmac_f32_16x16x64_bf16 v[24:27], v[28:31], v[68:75], v2
    v_cmp_eq_u32_e64 vcc, -1, v52
    v_smfmac_f32_16x16x64_bf16 v[16:19], v[32:35], a[72:79], v2
    s_cbranch_vccnz rem_stub_59
rem_cont_60:
    v_smfmac_f32_16x16x64_bf16 v[20:23], v[32:35], a[232:239], v2
    buffer_load_dwordx4 v[52:55], v0, s[8:11], s52 offen offset:2048
    s_waitcnt lgkmcnt(1)
    v_smfmac_f32_16x16x64_bf16 v[24:27], v[32:35], v[60:67], v2
    s_barrier
    ds_read_b128 v[60:63], v0 offset:8192
    v_smfmac_f32_16x16x64_bf16 v[16:19], v[36:39], a[80:87], v2
    buffer_store_dwordx4 v[76:79], v0, s[8:11], s59 offen sc1
    s_mov_b32 s59, s51
    ds_read_b128 v[64:67], v1 offset:8192
    v_smfmac_f32_16x16x64_bf16 v[20:23], v[36:39], a[240:247], v2
    s_add_u32 s100, s49, s93
    s_add_u32 s100, s100, 16384
    ds_read_b128 v[68:71], v0 offset:10240
    v_smfmac_f32_16x16x64_bf16 v[24:27], v[36:39], v[128:135], v2
    v_lshlrev_b32 v76, 3, v0
    s_mov_b32 m0, 13312
    ds_read_b128 v[72:75], v1 offset:10240
    s_waitcnt lgkmcnt(4)
    v_smfmac_f32_16x16x64_bf16 v[16:19], v[40:43], a[88:95], v2
    s_mov_b64 exec, s[64:65]
    buffer_load_dword v76, s[8:11], s100 offen sc1 lds
    s_mov_b64 exec, -1
    ds_read_b128 v[28:31], v0 offset:12288
    v_smfmac_f32_16x16x64_bf16 v[20:23], v[40:43], a[248:255], v2
    ds_read_b128 v[32:35], v1 offset:12288
    v_smfmac_f32_16x16x64_bf16 v[24:27], v[40:43], v[136:143], v2
    ds_read_b128 v[36:39], v0 offset:14336
    s_waitcnt lgkmcnt(6)
    v_smfmac_f32_16x16x64_bf16 v[16:19], v[60:63], a[96:103], v2
    s_add_u32 s100, s49, 32768
    ds_read_b128 v[40:43], v1 offset:14336
    s_waitcnt lgkmcnt(6)
    v_smfmac_f32_16x16x64_bf16 v[16:19], v[64:67], a[104:111], v2
    s_mov_b32 m0, 13312
    s_waitcnt lgkmcnt(5)
    v_smfmac_f32_16x16x64_bf16 v[16:19], v[68:71], a[112:119], v2
    s_and_b32 s4, s40, 1
    s_waitcnt lgkmcnt(4)
    v_smfmac_f32_16x16x64_bf16 v[16:19], v[72:75], a[120:127], v2
    s_sub_u32 s5, 0, s4
    s_waitcnt lgkmcnt(3)
    v_smfmac_f32_16x16x64_bf16 v[16:19], v[28:31], a[128:135], v2
    s_add_u32 s54, s40, 1
    s_waitcnt lgkmcnt(2)
    v_smfmac_f32_16x16x64_bf16 v[16:19], v[32:35], a[136:143], v2
    s_and_b32 s54, s54, 3
    s_waitcnt lgkmcnt(1)
    v_smfmac_f32_16x16x64_bf16 v[16:19], v[36:39], a[144:151], v2
    s_lshl_b32 s54, s54, 15
    s_waitcnt lgkmcnt(0)
    v_smfmac_f32_16x16x64_bf16 v[16:19], v[40:43], a[152:159], v2
    s_add_u32 s43, s54, s96
    v_smfmac_f32_16x16x64_bf16 v[20:23], v[60:63], v[80:87], v2
    s_add_u32 s44, s54, s97
    v_smfmac_f32_16x16x64_bf16 v[20:23], v[64:67], v[88:95], v2
    s_add_u32 s45, s54, s98
    v_mul_f32 v16, s58, v16
    v_smfmac_f32_16x16x64_bf16 v[20:23], v[68:71], v[96:103], v2
    s_add_u32 s46, s54, s99
    v_mul_f32 v17, s58, v17
    v_smfmac_f32_16x16x64_bf16 v[20:23], v[72:75], v[104:111], v2
    s_xor_b32 s47, s45, 0x10000
    v_mul_f32_e64 v18, s58, v18
    v_smfmac_f32_16x16x64_bf16 v[20:23], v[28:31], v[112:119], v2
    s_xor_b32 s48, s46, 0x10000
    v_mul_f32_e64 v19, s58, v19
    v_smfmac_f32_16x16x64_bf16 v[20:23], v[32:35], v[120:127], v2
    s_add_u32 s49, s49, 16384
    v_cvt_pk_bf16_f32 v76, v16, v17
    s_waitcnt vmcnt(2)
    v_smfmac_f32_16x16x64_bf16 v[20:23], v[36:39], v[44:51], v2
    v_cvt_pk_bf16_f32 v77, v18, v19
    v_smfmac_f32_16x16x64_bf16 v[20:23], v[40:43], v[52:59], v2
    ds_write_b64 v6, v[76:77] offset:2048
    v_smfmac_f32_16x16x64_bf16 v[24:27], v[60:63], v[144:151], v2
    v_smfmac_f32_16x16x64_bf16 v[24:27], v[64:67], v[152:159], v2
    v_cvt_pk_bf16_f32 v78, v20, v21
    v_cvt_pk_bf16_f32 v79, v22, v23
    ds_write_b64 v6, v[78:79] offset:4096
    v_smfmac_f32_16x16x64_bf16 v[24:27], v[68:71], v[160:167], v2
    ds_read_b128 v[60:63], v0 offset:16384
    v_smfmac_f32_16x16x64_bf16 v[24:27], v[72:75], v[168:175], v2
    ds_read_b128 v[64:67], v0 offset:17408
    v_smfmac_f32_16x16x64_bf16 v[24:27], v[28:31], v[176:183], v2
    ds_read_b128 v[68:71], v0 offset:18432
    v_smfmac_f32_16x16x64_bf16 v[24:27], v[32:35], v[184:191], v2
    ds_read_b128 v[72:75], v0 offset:19456
    s_waitcnt lgkmcnt(4)
    s_barrier
    ds_read_b64_tr_b16 v[44:45], v7 offset:2048
    ds_read_b64_tr_b16 v[46:47], v7 offset:2304
    ds_read_b64_tr_b16 v[48:49], v7 offset:2560
    ds_read_b64_tr_b16 v[50:51], v7 offset:2816
    ds_read_b64_tr_b16 v[52:53], v7 offset:3072
    ds_read_b64_tr_b16 v[54:55], v7 offset:3328
    v_smfmac_f32_16x16x64_bf16 v[24:27], v[36:39], v[192:199], v2
    ds_read_b64_tr_b16 v[56:57], v7 offset:3584
    ds_read_b64_tr_b16 v[58:59], v7 offset:3840
    v_smfmac_f32_16x16x64_bf16 v[24:27], v[40:43], v[200:207], v2
    s_waitcnt lgkmcnt(4)
    v_mfma_f32_16x16x32_bf16 v[16:19], v[60:63], v[44:47], 0
    ds_read_b128 v[28:31], v0 offset:20480
    ds_read_b128 v[32:35], v0 offset:21504
    v_mfma_f32_16x16x32_bf16 v[16:19], v[64:67], v[48:51], v[16:19]
    ds_read_b128 v[36:39], v0 offset:22528
    ds_read_b128 v[40:43], v0 offset:23552
    s_waitcnt lgkmcnt(4)
    v_mfma_f32_16x16x32_bf16 v[16:19], v[68:71], v[52:55], v[16:19]
    ds_read_b64_tr_b16 v[60:61], v7 offset:4096
    ds_read_b64_tr_b16 v[62:63], v7 offset:4352
    v_mfma_f32_16x16x32_bf16 v[16:19], v[72:75], v[56:59], v[16:19]
    ds_read_b64_tr_b16 v[64:65], v7 offset:4608
    ds_read_b64_tr_b16 v[66:67], v7 offset:4864
    s_waitcnt lgkmcnt(6)
    v_mfma_f32_16x16x32_bf16 v[20:23], v[28:31], v[44:47], 0
    ds_read_b64_tr_b16 v[68:69], v7 offset:5120
    ds_read_b64_tr_b16 v[70:71], v7 offset:5376
    v_mfma_f32_16x16x32_bf16 v[20:23], v[32:35], v[48:51], v[20:23]
    ds_read_b64_tr_b16 v[72:73], v7 offset:5632
    ds_read_b64_tr_b16 v[74:75], v7 offset:5888
    s_waitcnt lgkmcnt(8)
    v_mfma_f32_16x16x32_bf16 v[20:23], v[36:39], v[52:55], v[20:23]
    v_cvt_pk_bf16_f32 v76, v24, v25
    v_cvt_pk_bf16_f32 v77, v26, v27
    v_mfma_f32_16x16x32_bf16 v[20:23], v[40:43], v[56:59], v[20:23]
    ds_read_b128 v[28:31], v9 offset:24576
    ds_read_b128 v[32:35], v9 offset:25600
    s_waitcnt lgkmcnt(6)
    v_mfma_f32_16x16x32_bf16 v[40:43], v[60:63], v[44:47], 0
    v_exp_f32_e64 v16, v16
    v_mfma_f32_16x16x32_bf16 v[40:43], v[64:67], v[48:51], v[40:43]
    v_exp_f32 v17, v17
    s_waitcnt lgkmcnt(2)
    v_mfma_f32_16x16x32_bf16 v[40:43], v[68:71], v[52:55], v[40:43]
    v_exp_f32_e64 v18, v18
    v_mfma_f32_16x16x32_bf16 v[40:43], v[72:75], v[56:59], v[40:43]
    v_exp_f32 v19, v19
    v_exp_f32 v20, v20
    v_exp_f32 v21, v21
    v_exp_f32 v22, v22
    v_exp_f32_e64 v23, v23
    v_cvt_pk_bf16_f32 v16, v16, v17
    v_cvt_pk_bf16_f32 v17, v18, v19
    v_cvt_pk_bf16_f32 v18, v20, v21
    v_cvt_pk_bf16_f32 v19, v22, v23
    v_exp_f32 v40, v40
    s_waitcnt lgkmcnt(0)
    v_mfma_f32_16x16x32_bf16 v[60:63], v[28:31], v[16:19], 0
    v_exp_f32_e64 v41, v41
    v_mfma_f32_16x16x32_bf16 v[64:67], v[32:35], v[16:19], 0
    v_exp_f32_e64 v42, v42
    v_mfma_f32_16x16x32_bf16 v[68:71], v[12:15], v[16:19], 0
    v_exp_f32_e64 v43, v43
    v_cndmask_b32 v24, 0, v76, s[64:65]
    v_cvt_pk_bf16_f32 v40, v40, v41
    v_cvt_pk_bf16_f32 v41, v42, v43
sm_back_62:
    v_cndmask_b32 v42, 0, v40, s[64:65]
    v_cndmask_b32 v43, 0, v41, s[64:65]
    v_cndmask_b32 v25, 0, v77, s[64:65]
    v_cndmask_b32 v26, 0, v76, s[66:67]
    v_mfma_f32_16x16x16_bf16 v[68:71], v[12:13], v[42:43], v[68:71]
    v_cndmask_b32 v27, 0, v77, s[66:67]
    v_mfma_f32_16x16x16_bf16 v[60:63], v[24:25], v[40:41], v[60:63]
    v_add_u32_e64 v20, s50, v0
    v_mfma_f32_16x16x16_bf16 v[64:67], v[26:27], v[40:41], v[64:67]
    v_mov_b64 v[16:17], 0
    v_mov_b64 v[18:19], 0
    v_mov_b64 v[22:23], 0
    s_nop 0
    v_rcp_f32 v70, v68
    s_nop 0
    v_max_f32_e64 v69, v68, v70
    v_pk_mul_f32 v[60:61], v[60:61], v[70:71] op_sel_hi:[1,0]
    v_pk_mul_f32 v[62:63], v[62:63], v[70:71] op_sel_hi:[1,0]
    v_pk_mul_f32 v[64:65], v[64:65], v[70:71] op_sel_hi:[1,0]
    v_pk_mul_f32 v[66:67], v[66:67], v[70:71] op_sel_hi:[1,0]
    v_cvt_pk_bf16_f32 v36, v60, v61
    v_cvt_pk_bf16_f32 v37, v62, v63
    v_cvt_pk_bf16_f32 v38, v64, v65
    v_cvt_pk_bf16_f32 v39, v66, v67
    v_cmp_nge_f32 vcc, s92, v69
    s_mov_b64 exec, s[62:63]
    ds_write_b128 v20, v[36:39] offset:9216
    s_mov_b64 exec, -1
    s_cbranch_vccnz sm_slow_61
sm_ok_63:
    s_cmp_eq_u32 s40, 63
    s_cbranch_scc1 fin_64
    s_add_u32 m0, s93, 8192
    s_add_u32 s55, s49, 8192
    buffer_load_dwordx4 v0, s[8:11], s55 offen offset:0 sc1 lds
    buffer_load_dwordx4 v0, s[8:11], s55 offen offset:1024 sc1 lds
    ds_read_b128 v[44:47], v10 offset:49152
    ds_read_b128 v[48:51], v10 offset:50176
    s_waitcnt lgkmcnt(2)
    s_barrier
    ds_read_b128 v[28:31], v0 offset:9216
    ds_read_b128 v[32:35], v1 offset:9216
    ds_read_b128 v[36:39], v0 offset:11264
    ds_read_b128 v[40:43], v1 offset:11264
    ds_read_b128 v[52:55], v10 offset:57344
    ds_read_b128 v[56:59], v10 offset:58368
    v_mov_b64 v[20:21], 0
    s_mov_b32 m0, s93
    s_nop 0
    buffer_load_dwordx4 v0, s[8:11], s49 offen offset:0 sc1 lds
    buffer_load_dwordx4 v0, s[8:11], s49 offen offset:1024 sc1 lds
    s_add_u32 s51, s51, 4096
    s_xor_b32 s51, s51, 0x40000000
    s_mov_b32 s101, 0
    s_waitcnt lgkmcnt(5)
    v_smfmac_f32_16x16x64_bf16 v[16:19], v[28:31], v[44:51], v2
    ds_read_b128 v[60:63], v11 offset:0
    v_smfmac_f32_16x16x64_bf16 v[20:23], v[28:31], v[208:215], v2
    ds_read_b128 v[64:67], v11 offset:1024
    s_waitcnt lgkmcnt(6)
    v_smfmac_f32_16x16x64_bf16 v[20:23], v[32:35], v[216:223], v2
    ds_read_b128 v[68:71], v11 offset:8192
    s_waitcnt lgkmcnt(3)
    v_smfmac_f32_16x16x64_bf16 v[16:19], v[32:35], v[52:59], v2
    ds_read_b128 v[72:75], v11 offset:9216
    v_smfmac_f32_16x16x64_bf16 v[20:23], v[36:39], v[240:247], v2
    ds_read_b128 v[44:47], v11 offset:16384
    v_mov_b64 v[24:25], 0
    v_smfmac_f32_16x16x64_bf16 v[20:23], v[40:43], v[248:255], v2
    ds_read_b128 v[48:51], v11 offset:17408
    v_mov_b64 v[26:27], 0
    s_waitcnt lgkmcnt(4)
    v_smfmac_f32_16x16x64_bf16 v[16:19], v[36:39], v[60:67], v2
    ds_read_b128 v[52:55], v11 offset:24576
    s_waitcnt lgkmcnt(3)
    v_smfmac_f32_16x16x64_bf16 v[16:19], v[40:43], v[68:75], v2
    ds_read_b128 v[56:59], v11 offset:25600
    v_smfmac_f32_16x16x64_bf16 v[24:27], v[28:31], v[224:231], v2
    v_cvt_pk_bf16_f32 v20, v20, v21
    v_smfmac_f32_16x16x64_bf16 v[24:27], v[32:35], v[232:239], v2
    v_cvt_pk_bf16_f32 v21, v22, v23
    s_waitcnt lgkmcnt(2)
    v_smfmac_f32_16x16x64_bf16 v[24:27], v[36:39], v[44:51], v2
    v_cvt_pk_bf16_f32 v19, v18, v19
    s_waitcnt lgkmcnt(0)
    v_smfmac_f32_16x16x64_bf16 v[24:27], v[40:43], v[52:59], v2
    v_cvt_pk_bf16_f32 v18, v16, v17
    v_and_or_b32 v20, v20, -2, s4
    v_and_or_b32 v18, v18, -2, s4
    buffer_store_dwordx4 v[18:21], v4, s[8:11], s41 offen
    s_nop 1
    v_cvt_pk_bf16_f32 v24, v24, v25
    v_cvt_pk_bf16_f32 v25, v26, v27
    v_and_or_b32 v24, v24, -2, s4
    buffer_store_dwordx2 v[24:25], v5, s[8:11], s41 offen
    ds_read_b128 v[60:63], v0 offset:0
    s_sleep 4
    buffer_load_dwordx4 v[28:31], v0, s[8:11], s42 offen offset:0 sc1
    buffer_load_dwordx4 v[32:35], v0, s[8:11], s42 offen offset:1024 sc1
    buffer_load_dwordx4 v[36:39], v0, s[8:11], s42 offen offset:2048 sc1
    buffer_load_dwordx4 v[40:43], v0, s[8:11], s42 offen offset:3072 sc1
    s_sleep 2
    buffer_load_dwordx4 v[28:31], v0, s[8:11], s42 offen offset:0 sc1
    buffer_load_dwordx4 v[32:35], v0, s[8:11], s42 offen offset:1024 sc1
    buffer_load_dwordx4 v[36:39], v0, s[8:11], s42 offen offset:2048 sc1
    buffer_load_dwordx4 v[40:43], v0, s[8:11], s42 offen offset:3072 sc1
    s_waitcnt lgkmcnt(0)
ra_check_65:
    s_waitcnt vmcnt(7)
    v_bitop3_b32 v16, v28, v30, s5 bitop3:0x7e
    v_mfma_f32_16x16x32_bf16 v[68:71], v[28:31], v[60:63], 0
    s_waitcnt vmcnt(6)
    v_bitop3_b32 v17, v32, v34, s5 bitop3:0x7e
    v_or_b32_e64 v16, v16, v17
    v_mfma_f32_16x16x32_bf16 v[68:71], v[32:35], v[60:63], v[68:71]
    s_waitcnt vmcnt(5)
    v_bitop3_b32 v17, v36, v38, s5 bitop3:0x7e
    v_or_b32 v16, v16, v17
    v_lshlrev_b32_e64 v16, 31, v16
    v_mfma_f32_16x16x32_bf16 v[68:71], v[36:39], v[60:63], v[68:71]
    s_waitcnt vmcnt(4)
    v_bitop3_b32 v17, v40, v42, s5 bitop3:0x7e
    v_lshl_or_b32 v16, v17, 31, v16
    v_mfma_f32_16x16x32_bf16 v[68:71], v[40:43], v[60:63], v[68:71]
    v_cmp_gt_i32 vcc, 0, v16
    s_nop 0
    s_cbranch_vccnz ra_stub_66
ra_cont_67:
    s_nop 0
    v_permlane32_swap_b32 v68, v70
    v_permlane32_swap_b32 v69, v71
    v_pk_add_f32 v[68:69], v[68:69], v[70:71]
    v_cvt_pk_bf16_f32 v20, v68, v69
    s_mov_b64 exec, s[60:61]
    buffer_store_dword v20, v8, s[8:11], s45 offen
    s_mov_b64 exec, -1
    s_branch rec_top_Sl
kv_stub_54:
    v_lshrrev_b32 v46, 2, v0
    v_min_u32 v46, 64, v46
kvf_68:
    buffer_load_dword v47, v46, s[8:11], s3 offen sc1
    s_waitcnt vmcnt(0)
    v_cmp_gt_u32 vcc, 2, v47
    s_nop 0
    s_ff1_i32_b64 s7, vcc
    s_lshl_b32 s7, s7, 2
    s_cmp_eq_u32 s7, 64
    s_cselect_b32 s7, 128, s7
    s_add_u32 s54, s40, 2
    s_cmp_lt_u32 s54, s7
    s_cbranch_scc1 kvd_69
    s_sleep 2
    s_sub_u32 s53, s53, 1
    s_cbranch_scc0 kvf_68
    s_mov_b32 s53, 0
    s_mov_b32 s7, 128
kvd_69:
    s_branch kv_cont_55
pl_stub_57:
    s_mov_b32 s89, 1
    s_sub_u32 s53, s53, 1
    s_cbranch_scc1 giveup_70
    s_mov_b64 exec, vcc
    buffer_load_dwordx4 v[44:47], v3, s[8:11], s43 offen offset:0 sc1
    buffer_load_dwordx4 v[48:51], v3, s[8:11], s43 offen offset:1024 sc1
    s_mov_b64 exec, -1
    s_branch pl_check_56
giveup_70:
    s_mov_b32 s53, 0
    s_branch pl_cont_58
rem_stub_59:
    s_sub_u32 s53, s53, 1
    s_cbranch_scc1 rem_give_72
    s_sleep 3
    buffer_load_dwordx4 v[52:55], v3, s[8:11], s44 offen sc1
    s_waitcnt vmcnt(0)
    ds_write_b128 v9, v[52:55] offset:8192
    s_waitcnt lgkmcnt(0)
    v_max3_u32 v52, v52, v53, v54
    v_max_u32 v52, v52, v55
    v_cmp_eq_u32 vcc, -1, v52
    s_nop 0
    s_cbranch_vccnz rem_stub_59
    s_branch rem_cont_60
rem_give_72:
    s_mov_b32 s53, 0
    s_branch rem_cont_60
sm_slow_61:
    s_cmp_lg_u32 s101, 0
    s_cbranch_scc1 sm_ok_63
    s_mov_b32 s101, 1
    s_waitcnt lgkmcnt(0)
    ds_read_b128 v[68:71], v0 offset:16384
    s_waitcnt lgkmcnt(0)
    v_mfma_f32_16x16x32_bf16 v[16:19], v[68:71], v[44:47], 0
    s_nop 3
    ds_read_b128 v[68:71], v0 offset:17408
    s_waitcnt lgkmcnt(0)
    v_mfma_f32_16x16x32_bf16 v[16:19], v[68:71], v[48:51], v[16:19]
    s_nop 3
    ds_read_b128 v[68:71], v0 offset:18432
    s_waitcnt lgkmcnt(0)
    v_mfma_f32_16x16x32_bf16 v[16:19], v[68:71], v[52:55], v[16:19]
    s_nop 3
    ds_read_b128 v[68:71], v0 offset:19456
    s_waitcnt lgkmcnt(0)
    v_mfma_f32_16x16x32_bf16 v[16:19], v[68:71], v[56:59], v[16:19]
    s_nop 3
    ds_read_b128 v[68:71], v0 offset:20480
    s_waitcnt lgkmcnt(0)
    v_mfma_f32_16x16x32_bf16 v[20:23], v[68:71], v[44:47], 0
    s_nop 3
    ds_read_b128 v[68:71], v0 offset:21504
    s_waitcnt lgkmcnt(0)
    v_mfma_f32_16x16x32_bf16 v[20:23], v[68:71], v[48:51], v[20:23]
    s_nop 3
    ds_read_b128 v[68:71], v0 offset:22528
    s_waitcnt lgkmcnt(0)
    v_mfma_f32_16x16x32_bf16 v[20:23], v[68:71], v[52:55], v[20:23]
    s_nop 3
    ds_read_b128 v[68:71], v0 offset:23552
    s_waitcnt lgkmcnt(0)
    v_mfma_f32_16x16x32_bf16 v[20:23], v[68:71], v[56:59], v[20:23]
    s_nop 3
    ds_read_b64_tr_b16 v[68:69], v7 offset:4096
    ds_read_b64_tr_b16 v[70:71], v7 offset:4352
    s_waitcnt lgkmcnt(0)
    v_mfma_f32_16x16x32_bf16 v[40:43], v[68:71], v[44:47], 0
    s_nop 3
    ds_read_b64_tr_b16 v[68:69], v7 offset:4608
    ds_read_b64_tr_b16 v[70:71], v7 offset:4864
    s_waitcnt lgkmcnt(0)
    v_mfma_f32_16x16x32_bf16 v[40:43], v[68:71], v[48:51], v[40:43]
    s_nop 3
    ds_read_b64_tr_b16 v[68:69], v7 offset:5120
    ds_read_b64_tr_b16 v[70:71], v7 offset:5376
    s_waitcnt lgkmcnt(0)
    v_mfma_f32_16x16x32_bf16 v[40:43], v[68:71], v[52:55], v[40:43]
    s_nop 3
    ds_read_b64_tr_b16 v[68:69], v7 offset:5632
    ds_read_b64_tr_b16 v[70:71], v7 offset:5888
    s_waitcnt lgkmcnt(0)
    v_mfma_f32_16x16x32_bf16 v[40:43], v[68:71], v[56:59], v[40:43]
    s_nop 3
    v_max3_f32 v68, v16, v17, v18
    v_max3_f32 v68, v68, v19, v20
    v_max3_f32 v68, v68, v21, v22
    s_nop 0
    v_max3_f32 v68, v68, v23, v40
    v_max3_f32 v68, v68, v41, v42
    v_max_f32 v68, v68, v43
    v_mov_b32 v69, v68
    s_nop 1
    v_permlane16_swap_b32 v68, v69
    v_max_f32 v68, v68, v69
    v_mov_b32 v69, v68
    s_nop 1
    v_permlane32_swap_b32 v68, v69
    v_max_f32 v68, v68, v69
    v_sub_f32 v16, v16, v68
    v_sub_f32 v17, v17, v68
    v_sub_f32 v18, v18, v68
    v_sub_f32 v19, v19, v68
    v_sub_f32 v20, v20, v68
    v_sub_f32 v21, v21, v68
    v_sub_f32 v22, v22, v68
    v_sub_f32 v23, v23, v68
    v_sub_f32 v40, v40, v68
    v_sub_f32 v41, v41, v68
    v_sub_f32 v42, v42, v68
    v_sub_f32 v43, v43, v68
    v_exp_f32 v16, v16
    v_exp_f32 v17, v17
    v_exp_f32 v18, v18
    v_exp_f32 v19, v19
    v_exp_f32 v20, v20
    v_exp_f32 v21, v21
    v_exp_f32 v22, v22
    v_exp_f32 v23, v23
    v_exp_f32 v40, v40
    v_exp_f32 v41, v41
    v_exp_f32 v42, v42
    v_exp_f32 v43, v43
    v_cvt_pk_bf16_f32 v16, v16, v17
    v_cvt_pk_bf16_f32 v17, v18, v19
    v_cvt_pk_bf16_f32 v18, v20, v21
    v_cvt_pk_bf16_f32 v19, v22, v23
    v_cvt_pk_bf16_f32 v40, v40, v41
    v_cvt_pk_bf16_f32 v41, v42, v43
    v_mfma_f32_16x16x32_bf16 v[60:63], v[28:31], v[16:19], 0
    v_mfma_f32_16x16x32_bf16 v[64:67], v[32:35], v[16:19], 0
    v_mfma_f32_16x16x32_bf16 v[68:71], v[12:15], v[16:19], 0
    s_nop 7
    s_branch sm_back_62
fin_64:
    buffer_store_dwordx4 v[76:79], v0, s[8:11], s51 offen sc1
    s_branch main_end0
ra_stub_66:
    s_mov_b32 s88, 1
    s_sub_u32 s53, s53, 1
    s_cbranch_scc1 giveup_73
    s_mov_b64 exec, vcc
    buffer_load_dwordx4 v[28:31], v0, s[8:11], s42 offen offset:0 sc1
    buffer_load_dwordx4 v[32:35], v0, s[8:11], s42 offen offset:1024 sc1
    buffer_load_dwordx4 v[36:39], v0, s[8:11], s42 offen offset:2048 sc1
    buffer_load_dwordx4 v[40:43], v0, s[8:11], s42 offen offset:3072 sc1
    s_mov_b64 exec, -1
    s_branch ra_check_65
giveup_73:
    s_mov_b32 s53, 0
    s_branch ra_cont_67
globmode_12:
    s_cmp_eq_u32 s36, 0
    s_cbranch_scc1 rec_entry_Eg
    s_cmp_lg_u32 s68, -1
    s_cbranch_scc1 rec_entry_Sg
rec_entry_Pg:
.p2align 3
rec_top_Pg:
    s_add_u32 s40, s40, 1
    ds_read_b128 v[52:55], v9 offset:32768
    ds_read_b128 v[56:59], v9 offset:33792
    ds_read_b128 v[60:63], v9 offset:40960
    ds_read_b128 v[64:67], v9 offset:41984
    ds_read_b128 v[68:71], v9 offset:49152
    ds_read_b128 v[72:75], v9 offset:50176
    v_mov_b64 v[16:17], 0
    v_mov_b64 v[18:19], 0
    v_mov_b64 v[20:21], 0
    v_mov_b64 v[22:23], 0
    v_mov_b64 v[24:25], 0
    v_mov_b64 v[26:27], 0
    s_add_u32 s54, s40, 2
    s_cmp_ge_u32 s54, s7
    s_cbranch_scc1 kv_stub_74
kv_cont_75:
    s_barrier
    s_sleep 3
    buffer_load_dwordx4 v[44:47], v3, s[8:11], s43 offen offset:0 sc1
    buffer_load_dwordx4 v[48:51], v3, s[8:11], s43 offen offset:1024 sc1
    s_sleep 2
    buffer_load_dwordx4 v[44:47], v3, s[8:11], s43 offen offset:0 sc1
    buffer_load_dwordx4 v[48:51], v3, s[8:11], s43 offen offset:1024 sc1
pl_check_76:
    s_waitcnt vmcnt(2)
    v_max3_u32 v40, v44, v45, v46
    v_max3_u32 v40, v40, v47, v48
    v_max3_u32 v40, v40, v49, v50
    v_max_u32 v40, v40, v51
    ds_write_b128 v9, v[44:47] offset:0
    ds_write_b128 v9, v[48:51] offset:1024
    v_cmp_eq_u32 vcc, -1, v40
    s_nop 0
    s_cbranch_vccnz pl_stub_77
pl_cont_78:
    s_waitcnt lgkmcnt(0)
    s_barrier
    ds_read_b128 v[28:31], v0 offset:2048
    ds_read_b128 v[32:35], v1 offset:2048
    ds_read_b128 v[36:39], v0 offset:3072
    ds_read_b128 v[40:43], v1 offset:3072
    s_add_u32 m0, s93, -8192
    s_nop 0
    buffer_load_dwordx4 v3, s[8:11], s44 offen sc1 lds
    s_waitcnt lgkmcnt(3)
    v_smfmac_f32_16x16x64_bf16 v[16:19], v[28:31], a[0:7], v2
    v_smfmac_f32_16x16x64_bf16 v[20:23], v[28:31], a[160:167], v2
    buffer_load_dwordx4 v[44:47], v0, s[8:11], s52 offen offset:0
    v_smfmac_f32_16x16x64_bf16 v[24:27], v[28:31], v[52:59], v2
    ds_read_b128 v[52:55], v9 offset:57344
    s_waitcnt lgkmcnt(3)
    v_smfmac_f32_16x16x64_bf16 v[16:19], v[32:35], a[8:15], v2
    ds_read_b128 v[56:59], v9 offset:58368
    v_smfmac_f32_16x16x64_bf16 v[20:23], v[32:35], a[168:175], v2
    ds_read_b128 v[28:31], v0 offset:4096
    buffer_load_dwordx4 v[48:51], v0, s[8:11], s52 offen offset:1024
    v_smfmac_f32_16x16x64_bf16 v[24:27], v[32:35], v[60:67], v2
    ds_read_b128 v[60:63], v10 offset:0
    s_waitcnt lgkmcnt(5)
    v_smfmac_f32_16x16x64_bf16 v[16:19], v[36:39], a[16:23], v2
    ds_read_b128 v[64:67], v10 offset:1024
    v_smfmac_f32_16x16x64_bf16 v[20:23], v[36:39], a[176:183], v2
    ds_read_b128 v[32:35], v1 offset:4096
    v_smfmac_f32_16x16x64_bf16 v[24:27], v[36:39], v[68:75], v2
    ds_read_b128 v[68:71], v10 offset:8192
    s_waitcnt lgkmcnt(7)
    v_smfmac_f32_16x16x64_bf16 v[16:19], v[40:43], a[24:31], v2
    ds_read_b128 v[72:75], v10 offset:9216
    v_smfmac_f32_16x16x64_bf16 v[20:23], v[40:43], a[184:191], v2
    ds_read_b128 v[36:39], v0 offset:5120
    s_waitcnt lgkmcnt(7)
    v_smfmac_f32_16x16x64_bf16 v[24:27], v[40:43], v[52:59], v2
    ds_read_b128 v[52:55], v10 offset:16384
    s_waitcnt lgkmcnt(7)
    v_smfmac_f32_16x16x64_bf16 v[16:19], v[28:31], a[32:39], v2
    ds_read_b128 v[56:59], v10 offset:17408
    v_smfmac_f32_16x16x64_bf16 v[20:23], v[28:31], a[192:199], v2
    ds_read_b128 v[40:43], v1 offset:5120
    s_waitcnt lgkmcnt(7)
    v_smfmac_f32_16x16x64_bf16 v[24:27], v[28:31], v[60:67], v2
    ds_read_b128 v[60:63], v10 offset:24576
    s_waitcnt lgkmcnt(7)
    v_smfmac_f32_16x16x64_bf16 v[16:19], v[32:35], a[40:47], v2
    ds_read_b128 v[64:67], v10 offset:25600
    v_smfmac_f32_16x16x64_bf16 v[20:23], v[32:35], a[200:207], v2
    ds_read_b128 v[28:31], v0 offset:6144
    s_waitcnt lgkmcnt(7)
    v_smfmac_f32_16x16x64_bf16 v[24:27], v[32:35], v[68:75], v2
    ds_read_b128 v[68:71], v10 offset:32768
    s_waitcnt lgkmcnt(7)
    v_smfmac_f32_16x16x64_bf16 v[16:19], v[36:39], a[48:55], v2
    ds_read_b128 v[72:75], v10 offset:33792
    v_smfmac_f32_16x16x64_bf16 v[20:23], v[36:39], a[208:215], v2
    ds_read_b128 v[32:35], v1 offset:6144
    s_waitcnt lgkmcnt(7)
    v_smfmac_f32_16x16x64_bf16 v[24:27], v[36:39], v[52:59], v2
    s_waitcnt vmcnt(2)
    ds_read_b128 v[52:55], v9 offset:8192
    s_waitcnt lgkmcnt(7)
    v_smfmac_f32_16x16x64_bf16 v[16:19], v[40:43], a[56:63], v2
    buffer_load_dwordx4 v[56:59], v0, s[8:11], s52 offen offset:3072
    v_smfmac_f32_16x16x64_bf16 v[20:23], v[40:43], a[216:223], v2
    ds_read_b128 v[36:39], v0 offset:7168
    s_waitcnt lgkmcnt(6)
    v_smfmac_f32_16x16x64_bf16 v[24:27], v[40:43], v[60:67], v2
    ds_read_b128 v[60:63], v10 offset:40960
    s_waitcnt lgkmcnt(6)
    v_smfmac_f32_16x16x64_bf16 v[16:19], v[28:31], a[64:71], v2
    ds_read_b128 v[64:67], v10 offset:41984
    s_waitcnt lgkmcnt(3)
    v_max3_u32 v52, v52, v53, v54
    v_smfmac_f32_16x16x64_bf16 v[20:23], v[28:31], a[224:231], v2
    ds_read_b128 v[40:43], v1 offset:7168
    v_max_u32 v52, v52, v55
    v_smfmac_f32_16x16x64_bf16 v[24:27], v[28:31], v[68:75], v2
    v_cmp_eq_u32 vcc, -1, v52
    v_smfmac_f32_16x16x64_bf16 v[16:19], v[32:35], a[72:79], v2
    s_cbranch_vccnz rem_stub_79
rem_cont_80:
    v_smfmac_f32_16x16x64_bf16 v[20:23], v[32:35], a[232:239], v2
    buffer_load_dwordx4 v[52:55], v0, s[8:11], s52 offen offset:2048
    s_waitcnt lgkmcnt(1)
    v_smfmac_f32_16x16x64_bf16 v[24:27], v[32:35], v[60:67], v2
    s_barrier
    ds_read_b128 v[60:63], v0 offset:8192
    v_smfmac_f32_16x16x64_bf16 v[16:19], v[36:39], a[80:87], v2
    buffer_store_dwordx4 v[76:79], v0, s[8:11], s59 offen sc1
    s_mov_b32 s59, s51
    ds_read_b128 v[64:67], v1 offset:8192
    v_smfmac_f32_16x16x64_bf16 v[20:23], v[36:39], a[240:247], v2
    s_add_u32 s100, s49, s93
    s_add_u32 s100, s100, 16384
    ds_read_b128 v[68:71], v0 offset:10240
    v_smfmac_f32_16x16x64_bf16 v[24:27], v[36:39], v[128:135], v2
    v_lshlrev_b32 v76, 3, v0
    s_mov_b32 m0, 13312
    ds_read_b128 v[72:75], v1 offset:10240
    s_waitcnt lgkmcnt(4)
    v_smfmac_f32_16x16x64_bf16 v[16:19], v[40:43], a[88:95], v2
    s_mov_b64 exec, s[64:65]
    buffer_load_dword v76, s[8:11], s100 offen sc1 lds
    s_mov_b64 exec, -1
    ds_read_b128 v[28:31], v0 offset:12288
    v_smfmac_f32_16x16x64_bf16 v[20:23], v[40:43], a[248:255], v2
    ds_read_b128 v[32:35], v1 offset:12288
    v_smfmac_f32_16x16x64_bf16 v[24:27], v[40:43], v[136:143], v2
    ds_read_b128 v[36:39], v0 offset:14336
    s_waitcnt lgkmcnt(6)
    v_smfmac_f32_16x16x64_bf16 v[16:19], v[60:63], a[96:103], v2
    s_add_u32 s100, s49, 32768
    ds_read_b128 v[40:43], v1 offset:14336
    s_waitcnt lgkmcnt(6)
    v_smfmac_f32_16x16x64_bf16 v[16:19], v[64:67], a[104:111], v2
    s_mov_b32 m0, 13312
    s_waitcnt lgkmcnt(5)
    v_smfmac_f32_16x16x64_bf16 v[16:19], v[68:71], a[112:119], v2
    s_and_b32 s4, s40, 1
    s_waitcnt lgkmcnt(4)
    v_smfmac_f32_16x16x64_bf16 v[16:19], v[72:75], a[120:127], v2
    s_sub_u32 s5, 0, s4
    s_waitcnt lgkmcnt(3)
    v_smfmac_f32_16x16x64_bf16 v[16:19], v[28:31], a[128:135], v2
    s_add_u32 s54, s40, 1
    s_waitcnt lgkmcnt(2)
    v_smfmac_f32_16x16x64_bf16 v[16:19], v[32:35], a[136:143], v2
    s_and_b32 s54, s54, 3
    s_waitcnt lgkmcnt(1)
    v_smfmac_f32_16x16x64_bf16 v[16:19], v[36:39], a[144:151], v2
    s_lshl_b32 s54, s54, 15
    s_waitcnt lgkmcnt(0)
    v_smfmac_f32_16x16x64_bf16 v[16:19], v[40:43], a[152:159], v2
    s_add_u32 s43, s54, s96
    v_smfmac_f32_16x16x64_bf16 v[20:23], v[60:63], v[80:87], v2
    s_add_u32 s44, s54, s97
    v_smfmac_f32_16x16x64_bf16 v[20:23], v[64:67], v[88:95], v2
    s_add_u32 s45, s54, s98
    v_mul_f32 v16, s58, v16
    v_smfmac_f32_16x16x64_bf16 v[20:23], v[68:71], v[96:103], v2
    s_add_u32 s46, s54, s99
    v_mul_f32 v17, s58, v17
    v_smfmac_f32_16x16x64_bf16 v[20:23], v[72:75], v[104:111], v2
    s_xor_b32 s47, s45, 0x10000
    v_mul_f32 v18, s58, v18
    v_smfmac_f32_16x16x64_bf16 v[20:23], v[28:31], v[112:119], v2
    s_xor_b32 s48, s46, 0x10000
    v_mul_f32 v19, s58, v19
    v_smfmac_f32_16x16x64_bf16 v[20:23], v[32:35], v[120:127], v2
    s_add_u32 s49, s49, 16384
    v_cvt_pk_bf16_f32 v76, v16, v17
    s_waitcnt vmcnt(2)
    v_smfmac_f32_16x16x64_bf16 v[20:23], v[36:39], v[44:51], v2
    v_cvt_pk_bf16_f32 v77, v18, v19
    v_smfmac_f32_16x16x64_bf16 v[20:23], v[40:43], v[52:59], v2
    ds_write_b64 v6, v[76:77] offset:2048
    v_smfmac_f32_16x16x64_bf16 v[24:27], v[60:63], v[144:151], v2
    v_smfmac_f32_16x16x64_bf16 v[24:27], v[64:67], v[152:159], v2
    v_cvt_pk_bf16_f32 v78, v20, v21
    v_cvt_pk_bf16_f32 v79, v22, v23
    ds_write_b64 v6, v[78:79] offset:4096
    v_smfmac_f32_16x16x64_bf16 v[24:27], v[68:71], v[160:167], v2
    ds_read_b128 v[60:63], v0 offset:16384
    v_smfmac_f32_16x16x64_bf16 v[24:27], v[72:75], v[168:175], v2
    ds_read_b128 v[64:67], v0 offset:17408
    v_smfmac_f32_16x16x64_bf16 v[24:27], v[28:31], v[176:183], v2
    ds_read_b128 v[68:71], v0 offset:18432
    v_smfmac_f32_16x16x64_bf16 v[24:27], v[32:35], v[184:191], v2
    ds_read_b128 v[72:75], v0 offset:19456
    s_waitcnt lgkmcnt(4)
    s_barrier
    ds_read_b64_tr_b16 v[44:45], v7 offset:2048
    ds_read_b64_tr_b16 v[46:47], v7 offset:2304
    ds_read_b64_tr_b16 v[48:49], v7 offset:2560
    ds_read_b64_tr_b16 v[50:51], v7 offset:2816
    ds_read_b64_tr_b16 v[52:53], v7 offset:3072
    ds_read_b64_tr_b16 v[54:55], v7 offset:3328
    v_smfmac_f32_16x16x64_bf16 v[24:27], v[36:39], v[192:199], v2
    ds_read_b64_tr_b16 v[56:57], v7 offset:3584
    ds_read_b64_tr_b16 v[58:59], v7 offset:3840
    v_smfmac_f32_16x16x64_bf16 v[24:27], v[40:43], v[200:207], v2
    s_waitcnt lgkmcnt(4)
    v_mfma_f32_16x16x32_bf16 v[16:19], v[60:63], v[44:47], 0
    ds_read_b128 v[28:31], v0 offset:20480
    ds_read_b128 v[32:35], v0 offset:21504
    v_mfma_f32_16x16x32_bf16 v[16:19], v[64:67], v[48:51], v[16:19]
    ds_read_b128 v[36:39], v0 offset:22528
    ds_read_b128 v[40:43], v0 offset:23552
    s_waitcnt lgkmcnt(4)
    v_mfma_f32_16x16x32_bf16 v[16:19], v[68:71], v[52:55], v[16:19]
    ds_read_b64_tr_b16 v[60:61], v7 offset:4096
    ds_read_b64_tr_b16 v[62:63], v7 offset:4352
    v_mfma_f32_16x16x32_bf16 v[16:19], v[72:75], v[56:59], v[16:19]
    ds_read_b64_tr_b16 v[64:65], v7 offset:4608
    ds_read_b64_tr_b16 v[66:67], v7 offset:4864
    s_waitcnt lgkmcnt(6)
    v_mfma_f32_16x16x32_bf16 v[20:23], v[28:31], v[44:47], 0
    ds_read_b64_tr_b16 v[68:69], v7 offset:5120
    ds_read_b64_tr_b16 v[70:71], v7 offset:5376
    v_mfma_f32_16x16x32_bf16 v[20:23], v[32:35], v[48:51], v[20:23]
    ds_read_b64_tr_b16 v[72:73], v7 offset:5632
    ds_read_b64_tr_b16 v[74:75], v7 offset:5888
    s_waitcnt lgkmcnt(8)
    v_mfma_f32_16x16x32_bf16 v[20:23], v[36:39], v[52:55], v[20:23]
    v_cvt_pk_bf16_f32 v76, v24, v25
    v_cvt_pk_bf16_f32 v77, v26, v27
    v_mfma_f32_16x16x32_bf16 v[20:23], v[40:43], v[56:59], v[20:23]
    ds_read_b128 v[28:31], v9 offset:24576
    ds_read_b128 v[32:35], v9 offset:25600
    s_waitcnt lgkmcnt(6)
    v_mfma_f32_16x16x32_bf16 v[40:43], v[60:63], v[44:47], 0
    v_exp_f32 v16, v16
    v_mfma_f32_16x16x32_bf16 v[40:43], v[64:67], v[48:51], v[40:43]
    v_exp_f32 v17, v17
    s_waitcnt lgkmcnt(2)
    v_mfma_f32_16x16x32_bf16 v[40:43], v[68:71], v[52:55], v[40:43]
    v_exp_f32 v18, v18
    v_mfma_f32_16x16x32_bf16 v[40:43], v[72:75], v[56:59], v[40:43]
    v_exp_f32 v19, v19
    v_exp_f32 v20, v20
    v_exp_f32 v21, v21
    v_exp_f32 v22, v22
    v_exp_f32 v23, v23
    v_cvt_pk_bf16_f32 v16, v16, v17
    v_cvt_pk_bf16_f32 v17, v18, v19
    v_cvt_pk_bf16_f32 v18, v20, v21
    v_cvt_pk_bf16_f32 v19, v22, v23
    v_exp_f32 v40, v40
    s_waitcnt lgkmcnt(0)
    v_mfma_f32_16x16x32_bf16 v[60:63], v[28:31], v[16:19], 0
    v_exp_f32 v41, v41
    v_mfma_f32_16x16x32_bf16 v[64:67], v[32:35], v[16:19], 0
    v_exp_f32 v42, v42
    v_mfma_f32_16x16x32_bf16 v[68:71], v[12:15], v[16:19], 0
    v_exp_f32 v43, v43
    v_cndmask_b32 v24, 0, v76, s[64:65]
    v_cvt_pk_bf16_f32 v40, v40, v41
    v_cvt_pk_bf16_f32 v41, v42, v43
sm_back_82:
    v_cndmask_b32 v42, 0, v40, s[64:65]
    v_cndmask_b32 v43, 0, v41, s[64:65]
    v_cndmask_b32 v25, 0, v77, s[64:65]
    v_cndmask_b32 v26, 0, v76, s[66:67]
    v_mfma_f32_16x16x16_bf16 v[68:71], v[12:13], v[42:43], v[68:71]
    v_cndmask_b32 v27, 0, v77, s[66:67]
    v_mfma_f32_16x16x16_bf16 v[60:63], v[24:25], v[40:41], v[60:63]
    v_add_u32 v20, s50, v0
    v_mfma_f32_16x16x16_bf16 v[64:67], v[26:27], v[40:41], v[64:67]
    v_mov_b64 v[16:17], 0
    v_mov_b64 v[18:19], 0
    v_mov_b64 v[22:23], 0
    s_nop 0
    v_rcp_f32 v70, v68
    s_nop 0
    v_max_f32 v69, v68, v70
    v_pk_mul_f32 v[60:61], v[60:61], v[70:71] op_sel_hi:[1,0]
    v_pk_mul_f32 v[62:63], v[62:63], v[70:71] op_sel_hi:[1,0]
    v_pk_mul_f32 v[64:65], v[64:65], v[70:71] op_sel_hi:[1,0]
    v_pk_mul_f32 v[66:67], v[66:67], v[70:71] op_sel_hi:[1,0]
    v_cvt_pk_bf16_f32 v36, v60, v61
    v_cvt_pk_bf16_f32 v37, v62, v63
    v_cvt_pk_bf16_f32 v38, v64, v65
    v_cvt_pk_bf16_f32 v39, v66, v67
    v_cmp_nge_f32 vcc, s92, v69
    s_mov_b64 exec, s[62:63]
    ds_write_b128 v20, v[36:39] offset:9216
    s_mov_b64 exec, -1
    s_cbranch_vccnz sm_slow_81
sm_ok_83:
    s_cmp_eq_u32 s40, 63
    s_cbranch_scc1 fin_84
    s_add_u32 m0, s93, 8192
    s_add_u32 s55, s49, 8192
    buffer_load_dwordx4 v0, s[8:11], s55 offen offset:0 sc1 lds
    buffer_load_dwordx4 v0, s[8:11], s55 offen offset:1024 sc1 lds
    ds_read_b128 v[44:47], v10 offset:49152
    ds_read_b128 v[48:51], v10 offset:50176
    s_waitcnt lgkmcnt(2)
    s_barrier
    ds_read_b128 v[28:31], v0 offset:9216
    ds_read_b128 v[32:35], v1 offset:9216
    ds_read_b128 v[36:39], v0 offset:11264
    ds_read_b128 v[40:43], v1 offset:11264
    ds_read_b128 v[52:55], v10 offset:57344
    ds_read_b128 v[56:59], v10 offset:58368
    v_mov_b64 v[20:21], 0
    s_mov_b32 m0, s93
    s_nop 0
    buffer_load_dwordx4 v0, s[8:11], s49 offen offset:0 sc1 lds
    buffer_load_dwordx4 v0, s[8:11], s49 offen offset:1024 sc1 lds
    s_add_u32 s51, s51, 4096
    s_xor_b32 s51, s51, 0x40000000
    s_mov_b32 s101, 0
    s_waitcnt lgkmcnt(5)
    v_smfmac_f32_16x16x64_bf16 v[16:19], v[28:31], v[44:51], v2
    ds_read_b128 v[60:63], v11 offset:0
    v_smfmac_f32_16x16x64_bf16 v[20:23], v[28:31], v[208:215], v2
    ds_read_b128 v[64:67], v11 offset:1024
    s_waitcnt lgkmcnt(6)
    v_smfmac_f32_16x16x64_bf16 v[20:23], v[32:35], v[216:223], v2
    ds_read_b128 v[68:71], v11 offset:8192
    s_waitcnt lgkmcnt(3)
    v_smfmac_f32_16x16x64_bf16 v[16:19], v[32:35], v[52:59], v2
    ds_read_b128 v[72:75], v11 offset:9216
    v_smfmac_f32_16x16x64_bf16 v[20:23], v[36:39], v[240:247], v2
    ds_read_b128 v[44:47], v11 offset:16384
    v_mov_b64 v[24:25], 0
    v_smfmac_f32_16x16x64_bf16 v[20:23], v[40:43], v[248:255], v2
    ds_read_b128 v[48:51], v11 offset:17408
    v_mov_b64 v[26:27], 0
    s_waitcnt lgkmcnt(4)
    v_smfmac_f32_16x16x64_bf16 v[16:19], v[36:39], v[60:67], v2
    ds_read_b128 v[52:55], v11 offset:24576
    s_waitcnt lgkmcnt(3)
    v_smfmac_f32_16x16x64_bf16 v[16:19], v[40:43], v[68:75], v2
    ds_read_b128 v[56:59], v11 offset:25600
    v_smfmac_f32_16x16x64_bf16 v[24:27], v[28:31], v[224:231], v2
    v_cvt_pk_bf16_f32 v20, v20, v21
    v_smfmac_f32_16x16x64_bf16 v[24:27], v[32:35], v[232:239], v2
    v_cvt_pk_bf16_f32 v21, v22, v23
    s_waitcnt lgkmcnt(2)
    v_smfmac_f32_16x16x64_bf16 v[24:27], v[36:39], v[44:51], v2
    v_cvt_pk_bf16_f32 v19, v18, v19
    s_waitcnt lgkmcnt(0)
    v_smfmac_f32_16x16x64_bf16 v[24:27], v[40:43], v[52:59], v2
    v_cvt_pk_bf16_f32 v18, v16, v17
    v_and_or_b32 v20, v20, -2, s4
    v_and_or_b32 v18, v18, -2, s4
    buffer_store_dwordx4 v[18:21], v4, s[8:11], s41 offen sc1
    s_nop 1
    v_cvt_pk_bf16_f32 v24, v24, v25
    v_cvt_pk_bf16_f32 v25, v26, v27
    v_and_or_b32 v24, v24, -2, s4
    buffer_store_dwordx2 v[24:25], v5, s[8:11], s41 offen sc1
    s_branch rec_top_Pg
kv_stub_74:
    v_lshrrev_b32 v46, 2, v0
    v_min_u32 v46, 64, v46
kvf_85:
    buffer_load_dword v47, v46, s[8:11], s3 offen sc1
    s_waitcnt vmcnt(0)
    v_cmp_gt_u32 vcc, 2, v47
    s_nop 0
    s_ff1_i32_b64 s7, vcc
    s_lshl_b32 s7, s7, 2
    s_cmp_eq_u32 s7, 64
    s_cselect_b32 s7, 128, s7
    s_add_u32 s54, s40, 2
    s_cmp_lt_u32 s54, s7
    s_cbranch_scc1 kvd_86
    s_sleep 2
    s_sub_u32 s53, s53, 1
    s_cbranch_scc0 kvf_85
    s_mov_b32 s53, 0
    s_mov_b32 s7, 128
kvd_86:
    s_branch kv_cont_75
pl_stub_77:
    s_mov_b32 s89, 1
    s_sub_u32 s53, s53, 1
    s_cbranch_scc1 giveup_87
    s_mov_b64 exec, vcc
    buffer_load_dwordx4 v[44:47], v3, s[8:11], s43 offen offset:0 sc1
    buffer_load_dwordx4 v[48:51], v3, s[8:11], s43 offen offset:1024 sc1
    s_mov_b64 exec, -1
    s_branch pl_check_76
giveup_87:
    s_mov_b32 s53, 0
    s_branch pl_cont_78
rem_stub_79:
    s_sub_u32 s53, s53, 1
    s_cbranch_scc1 rem_give_89
    s_sleep 3
    buffer_load_dwordx4 v[52:55], v3, s[8:11], s44 offen sc1
    s_waitcnt vmcnt(0)
    ds_write_b128 v9, v[52:55] offset:8192
    s_waitcnt lgkmcnt(0)
    v_max3_u32 v52, v52, v53, v54
    v_max_u32 v52, v52, v55
    v_cmp_eq_u32 vcc, -1, v52
    s_nop 0
    s_cbranch_vccnz rem_stub_79
    s_branch rem_cont_80
rem_give_89:
    s_mov_b32 s53, 0
    s_branch rem_cont_80
sm_slow_81:
    s_cmp_lg_u32 s101, 0
    s_cbranch_scc1 sm_ok_83
    s_mov_b32 s101, 1
    s_waitcnt lgkmcnt(0)
    ds_read_b128 v[68:71], v0 offset:16384
    s_waitcnt lgkmcnt(0)
    v_mfma_f32_16x16x32_bf16 v[16:19], v[68:71], v[44:47], 0
    s_nop 3
    ds_read_b128 v[68:71], v0 offset:17408
    s_waitcnt lgkmcnt(0)
    v_mfma_f32_16x16x32_bf16 v[16:19], v[68:71], v[48:51], v[16:19]
    s_nop 3
    ds_read_b128 v[68:71], v0 offset:18432
    s_waitcnt lgkmcnt(0)
    v_mfma_f32_16x16x32_bf16 v[16:19], v[68:71], v[52:55], v[16:19]
    s_nop 3
    ds_read_b128 v[68:71], v0 offset:19456
    s_waitcnt lgkmcnt(0)
    v_mfma_f32_16x16x32_bf16 v[16:19], v[68:71], v[56:59], v[16:19]
    s_nop 3
    ds_read_b128 v[68:71], v0 offset:20480
    s_waitcnt lgkmcnt(0)
    v_mfma_f32_16x16x32_bf16 v[20:23], v[68:71], v[44:47], 0
    s_nop 3
    ds_read_b128 v[68:71], v0 offset:21504
    s_waitcnt lgkmcnt(0)
    v_mfma_f32_16x16x32_bf16 v[20:23], v[68:71], v[48:51], v[20:23]
    s_nop 3
    ds_read_b128 v[68:71], v0 offset:22528
    s_waitcnt lgkmcnt(0)
    v_mfma_f32_16x16x32_bf16 v[20:23], v[68:71], v[52:55], v[20:23]
    s_nop 3
    ds_read_b128 v[68:71], v0 offset:23552
    s_waitcnt lgkmcnt(0)
    v_mfma_f32_16x16x32_bf16 v[20:23], v[68:71], v[56:59], v[20:23]
    s_nop 3
    ds_read_b64_tr_b16 v[68:69], v7 offset:4096
    ds_read_b64_tr_b16 v[70:71], v7 offset:4352
    s_waitcnt lgkmcnt(0)
    v_mfma_f32_16x16x32_bf16 v[40:43], v[68:71], v[44:47], 0
    s_nop 3
    ds_read_b64_tr_b16 v[68:69], v7 offset:4608
    ds_read_b64_tr_b16 v[70:71], v7 offset:4864
    s_waitcnt lgkmcnt(0)
    v_mfma_f32_16x16x32_bf16 v[40:43], v[68:71], v[48:51], v[40:43]
    s_nop 3
    ds_read_b64_tr_b16 v[68:69], v7 offset:5120
    ds_read_b64_tr_b16 v[70:71], v7 offset:5376
    s_waitcnt lgkmcnt(0)
    v_mfma_f32_16x16x32_bf16 v[40:43], v[68:71], v[52:55], v[40:43]
    s_nop 3
    ds_read_b64_tr_b16 v[68:69], v7 offset:5632
    ds_read_b64_tr_b16 v[70:71], v7 offset:5888
    s_waitcnt lgkmcnt(0)
    v_mfma_f32_16x16x32_bf16 v[40:43], v[68:71], v[56:59], v[40:43]
    s_nop 3
    v_max3_f32 v68, v16, v17, v18
    v_max3_f32 v68, v68, v19, v20
    v_max3_f32 v68, v68, v21, v22
    s_nop 0
    v_max3_f32 v68, v68, v23, v40
    v_max3_f32 v68, v68, v41, v42
    v_max_f32 v68, v68, v43
    v_mov_b32 v69, v68
    s_nop 1
    v_permlane16_swap_b32 v68, v69
    v_max_f32 v68, v68, v69
    v_mov_b32 v69, v68
    s_nop 1
    v_permlane32_swap_b32 v68, v69
    v_max_f32 v68, v68, v69
    v_sub_f32 v16, v16, v68
    v_sub_f32 v17, v17, v68
    v_sub_f32 v18, v18, v68
    v_sub_f32 v19, v19, v68
    v_sub_f32 v20, v20, v68
    v_sub_f32 v21, v21, v68
    v_sub_f32 v22, v22, v68
    v_sub_f32 v23, v23, v68
    v_sub_f32 v40, v40, v68
    v_sub_f32 v41, v41, v68
    v_sub_f32 v42, v42, v68
    v_sub_f32 v43, v43, v68
    v_exp_f32 v16, v16
    v_exp_f32 v17, v17
    v_exp_f32 v18, v18
    v_exp_f32 v19, v19
    v_exp_f32 v20, v20
    v_exp_f32 v21, v21
    v_exp_f32 v22, v22
    v_exp_f32 v23, v23
    v_exp_f32 v40, v40
    v_exp_f32 v41, v41
    v_exp_f32 v42, v42
    v_exp_f32 v43, v43
    v_cvt_pk_bf16_f32 v16, v16, v17
    v_cvt_pk_bf16_f32 v17, v18, v19
    v_cvt_pk_bf16_f32 v18, v20, v21
    v_cvt_pk_bf16_f32 v19, v22, v23
    v_cvt_pk_bf16_f32 v40, v40, v41
    v_cvt_pk_bf16_f32 v41, v42, v43
    v_mfma_f32_16x16x32_bf16 v[60:63], v[28:31], v[16:19], 0
    v_mfma_f32_16x16x32_bf16 v[64:67], v[32:35], v[16:19], 0
    v_mfma_f32_16x16x32_bf16 v[68:71], v[12:15], v[16:19], 0
    s_nop 7
    s_branch sm_back_82
fin_84:
    buffer_store_dwordx4 v[76:79], v0, s[8:11], s51 offen sc1
    s_branch main_end0
rec_entry_Eg:
    v_mov_b32 v20, v26
    s_mov_b64 exec, s[60:61]
    buffer_store_dword v20, v8, s[8:11], s45 offen sc1
    buffer_store_dword v20, v8, s[8:11], s46 offen sc1
    s_mov_b64 exec, -1
.p2align 3
rec_top_Eg:
    s_add_u32 s40, s40, 1
    s_barrier
    ds_read_b128 v[52:55], v9 offset:32768
    ds_read_b128 v[56:59], v9 offset:33792
    ds_read_b128 v[60:63], v9 offset:40960
    ds_read_b128 v[64:67], v9 offset:41984
    ds_read_b128 v[68:71], v9 offset:49152
    ds_read_b128 v[72:75], v9 offset:50176
    v_mov_b64 v[24:25], -1
    v_mov_b64 v[26:27], -1
    s_waitcnt vmcnt(2)
    v_mov_b32 v44, -1
    v_mov_b64 v[16:17], 0
    v_mov_b64 v[18:19], 0
    v_mov_b64 v[20:21], 0
    v_mov_b64 v[22:23], 0
    s_add_u32 s54, s40, 2
    s_cmp_ge_u32 s54, s7
    s_cbranch_scc1 kv_stub_90
kv_cont_91:
    s_mov_b64 exec, 0xff
    buffer_store_dwordx4 v[24:27], v0, s[8:11], s47 offen sc1
    s_mov_b64 exec, -1
    s_nop 0
    v_mov_b64 v[24:25], 0
    v_mov_b64 v[26:27], 0
    s_waitcnt lgkmcnt(0)
    s_barrier
    ds_read_b128 v[28:31], v0 offset:2048
    ds_read_b128 v[32:35], v1 offset:2048
    ds_read_b128 v[36:39], v0 offset:3072
    ds_read_b128 v[40:43], v1 offset:3072
    s_add_u32 m0, s93, -8192
    s_nop 0
    buffer_load_dwordx4 v3, s[8:11], s44 offen sc1 lds
    s_waitcnt lgkmcnt(3)
    v_smfmac_f32_16x16x64_bf16 v[16:19], v[28:31], a[0:7], v2
    s_mov_b64 exec, s[60:61]
    buffer_store_dword v44, v8, s[8:11], s48 offen sc1
    s_mov_b64 exec, -1
    v_smfmac_f32_16x16x64_bf16 v[20:23], v[28:31], a[160:167], v2
    buffer_load_dwordx4 v[44:47], v0, s[8:11], s52 offen offset:0
    v_smfmac_f32_16x16x64_bf16 v[24:27], v[28:31], v[52:59], v2
    ds_read_b128 v[52:55], v9 offset:57344
    s_waitcnt lgkmcnt(3)
    v_smfmac_f32_16x16x64_bf16 v[16:19], v[32:35], a[8:15], v2
    ds_read_b128 v[56:59], v9 offset:58368
    v_smfmac_f32_16x16x64_bf16 v[20:23], v[32:35], a[168:175], v2
    ds_read_b128 v[28:31], v0 offset:4096
    buffer_load_dwordx4 v[48:51], v0, s[8:11], s52 offen offset:1024
    v_smfmac_f32_16x16x64_bf16 v[24:27], v[32:35], v[60:67], v2
    ds_read_b128 v[60:63], v10 offset:0
    s_waitcnt lgkmcnt(5)
    v_smfmac_f32_16x16x64_bf16 v[16:19], v[36:39], a[16:23], v2
    ds_read_b128 v[64:67], v10 offset:1024
    v_smfmac_f32_16x16x64_bf16 v[20:23], v[36:39], a[176:183], v2
    ds_read_b128 v[32:35], v1 offset:4096
    v_smfmac_f32_16x16x64_bf16 v[24:27], v[36:39], v[68:75], v2
    ds_read_b128 v[68:71], v10 offset:8192
    s_waitcnt lgkmcnt(7)
    v_smfmac_f32_16x16x64_bf16 v[16:19], v[40:43], a[24:31], v2
    ds_read_b128 v[72:75], v10 offset:9216
    v_smfmac_f32_16x16x64_bf16 v[20:23], v[40:43], a[184:191], v2
    ds_read_b128 v[36:39], v0 offset:5120
    s_waitcnt lgkmcnt(7)
    v_smfmac_f32_16x16x64_bf16 v[24:27], v[40:43], v[52:59], v2
    ds_read_b128 v[52:55], v10 offset:16384
    s_waitcnt lgkmcnt(7)
    v_smfmac_f32_16x16x64_bf16 v[16:19], v[28:31], a[32:39], v2
    ds_read_b128 v[56:59], v10 offset:17408
    v_smfmac_f32_16x16x64_bf16 v[20:23], v[28:31], a[192:199], v2
    ds_read_b128 v[40:43], v1 offset:5120
    s_waitcnt lgkmcnt(7)
    v_smfmac_f32_16x16x64_bf16 v[24:27], v[28:31], v[60:67], v2
    ds_read_b128 v[60:63], v10 offset:24576
    s_waitcnt lgkmcnt(7)
    v_smfmac_f32_16x16x64_bf16 v[16:19], v[32:35], a[40:47], v2
    ds_read_b128 v[64:67], v10 offset:25600
    v_smfmac_f32_16x16x64_bf16 v[20:23], v[32:35], a[200:207], v2
    ds_read_b128 v[28:31], v0 offset:6144
    s_waitcnt lgkmcnt(7)
    v_smfmac_f32_16x16x64_bf16 v[24:27], v[32:35], v[68:75], v2
    ds_read_b128 v[68:71], v10 offset:32768
    s_waitcnt lgkmcnt(7)
    v_smfmac_f32_16x16x64_bf16 v[16:19], v[36:39], a[48:55], v2
    ds_read_b128 v[72:75], v10 offset:33792
    v_smfmac_f32_16x16x64_bf16 v[20:23], v[36:39], a[208:215], v2
    ds_read_b128 v[32:35], v1 offset:6144
    s_waitcnt lgkmcnt(7)
    v_smfmac_f32_16x16x64_bf16 v[24:27], v[36:39], v[52:59], v2
    s_waitcnt vmcnt(3)
    ds_read_b128 v[52:55], v9 offset:8192
    s_waitcnt lgkmcnt(7)
    v_smfmac_f32_16x16x64_bf16 v[16:19], v[40:43], a[56:63], v2
    buffer_load_dwordx4 v[56:59], v0, s[8:11], s52 offen offset:3072
    v_smfmac_f32_16x16x64_bf16 v[20:23], v[40:43], a[216:223], v2
    ds_read_b128 v[36:39], v0 offset:7168
    s_waitcnt lgkmcnt(6)
    v_smfmac_f32_16x16x64_bf16 v[24:27], v[40:43], v[60:67], v2
    ds_read_b128 v[60:63], v10 offset:40960
    s_waitcnt lgkmcnt(6)
    v_smfmac_f32_16x16x64_bf16 v[16:19], v[28:31], a[64:71], v2
    ds_read_b128 v[64:67], v10 offset:41984
    s_waitcnt lgkmcnt(3)
    v_max3_u32 v52, v52, v53, v54
    v_smfmac_f32_16x16x64_bf16 v[20:23], v[28:31], a[224:231], v2
    ds_read_b128 v[40:43], v1 offset:7168
    v_max_u32 v52, v52, v55
    v_smfmac_f32_16x16x64_bf16 v[24:27], v[28:31], v[68:75], v2
    v_cmp_eq_u32 vcc, -1, v52
    v_smfmac_f32_16x16x64_bf16 v[16:19], v[32:35], a[72:79], v2
    s_cbranch_vccnz rem_stub_92
rem_cont_93:
    v_smfmac_f32_16x16x64_bf16 v[20:23], v[32:35], a[232:239], v2
    buffer_load_dwordx4 v[52:55], v0, s[8:11], s52 offen offset:2048
    s_waitcnt lgkmcnt(1)
    v_smfmac_f32_16x16x64_bf16 v[24:27], v[32:35], v[60:67], v2
    s_barrier
    ds_read_b128 v[60:63], v0 offset:8192
    v_smfmac_f32_16x16x64_bf16 v[16:19], v[36:39], a[80:87], v2
    buffer_store_dwordx4 v[76:79], v0, s[8:11], s59 offen sc1
    s_mov_b32 s59, s51
    ds_read_b128 v[64:67], v1 offset:8192
    v_smfmac_f32_16x16x64_bf16 v[20:23], v[36:39], a[240:247], v2
    s_add_u32 s100, s49, s93
    s_add_u32 s100, s100, 16384
    ds_read_b128 v[68:71], v0 offset:10240
    v_smfmac_f32_16x16x64_bf16 v[24:27], v[36:39], v[128:135], v2
    v_lshlrev_b32 v76, 3, v0
    s_mov_b32 m0, 13312
    ds_read_b128 v[72:75], v1 offset:10240
    s_waitcnt lgkmcnt(4)
    v_smfmac_f32_16x16x64_bf16 v[16:19], v[40:43], a[88:95], v2
    s_mov_b64 exec, s[64:65]
    buffer_load_dword v76, s[8:11], s100 offen sc1 lds
    s_mov_b64 exec, -1
    ds_read_b128 v[28:31], v0 offset:12288
    v_smfmac_f32_16x16x64_bf16 v[20:23], v[40:43], a[248:255], v2
    ds_read_b128 v[32:35], v1 offset:12288
    v_smfmac_f32_16x16x64_bf16 v[24:27], v[40:43], v[136:143], v2
    ds_read_b128 v[36:39], v0 offset:14336
    s_waitcnt lgkmcnt(6)
    v_smfmac_f32_16x16x64_bf16 v[16:19], v[60:63], a[96:103], v2
    s_add_u32 s100, s49, 32768
    ds_read_b128 v[40:43], v1 offset:14336
    s_waitcnt lgkmcnt(6)
    v_smfmac_f32_16x16x64_bf16 v[16:19], v[64:67], a[104:111], v2
    s_mov_b32 m0, 13312
    s_waitcnt lgkmcnt(5)
    v_smfmac_f32_16x16x64_bf16 v[16:19], v[68:71], a[112:119], v2
    s_and_b32 s4, s40, 1
    s_waitcnt lgkmcnt(4)
    v_smfmac_f32_16x16x64_bf16 v[16:19], v[72:75], a[120:127], v2
    s_sub_u32 s5, 0, s4
    s_waitcnt lgkmcnt(3)
    v_smfmac_f32_16x16x64_bf16 v[16:19], v[28:31], a[128:135], v2
    s_add_u32 s54, s40, 1
    s_waitcnt lgkmcnt(2)
    v_smfmac_f32_16x16x64_bf16 v[16:19], v[32:35], a[136:143], v2
    s_and_b32 s54, s54, 3
    s_waitcnt lgkmcnt(1)
    v_smfmac_f32_16x16x64_bf16 v[16:19], v[36:39], a[144:151], v2
    s_lshl_b32 s54, s54, 15
    s_waitcnt lgkmcnt(0)
    v_smfmac_f32_16x16x64_bf16 v[16:19], v[40:43], a[152:159], v2
    s_add_u32 s43, s54, s96
    v_smfmac_f32_16x16x64_bf16 v[20:23], v[60:63], v[80:87], v2
    s_add_u32 s44, s54, s97
    v_smfmac_f32_16x16x64_bf16 v[20:23], v[64:67], v[88:95], v2
    s_add_u32 s45, s54, s98
    v_mul_f32 v16, s58, v16
    v_smfmac_f32_16x16x64_bf16 v[20:23], v[68:71], v[96:103], v2
    s_add_u32 s46, s54, s99
    v_mul_f32 v17, s58, v17
    v_smfmac_f32_16x16x64_bf16 v[20:23], v[72:75], v[104:111], v2
    s_xor_b32 s47, s45, 0x10000
    v_mul_f32 v18, s58, v18
    v_smfmac_f32_16x16x64_bf16 v[20:23], v[28:31], v[112:119], v2
    s_xor_b32 s48, s46, 0x10000
    v_mul_f32 v19, s58, v19
    v_smfmac_f32_16x16x64_bf16 v[20:23], v[32:35], v[120:127], v2
    s_add_u32 s49, s49, 16384
    v_cvt_pk_bf16_f32 v76, v16, v17
    s_waitcnt vmcnt(2)
    v_smfmac_f32_16x16x64_bf16 v[20:23], v[36:39], v[44:51], v2
    v_cvt_pk_bf16_f32 v77, v18, v19
    v_smfmac_f32_16x16x64_bf16 v[20:23], v[40:43], v[52:59], v2
    ds_write_b64 v6, v[76:77] offset:2048
    v_smfmac_f32_16x16x64_bf16 v[24:27], v[60:63], v[144:151], v2
    v_smfmac_f32_16x16x64_bf16 v[24:27], v[64:67], v[152:159], v2
    v_cvt_pk_bf16_f32 v78, v20, v21
    v_cvt_pk_bf16_f32 v79, v22, v23
    ds_write_b64 v6, v[78:79] offset:4096
    v_smfmac_f32_16x16x64_bf16 v[24:27], v[68:71], v[160:167], v2
    ds_read_b128 v[60:63], v0 offset:16384
    v_smfmac_f32_16x16x64_bf16 v[24:27], v[72:75], v[168:175], v2
    ds_read_b128 v[64:67], v0 offset:17408
    v_smfmac_f32_16x16x64_bf16 v[24:27], v[28:31], v[176:183], v2
    ds_read_b128 v[68:71], v0 offset:18432
    v_smfmac_f32_16x16x64_bf16 v[24:27], v[32:35], v[184:191], v2
    ds_read_b128 v[72:75], v0 offset:19456
    s_waitcnt lgkmcnt(4)
    s_barrier
    ds_read_b64_tr_b16 v[44:45], v7 offset:2048
    ds_read_b64_tr_b16 v[46:47], v7 offset:2304
    ds_read_b64_tr_b16 v[48:49], v7 offset:2560
    ds_read_b64_tr_b16 v[50:51], v7 offset:2816
    ds_read_b64_tr_b16 v[52:53], v7 offset:3072
    ds_read_b64_tr_b16 v[54:55], v7 offset:3328
    v_smfmac_f32_16x16x64_bf16 v[24:27], v[36:39], v[192:199], v2
    ds_read_b64_tr_b16 v[56:57], v7 offset:3584
    ds_read_b64_tr_b16 v[58:59], v7 offset:3840
    v_smfmac_f32_16x16x64_bf16 v[24:27], v[40:43], v[200:207], v2
    s_waitcnt lgkmcnt(4)
    v_mfma_f32_16x16x32_bf16 v[16:19], v[60:63], v[44:47], 0
    ds_read_b128 v[28:31], v0 offset:20480
    ds_read_b128 v[32:35], v0 offset:21504
    v_mfma_f32_16x16x32_bf16 v[16:19], v[64:67], v[48:51], v[16:19]
    ds_read_b128 v[36:39], v0 offset:22528
    ds_read_b128 v[40:43], v0 offset:23552
    s_waitcnt lgkmcnt(4)
    v_mfma_f32_16x16x32_bf16 v[16:19], v[68:71], v[52:55], v[16:19]
    ds_read_b64_tr_b16 v[60:61], v7 offset:4096
    ds_read_b64_tr_b16 v[62:63], v7 offset:4352
    v_mfma_f32_16x16x32_bf16 v[16:19], v[72:75], v[56:59], v[16:19]
    ds_read_b64_tr_b16 v[64:65], v7 offset:4608
    ds_read_b64_tr_b16 v[66:67], v7 offset:4864
    s_waitcnt lgkmcnt(6)
    v_mfma_f32_16x16x32_bf16 v[20:23], v[28:31], v[44:47], 0
    ds_read_b64_tr_b16 v[68:69], v7 offset:5120
    ds_read_b64_tr_b16 v[70:71], v7 offset:5376
    v_mfma_f32_16x16x32_bf16 v[20:23], v[32:35], v[48:51], v[20:23]
    ds_read_b64_tr_b16 v[72:73], v7 offset:5632
    ds_read_b64_tr_b16 v[74:75], v7 offset:5888
    s_waitcnt lgkmcnt(8)
    v_mfma_f32_16x16x32_bf16 v[20:23], v[36:39], v[52:55], v[20:23]
    v_cvt_pk_bf16_f32 v76, v24, v25
    v_cvt_pk_bf16_f32 v77, v26, v27
    v_mfma_f32_16x16x32_bf16 v[20:23], v[40:43], v[56:59], v[20:23]
    ds_read_b128 v[28:31], v9 offset:24576
    ds_read_b128 v[32:35], v9 offset:25600
    s_waitcnt lgkmcnt(6)
    v_mfma_f32_16x16x32_bf16 v[40:43], v[60:63], v[44:47], 0
    v_exp_f32 v16, v16
    v_mfma_f32_16x16x32_bf16 v[40:43], v[64:67], v[48:51], v[40:43]
    v_exp_f32 v17, v17
    s_waitcnt lgkmcnt(2)
    v_mfma_f32_16x16x32_bf16 v[40:43], v[68:71], v[52:55], v[40:43]
    v_exp_f32 v18, v18
    v_mfma_f32_16x16x32_bf16 v[40:43], v[72:75], v[56:59], v[40:43]
    v_exp_f32 v19, v19
    v_exp_f32 v20, v20
    v_exp_f32 v21, v21
    v_exp_f32 v22, v22
    v_exp_f32 v23, v23
    v_cvt_pk_bf16_f32 v16, v16, v17
    v_cvt_pk_bf16_f32 v17, v18, v19
    v_cvt_pk_bf16_f32 v18, v20, v21
    v_cvt_pk_bf16_f32 v19, v22, v23
    v_exp_f32 v40, v40
    s_waitcnt lgkmcnt(0)
    v_mfma_f32_16x16x32_bf16 v[60:63], v[28:31], v[16:19], 0
    v_exp_f32 v41, v41
    v_mfma_f32_16x16x32_bf16 v[64:67], v[32:35], v[16:19], 0
    v_exp_f32 v42, v42
    v_mfma_f32_16x16x32_bf16 v[68:71], v[12:15], v[16:19], 0
    v_exp_f32 v43, v43
    v_cndmask_b32 v24, 0, v76, s[64:65]
    v_cvt_pk_bf16_f32 v40, v40, v41
    v_cvt_pk_bf16_f32 v41, v42, v43
sm_back_95:
    v_cndmask_b32 v42, 0, v40, s[64:65]
    v_cndmask_b32 v43, 0, v41, s[64:65]
    v_cndmask_b32 v25, 0, v77, s[64:65]
    v_cndmask_b32 v26, 0, v76, s[66:67]
    v_mfma_f32_16x16x16_bf16 v[68:71], v[12:13], v[42:43], v[68:71]
    v_cndmask_b32 v27, 0, v77, s[66:67]
    v_mfma_f32_16x16x16_bf16 v[60:63], v[24:25], v[40:41], v[60:63]
    v_add_u32 v20, s50, v0
    v_mfma_f32_16x16x16_bf16 v[64:67], v[26:27], v[40:41], v[64:67]
    v_mov_b64 v[16:17], 0
    v_mov_b64 v[18:19], 0
    v_mov_b64 v[22:23], 0
    s_nop 0
    v_rcp_f32 v70, v68
    s_nop 0
    v_max_f32 v69, v68, v70
    v_pk_mul_f32 v[60:61], v[60:61], v[70:71] op_sel_hi:[1,0]
    v_pk_mul_f32 v[62:63], v[62:63], v[70:71] op_sel_hi:[1,0]
    v_pk_mul_f32 v[64:65], v[64:65], v[70:71] op_sel_hi:[1,0]
    v_pk_mul_f32 v[66:67], v[66:67], v[70:71] op_sel_hi:[1,0]
    v_cvt_pk_bf16_f32 v36, v60, v61
    v_cvt_pk_bf16_f32 v37, v62, v63
    v_cvt_pk_bf16_f32 v38, v64, v65
    v_cvt_pk_bf16_f32 v39, v66, v67
    v_cmp_nge_f32 vcc, s92, v69
    s_mov_b64 exec, s[62:63]
    ds_write_b128 v20, v[36:39] offset:9216
    s_mov_b64 exec, -1
    s_cbranch_vccnz sm_slow_94
sm_ok_96:
    s_cmp_eq_u32 s40, 63
    s_cbranch_scc1 fin_97
    s_add_u32 m0, s93, 8192
    s_add_u32 s55, s49, 8192
    buffer_load_dwordx4 v0, s[8:11], s55 offen offset:0 sc1 lds
    buffer_load_dwordx4 v0, s[8:11], s55 offen offset:1024 sc1 lds
    ds_read_b128 v[44:47], v10 offset:49152
    ds_read_b128 v[48:51], v10 offset:50176
    s_waitcnt lgkmcnt(2)
    s_barrier
    ds_read_b128 v[28:31], v0 offset:9216
    ds_read_b128 v[32:35], v1 offset:9216
    ds_read_b128 v[36:39], v0 offset:11264
    ds_read_b128 v[40:43], v1 offset:11264
    ds_read_b128 v[52:55], v10 offset:57344
    ds_read_b128 v[56:59], v10 offset:58368
    v_mov_b64 v[20:21], 0
    s_mov_b32 m0, s93
    s_nop 0
    buffer_load_dwordx4 v0, s[8:11], s49 offen offset:0 sc1 lds
    buffer_load_dwordx4 v0, s[8:11], s49 offen offset:1024 sc1 lds
    s_add_u32 s51, s51, 4096
    s_xor_b32 s51, s51, 0x40000000
    s_mov_b32 s101, 0
    s_waitcnt lgkmcnt(5)
    v_smfmac_f32_16x16x64_bf16 v[16:19], v[28:31], v[44:51], v2
    ds_read_b128 v[60:63], v11 offset:0
    v_smfmac_f32_16x16x64_bf16 v[20:23], v[28:31], v[208:215], v2
    ds_read_b128 v[64:67], v11 offset:1024
    s_waitcnt lgkmcnt(6)
    v_smfmac_f32_16x16x64_bf16 v[20:23], v[32:35], v[216:223], v2
    ds_read_b128 v[68:71], v11 offset:8192
    s_waitcnt lgkmcnt(3)
    v_smfmac_f32_16x16x64_bf16 v[16:19], v[32:35], v[52:59], v2
    ds_read_b128 v[72:75], v11 offset:9216
    v_smfmac_f32_16x16x64_bf16 v[20:23], v[36:39], v[240:247], v2
    ds_read_b128 v[44:47], v11 offset:16384
    v_mov_b64 v[24:25], 0
    v_smfmac_f32_16x16x64_bf16 v[20:23], v[40:43], v[248:255], v2
    ds_read_b128 v[48:51], v11 offset:17408
    v_mov_b64 v[26:27], 0
    s_waitcnt lgkmcnt(4)
    v_smfmac_f32_16x16x64_bf16 v[16:19], v[36:39], v[60:67], v2
    ds_read_b128 v[52:55], v11 offset:24576
    s_waitcnt lgkmcnt(3)
    v_smfmac_f32_16x16x64_bf16 v[16:19], v[40:43], v[68:75], v2
    ds_read_b128 v[56:59], v11 offset:25600
    v_smfmac_f32_16x16x64_bf16 v[24:27], v[28:31], v[224:231], v2
    v_cvt_pk_bf16_f32 v20, v20, v21
    v_smfmac_f32_16x16x64_bf16 v[24:27], v[32:35], v[232:239], v2
    v_cvt_pk_bf16_f32 v21, v22, v23
    s_waitcnt lgkmcnt(2)
    v_smfmac_f32_16x16x64_bf16 v[24:27], v[36:39], v[44:51], v2
    v_cvt_pk_bf16_f32 v19, v18, v19
    s_waitcnt lgkmcnt(0)
    v_smfmac_f32_16x16x64_bf16 v[24:27], v[40:43], v[52:59], v2
    v_cvt_pk_bf16_f32 v18, v16, v17
    v_and_or_b32 v20, v20, -2, s4
    v_and_or_b32 v18, v18, -2, s4
    buffer_store_dwordx4 v[18:21], v4, s[8:11], s41 offen sc1
    s_nop 1
    v_cvt_pk_bf16_f32 v24, v24, v25
    v_cvt_pk_bf16_f32 v25, v26, v27
    v_and_or_b32 v24, v24, -2, s4
    buffer_store_dwordx2 v[24:25], v5, s[8:11], s41 offen sc1
    ds_read_b128 v[60:63], v0 offset:0
    s_sleep 4
    buffer_load_dwordx4 v[28:31], v0, s[8:11], s42 offen offset:0 sc1
    buffer_load_dwordx4 v[32:35], v0, s[8:11], s42 offen offset:1024 sc1
    buffer_load_dwordx4 v[36:39], v0, s[8:11], s42 offen offset:2048 sc1
    buffer_load_dwordx4 v[40:43], v0, s[8:11], s42 offen offset:3072 sc1
    s_sleep 2
    buffer_load_dwordx4 v[28:31], v0, s[8:11], s42 offen offset:0 sc1
    buffer_load_dwordx4 v[32:35], v0, s[8:11], s42 offen offset:1024 sc1
    buffer_load_dwordx4 v[36:39], v0, s[8:11], s42 offen offset:2048 sc1
    buffer_load_dwordx4 v[40:43], v0, s[8:11], s42 offen offset:3072 sc1
    s_waitcnt lgkmcnt(0)
ra_check_98:
    s_waitcnt vmcnt(7)
    v_bitop3_b32 v16, v28, v30, s5 bitop3:0x7e
    v_mfma_f32_16x16x32_bf16 v[68:71], v[28:31], v[60:63], 0
    s_waitcnt vmcnt(6)
    v_bitop3_b32 v17, v32, v34, s5 bitop3:0x7e
    v_or_b32 v16, v16, v17
    v_mfma_f32_16x16x32_bf16 v[68:71], v[32:35], v[60:63], v[68:71]
    s_waitcnt vmcnt(5)
    v_bitop3_b32 v17, v36, v38, s5 bitop3:0x7e
    v_or_b32 v16, v16, v17
    v_lshlrev_b32 v16, 31, v16
    v_mfma_f32_16x16x32_bf16 v[68:71], v[36:39], v[60:63], v[68:71]
    s_waitcnt vmcnt(4)
    v_bitop3_b32 v17, v40, v42, s5 bitop3:0x7e
    v_lshl_or_b32 v16, v17, 31, v16
    v_mfma_f32_16x16x32_bf16 v[68:71], v[40:43], v[60:63], v[68:71]
    v_cmp_gt_i32 vcc, 0, v16
    s_nop 0
    s_cbranch_vccnz ra_stub_99
ra_cont_100:
    s_nop 0
    v_permlane32_swap_b32 v68, v70
    v_permlane32_swap_b32 v69, v71
    v_pk_add_f32 v[68:69], v[68:69], v[70:71]
    v_cvt_pk_bf16_f32 v20, v68, v69
    s_mov_b64 exec, s[60:61]
    buffer_store_dword v20, v8, s[8:11], s45 offen sc1
    buffer_store_dword v20, v8, s[8:11], s46 offen sc1
    s_mov_b64 exec, -1
    s_branch rec_top_Eg
kv_stub_90:
    v_lshrrev_b32 v46, 2, v0
    v_min_u32 v46, 64, v46
kvf_101:
    buffer_load_dword v47, v46, s[8:11], s3 offen sc1
    s_waitcnt vmcnt(0)
    v_cmp_gt_u32 vcc, 2, v47
    s_nop 0
    s_ff1_i32_b64 s7, vcc
    s_lshl_b32 s7, s7, 2
    s_cmp_eq_u32 s7, 64
    s_cselect_b32 s7, 128, s7
    s_add_u32 s54, s40, 2
    s_cmp_lt_u32 s54, s7
    s_cbranch_scc1 kvd_102
    s_sleep 2
    s_sub_u32 s53, s53, 1
    s_cbranch_scc0 kvf_101
    s_mov_b32 s53, 0
    s_mov_b32 s7, 128
kvd_102:
    s_branch kv_cont_91
rem_stub_92:
    s_sub_u32 s53, s53, 1
    s_cbranch_scc1 rem_give_104
    s_sleep 3
    buffer_load_dwordx4 v[52:55], v3, s[8:11], s44 offen sc1
    s_waitcnt vmcnt(0)
    ds_write_b128 v9, v[52:55] offset:8192
    s_waitcnt lgkmcnt(0)
    v_max3_u32 v52, v52, v53, v54
    v_max_u32 v52, v52, v55
    v_cmp_eq_u32 vcc, -1, v52
    s_nop 0
    s_cbranch_vccnz rem_stub_92
    s_branch rem_cont_93
rem_give_104:
    s_mov_b32 s53, 0
    s_branch rem_cont_93
sm_slow_94:
    s_cmp_lg_u32 s101, 0
    s_cbranch_scc1 sm_ok_96
    s_mov_b32 s101, 1
    s_waitcnt lgkmcnt(0)
    ds_read_b128 v[68:71], v0 offset:16384
    s_waitcnt lgkmcnt(0)
    v_mfma_f32_16x16x32_bf16 v[16:19], v[68:71], v[44:47], 0
    s_nop 3
    ds_read_b128 v[68:71], v0 offset:17408
    s_waitcnt lgkmcnt(0)
    v_mfma_f32_16x16x32_bf16 v[16:19], v[68:71], v[48:51], v[16:19]
    s_nop 3
    ds_read_b128 v[68:71], v0 offset:18432
    s_waitcnt lgkmcnt(0)
    v_mfma_f32_16x16x32_bf16 v[16:19], v[68:71], v[52:55], v[16:19]
    s_nop 3
    ds_read_b128 v[68:71], v0 offset:19456
    s_waitcnt lgkmcnt(0)
    v_mfma_f32_16x16x32_bf16 v[16:19], v[68:71], v[56:59], v[16:19]
    s_nop 3
    ds_read_b128 v[68:71], v0 offset:20480
    s_waitcnt lgkmcnt(0)
    v_mfma_f32_16x16x32_bf16 v[20:23], v[68:71], v[44:47], 0
    s_nop 3
    ds_read_b128 v[68:71], v0 offset:21504
    s_waitcnt lgkmcnt(0)
    v_mfma_f32_16x16x32_bf16 v[20:23], v[68:71], v[48:51], v[20:23]
    s_nop 3
    ds_read_b128 v[68:71], v0 offset:22528
    s_waitcnt lgkmcnt(0)
    v_mfma_f32_16x16x32_bf16 v[20:23], v[68:71], v[52:55], v[20:23]
    s_nop 3
    ds_read_b128 v[68:71], v0 offset:23552
    s_waitcnt lgkmcnt(0)
    v_mfma_f32_16x16x32_bf16 v[20:23], v[68:71], v[56:59], v[20:23]
    s_nop 3
    ds_read_b64_tr_b16 v[68:69], v7 offset:4096
    ds_read_b64_tr_b16 v[70:71], v7 offset:4352
    s_waitcnt lgkmcnt(0)
    v_mfma_f32_16x16x32_bf16 v[40:43], v[68:71], v[44:47], 0
    s_nop 3
    ds_read_b64_tr_b16 v[68:69], v7 offset:4608
    ds_read_b64_tr_b16 v[70:71], v7 offset:4864
    s_waitcnt lgkmcnt(0)
    v_mfma_f32_16x16x32_bf16 v[40:43], v[68:71], v[48:51], v[40:43]
    s_nop 3
    ds_read_b64_tr_b16 v[68:69], v7 offset:5120
    ds_read_b64_tr_b16 v[70:71], v7 offset:5376
    s_waitcnt lgkmcnt(0)
    v_mfma_f32_16x16x32_bf16 v[40:43], v[68:71], v[52:55], v[40:43]
    s_nop 3
    ds_read_b64_tr_b16 v[68:69], v7 offset:5632
    ds_read_b64_tr_b16 v[70:71], v7 offset:5888
    s_waitcnt lgkmcnt(0)
    v_mfma_f32_16x16x32_bf16 v[40:43], v[68:71], v[56:59], v[40:43]
    s_nop 3
    v_max3_f32 v68, v16, v17, v18
    v_max3_f32 v68, v68, v19, v20
    v_max3_f32 v68, v68, v21, v22
    s_nop 0
    v_max3_f32 v68, v68, v23, v40
    v_max3_f32 v68, v68, v41, v42
    v_max_f32 v68, v68, v43
    v_mov_b32 v69, v68
    s_nop 1
    v_permlane16_swap_b32 v68, v69
    v_max_f32 v68, v68, v69
    v_mov_b32 v69, v68
    s_nop 1
    v_permlane32_swap_b32 v68, v69
    v_max_f32 v68, v68, v69
    v_sub_f32 v16, v16, v68
    v_sub_f32 v17, v17, v68
    v_sub_f32 v18, v18, v68
    v_sub_f32 v19, v19, v68
    v_sub_f32 v20, v20, v68
    v_sub_f32 v21, v21, v68
    v_sub_f32 v22, v22, v68
    v_sub_f32 v23, v23, v68
    v_sub_f32 v40, v40, v68
    v_sub_f32 v41, v41, v68
    v_sub_f32 v42, v42, v68
    v_sub_f32 v43, v43, v68
    v_exp_f32 v16, v16
    v_exp_f32 v17, v17
    v_exp_f32 v18, v18
    v_exp_f32 v19, v19
    v_exp_f32 v20, v20
    v_exp_f32 v21, v21
    v_exp_f32 v22, v22
    v_exp_f32 v23, v23
    v_exp_f32 v40, v40
    v_exp_f32 v41, v41
    v_exp_f32 v42, v42
    v_exp_f32 v43, v43
    v_cvt_pk_bf16_f32 v16, v16, v17
    v_cvt_pk_bf16_f32 v17, v18, v19
    v_cvt_pk_bf16_f32 v18, v20, v21
    v_cvt_pk_bf16_f32 v19, v22, v23
    v_cvt_pk_bf16_f32 v40, v40, v41
    v_cvt_pk_bf16_f32 v41, v42, v43
    v_mfma_f32_16x16x32_bf16 v[60:63], v[28:31], v[16:19], 0
    v_mfma_f32_16x16x32_bf16 v[64:67], v[32:35], v[16:19], 0
    v_mfma_f32_16x16x32_bf16 v[68:71], v[12:15], v[16:19], 0
    s_nop 7
    s_branch sm_back_95
fin_97:
    buffer_store_dwordx4 v[76:79], v0, s[8:11], s51 offen sc1
    s_branch main_end0
ra_stub_99:
    s_mov_b32 s88, 1
    s_sub_u32 s53, s53, 1
    s_cbranch_scc1 giveup_105
    s_mov_b64 exec, vcc
    buffer_load_dwordx4 v[28:31], v0, s[8:11], s42 offen offset:0 sc1
    buffer_load_dwordx4 v[32:35], v0, s[8:11], s42 offen offset:1024 sc1
    buffer_load_dwordx4 v[36:39], v0, s[8:11], s42 offen offset:2048 sc1
    buffer_load_dwordx4 v[40:43], v0, s[8:11], s42 offen offset:3072 sc1
    s_mov_b64 exec, -1
    s_branch ra_check_98
giveup_105:
    s_mov_b32 s53, 0
    s_branch ra_cont_100
rec_entry_Sg:
    v_mov_b32 v20, v26
    s_mov_b64 exec, s[60:61]
    buffer_store_dword v20, v8, s[8:11], s45 offen sc1
    s_mov_b64 exec, -1
.p2align 3
rec_top_Sg:
    s_add_u32 s40, s40, 1
    s_barrier
    ds_read_b128 v[52:55], v9 offset:32768
    ds_read_b128 v[56:59], v9 offset:33792
    ds_read_b128 v[60:63], v9 offset:40960
    ds_read_b128 v[64:67], v9 offset:41984
    ds_read_b128 v[68:71], v9 offset:49152
    ds_read_b128 v[72:75], v9 offset:50176
    v_mov_b64 v[24:25], -1
    v_mov_b64 v[26:27], -1
    v_mov_b64 v[16:17], 0
    v_mov_b64 v[18:19], 0
    v_mov_b64 v[20:21], 0
    v_mov_b64 v[22:23], 0
    s_add_u32 s54, s40, 2
    s_cmp_ge_u32 s54, s7
    s_cbranch_scc1 kv_stub_106
kv_cont_107:
    s_sleep 2
    buffer_load_dwordx4 v[44:47], v3, s[8:11], s43 offen offset:0 sc1
    buffer_load_dwordx4 v[48:51], v3, s[8:11], s43 offen offset:1024 sc1
    s_sleep 2
    buffer_load_dwordx4 v[44:47], v3, s[8:11], s43 offen offset:0 sc1
    buffer_load_dwordx4 v[48:51], v3, s[8:11], s43 offen offset:1024 sc1
pl_check_108:
    s_waitcnt vmcnt(2)
    v_max3_u32 v40, v44, v45, v46
    v_max3_u32 v40, v40, v47, v48
    v_max3_u32 v40, v40, v49, v50
    v_max_u32 v40, v40, v51
    ds_write_b128 v9, v[44:47] offset:0
    ds_write_b128 v9, v[48:51] offset:1024
    v_cmp_eq_u32 vcc, -1, v40
    s_nop 0
    s_cbranch_vccnz pl_stub_109
pl_cont_110:
    s_mov_b64 exec, 0xff
    buffer_store_dwordx4 v[24:27], v0, s[8:11], s47 offen sc1
    s_mov_b64 exec, -1
    s_nop 0
    v_mov_b64 v[24:25], 0
    v_mov_b64 v[26:27], 0
    s_waitcnt lgkmcnt(0)
    s_barrier
    ds_read_b128 v[28:31], v0 offset:2048
    ds_read_b128 v[32:35], v1 offset:2048
    ds_read_b128 v[36:39], v0 offset:3072
    ds_read_b128 v[40:43], v1 offset:3072
    s_add_u32 m0, s93, -8192
    s_nop 0
    buffer_load_dwordx4 v3, s[8:11], s44 offen sc1 lds
    s_waitcnt lgkmcnt(3)
    v_smfmac_f32_16x16x64_bf16 v[16:19], v[28:31], a[0:7], v2
    v_smfmac_f32_16x16x64_bf16 v[20:23], v[28:31], a[160:167], v2
    buffer_load_dwordx4 v[44:47], v0, s[8:11], s52 offen offset:0
    v_smfmac_f32_16x16x64_bf16 v[24:27], v[28:31], v[52:59], v2
    ds_read_b128 v[52:55], v9 offset:57344
    s_waitcnt lgkmcnt(3)
    v_smfmac_f32_16x16x64_bf16 v[16:19], v[32:35], a[8:15], v2
    ds_read_b128 v[56:59], v9 offset:58368
    v_smfmac_f32_16x16x64_bf16 v[20:23], v[32:35], a[168:175], v2
    ds_read_b128 v[28:31], v0 offset:4096
    buffer_load_dwordx4 v[48:51], v0, s[8:11], s52 offen offset:1024
    v_smfmac_f32_16x16x64_bf16 v[24:27], v[32:35], v[60:67], v2
    ds_read_b128 v[60:63], v10 offset:0
    s_waitcnt lgkmcnt(5)
    v_smfmac_f32_16x16x64_bf16 v[16:19], v[36:39], a[16:23], v2
    ds_read_b128 v[64:67], v10 offset:1024
    v_smfmac_f32_16x16x64_bf16 v[20:23], v[36:39], a[176:183], v2
    ds_read_b128 v[32:35], v1 offset:4096
    v_smfmac_f32_16x16x64_bf16 v[24:27], v[36:39], v[68:75], v2
    ds_read_b128 v[68:71], v10 offset:8192
    s_waitcnt lgkmcnt(7)
    v_smfmac_f32_16x16x64_bf16 v[16:19], v[40:43], a[24:31], v2
    ds_read_b128 v[72:75], v10 offset:9216
    v_smfmac_f32_16x16x64_bf16 v[20:23], v[40:43], a[184:191], v2
    ds_read_b128 v[36:39], v0 offset:5120
    s_waitcnt lgkmcnt(7)
    v_smfmac_f32_16x16x64_bf16 v[24:27], v[40:43], v[52:59], v2
    ds_read_b128 v[52:55], v10 offset:16384
    s_waitcnt lgkmcnt(7)
    v_smfmac_f32_16x16x64_bf16 v[16:19], v[28:31], a[32:39], v2
    ds_read_b128 v[56:59], v10 offset:17408
    v_smfmac_f32_16x16x64_bf16 v[20:23], v[28:31], a[192:199], v2
    ds_read_b128 v[40:43], v1 offset:5120
    s_waitcnt lgkmcnt(7)
    v_smfmac_f32_16x16x64_bf16 v[24:27], v[28:31], v[60:67], v2
    ds_read_b128 v[60:63], v10 offset:24576
    s_waitcnt lgkmcnt(7)
    v_smfmac_f32_16x16x64_bf16 v[16:19], v[32:35], a[40:47], v2
    ds_read_b128 v[64:67], v10 offset:25600
    v_smfmac_f32_16x16x64_bf16 v[20:23], v[32:35], a[200:207], v2
    ds_read_b128 v[28:31], v0 offset:6144
    s_waitcnt lgkmcnt(7)
    v_smfmac_f32_16x16x64_bf16 v[24:27], v[32:35], v[68:75], v2
    ds_read_b128 v[68:71], v10 offset:32768
    s_waitcnt lgkmcnt(7)
    v_smfmac_f32_16x16x64_bf16 v[16:19], v[36:39], a[48:55], v2
    ds_read_b128 v[72:75], v10 offset:33792
    v_smfmac_f32_16x16x64_bf16 v[20:23], v[36:39], a[208:215], v2
    ds_read_b128 v[32:35], v1 offset:6144
    s_waitcnt lgkmcnt(7)
    v_smfmac_f32_16x16x64_bf16 v[24:27], v[36:39], v[52:59], v2
    s_waitcnt vmcnt(2)
    ds_read_b128 v[52:55], v9 offset:8192
    s_waitcnt lgkmcnt(7)
    v_smfmac_f32_16x16x64_bf16 v[16:19], v[40:43], a[56:63], v2
    buffer_load_dwordx4 v[56:59], v0, s[8:11], s52 offen offset:3072
    v_smfmac_f32_16x16x64_bf16 v[20:23], v[40:43], a[216:223], v2
    ds_read_b128 v[36:39], v0 offset:7168
    s_waitcnt lgkmcnt(6)
    v_smfmac_f32_16x16x64_bf16 v[24:27], v[40:43], v[60:67], v2
    ds_read_b128 v[60:63], v10 offset:40960
    s_waitcnt lgkmcnt(6)
    v_smfmac_f32_16x16x64_bf16 v[16:19], v[28:31], a[64:71], v2
    ds_read_b128 v[64:67], v10 offset:41984
    s_waitcnt lgkmcnt(3)
    v_max3_u32 v52, v52, v53, v54
    v_smfmac_f32_16x16x64_bf16 v[20:23], v[28:31], a[224:231], v2
    ds_read_b128 v[40:43], v1 offset:7168
    v_max_u32 v52, v52, v55
    v_smfmac_f32_16x16x64_bf16 v[24:27], v[28:31], v[68:75], v2
    v_cmp_eq_u32 vcc, -1, v52
    v_smfmac_f32_16x16x64_bf16 v[16:19], v[32:35], a[72:79], v2
    s_cbranch_vccnz rem_stub_111
rem_cont_112:
    v_smfmac_f32_16x16x64_bf16 v[20:23], v[32:35], a[232:239], v2
    buffer_load_dwordx4 v[52:55], v0, s[8:11], s52 offen offset:2048
    s_waitcnt lgkmcnt(1)
    v_smfmac_f32_16x16x64_bf16 v[24:27], v[32:35], v[60:67], v2
    s_barrier
    ds_read_b128 v[60:63], v0 offset:8192
    v_smfmac_f32_16x16x64_bf16 v[16:19], v[36:39], a[80:87], v2
    buffer_store_dwordx4 v[76:79], v0, s[8:11], s59 offen sc1
    s_mov_b32 s59, s51
    ds_read_b128 v[64:67], v1 offset:8192
    v_smfmac_f32_16x16x64_bf16 v[20:23], v[36:39], a[240:247], v2
    s_add_u32 s100, s49, s93
    s_add_u32 s100, s100, 16384
    ds_read_b128 v[68:71], v0 offset:10240
    v_smfmac_f32_16x16x64_bf16 v[24:27], v[36:39], v[128:135], v2
    v_lshlrev_b32 v76, 3, v0
    s_mov_b32 m0, 13312
    ds_read_b128 v[72:75], v1 offset:10240
    s_waitcnt lgkmcnt(4)
    v_smfmac_f32_16x16x64_bf16 v[16:19], v[40:43], a[88:95], v2
    s_mov_b64 exec, s[64:65]
    buffer_load_dword v76, s[8:11], s100 offen sc1 lds
    s_mov_b64 exec, -1
    ds_read_b128 v[28:31], v0 offset:12288
    v_smfmac_f32_16x16x64_bf16 v[20:23], v[40:43], a[248:255], v2
    ds_read_b128 v[32:35], v1 offset:12288
    v_smfmac_f32_16x16x64_bf16 v[24:27], v[40:43], v[136:143], v2
    ds_read_b128 v[36:39], v0 offset:14336
    s_waitcnt lgkmcnt(6)
    v_smfmac_f32_16x16x64_bf16 v[16:19], v[60:63], a[96:103], v2
    s_add_u32 s100, s49, 32768
    ds_read_b128 v[40:43], v1 offset:14336
    s_waitcnt lgkmcnt(6)
    v_smfmac_f32_16x16x64_bf16 v[16:19], v[64:67], a[104:111], v2
    s_mov_b32 m0, 13312
    s_waitcnt lgkmcnt(5)
    v_smfmac_f32_16x16x64_bf16 v[16:19], v[68:71], a[112:119], v2
    s_and_b32 s4, s40, 1
    s_waitcnt lgkmcnt(4)
    v_smfmac_f32_16x16x64_bf16 v[16:19], v[72:75], a[120:127], v2
    s_sub_u32 s5, 0, s4
    s_waitcnt lgkmcnt(3)
    v_smfmac_f32_16x16x64_bf16 v[16:19], v[28:31], a[128:135], v2
    s_add_u32 s54, s40, 1
    s_waitcnt lgkmcnt(2)
    v_smfmac_f32_16x16x64_bf16 v[16:19], v[32:35], a[136:143], v2
    s_and_b32 s54, s54, 3
    s_waitcnt lgkmcnt(1)
    v_smfmac_f32_16x16x64_bf16 v[16:19], v[36:39], a[144:151], v2
    s_lshl_b32 s54, s54, 15
    s_waitcnt lgkmcnt(0)
    v_smfmac_f32_16x16x64_bf16 v[16:19], v[40:43], a[152:159], v2
    s_add_u32 s43, s54, s96
    v_smfmac_f32_16x16x64_bf16 v[20:23], v[60:63], v[80:87], v2
    s_add_u32 s44, s54, s97
    v_smfmac_f32_16x16x64_bf16 v[20:23], v[64:67], v[88:95], v2
    s_add_u32 s45, s54, s98
    v_mul_f32 v16, s58, v16
    v_smfmac_f32_16x16x64_bf16 v[20:23], v[68:71], v[96:103], v2
    s_add_u32 s46, s54, s99
    v_mul_f32 v17, s58, v17
    v_smfmac_f32_16x16x64_bf16 v[20:23], v[72:75], v[104:111], v2
    s_xor_b32 s47, s45, 0x10000
    v_mul_f32 v18, s58, v18
    v_smfmac_f32_16x16x64_bf16 v[20:23], v[28:31], v[112:119], v2
    s_xor_b32 s48, s46, 0x10000
    v_mul_f32 v19, s58, v19
    v_smfmac_f32_16x16x64_bf16 v[20:23], v[32:35], v[120:127], v2
    s_add_u32 s49, s49, 16384
    v_cvt_pk_bf16_f32 v76, v16, v17
    s_waitcnt vmcnt(2)
    v_smfmac_f32_16x16x64_bf16 v[20:23], v[36:39], v[44:51], v2
    v_cvt_pk_bf16_f32 v77, v18, v19
    v_smfmac_f32_16x16x64_bf16 v[20:23], v[40:43], v[52:59], v2
    ds_write_b64 v6, v[76:77] offset:2048
    v_smfmac_f32_16x16x64_bf16 v[24:27], v[60:63], v[144:151], v2
    v_smfmac_f32_16x16x64_bf16 v[24:27], v[64:67], v[152:159], v2
    v_cvt_pk_bf16_f32 v78, v20, v21
    v_cvt_pk_bf16_f32 v79, v22, v23
    ds_write_b64 v6, v[78:79] offset:4096
    v_smfmac_f32_16x16x64_bf16 v[24:27], v[68:71], v[160:167], v2
    ds_read_b128 v[60:63], v0 offset:16384
    v_smfmac_f32_16x16x64_bf16 v[24:27], v[72:75], v[168:175], v2
    ds_read_b128 v[64:67], v0 offset:17408
    v_smfmac_f32_16x16x64_bf16 v[24:27], v[28:31], v[176:183], v2
    ds_read_b128 v[68:71], v0 offset:18432
    v_smfmac_f32_16x16x64_bf16 v[24:27], v[32:35], v[184:191], v2
    ds_read_b128 v[72:75], v0 offset:19456
    s_waitcnt lgkmcnt(4)
    s_barrier
    ds_read_b64_tr_b16 v[44:45], v7 offset:2048
    ds_read_b64_tr_b16 v[46:47], v7 offset:2304
    ds_read_b64_tr_b16 v[48:49], v7 offset:2560
    ds_read_b64_tr_b16 v[50:51], v7 offset:2816
    ds_read_b64_tr_b16 v[52:53], v7 offset:3072
    ds_read_b64_tr_b16 v[54:55], v7 offset:3328
    v_smfmac_f32_16x16x64_bf16 v[24:27], v[36:39], v[192:199], v2
    ds_read_b64_tr_b16 v[56:57], v7 offset:3584
    ds_read_b64_tr_b16 v[58:59], v7 offset:3840
    v_smfmac_f32_16x16x64_bf16 v[24:27], v[40:43], v[200:207], v2
    s_waitcnt lgkmcnt(4)
    v_mfma_f32_16x16x32_bf16 v[16:19], v[60:63], v[44:47], 0
    ds_read_b128 v[28:31], v0 offset:20480
    ds_read_b128 v[32:35], v0 offset:21504
    v_mfma_f32_16x16x32_bf16 v[16:19], v[64:67], v[48:51], v[16:19]
    ds_read_b128 v[36:39], v0 offset:22528
    ds_read_b128 v[40:43], v0 offset:23552
    s_waitcnt lgkmcnt(4)
    v_mfma_f32_16x16x32_bf16 v[16:19], v[68:71], v[52:55], v[16:19]
    ds_read_b64_tr_b16 v[60:61], v7 offset:4096
    ds_read_b64_tr_b16 v[62:63], v7 offset:4352
    v_mfma_f32_16x16x32_bf16 v[16:19], v[72:75], v[56:59], v[16:19]
    ds_read_b64_tr_b16 v[64:65], v7 offset:4608
    ds_read_b64_tr_b16 v[66:67], v7 offset:4864
    s_waitcnt lgkmcnt(6)
    v_mfma_f32_16x16x32_bf16 v[20:23], v[28:31], v[44:47], 0
    ds_read_b64_tr_b16 v[68:69], v7 offset:5120
    ds_read_b64_tr_b16 v[70:71], v7 offset:5376
    v_mfma_f32_16x16x32_bf16 v[20:23], v[32:35], v[48:51], v[20:23]
    ds_read_b64_tr_b16 v[72:73], v7 offset:5632
    ds_read_b64_tr_b16 v[74:75], v7 offset:5888
    s_waitcnt lgkmcnt(8)
    v_mfma_f32_16x16x32_bf16 v[20:23], v[36:39], v[52:55], v[20:23]
    v_cvt_pk_bf16_f32 v76, v24, v25
    v_cvt_pk_bf16_f32 v77, v26, v27
    v_mfma_f32_16x16x32_bf16 v[20:23], v[40:43], v[56:59], v[20:23]
    ds_read_b128 v[28:31], v9 offset:24576
    ds_read_b128 v[32:35], v9 offset:25600
    s_waitcnt lgkmcnt(6)
    v_mfma_f32_16x16x32_bf16 v[40:43], v[60:63], v[44:47], 0
    v_exp_f32 v16, v16
    v_mfma_f32_16x16x32_bf16 v[40:43], v[64:67], v[48:51], v[40:43]
    v_exp_f32 v17, v17
    s_waitcnt lgkmcnt(2)
    v_mfma_f32_16x16x32_bf16 v[40:43], v[68:71], v[52:55], v[40:43]
    v_exp_f32 v18, v18
    v_mfma_f32_16x16x32_bf16 v[40:43], v[72:75], v[56:59], v[40:43]
    v_exp_f32 v19, v19
    v_exp_f32 v20, v20
    v_exp_f32 v21, v21
    v_exp_f32 v22, v22
    v_exp_f32 v23, v23
    v_cvt_pk_bf16_f32 v16, v16, v17
    v_cvt_pk_bf16_f32 v17, v18, v19
    v_cvt_pk_bf16_f32 v18, v20, v21
    v_cvt_pk_bf16_f32 v19, v22, v23
    v_exp_f32 v40, v40
    s_waitcnt lgkmcnt(0)
    v_mfma_f32_16x16x32_bf16 v[60:63], v[28:31], v[16:19], 0
    v_exp_f32 v41, v41
    v_mfma_f32_16x16x32_bf16 v[64:67], v[32:35], v[16:19], 0
    v_exp_f32 v42, v42
    v_mfma_f32_16x16x32_bf16 v[68:71], v[12:15], v[16:19], 0
    v_exp_f32 v43, v43
    v_cndmask_b32 v24, 0, v76, s[64:65]
    v_cvt_pk_bf16_f32 v40, v40, v41
    v_cvt_pk_bf16_f32 v41, v42, v43
sm_back_114:
    v_cndmask_b32 v42, 0, v40, s[64:65]
    v_cndmask_b32 v43, 0, v41, s[64:65]
    v_cndmask_b32 v25, 0, v77, s[64:65]
    v_cndmask_b32 v26, 0, v76, s[66:67]
    v_mfma_f32_16x16x16_bf16 v[68:71], v[12:13], v[42:43], v[68:71]
    v_cndmask_b32 v27, 0, v77, s[66:67]
    v_mfma_f32_16x16x16_bf16 v[60:63], v[24:25], v[40:41], v[60:63]
    v_add_u32 v20, s50, v0
    v_mfma_f32_16x16x16_bf16 v[64:67], v[26:27], v[40:41], v[64:67]
    v_mov_b64 v[16:17], 0
    v_mov_b64 v[18:19], 0
    v_mov_b64 v[22:23], 0
    s_nop 0
    v_rcp_f32 v70, v68
    s_nop 0
    v_max_f32 v69, v68, v70
    v_pk_mul_f32 v[60:61], v[60:61], v[70:71] op_sel_hi:[1,0]
    v_pk_mul_f32 v[62:63], v[62:63], v[70:71] op_sel_hi:[1,0]
    v_pk_mul_f32 v[64:65], v[64:65], v[70:71] op_sel_hi:[1,0]
    v_pk_mul_f32 v[66:67], v[66:67], v[70:71] op_sel_hi:[1,0]
    v_cvt_pk_bf16_f32 v36, v60, v61
    v_cvt_pk_bf16_f32 v37, v62, v63
    v_cvt_pk_bf16_f32 v38, v64, v65
    v_cvt_pk_bf16_f32 v39, v66, v67
    v_cmp_nge_f32 vcc, s92, v69
    s_mov_b64 exec, s[62:63]
    ds_write_b128 v20, v[36:39] offset:9216
    s_mov_b64 exec, -1
    s_cbranch_vccnz sm_slow_113
sm_ok_115:
    s_cmp_eq_u32 s40, 63
    s_cbranch_scc1 fin_116
    s_add_u32 m0, s93, 8192
    s_add_u32 s55, s49, 8192
    buffer_load_dwordx4 v0, s[8:11], s55 offen offset:0 sc1 lds
    buffer_load_dwordx4 v0, s[8:11], s55 offen offset:1024 sc1 lds
    ds_read_b128 v[44:47], v10 offset:49152
    ds_read_b128 v[48:51], v10 offset:50176
    s_waitcnt lgkmcnt(2)
    s_barrier
    ds_read_b128 v[28:31], v0 offset:9216
    ds_read_b128 v[32:35], v1 offset:9216
    ds_read_b128 v[36:39], v0 offset:11264
    ds_read_b128 v[40:43], v1 offset:11264
    ds_read_b128 v[52:55], v10 offset:57344
    ds_read_b128 v[56:59], v10 offset:58368
    v_mov_b64 v[20:21], 0
    s_mov_b32 m0, s93
    s_nop 0
    buffer_load_dwordx4 v0, s[8:11], s49 offen offset:0 sc1 lds
    buffer_load_dwordx4 v0, s[8:11], s49 offen offset:1024 sc1 lds
    s_add_u32 s51, s51, 4096
    s_xor_b32 s51, s51, 0x40000000
    s_mov_b32 s101, 0
    s_waitcnt lgkmcnt(5)
    v_smfmac_f32_16x16x64_bf16 v[16:19], v[28:31], v[44:51], v2
    ds_read_b128 v[60:63], v11 offset:0
    v_smfmac_f32_16x16x64_bf16 v[20:23], v[28:31], v[208:215], v2
    ds_read_b128 v[64:67], v11 offset:1024
    s_waitcnt lgkmcnt(6)
    v_smfmac_f32_16x16x64_bf16 v[20:23], v[32:35], v[216:223], v2
    ds_read_b128 v[68:71], v11 offset:8192
    s_waitcnt lgkmcnt(3)
    v_smfmac_f32_16x16x64_bf16 v[16:19], v[32:35], v[52:59], v2
    ds_read_b128 v[72:75], v11 offset:9216
    v_smfmac_f32_16x16x64_bf16 v[20:23], v[36:39], v[240:247], v2
    ds_read_b128 v[44:47], v11 offset:16384
    v_mov_b64 v[24:25], 0
    v_smfmac_f32_16x16x64_bf16 v[20:23], v[40:43], v[248:255], v2
    ds_read_b128 v[48:51], v11 offset:17408
    v_mov_b64 v[26:27], 0
    s_waitcnt lgkmcnt(4)
    v_smfmac_f32_16x16x64_bf16 v[16:19], v[36:39], v[60:67], v2
    ds_read_b128 v[52:55], v11 offset:24576
    s_waitcnt lgkmcnt(3)
    v_smfmac_f32_16x16x64_bf16 v[16:19], v[40:43], v[68:75], v2
    ds_read_b128 v[56:59], v11 offset:25600
    v_smfmac_f32_16x16x64_bf16 v[24:27], v[28:31], v[224:231], v2
    v_cvt_pk_bf16_f32 v20, v20, v21
    v_smfmac_f32_16x16x64_bf16 v[24:27], v[32:35], v[232:239], v2
    v_cvt_pk_bf16_f32 v21, v22, v23
    s_waitcnt lgkmcnt(2)
    v_smfmac_f32_16x16x64_bf16 v[24:27], v[36:39], v[44:51], v2
    v_cvt_pk_bf16_f32 v19, v18, v19
    s_waitcnt lgkmcnt(0)
    v_smfmac_f32_16x16x64_bf16 v[24:27], v[40:43], v[52:59], v2
    v_cvt_pk_bf16_f32 v18, v16, v17
    v_and_or_b32 v20, v20, -2, s4
    v_and_or_b32 v18, v18, -2, s4
    buffer_store_dwordx4 v[18:21], v4, s[8:11], s41 offen sc1
    s_nop 1
    v_cvt_pk_bf16_f32 v24, v24, v25
    v_cvt_pk_bf16_f32 v25, v26, v27
    v_and_or_b32 v24, v24, -2, s4
    buffer_store_dwordx2 v[24:25], v5, s[8:11], s41 offen sc1
    ds_read_b128 v[60:63], v0 offset:0
    s_sleep 4
    buffer_load_dwordx4 v[28:31], v0, s[8:11], s42 offen offset:0 sc1
    buffer_load_dwordx4 v[32:35], v0, s[8:11], s42 offen offset:1024 sc1
    buffer_load_dwordx4 v[36:39], v0, s[8:11], s42 offen offset:2048 sc1
    buffer_load_dwordx4 v[40:43], v0, s[8:11], s42 offen offset:3072 sc1
    s_sleep 2
    buffer_load_dwordx4 v[28:31], v0, s[8:11], s42 offen offset:0 sc1
    buffer_load_dwordx4 v[32:35], v0, s[8:11], s42 offen offset:1024 sc1
    buffer_load_dwordx4 v[36:39], v0, s[8:11], s42 offen offset:2048 sc1
    buffer_load_dwordx4 v[40:43], v0, s[8:11], s42 offen offset:3072 sc1
    s_waitcnt lgkmcnt(0)
ra_check_117:
    s_waitcnt vmcnt(7)
    v_bitop3_b32 v16, v28, v30, s5 bitop3:0x7e
    v_mfma_f32_16x16x32_bf16 v[68:71], v[28:31], v[60:63], 0
    s_waitcnt vmcnt(6)
    v_bitop3_b32 v17, v32, v34, s5 bitop3:0x7e
    v_or_b32 v16, v16, v17
    v_mfma_f32_16x16x32_bf16 v[68:71], v[32:35], v[60:63], v[68:71]
    s_waitcnt vmcnt(5)
    v_bitop3_b32 v17, v36, v38, s5 bitop3:0x7e
    v_or_b32 v16, v16, v17
    v_lshlrev_b32 v16, 31, v16
    v_mfma_f32_16x16x32_bf16 v[68:71], v[36:39], v[60:63], v[68:71]
    s_waitcnt vmcnt(4)
    v_bitop3_b32 v17, v40, v42, s5 bitop3:0x7e
    v_lshl_or_b32 v16, v17, 31, v16
    v_mfma_f32_16x16x32_bf16 v[68:71], v[40:43], v[60:63], v[68:71]
    v_cmp_gt_i32 vcc, 0, v16
    s_nop 0
    s_cbranch_vccnz ra_stub_118
ra_cont_119:
    s_nop 0
    v_permlane32_swap_b32 v68, v70
    v_permlane32_swap_b32 v69, v71
    v_pk_add_f32 v[68:69], v[68:69], v[70:71]
    v_cvt_pk_bf16_f32 v20, v68, v69
    s_mov_b64 exec, s[60:61]
    buffer_store_dword v20, v8, s[8:11], s45 offen sc1
    s_mov_b64 exec, -1
    s_branch rec_top_Sg
kv_stub_106:
    v_lshrrev_b32 v46, 2, v0
    v_min_u32 v46, 64, v46
kvf_120:
    buffer_load_dword v47, v46, s[8:11], s3 offen sc1
    s_waitcnt vmcnt(0)
    v_cmp_gt_u32 vcc, 2, v47
    s_nop 0
    s_ff1_i32_b64 s7, vcc
    s_lshl_b32 s7, s7, 2
    s_cmp_eq_u32 s7, 64
    s_cselect_b32 s7, 128, s7
    s_add_u32 s54, s40, 2
    s_cmp_lt_u32 s54, s7
    s_cbranch_scc1 kvd_121
    s_sleep 2
    s_sub_u32 s53, s53, 1
    s_cbranch_scc0 kvf_120
    s_mov_b32 s53, 0
    s_mov_b32 s7, 128
kvd_121:
    s_branch kv_cont_107
pl_stub_109:
    s_mov_b32 s89, 1
    s_sub_u32 s53, s53, 1
    s_cbranch_scc1 giveup_122
    s_mov_b64 exec, vcc
    buffer_load_dwordx4 v[44:47], v3, s[8:11], s43 offen offset:0 sc1
    buffer_load_dwordx4 v[48:51], v3, s[8:11], s43 offen offset:1024 sc1
    s_mov_b64 exec, -1
    s_branch pl_check_108
giveup_122:
    s_mov_b32 s53, 0
    s_branch pl_cont_110
rem_stub_111:
    s_sub_u32 s53, s53, 1
    s_cbranch_scc1 rem_give_124
    s_sleep 3
    buffer_load_dwordx4 v[52:55], v3, s[8:11], s44 offen sc1
    s_waitcnt vmcnt(0)
    ds_write_b128 v9, v[52:55] offset:8192
    s_waitcnt lgkmcnt(0)
    v_max3_u32 v52, v52, v53, v54
    v_max_u32 v52, v52, v55
    v_cmp_eq_u32 vcc, -1, v52
    s_nop 0
    s_cbranch_vccnz rem_stub_111
    s_branch rem_cont_112
rem_give_124:
    s_mov_b32 s53, 0
    s_branch rem_cont_112
sm_slow_113:
    s_cmp_lg_u32 s101, 0
    s_cbranch_scc1 sm_ok_115
    s_mov_b32 s101, 1
    s_waitcnt lgkmcnt(0)
    ds_read_b128 v[68:71], v0 offset:16384
    s_waitcnt lgkmcnt(0)
    v_mfma_f32_16x16x32_bf16 v[16:19], v[68:71], v[44:47], 0
    s_nop 3
    ds_read_b128 v[68:71], v0 offset:17408
    s_waitcnt lgkmcnt(0)
    v_mfma_f32_16x16x32_bf16 v[16:19], v[68:71], v[48:51], v[16:19]
    s_nop 3
    ds_read_b128 v[68:71], v0 offset:18432
    s_waitcnt lgkmcnt(0)
    v_mfma_f32_16x16x32_bf16 v[16:19], v[68:71], v[52:55], v[16:19]
    s_nop 3
    ds_read_b128 v[68:71], v0 offset:19456
    s_waitcnt lgkmcnt(0)
    v_mfma_f32_16x16x32_bf16 v[16:19], v[68:71], v[56:59], v[16:19]
    s_nop 3
    ds_read_b128 v[68:71], v0 offset:20480
    s_waitcnt lgkmcnt(0)
    v_mfma_f32_16x16x32_bf16 v[20:23], v[68:71], v[44:47], 0
    s_nop 3
    ds_read_b128 v[68:71], v0 offset:21504
    s_waitcnt lgkmcnt(0)
    v_mfma_f32_16x16x32_bf16 v[20:23], v[68:71], v[48:51], v[20:23]
    s_nop 3
    ds_read_b128 v[68:71], v0 offset:22528
    s_waitcnt lgkmcnt(0)
    v_mfma_f32_16x16x32_bf16 v[20:23], v[68:71], v[52:55], v[20:23]
    s_nop 3
    ds_read_b128 v[68:71], v0 offset:23552
    s_waitcnt lgkmcnt(0)
    v_mfma_f32_16x16x32_bf16 v[20:23], v[68:71], v[56:59], v[20:23]
    s_nop 3
    ds_read_b64_tr_b16 v[68:69], v7 offset:4096
    ds_read_b64_tr_b16 v[70:71], v7 offset:4352
    s_waitcnt lgkmcnt(0)
    v_mfma_f32_16x16x32_bf16 v[40:43], v[68:71], v[44:47], 0
    s_nop 3
    ds_read_b64_tr_b16 v[68:69], v7 offset:4608
    ds_read_b64_tr_b16 v[70:71], v7 offset:4864
    s_waitcnt lgkmcnt(0)
    v_mfma_f32_16x16x32_bf16 v[40:43], v[68:71], v[48:51], v[40:43]
    s_nop 3
    ds_read_b64_tr_b16 v[68:69], v7 offset:5120
    ds_read_b64_tr_b16 v[70:71], v7 offset:5376
    s_waitcnt lgkmcnt(0)
    v_mfma_f32_16x16x32_bf16 v[40:43], v[68:71], v[52:55], v[40:43]
    s_nop 3
    ds_read_b64_tr_b16 v[68:69], v7 offset:5632
    ds_read_b64_tr_b16 v[70:71], v7 offset:5888
    s_waitcnt lgkmcnt(0)
    v_mfma_f32_16x16x32_bf16 v[40:43], v[68:71], v[56:59], v[40:43]
    s_nop 3
    v_max3_f32 v68, v16, v17, v18
    v_max3_f32 v68, v68, v19, v20
    v_max3_f32 v68, v68, v21, v22
    s_nop 0
    v_max3_f32 v68, v68, v23, v40
    v_max3_f32 v68, v68, v41, v42
    v_max_f32 v68, v68, v43
    v_mov_b32 v69, v68
    s_nop 1
    v_permlane16_swap_b32 v68, v69
    v_max_f32 v68, v68, v69
    v_mov_b32 v69, v68
    s_nop 1
    v_permlane32_swap_b32 v68, v69
    v_max_f32 v68, v68, v69
    v_sub_f32 v16, v16, v68
    v_sub_f32 v17, v17, v68
    v_sub_f32 v18, v18, v68
    v_sub_f32 v19, v19, v68
    v_sub_f32 v20, v20, v68
    v_sub_f32 v21, v21, v68
    v_sub_f32 v22, v22, v68
    v_sub_f32 v23, v23, v68
    v_sub_f32 v40, v40, v68
    v_sub_f32 v41, v41, v68
    v_sub_f32 v42, v42, v68
    v_sub_f32 v43, v43, v68
    v_exp_f32 v16, v16
    v_exp_f32 v17, v17
    v_exp_f32 v18, v18
    v_exp_f32 v19, v19
    v_exp_f32 v20, v20
    v_exp_f32 v21, v21
    v_exp_f32 v22, v22
    v_exp_f32 v23, v23
    v_exp_f32 v40, v40
    v_exp_f32 v41, v41
    v_exp_f32 v42, v42
    v_exp_f32 v43, v43
    v_cvt_pk_bf16_f32 v16, v16, v17
    v_cvt_pk_bf16_f32 v17, v18, v19
    v_cvt_pk_bf16_f32 v18, v20, v21
    v_cvt_pk_bf16_f32 v19, v22, v23
    v_cvt_pk_bf16_f32 v40, v40, v41
    v_cvt_pk_bf16_f32 v41, v42, v43
    v_mfma_f32_16x16x32_bf16 v[60:63], v[28:31], v[16:19], 0
    v_mfma_f32_16x16x32_bf16 v[64:67], v[32:35], v[16:19], 0
    v_mfma_f32_16x16x32_bf16 v[68:71], v[12:15], v[16:19], 0
    s_nop 7
    s_branch sm_back_114
fin_116:
    buffer_store_dwordx4 v[76:79], v0, s[8:11], s51 offen sc1
    s_branch main_end0
ra_stub_118:
    s_mov_b32 s88, 1
    s_sub_u32 s53, s53, 1
    s_cbranch_scc1 giveup_125
    s_mov_b64 exec, vcc
    buffer_load_dwordx4 v[28:31], v0, s[8:11], s42 offen offset:0 sc1
    buffer_load_dwordx4 v[32:35], v0, s[8:11], s42 offen offset:1024 sc1
    buffer_load_dwordx4 v[36:39], v0, s[8:11], s42 offen offset:2048 sc1
    buffer_load_dwordx4 v[40:43], v0, s[8:11], s42 offen offset:3072 sc1
    s_mov_b64 exec, -1
    s_branch ra_check_117
giveup_125:
    s_mov_b32 s53, 0
    s_branch ra_cont_119
main_end0:
    s_endpgm
main_worker:
    s_mov_b32 s53, 0x80000
    s_sub_u32 s70, s38, 2
    s_lshl_b32 s70, s70, 5
    s_add_u32 s70, s70, s37
    s_lshl_b32 s78, s70, 10
    s_add_u32 s78, s78, 7340032
    s_mul_i32 s71, s37, 6
    s_add_u32 s71, s71, s38
    s_sub_u32 s71, s71, 2
    s_load_dwordx2 s[12:13], s[0:1], 88
    s_load_dwordx2 s[16:17], s[0:1], 80
    s_load_dwordx2 s[20:21], s[0:1], 0
    s_load_dwordx2 s[24:25], s[0:1], 96
    s_waitcnt lgkmcnt(0)
    s_and_b32 s13, s13, 0xffff
    s_mov_b32 s14, 4915200
    s_mov_b32 s15, 0x20000
    s_and_b32 s17, s17, 0xffff
    s_mov_b32 s18, 1280
    s_mov_b32 s19, 0x20000
    s_and_b32 s21, s21, 0xffff
    s_mov_b32 s22, 2621440
    s_mov_b32 s23, 0x20000
    s_and_b32 s25, s25, 0xffff
    s_mov_b32 s26, 2621440
    s_mov_b32 s27, 0x20000
    s_cmp_ge_u32 s71, 64
    s_cbranch_scc1 doln_126
    s_lshl_b32 s54, s36, 6
    v_add_u32 v0, s54, v0
    s_mov_b32 s82, s71
    s_cmp_ge_u32 s71, 16
    s_cbranch_scc1 nz_128
    v_mov_b64 v[4:5], 0
    v_mov_b64 v[6:7], 0
    v_lshlrev_b32 v1, 4, v0
    s_lshl_b32 s54, s71, 12
    s_add_u32 s54, s54, 2359296
    buffer_store_dwordx4 v[4:7], v1, s[8:11], s54 offen sc1
nz_128:
    v_lshrrev_b32 v3, 2, v0
    v_mul_u32_u24 v2, 76800, v3
    v_and_b32 v1, 3, v0
    v_lshl_add_u32 v2, v1, 4, v2
    s_lshl_b32 s54, s82, 6
    buffer_load_dwordx4 v[32:35], v2, s[12:15], s54 offen
    s_add_u32 s54, s54, 7680
    buffer_load_dwordx4 v[36:39], v2, s[12:15], s54 offen
    s_add_u32 s54, s54, 7680
    buffer_load_dwordx4 v[40:43], v2, s[12:15], s54 offen
    s_add_u32 s54, s54, 7680
    buffer_load_dwordx4 v[44:47], v2, s[12:15], s54 offen
    s_add_u32 s54, s54, 7680
    buffer_load_dwordx4 v[48:51], v2, s[12:15], s54 offen
    s_add_u32 s54, s54, 7680
    buffer_load_dwordx4 v[52:55], v2, s[12:15], s54 offen
    s_add_u32 s54, s54, 7680
    buffer_load_dwordx4 v[56:59], v2, s[12:15], s54 offen
    s_add_u32 s54, s54, 7680
    buffer_load_dwordx4 v[60:63], v2, s[12:15], s54 offen
    s_add_u32 s54, s54, 7680
    buffer_load_dwordx4 v[64:67], v2, s[12:15], s54 offen
    s_add_u32 s54, s54, 7680
    buffer_load_dwordx4 v[68:71], v2, s[12:15], s54 offen
    v_mul_u32_u24 v1, 20, v3
    buffer_load_dword v24, v1, s[16:19], 0 offen offset:0
    buffer_load_dword v25, v1, s[16:19], 0 offen offset:4
    buffer_load_dword v26, v1, s[16:19], 0 offen offset:8
    buffer_load_dword v27, v1, s[16:19], 0 offen offset:12
    buffer_load_dword v28, v1, s[16:19], 0 offen offset:16
    s_waitcnt vmcnt(0)
    v_lshlrev_b32 v4, 16, v24
    v_and_b32 v5, 0xffff0000, v24
    v_lshlrev_b32 v6, 16, v25
    v_and_b32 v7, 0xffff0000, v25
    v_lshlrev_b32 v8, 16, v26
    v_and_b32 v9, 0xffff0000, v26
    v_lshlrev_b32 v10, 16, v27
    v_and_b32 v11, 0xffff0000, v27
    v_lshlrev_b32 v12, 16, v28
    v_and_b32 v13, 0xffff0000, v28
    v_mul_f32 v1, 0xbfb8aa3b, v4
    v_exp_f32 v1, v1
    s_nop 0
    v_add_f32 v1, 1.0, v1
    v_rcp_f32 v1, v1
    s_nop 0
    v_mul_f32 v4, v4, v1
    v_mul_f32 v1, 0xbfb8aa3b, v5
    v_exp_f32 v1, v1
    s_nop 0
    v_add_f32 v1, 1.0, v1
    v_rcp_f32 v1, v1
    s_nop 0
    v_mul_f32 v5, v5, v1
    v_mul_f32 v1, 0xbfb8aa3b, v6
    v_exp_f32 v1, v1
    s_nop 0
    v_add_f32 v1, 1.0, v1
    v_rcp_f32 v1, v1
    s_nop 0
    v_mul_f32 v6, v6, v1
    v_mul_f32 v1, 0xbfb8aa3b, v7
    v_exp_f32 v1, v1
    s_nop 0
    v_add_f32 v1, 1.0, v1
    v_rcp_f32 v1, v1
    s_nop 0
    v_mul_f32 v7, v7, v1
    v_mul_f32 v1, 0xbfb8aa3b, v8
    v_exp_f32 v1, v1
    s_nop 0
    v_add_f32 v1, 1.0, v1
    v_rcp_f32 v1, v1
    s_nop 0
    v_mul_f32 v8, v8, v1
    v_mul_f32 v1, 0xbfb8aa3b, v9
    v_exp_f32 v1, v1
    s_nop 0
    v_add_f32 v1, 1.0, v1
    v_rcp_f32 v1, v1
    s_nop 0
    v_mul_f32 v9, v9, v1
    v_mul_f32 v1, 0xbfb8aa3b, v10
    v_exp_f32 v1, v1
    s_nop 0
    v_add_f32 v1, 1.0, v1
    v_rcp_f32 v1, v1
    s_nop 0
    v_mul_f32 v10, v10, v1
    v_mul_f32 v1, 0xbfb8aa3b, v11
    v_exp_f32 v1, v1
    s_nop 0
    v_add_f32 v1, 1.0, v1
    v_rcp_f32 v1, v1
    s_nop 0
    v_mul_f32 v11, v11, v1
    v_mul_f32 v1, 0xbfb8aa3b, v12
    v_exp_f32 v1, v1
    s_nop 0
    v_add_f32 v1, 1.0, v1
    v_rcp_f32 v1, v1
    s_nop 0
    v_mul_f32 v12, v12, v1
    v_mul_f32 v1, 0xbfb8aa3b, v13
    v_exp_f32 v1, v1
    s_nop 0
    v_add_f32 v1, 1.0, v1
    v_rcp_f32 v1, v1
    s_nop 0
    v_mul_f32 v13, v13, v1
    v_cvt_pk_bf16_f32 v5, v4, v5
    v_lshlrev_b32 v4, 16, v5
    v_and_b32 v5, 0xffff0000, v5
    v_cvt_pk_bf16_f32 v7, v6, v7
    v_lshlrev_b32 v6, 16, v7
    v_and_b32 v7, 0xffff0000, v7
    v_cvt_pk_bf16_f32 v9, v8, v9
    v_lshlrev_b32 v8, 16, v9
    v_and_b32 v9, 0xffff0000, v9
    v_cvt_pk_bf16_f32 v11, v10, v11
    v_lshlrev_b32 v10, 16, v11
    v_and_b32 v11, 0xffff0000, v11
    v_cvt_pk_bf16_f32 v13, v12, v13
    v_lshlrev_b32 v12, 16, v13
    v_and_b32 v13, 0xffff0000, v13
    v_lshlrev_b32 v24, 16, v32
    v_and_b32 v25, 0xffff0000, v32
    v_mul_f32 v16, v4, v24
    v_mul_f32 v17, v4, v25
    v_lshlrev_b32 v24, 16, v33
    v_and_b32 v25, 0xffff0000, v33
    v_mul_f32 v18, v4, v24
    v_mul_f32 v19, v4, v25
    v_lshlrev_b32 v24, 16, v34
    v_and_b32 v25, 0xffff0000, v34
    v_mul_f32 v20, v4, v24
    v_mul_f32 v21, v4, v25
    v_lshlrev_b32 v24, 16, v35
    v_and_b32 v25, 0xffff0000, v35
    v_mul_f32 v22, v4, v24
    v_mul_f32 v23, v4, v25
    v_lshlrev_b32 v24, 16, v36
    v_and_b32 v25, 0xffff0000, v36
    v_fmac_f32 v16, v5, v24
    v_fmac_f32 v17, v5, v25
    v_lshlrev_b32 v24, 16, v37
    v_and_b32 v25, 0xffff0000, v37
    v_fmac_f32 v18, v5, v24
    v_fmac_f32 v19, v5, v25
    v_lshlrev_b32 v24, 16, v38
    v_and_b32 v25, 0xffff0000, v38
    v_fmac_f32 v20, v5, v24
    v_fmac_f32 v21, v5, v25
    v_lshlrev_b32 v24, 16, v39
    v_and_b32 v25, 0xffff0000, v39
    v_fmac_f32 v22, v5, v24
    v_fmac_f32 v23, v5, v25
    v_lshlrev_b32 v24, 16, v40
    v_and_b32 v25, 0xffff0000, v40
    v_fmac_f32 v16, v6, v24
    v_fmac_f32 v17, v6, v25
    v_lshlrev_b32 v24, 16, v41
    v_and_b32 v25, 0xffff0000, v41
    v_fmac_f32 v18, v6, v24
    v_fmac_f32 v19, v6, v25
    v_lshlrev_b32 v24, 16, v42
    v_and_b32 v25, 0xffff0000, v42
    v_fmac_f32 v20, v6, v24
    v_fmac_f32 v21, v6, v25
    v_lshlrev_b32 v24, 16, v43
    v_and_b32 v25, 0xffff0000, v43
    v_fmac_f32 v22, v6, v24
    v_fmac_f32 v23, v6, v25
    v_lshlrev_b32 v24, 16, v44
    v_and_b32 v25, 0xffff0000, v44
    v_fmac_f32 v16, v7, v24
    v_fmac_f32 v17, v7, v25
    v_lshlrev_b32 v24, 16, v45
    v_and_b32 v25, 0xffff0000, v45
    v_fmac_f32 v18, v7, v24
    v_fmac_f32 v19, v7, v25
    v_lshlrev_b32 v24, 16, v46
    v_and_b32 v25, 0xffff0000, v46
    v_fmac_f32 v20, v7, v24
    v_fmac_f32 v21, v7, v25
    v_lshlrev_b32 v24, 16, v47
    v_and_b32 v25, 0xffff0000, v47
    v_fmac_f32 v22, v7, v24
    v_fmac_f32 v23, v7, v25
    v_lshlrev_b32 v24, 16, v48
    v_and_b32 v25, 0xffff0000, v48
    v_fmac_f32 v16, v8, v24
    v_fmac_f32 v17, v8, v25
    v_lshlrev_b32 v24, 16, v49
    v_and_b32 v25, 0xffff0000, v49
    v_fmac_f32 v18, v8, v24
    v_fmac_f32 v19, v8, v25
    v_lshlrev_b32 v24, 16, v50
    v_and_b32 v25, 0xffff0000, v50
    v_fmac_f32 v20, v8, v24
    v_fmac_f32 v21, v8, v25
    v_lshlrev_b32 v24, 16, v51
    v_and_b32 v25, 0xffff0000, v51
    v_fmac_f32 v22, v8, v24
    v_fmac_f32 v23, v8, v25
    v_lshlrev_b32 v24, 16, v52
    v_and_b32 v25, 0xffff0000, v52
    v_fmac_f32 v16, v9, v24
    v_fmac_f32 v17, v9, v25
    v_lshlrev_b32 v24, 16, v53
    v_and_b32 v25, 0xffff0000, v53
    v_fmac_f32 v18, v9, v24
    v_fmac_f32 v19, v9, v25
    v_lshlrev_b32 v24, 16, v54
    v_and_b32 v25, 0xffff0000, v54
    v_fmac_f32 v20, v9, v24
    v_fmac_f32 v21, v9, v25
    v_lshlrev_b32 v24, 16, v55
    v_and_b32 v25, 0xffff0000, v55
    v_fmac_f32 v22, v9, v24
    v_fmac_f32 v23, v9, v25
    v_lshlrev_b32 v24, 16, v56
    v_and_b32 v25, 0xffff0000, v56
    v_fmac_f32 v16, v10, v24
    v_fmac_f32 v17, v10, v25
    v_lshlrev_b32 v24, 16, v57
    v_and_b32 v25, 0xffff0000, v57
    v_fmac_f32 v18, v10, v24
    v_fmac_f32 v19, v10, v25
    v_lshlrev_b32 v24, 16, v58
    v_and_b32 v25, 0xffff0000, v58
    v_fmac_f32 v20, v10, v24
    v_fmac_f32 v21, v10, v25
    v_lshlrev_b32 v24, 16, v59
    v_and_b32 v25, 0xffff0000, v59
    v_fmac_f32 v22, v10, v24
    v_fmac_f32 v23, v10, v25
    v_lshlrev_b32 v24, 16, v60
    v_and_b32 v25, 0xffff0000, v60
    v_fmac_f32 v16, v11, v24
    v_fmac_f32 v17, v11, v25
    v_lshlrev_b32 v24, 16, v61
    v_and_b32 v25, 0xffff0000, v61
    v_fmac_f32 v18, v11, v24
    v_fmac_f32 v19, v11, v25
    v_lshlrev_b32 v24, 16, v62
    v_and_b32 v25, 0xffff0000, v62
    v_fmac_f32 v20, v11, v24
    v_fmac_f32 v21, v11, v25
    v_lshlrev_b32 v24, 16, v63
    v_and_b32 v25, 0xffff0000, v63
    v_fmac_f32 v22, v11, v24
    v_fmac_f32 v23, v11, v25
    v_lshlrev_b32 v24, 16, v64
    v_and_b32 v25, 0xffff0000, v64
    v_fmac_f32 v16, v12, v24
    v_fmac_f32 v17, v12, v25
    v_lshlrev_b32 v24, 16, v65
    v_and_b32 v25, 0xffff0000, v65
    v_fmac_f32 v18, v12, v24
    v_fmac_f32 v19, v12, v25
    v_lshlrev_b32 v24, 16, v66
    v_and_b32 v25, 0xffff0000, v66
    v_fmac_f32 v20, v12, v24
    v_fmac_f32 v21, v12, v25
    v_lshlrev_b32 v24, 16, v67
    v_and_b32 v25, 0xffff0000, v67
    v_fmac_f32 v22, v12, v24
    v_fmac_f32 v23, v12, v25
    v_lshlrev_b32 v24, 16, v68
    v_and_b32 v25, 0xffff0000, v68
    v_fmac_f32 v16, v13, v24
    v_fmac_f32 v17, v13, v25
    v_lshlrev_b32 v24, 16, v69
    v_and_b32 v25, 0xffff0000, v69
    v_fmac_f32 v18, v13, v24
    v_fmac_f32 v19, v13, v25
    v_lshlrev_b32 v24, 16, v70
    v_and_b32 v25, 0xffff0000, v70
    v_fmac_f32 v20, v13, v24
    v_fmac_f32 v21, v13, v25
    v_lshlrev_b32 v24, 16, v71
    v_and_b32 v25, 0xffff0000, v71
    v_fmac_f32 v22, v13, v24
    v_fmac_f32 v23, v13, v25
    v_lshlrev_b32 v1, 5, v0
    ds_write_b128 v1, v[16:19]
    ds_write_b128 v1, v[20:23] offset:16
    s_waitcnt lgkmcnt(0)
    s_barrier
    v_and_b32 v1, 31, v0
    v_lshlrev_b32 v1, 2, v1
    v_lshrrev_b32 v3, 5, v0
    v_lshl_add_u32 v3, v3, 10, v1
    ds_read_b32 v16, v3 offset:0
    ds_read_b32 v17, v3 offset:128
    ds_read_b32 v18, v3 offset:256
    ds_read_b32 v19, v3 offset:384
    ds_read_b32 v20, v3 offset:512
    ds_read_b32 v21, v3 offset:640
    ds_read_b32 v22, v3 offset:768
    ds_read_b32 v23, v3 offset:896
    s_waitcnt lgkmcnt(0)
    v_add_f32 v16, v16, v17
    v_add_f32 v16, v16, v18
    v_add_f32 v16, v16, v19
    v_add_f32 v16, v16, v20
    v_add_f32 v16, v16, v21
    v_add_f32 v16, v16, v22
    v_add_f32 v16, v16, v23
    v_lshlrev_b32 v3, 2, v0
    ds_write_b32 v3, v16 offset:8192
    s_waitcnt lgkmcnt(0)
    s_barrier
    ds_read_b32 v16, v1 offset:8192
    ds_read_b32 v17, v1 offset:8320
    ds_read_b32 v18, v1 offset:8448
    ds_read_b32 v19, v1 offset:8576
    ds_read_b32 v20, v1 offset:8704
    ds_read_b32 v21, v1 offset:8832
    ds_read_b32 v22, v1 offset:8960
    ds_read_b32 v23, v1 offset:9088
    s_waitcnt lgkmcnt(0)
    v_add_f32 v16, v16, v17
    v_add_f32 v16, v16, v18
    v_add_f32 v16, v16, v19
    v_add_f32 v16, v16, v20
    v_add_f32 v16, v16, v21
    v_add_f32 v16, v16, v22
    v_add_f32 v16, v16, v23
    v_cvt_pk_bf16_f32 v16, v16, v16
    v_lshlrev_b32 v16, 16, v16
    v_add_f32 v17, 1.0, v16
    v_cvt_pk_bf16_f32 v17, v17, v17
    v_lshlrev_b32 v17, 16, v17
    s_sub_u32 s54, s82, 20
    s_cmp_lt_u32 s54, 20
    s_cselect_b32 s55, 1, 0
    s_sub_u32 s54, s82, 80
    s_cmp_lt_u32 s54, 20
    s_cselect_b32 s55, 1, s55
    s_cmp_eq_u32 s55, 1
    s_cselect_b64 vcc, -1, 0
    v_cndmask_b32 v16, v16, v17, vcc
    s_lshl_b32 s54, s82, 7
    s_add_u32 s54, s54, 0
    v_cmp_gt_u32 vcc, 32, v0
    s_nop 0
    s_and_saveexec_b64 s[56:57], vcc
    s_cbranch_execz modskip_130
    buffer_store_dword v16, v1, s[8:11], s54 offen sc1
modskip_130:
    s_mov_b64 exec, -1
    s_cmp_ge_u32 s82, 40
    s_cbranch_scc1 fill_127
    s_mov_b32 s75, 240
    s_waitcnt vmcnt(0) lgkmcnt(0)
    s_barrier
    s_cmp_lg_u32 s36, 0
    s_cbranch_scc1 sg_131
    v_mov_b32 v4, 0
    v_mov_b32 v5, 1
    s_mov_b64 exec, 1
    buffer_atomic_add v5, v4, s[32:35], s75 offen sc0
    s_waitcnt vmcnt(0)
    v_readfirstlane_b32 s54, v5
    s_mov_b64 exec, -1
    s_cmp_lg_u32 s54, 39
    s_cbranch_scc1 sg_131
    v_mov_b32 v4, 96
    v_mov_b32 v5, 1
    s_mov_b64 exec, 1
    buffer_store_dword v5, v4, s[32:35], 0 offen sc1
    s_mov_b64 exec, -1
sg_131:
fill_127:
    s_add_u32 s82, s82, 64
    s_cmp_lt_u32 s82, 120
    s_cbranch_scc1 nz_128
    v_mov_b64 v[4:5], -1
    v_mov_b64 v[6:7], -1
    v_lshlrev_b32 v1, 4, v0
    s_mul_i32 s54, s71, 10240
    s_add_u32 s54, s54, 2490368
    buffer_store_dwordx4 v[4:7], v1, s[8:11], s54 offen sc1
    s_add_u32 s54, s54, 4096
    buffer_store_dwordx4 v[4:7], v1, s[8:11], s54 offen sc1
    s_add_u32 s54, s54, 2048
    buffer_store_dwordx4 v[4:7], v1, s[8:11], s54 offen sc1
    s_add_u32 s54, s54, 2048
    v_and_b32 v0, 63, v0
    s_mov_b32 s75, 96
    s_cmp_lg_u32 s36, 0
    s_cbranch_scc1 wd_133
    v_min_u32 v8, 0, v0
    v_mul_u32_u24 v8, 0, v8
wt_132:
    buffer_load_dword v9, v8, s[32:35], s75 offen sc1
    s_waitcnt vmcnt(0)
    v_cmp_gt_u32 vcc, 1, v9
    s_nop 0
    s_cbranch_vccz wd_133
    s_sleep 4
    s_sub_u32 s53, s53, 1
    s_cbranch_scc0 wt_132
    s_mov_b32 s53, 0
wd_133:
    s_barrier
    s_mov_b32 s75, 2359296
    s_waitcnt vmcnt(0) lgkmcnt(0)
    s_barrier
    s_cmp_lg_u32 s36, 0
    s_cbranch_scc1 sg_134
    v_mov_b32 v4, 0
    v_mov_b32 v5, 1
    s_mov_b64 exec, 1
    buffer_atomic_add v5, v4, s[8:11], s75 offen
    s_mov_b64 exec, -1
sg_134:
    s_branch p1d_129
doln_126:
    s_sub_u32 s73, s71, 64
    s_lshl_b32 s72, s73, 2
    s_add_u32 s72, s72, s36
    s_lshl_b32 s72, s72, 2
    v_lshrrev_b32 v4, 4, v0
    v_add_u32 v4, s72, v4
    v_mul_u32_u24 v1, 1280, v4
    v_and_b32 v5, 15, v0
    v_lshl_add_u32 v1, v5, 4, v1
    v_lshlrev_b32 v2, 5, v5
    v_lshrrev_b32 v6, 4, v4
    v_mul_u32_u24 v3, 20480, v6
    v_and_b32 v6, 15, v4
    v_lshl_add_u32 v3, v6, 4, v3
    v_bfe_u32 v6, v0, 0, 2
    v_lshl_add_u32 v3, v6, 8, v3
    v_bfe_u32 v6, v0, 2, 2
    v_lshl_add_u32 v3, v6, 10, v3
    buffer_load_dwordx4 v[8:11], v1, s[20:23], 0 offen offset:0
    buffer_load_dwordx4 v[12:15], v1, s[20:23], 0 offen offset:256
    buffer_load_dwordx4 v[16:19], v1, s[20:23], 0 offen offset:512
    buffer_load_dwordx4 v[20:23], v1, s[20:23], 0 offen offset:768
    buffer_load_dwordx4 v[24:27], v1, s[20:23], 0 offen offset:1024
    s_waitcnt vmcnt(0)
    v_lshlrev_b32 v32, 16, v8
    v_and_b32 v33, 0xffff0000, v8
    v_lshlrev_b32 v34, 16, v9
    v_and_b32 v35, 0xffff0000, v9
    v_lshlrev_b32 v36, 16, v10
    v_and_b32 v37, 0xffff0000, v10
    v_lshlrev_b32 v38, 16, v11
    v_and_b32 v39, 0xffff0000, v11
    v_lshlrev_b32 v40, 16, v12
    v_and_b32 v41, 0xffff0000, v12
    v_lshlrev_b32 v42, 16, v13
    v_and_b32 v43, 0xffff0000, v13
    v_lshlrev_b32 v44, 16, v14
    v_and_b32 v45, 0xffff0000, v14
    v_lshlrev_b32 v46, 16, v15
    v_and_b32 v47, 0xffff0000, v15
    v_lshlrev_b32 v48, 16, v16
    v_and_b32 v49, 0xffff0000, v16
    v_lshlrev_b32 v50, 16, v17
    v_and_b32 v51, 0xffff0000, v17
    v_lshlrev_b32 v52, 16, v18
    v_and_b32 v53, 0xffff0000, v18
    v_lshlrev_b32 v54, 16, v19
    v_and_b32 v55, 0xffff0000, v19
    v_lshlrev_b32 v56, 16, v20
    v_and_b32 v57, 0xffff0000, v20
    v_lshlrev_b32 v58, 16, v21
    v_and_b32 v59, 0xffff0000, v21
    v_lshlrev_b32 v60, 16, v22
    v_and_b32 v61, 0xffff0000, v22
    v_lshlrev_b32 v62, 16, v23
    v_and_b32 v63, 0xffff0000, v23
    v_lshlrev_b32 v64, 16, v24
    v_and_b32 v65, 0xffff0000, v24
    v_lshlrev_b32 v66, 16, v25
    v_and_b32 v67, 0xffff0000, v25
    v_lshlrev_b32 v68, 16, v26
    v_and_b32 v69, 0xffff0000, v26
    v_lshlrev_b32 v70, 16, v27
    v_and_b32 v71, 0xffff0000, v27
    v_pk_add_f32 v[28:29], v[32:33], v[34:35]
    v_pk_add_f32 v[28:29], v[28:29], v[36:37]
    v_pk_add_f32 v[28:29], v[28:29], v[38:39]
    v_pk_add_f32 v[28:29], v[28:29], v[40:41]
    v_pk_add_f32 v[28:29], v[28:29], v[42:43]
    v_pk_add_f32 v[28:29], v[28:29], v[44:45]
    v_pk_add_f32 v[28:29], v[28:29], v[46:47]
    v_pk_add_f32 v[28:29], v[28:29], v[48:49]
    v_pk_add_f32 v[28:29], v[28:29], v[50:51]
    v_pk_add_f32 v[28:29], v[28:29], v[52:53]
    v_pk_add_f32 v[28:29], v[28:29], v[54:55]
    v_pk_add_f32 v[28:29], v[28:29], v[56:57]
    v_pk_add_f32 v[28:29], v[28:29], v[58:59]
    v_pk_add_f32 v[28:29], v[28:29], v[60:61]
    v_pk_add_f32 v[28:29], v[28:29], v[62:63]
    v_pk_add_f32 v[28:29], v[28:29], v[64:65]
    v_pk_add_f32 v[28:29], v[28:29], v[66:67]
    v_pk_add_f32 v[28:29], v[28:29], v[68:69]
    v_pk_add_f32 v[28:29], v[28:29], v[70:71]
    v_add_f32 v5, v28, v29
    s_nop 1
    v_add_f32 v5, v5, v5 row_ror:1
    s_nop 1
    v_add_f32 v5, v5, v5 row_ror:2
    s_nop 1
    v_add_f32 v5, v5, v5 row_ror:4
    s_nop 1
    v_add_f32 v5, v5, v5 row_ror:8
    v_mul_f32 v5, 0x3acccccd, v5
    v_mov_b32 v6, 0
    v_sub_f32 v28, v32, v5
    v_fmac_f32 v6, v28, v28
    v_sub_f32 v29, v33, v5
    v_fmac_f32 v6, v29, v29
    v_sub_f32 v28, v34, v5
    v_fmac_f32 v6, v28, v28
    v_sub_f32 v29, v35, v5
    v_fmac_f32 v6, v29, v29
    v_sub_f32 v28, v36, v5
    v_fmac_f32 v6, v28, v28
    v_sub_f32 v29, v37, v5
    v_fmac_f32 v6, v29, v29
    v_sub_f32 v28, v38, v5
    v_fmac_f32 v6, v28, v28
    v_sub_f32 v29, v39, v5
    v_fmac_f32 v6, v29, v29
    v_sub_f32 v28, v40, v5
    v_fmac_f32 v6, v28, v28
    v_sub_f32 v29, v41, v5
    v_fmac_f32 v6, v29, v29
    v_sub_f32 v28, v42, v5
    v_fmac_f32 v6, v28, v28
    v_sub_f32 v29, v43, v5
    v_fmac_f32 v6, v29, v29
    v_sub_f32 v28, v44, v5
    v_fmac_f32 v6, v28, v28
    v_sub_f32 v29, v45, v5
    v_fmac_f32 v6, v29, v29
    v_sub_f32 v28, v46, v5
    v_fmac_f32 v6, v28, v28
    v_sub_f32 v29, v47, v5
    v_fmac_f32 v6, v29, v29
    v_sub_f32 v28, v48, v5
    v_fmac_f32 v6, v28, v28
    v_sub_f32 v29, v49, v5
    v_fmac_f32 v6, v29, v29
    v_sub_f32 v28, v50, v5
    v_fmac_f32 v6, v28, v28
    v_sub_f32 v29, v51, v5
    v_fmac_f32 v6, v29, v29
    v_sub_f32 v28, v52, v5
    v_fmac_f32 v6, v28, v28
    v_sub_f32 v29, v53, v5
    v_fmac_f32 v6, v29, v29
    v_sub_f32 v28, v54, v5
    v_fmac_f32 v6, v28, v28
    v_sub_f32 v29, v55, v5
    v_fmac_f32 v6, v29, v29
    v_sub_f32 v28, v56, v5
    v_fmac_f32 v6, v28, v28
    v_sub_f32 v29, v57, v5
    v_fmac_f32 v6, v29, v29
    v_sub_f32 v28, v58, v5
    v_fmac_f32 v6, v28, v28
    v_sub_f32 v29, v59, v5
    v_fmac_f32 v6, v29, v29
    v_sub_f32 v28, v60, v5
    v_fmac_f32 v6, v28, v28
    v_sub_f32 v29, v61, v5
    v_fmac_f32 v6, v29, v29
    v_sub_f32 v28, v62, v5
    v_fmac_f32 v6, v28, v28
    v_sub_f32 v29, v63, v5
    v_fmac_f32 v6, v29, v29
    v_sub_f32 v28, v64, v5
    v_fmac_f32 v6, v28, v28
    v_sub_f32 v29, v65, v5
    v_fmac_f32 v6, v29, v29
    v_sub_f32 v28, v66, v5
    v_fmac_f32 v6, v28, v28
    v_sub_f32 v29, v67, v5
    v_fmac_f32 v6, v29, v29
    v_sub_f32 v28, v68, v5
    v_fmac_f32 v6, v28, v28
    v_sub_f32 v29, v69, v5
    v_fmac_f32 v6, v29, v29
    v_sub_f32 v28, v70, v5
    v_fmac_f32 v6, v28, v28
    v_sub_f32 v29, v71, v5
    v_fmac_f32 v6, v29, v29
    s_nop 1
    v_add_f32 v6, v6, v6 row_ror:1
    s_nop 1
    v_add_f32 v6, v6, v6 row_ror:2
    s_nop 1
    v_add_f32 v6, v6, v6 row_ror:4
    s_nop 1
    v_add_f32 v6, v6, v6 row_ror:8
    v_mul_f32 v6, 0x3acccccd, v6
    v_cvt_pk_bf16_f32 v6, v5, v6
    v_lshlrev_b32 v5, 16, v6
    v_and_b32 v6, 0xffff0000, v6
    v_add_f32 v6, 0x3727c5ac, v6
    v_cvt_pk_bf16_f32 v6, v6, v6
    v_lshlrev_b32 v6, 16, v6
    v_sqrt_f32 v6, v6
    s_nop 0
    v_cvt_pk_bf16_f32 v6, v6, v6
    v_lshlrev_b32 v6, 16, v6
    v_rcp_f32 v28, v6
    v_mov_b32 v30, v5
    v_pk_add_f32 v[32:33], v[32:33], v[30:31] op_sel_hi:[1,0] neg_lo:[0,1] neg_hi:[0,1]
    v_cvt_pk_bf16_f32 v33, v32, v33
    v_lshlrev_b32 v32, 16, v33
    v_and_b32 v33, 0xffff0000, v33
    v_pk_mul_f32 v[32:33], v[32:33], v[28:29] op_sel_hi:[1,0]
    v_cvt_pk_bf16_f32 v33, v32, v33
    v_lshlrev_b32 v32, 16, v33
    v_and_b32 v33, 0xffff0000, v33
    v_pk_add_f32 v[34:35], v[34:35], v[30:31] op_sel_hi:[1,0] neg_lo:[0,1] neg_hi:[0,1]
    v_cvt_pk_bf16_f32 v35, v34, v35
    v_lshlrev_b32 v34, 16, v35
    v_and_b32 v35, 0xffff0000, v35
    v_pk_mul_f32 v[34:35], v[34:35], v[28:29] op_sel_hi:[1,0]
    v_cvt_pk_bf16_f32 v35, v34, v35
    v_lshlrev_b32 v34, 16, v35
    v_and_b32 v35, 0xffff0000, v35
    v_pk_add_f32 v[36:37], v[36:37], v[30:31] op_sel_hi:[1,0] neg_lo:[0,1] neg_hi:[0,1]
    v_cvt_pk_bf16_f32 v37, v36, v37
    v_lshlrev_b32 v36, 16, v37
    v_and_b32 v37, 0xffff0000, v37
    v_pk_mul_f32 v[36:37], v[36:37], v[28:29] op_sel_hi:[1,0]
    v_cvt_pk_bf16_f32 v37, v36, v37
    v_lshlrev_b32 v36, 16, v37
    v_and_b32 v37, 0xffff0000, v37
    v_pk_add_f32 v[38:39], v[38:39], v[30:31] op_sel_hi:[1,0] neg_lo:[0,1] neg_hi:[0,1]
    v_cvt_pk_bf16_f32 v39, v38, v39
    v_lshlrev_b32 v38, 16, v39
    v_and_b32 v39, 0xffff0000, v39
    v_pk_mul_f32 v[38:39], v[38:39], v[28:29] op_sel_hi:[1,0]
    v_cvt_pk_bf16_f32 v39, v38, v39
    v_lshlrev_b32 v38, 16, v39
    v_and_b32 v39, 0xffff0000, v39
    v_pk_add_f32 v[40:41], v[40:41], v[30:31] op_sel_hi:[1,0] neg_lo:[0,1] neg_hi:[0,1]
    v_cvt_pk_bf16_f32 v41, v40, v41
    v_lshlrev_b32 v40, 16, v41
    v_and_b32 v41, 0xffff0000, v41
    v_pk_mul_f32 v[40:41], v[40:41], v[28:29] op_sel_hi:[1,0]
    v_cvt_pk_bf16_f32 v41, v40, v41
    v_lshlrev_b32 v40, 16, v41
    v_and_b32 v41, 0xffff0000, v41
    v_pk_add_f32 v[42:43], v[42:43], v[30:31] op_sel_hi:[1,0] neg_lo:[0,1] neg_hi:[0,1]
    v_cvt_pk_bf16_f32 v43, v42, v43
    v_lshlrev_b32 v42, 16, v43
    v_and_b32 v43, 0xffff0000, v43
    v_pk_mul_f32 v[42:43], v[42:43], v[28:29] op_sel_hi:[1,0]
    v_cvt_pk_bf16_f32 v43, v42, v43
    v_lshlrev_b32 v42, 16, v43
    v_and_b32 v43, 0xffff0000, v43
    v_pk_add_f32 v[44:45], v[44:45], v[30:31] op_sel_hi:[1,0] neg_lo:[0,1] neg_hi:[0,1]
    v_cvt_pk_bf16_f32 v45, v44, v45
    v_lshlrev_b32 v44, 16, v45
    v_and_b32 v45, 0xffff0000, v45
    v_pk_mul_f32 v[44:45], v[44:45], v[28:29] op_sel_hi:[1,0]
    v_cvt_pk_bf16_f32 v45, v44, v45
    v_lshlrev_b32 v44, 16, v45
    v_and_b32 v45, 0xffff0000, v45
    v_pk_add_f32 v[46:47], v[46:47], v[30:31] op_sel_hi:[1,0] neg_lo:[0,1] neg_hi:[0,1]
    v_cvt_pk_bf16_f32 v47, v46, v47
    v_lshlrev_b32 v46, 16, v47
    v_and_b32 v47, 0xffff0000, v47
    v_pk_mul_f32 v[46:47], v[46:47], v[28:29] op_sel_hi:[1,0]
    v_cvt_pk_bf16_f32 v47, v46, v47
    v_lshlrev_b32 v46, 16, v47
    v_and_b32 v47, 0xffff0000, v47
    v_pk_add_f32 v[48:49], v[48:49], v[30:31] op_sel_hi:[1,0] neg_lo:[0,1] neg_hi:[0,1]
    v_cvt_pk_bf16_f32 v49, v48, v49
    v_lshlrev_b32 v48, 16, v49
    v_and_b32 v49, 0xffff0000, v49
    v_pk_mul_f32 v[48:49], v[48:49], v[28:29] op_sel_hi:[1,0]
    v_cvt_pk_bf16_f32 v49, v48, v49
    v_lshlrev_b32 v48, 16, v49
    v_and_b32 v49, 0xffff0000, v49
    v_pk_add_f32 v[50:51], v[50:51], v[30:31] op_sel_hi:[1,0] neg_lo:[0,1] neg_hi:[0,1]
    v_cvt_pk_bf16_f32 v51, v50, v51
    v_lshlrev_b32 v50, 16, v51
    v_and_b32 v51, 0xffff0000, v51
    v_pk_mul_f32 v[50:51], v[50:51], v[28:29] op_sel_hi:[1,0]
    v_cvt_pk_bf16_f32 v51, v50, v51
    v_lshlrev_b32 v50, 16, v51
    v_and_b32 v51, 0xffff0000, v51
    v_pk_add_f32 v[52:53], v[52:53], v[30:31] op_sel_hi:[1,0] neg_lo:[0,1] neg_hi:[0,1]
    v_cvt_pk_bf16_f32 v53, v52, v53
    v_lshlrev_b32 v52, 16, v53
    v_and_b32 v53, 0xffff0000, v53
    v_pk_mul_f32 v[52:53], v[52:53], v[28:29] op_sel_hi:[1,0]
    v_cvt_pk_bf16_f32 v53, v52, v53
    v_lshlrev_b32 v52, 16, v53
    v_and_b32 v53, 0xffff0000, v53
    v_pk_add_f32 v[54:55], v[54:55], v[30:31] op_sel_hi:[1,0] neg_lo:[0,1] neg_hi:[0,1]
    v_cvt_pk_bf16_f32 v55, v54, v55
    v_lshlrev_b32 v54, 16, v55
    v_and_b32 v55, 0xffff0000, v55
    v_pk_mul_f32 v[54:55], v[54:55], v[28:29] op_sel_hi:[1,0]
    v_cvt_pk_bf16_f32 v55, v54, v55
    v_lshlrev_b32 v54, 16, v55
    v_and_b32 v55, 0xffff0000, v55
    v_pk_add_f32 v[56:57], v[56:57], v[30:31] op_sel_hi:[1,0] neg_lo:[0,1] neg_hi:[0,1]
    v_cvt_pk_bf16_f32 v57, v56, v57
    v_lshlrev_b32 v56, 16, v57
    v_and_b32 v57, 0xffff0000, v57
    v_pk_mul_f32 v[56:57], v[56:57], v[28:29] op_sel_hi:[1,0]
    v_cvt_pk_bf16_f32 v57, v56, v57
    v_lshlrev_b32 v56, 16, v57
    v_and_b32 v57, 0xffff0000, v57
    v_pk_add_f32 v[58:59], v[58:59], v[30:31] op_sel_hi:[1,0] neg_lo:[0,1] neg_hi:[0,1]
    v_cvt_pk_bf16_f32 v59, v58, v59
    v_lshlrev_b32 v58, 16, v59
    v_and_b32 v59, 0xffff0000, v59
    v_pk_mul_f32 v[58:59], v[58:59], v[28:29] op_sel_hi:[1,0]
    v_cvt_pk_bf16_f32 v59, v58, v59
    v_lshlrev_b32 v58, 16, v59
    v_and_b32 v59, 0xffff0000, v59
    v_pk_add_f32 v[60:61], v[60:61], v[30:31] op_sel_hi:[1,0] neg_lo:[0,1] neg_hi:[0,1]
    v_cvt_pk_bf16_f32 v61, v60, v61
    v_lshlrev_b32 v60, 16, v61
    v_and_b32 v61, 0xffff0000, v61
    v_pk_mul_f32 v[60:61], v[60:61], v[28:29] op_sel_hi:[1,0]
    v_cvt_pk_bf16_f32 v61, v60, v61
    v_lshlrev_b32 v60, 16, v61
    v_and_b32 v61, 0xffff0000, v61
    v_pk_add_f32 v[62:63], v[62:63], v[30:31] op_sel_hi:[1,0] neg_lo:[0,1] neg_hi:[0,1]
    v_cvt_pk_bf16_f32 v63, v62, v63
    v_lshlrev_b32 v62, 16, v63
    v_and_b32 v63, 0xffff0000, v63
    v_pk_mul_f32 v[62:63], v[62:63], v[28:29] op_sel_hi:[1,0]
    v_cvt_pk_bf16_f32 v63, v62, v63
    v_lshlrev_b32 v62, 16, v63
    v_and_b32 v63, 0xffff0000, v63
    v_pk_add_f32 v[64:65], v[64:65], v[30:31] op_sel_hi:[1,0] neg_lo:[0,1] neg_hi:[0,1]
    v_cvt_pk_bf16_f32 v65, v64, v65
    v_lshlrev_b32 v64, 16, v65
    v_and_b32 v65, 0xffff0000, v65
    v_pk_mul_f32 v[64:65], v[64:65], v[28:29] op_sel_hi:[1,0]
    v_cvt_pk_bf16_f32 v65, v64, v65
    v_lshlrev_b32 v64, 16, v65
    v_and_b32 v65, 0xffff0000, v65
    v_pk_add_f32 v[66:67], v[66:67], v[30:31] op_sel_hi:[1,0] neg_lo:[0,1] neg_hi:[0,1]
    v_cvt_pk_bf16_f32 v67, v66, v67
    v_lshlrev_b32 v66, 16, v67
    v_and_b32 v67, 0xffff0000, v67
    v_pk_mul_f32 v[66:67], v[66:67], v[28:29] op_sel_hi:[1,0]
    v_cvt_pk_bf16_f32 v67, v66, v67
    v_lshlrev_b32 v66, 16, v67
    v_and_b32 v67, 0xffff0000, v67
    v_pk_add_f32 v[68:69], v[68:69], v[30:31] op_sel_hi:[1,0] neg_lo:[0,1] neg_hi:[0,1]
    v_cvt_pk_bf16_f32 v69, v68, v69
    v_lshlrev_b32 v68, 16, v69
    v_and_b32 v69, 0xffff0000, v69
    v_pk_mul_f32 v[68:69], v[68:69], v[28:29] op_sel_hi:[1,0]
    v_cvt_pk_bf16_f32 v69, v68, v69
    v_lshlrev_b32 v68, 16, v69
    v_and_b32 v69, 0xffff0000, v69
    v_pk_add_f32 v[70:71], v[70:71], v[30:31] op_sel_hi:[1,0] neg_lo:[0,1] neg_hi:[0,1]
    v_cvt_pk_bf16_f32 v71, v70, v71
    v_lshlrev_b32 v70, 16, v71
    v_and_b32 v71, 0xffff0000, v71
    v_pk_mul_f32 v[70:71], v[70:71], v[28:29] op_sel_hi:[1,0]
    v_cvt_pk_bf16_f32 v71, v70, v71
    v_lshlrev_b32 v70, 16, v71
    v_and_b32 v71, 0xffff0000, v71
    s_mov_b32 s75, 96
    s_cmp_lg_u32 s36, 0
    s_cbranch_scc1 wd_136
    v_min_u32 v8, 0, v0
    v_mul_u32_u24 v8, 0, v8
wt_135:
    buffer_load_dword v9, v8, s[32:35], s75 offen sc1
    s_waitcnt vmcnt(0)
    v_cmp_gt_u32 vcc, 1, v9
    s_nop 0
    s_cbranch_vccz wd_136
    s_sleep 4
    s_sub_u32 s53, s53, 1
    s_cbranch_scc0 wt_135
    s_mov_b32 s53, 0
wd_136:
    s_barrier
    s_mov_b32 s54, 0
    s_mov_b32 s56, 2560
    buffer_load_dwordx4 v[72:75], v2, s[8:11], s56 offen offset:0 sc1
    buffer_load_dwordx4 v[112:115], v2, s[8:11], s54 offen offset:0 sc1
    buffer_load_dwordx4 v[76:79], v2, s[8:11], s56 offen offset:16 sc1
    buffer_load_dwordx4 v[116:119], v2, s[8:11], s54 offen offset:16 sc1
    buffer_load_dwordx4 v[80:83], v2, s[8:11], s56 offen offset:512 sc1
    buffer_load_dwordx4 v[120:123], v2, s[8:11], s54 offen offset:512 sc1
    buffer_load_dwordx4 v[84:87], v2, s[8:11], s56 offen offset:528 sc1
    buffer_load_dwordx4 v[124:127], v2, s[8:11], s54 offen offset:528 sc1
    buffer_load_dwordx4 v[88:91], v2, s[8:11], s56 offen offset:1024 sc1
    buffer_load_dwordx4 v[128:131], v2, s[8:11], s54 offen offset:1024 sc1
    buffer_load_dwordx4 v[92:95], v2, s[8:11], s56 offen offset:1040 sc1
    buffer_load_dwordx4 v[132:135], v2, s[8:11], s54 offen offset:1040 sc1
    buffer_load_dwordx4 v[96:99], v2, s[8:11], s56 offen offset:1536 sc1
    buffer_load_dwordx4 v[136:139], v2, s[8:11], s54 offen offset:1536 sc1
    buffer_load_dwordx4 v[100:103], v2, s[8:11], s56 offen offset:1552 sc1
    buffer_load_dwordx4 v[140:143], v2, s[8:11], s54 offen offset:1552 sc1
    buffer_load_dwordx4 v[104:107], v2, s[8:11], s56 offen offset:2048 sc1
    buffer_load_dwordx4 v[144:147], v2, s[8:11], s54 offen offset:2048 sc1
    buffer_load_dwordx4 v[108:111], v2, s[8:11], s56 offen offset:2064 sc1
    buffer_load_dwordx4 v[148:151], v2, s[8:11], s54 offen offset:2064 sc1
    s_mov_b32 s55, 8388608
    s_waitcnt vmcnt(16)
    v_pk_mul_f32 v[32:33], v[32:33], v[72:73]
    v_cvt_pk_bf16_f32 v33, v32, v33
    v_lshlrev_b32 v32, 16, v33
    v_and_b32 v33, 0xffff0000, v33
    v_pk_add_f32 v[32:33], v[32:33], v[112:113]
    v_cvt_pk_bf16_f32 v152, v32, v33
    v_pk_mul_f32 v[34:35], v[34:35], v[74:75]
    v_cvt_pk_bf16_f32 v35, v34, v35
    v_lshlrev_b32 v34, 16, v35
    v_and_b32 v35, 0xffff0000, v35
    v_pk_add_f32 v[34:35], v[34:35], v[114:115]
    v_cvt_pk_bf16_f32 v153, v34, v35
    v_pk_mul_f32 v[36:37], v[36:37], v[76:77]
    v_cvt_pk_bf16_f32 v37, v36, v37
    v_lshlrev_b32 v36, 16, v37
    v_and_b32 v37, 0xffff0000, v37
    v_pk_add_f32 v[36:37], v[36:37], v[116:117]
    v_cvt_pk_bf16_f32 v154, v36, v37
    v_pk_mul_f32 v[38:39], v[38:39], v[78:79]
    v_cvt_pk_bf16_f32 v39, v38, v39
    v_lshlrev_b32 v38, 16, v39
    v_and_b32 v39, 0xffff0000, v39
    v_pk_add_f32 v[38:39], v[38:39], v[118:119]
    v_cvt_pk_bf16_f32 v155, v38, v39
    buffer_store_dwordx4 v[152:155], v3, s[8:11], s55 offen sc1
    s_add_u32 s55, s55, 4096
    s_waitcnt vmcnt(13)
    v_pk_mul_f32 v[40:41], v[40:41], v[80:81]
    v_cvt_pk_bf16_f32 v41, v40, v41
    v_lshlrev_b32 v40, 16, v41
    v_and_b32 v41, 0xffff0000, v41
    v_pk_add_f32 v[40:41], v[40:41], v[120:121]
    v_cvt_pk_bf16_f32 v156, v40, v41
    v_pk_mul_f32 v[42:43], v[42:43], v[82:83]
    v_cvt_pk_bf16_f32 v43, v42, v43
    v_lshlrev_b32 v42, 16, v43
    v_and_b32 v43, 0xffff0000, v43
    v_pk_add_f32 v[42:43], v[42:43], v[122:123]
    v_cvt_pk_bf16_f32 v157, v42, v43
    v_pk_mul_f32 v[44:45], v[44:45], v[84:85]
    v_cvt_pk_bf16_f32 v45, v44, v45
    v_lshlrev_b32 v44, 16, v45
    v_and_b32 v45, 0xffff0000, v45
    v_pk_add_f32 v[44:45], v[44:45], v[124:125]
    v_cvt_pk_bf16_f32 v158, v44, v45
    v_pk_mul_f32 v[46:47], v[46:47], v[86:87]
    v_cvt_pk_bf16_f32 v47, v46, v47
    v_lshlrev_b32 v46, 16, v47
    v_and_b32 v47, 0xffff0000, v47
    v_pk_add_f32 v[46:47], v[46:47], v[126:127]
    v_cvt_pk_bf16_f32 v159, v46, v47
    buffer_store_dwordx4 v[156:159], v3, s[8:11], s55 offen sc1
    s_add_u32 s55, s55, 4096
    s_waitcnt vmcnt(10)
    v_pk_mul_f32 v[48:49], v[48:49], v[88:89]
    v_cvt_pk_bf16_f32 v49, v48, v49
    v_lshlrev_b32 v48, 16, v49
    v_and_b32 v49, 0xffff0000, v49
    v_pk_add_f32 v[48:49], v[48:49], v[128:129]
    v_cvt_pk_bf16_f32 v160, v48, v49
    v_pk_mul_f32 v[50:51], v[50:51], v[90:91]
    v_cvt_pk_bf16_f32 v51, v50, v51
    v_lshlrev_b32 v50, 16, v51
    v_and_b32 v51, 0xffff0000, v51
    v_pk_add_f32 v[50:51], v[50:51], v[130:131]
    v_cvt_pk_bf16_f32 v161, v50, v51
    v_pk_mul_f32 v[52:53], v[52:53], v[92:93]
    v_cvt_pk_bf16_f32 v53, v52, v53
    v_lshlrev_b32 v52, 16, v53
    v_and_b32 v53, 0xffff0000, v53
    v_pk_add_f32 v[52:53], v[52:53], v[132:133]
    v_cvt_pk_bf16_f32 v162, v52, v53
    v_pk_mul_f32 v[54:55], v[54:55], v[94:95]
    v_cvt_pk_bf16_f32 v55, v54, v55
    v_lshlrev_b32 v54, 16, v55
    v_and_b32 v55, 0xffff0000, v55
    v_pk_add_f32 v[54:55], v[54:55], v[134:135]
    v_cvt_pk_bf16_f32 v163, v54, v55
    buffer_store_dwordx4 v[160:163], v3, s[8:11], s55 offen sc1
    s_add_u32 s55, s55, 4096
    s_waitcnt vmcnt(7)
    v_pk_mul_f32 v[56:57], v[56:57], v[96:97]
    v_cvt_pk_bf16_f32 v57, v56, v57
    v_lshlrev_b32 v56, 16, v57
    v_and_b32 v57, 0xffff0000, v57
    v_pk_add_f32 v[56:57], v[56:57], v[136:137]
    v_cvt_pk_bf16_f32 v164, v56, v57
    v_pk_mul_f32 v[58:59], v[58:59], v[98:99]
    v_cvt_pk_bf16_f32 v59, v58, v59
    v_lshlrev_b32 v58, 16, v59
    v_and_b32 v59, 0xffff0000, v59
    v_pk_add_f32 v[58:59], v[58:59], v[138:139]
    v_cvt_pk_bf16_f32 v165, v58, v59
    v_pk_mul_f32 v[60:61], v[60:61], v[100:101]
    v_cvt_pk_bf16_f32 v61, v60, v61
    v_lshlrev_b32 v60, 16, v61
    v_and_b32 v61, 0xffff0000, v61
    v_pk_add_f32 v[60:61], v[60:61], v[140:141]
    v_cvt_pk_bf16_f32 v166, v60, v61
    v_pk_mul_f32 v[62:63], v[62:63], v[102:103]
    v_cvt_pk_bf16_f32 v63, v62, v63
    v_lshlrev_b32 v62, 16, v63
    v_and_b32 v63, 0xffff0000, v63
    v_pk_add_f32 v[62:63], v[62:63], v[142:143]
    v_cvt_pk_bf16_f32 v167, v62, v63
    buffer_store_dwordx4 v[164:167], v3, s[8:11], s55 offen sc1
    s_add_u32 s55, s55, 4096
    s_waitcnt vmcnt(4)
    v_pk_mul_f32 v[64:65], v[64:65], v[104:105]
    v_cvt_pk_bf16_f32 v65, v64, v65
    v_lshlrev_b32 v64, 16, v65
    v_and_b32 v65, 0xffff0000, v65
    v_pk_add_f32 v[64:65], v[64:65], v[144:145]
    v_cvt_pk_bf16_f32 v168, v64, v65
    v_pk_mul_f32 v[66:67], v[66:67], v[106:107]
    v_cvt_pk_bf16_f32 v67, v66, v67
    v_lshlrev_b32 v66, 16, v67
    v_and_b32 v67, 0xffff0000, v67
    v_pk_add_f32 v[66:67], v[66:67], v[146:147]
    v_cvt_pk_bf16_f32 v169, v66, v67
    v_pk_mul_f32 v[68:69], v[68:69], v[108:109]
    v_cvt_pk_bf16_f32 v69, v68, v69
    v_lshlrev_b32 v68, 16, v69
    v_and_b32 v69, 0xffff0000, v69
    v_pk_add_f32 v[68:69], v[68:69], v[148:149]
    v_cvt_pk_bf16_f32 v170, v68, v69
    v_pk_mul_f32 v[70:71], v[70:71], v[110:111]
    v_cvt_pk_bf16_f32 v71, v70, v71
    v_lshlrev_b32 v70, 16, v71
    v_and_b32 v71, 0xffff0000, v71
    v_pk_add_f32 v[70:71], v[70:71], v[150:151]
    v_cvt_pk_bf16_f32 v171, v70, v71
    buffer_store_dwordx4 v[168:171], v3, s[8:11], s55 offen sc1
    s_add_u32 s55, s55, 4096
    s_lshr_b32 s75, s73, 3
    s_lshl_b32 s75, s75, 7
    s_add_u32 s75, s75, 2360320
    s_waitcnt vmcnt(0) lgkmcnt(0)
    s_barrier
    s_cmp_lg_u32 s36, 0
    s_cbranch_scc1 sg_137
    v_mov_b32 v4, 0
    v_mov_b32 v5, 1
    s_mov_b64 exec, 1
    buffer_atomic_add v5, v4, s[8:11], s75 offen
    s_mov_b64 exec, -1
sg_137:
p1d_129:
    s_mov_b32 s71, 0
rtop_138:
    s_mul_i32 s73, s70, 171
    s_lshr_b32 s73, s73, 10
    s_mul_i32 s72, s73, 6
    s_sub_u32 s72, s70, s72
    s_cmp_lt_u32 s71, 2
    s_cbranch_scc1 half_145
    s_cmp_eq_u32 s71, 4
    s_cbranch_scc1 r4_144
    s_add_u32 s72, s72, 6
    s_cmp_eq_u32 s71, 3
    s_cbranch_scc1 dokv_140
    s_bitcmp0_b32 s73, 0
    s_cselect_b32 s54, 6, 0
    s_sub_u32 s72, s72, s54
    s_lshr_b32 s73, s73, 1
    s_branch doq_139
r4_144:
    s_add_u32 s72, s72, 12
    s_cmp_lt_u32 s72, 16
    s_cbranch_scc1 dokv_140
    s_and_b32 s54, s73, 1
    s_lshl_b32 s54, s54, 1
    s_add_u32 s72, s72, s54
    s_sub_u32 s72, s72, 4
    s_lshr_b32 s73, s73, 1
doq_139:
    s_load_dwordx2 s[12:13], s[0:1], 16
    s_waitcnt lgkmcnt(0)
    s_and_b32 s13, s13, 0xffff
    s_mov_b32 s14, 5242880
    s_mov_b32 s15, 0x20000
    s_lshl_b32 s45, s72, 2
    s_add_u32 s45, s45, s36
    s_mul_i32 s40, s45, 40960
    s_add_u32 s40, s40, 8388608
    s_lshl_b32 s41, s73, 9
    v_lshlrev_b32 v1, 4, v0
    v_bfe_u32 v2, v0, 4, 2
    v_lshlrev_b32 v8, 3, v2
    v_bfe_u32 v2, v0, 2, 2
    v_lshl_add_u32 v8, v2, 0, v8
    s_mov_b32 s55, 8192
    v_mul_lo_u32 v8, v8, s55
    v_lshrrev_b32 v2, 3, v0
    v_and_b32 v2, 2, v2
    v_xor_b32 v2, v2, v0
    v_and_b32 v2, 3, v2
    v_lshl_add_u32 v8, v2, 4, v8
    v_bfe_u32 v2, v0, 2, 4
    v_lshlrev_b32 v4, 6, v2
    v_bfe_u32 v2, v0, 4, 1
    v_lshl_add_u32 v4, v2, 5, v4
    v_bfe_u32 v2, v0, 0, 2
    v_lshl_add_u32 v4, v2, 3, v4
    v_xor_b32 v5, 32, v4
    v_add_u32 v6, 65536, v4
    v_add_u32 v7, 65536, v5
    s_and_b32 s54, s36, 1
    s_mul_i32 s54, s54, 32768
    s_lshr_b32 s55, s36, 1
    s_lshl_b32 s55, s55, 6
    s_add_u32 s54, s54, s55
    v_add_u32 v8, s54, v8
    v_add_u32 v11, 384, v8
    v_add_u32 v10, 256, v8
    v_add_u32 v9, 128, v8
    v_add_u32 v8, 0, v8
    s_lshl_b32 s42, s36, 10
    s_add_u32 m0, s42, 0
    s_nop 0
    buffer_load_dwordx4 v8, s[12:15], s41 offen lds
    s_add_u32 m0, s42, 4096
    s_nop 0
    buffer_load_dwordx4 v9, s[12:15], s41 offen lds
    s_add_u32 m0, s42, 8192
    s_nop 0
    buffer_load_dwordx4 v10, s[12:15], s41 offen lds
    s_add_u32 m0, s42, 12288
    s_nop 0
    buffer_load_dwordx4 v11, s[12:15], s41 offen lds
    s_add_u32 s41, s41, 262144
    s_add_u32 m0, s42, 16384
    s_nop 0
    buffer_load_dwordx4 v8, s[12:15], s41 offen lds
    s_add_u32 m0, s42, 20480
    s_nop 0
    buffer_load_dwordx4 v9, s[12:15], s41 offen lds
    s_add_u32 m0, s42, 24576
    s_nop 0
    buffer_load_dwordx4 v10, s[12:15], s41 offen lds
    s_add_u32 m0, s42, 28672
    s_nop 0
    buffer_load_dwordx4 v11, s[12:15], s41 offen lds
    s_add_u32 s41, s41, 262144
    s_add_u32 m0, s42, 32768
    s_nop 0
    buffer_load_dwordx4 v8, s[12:15], s41 offen lds
    s_add_u32 m0, s42, 36864
    s_nop 0
    buffer_load_dwordx4 v9, s[12:15], s41 offen lds
    s_add_u32 m0, s42, 40960
    s_nop 0
    buffer_load_dwordx4 v10, s[12:15], s41 offen lds
    s_add_u32 m0, s42, 45056
    s_nop 0
    buffer_load_dwordx4 v11, s[12:15], s41 offen lds
    s_add_u32 s41, s41, 262144
    s_add_u32 m0, s42, 49152
    s_nop 0
    buffer_load_dwordx4 v8, s[12:15], s41 offen lds
    s_add_u32 m0, s42, 53248
    s_nop 0
    buffer_load_dwordx4 v9, s[12:15], s41 offen lds
    s_add_u32 m0, s42, 57344
    s_nop 0
    buffer_load_dwordx4 v10, s[12:15], s41 offen lds
    s_add_u32 m0, s42, 61440
    s_nop 0
    buffer_load_dwordx4 v11, s[12:15], s41 offen lds
    s_add_u32 s41, s41, 262144
    buffer_load_dwordx4 v[16:19], v1, s[8:11], s40 offen sc1
    s_add_u32 s55, s40, 20480
    buffer_load_dwordx4 v[20:23], v1, s[8:11], s55 offen sc1
    s_add_u32 s40, s40, 1024
    buffer_load_dwordx4 v[24:27], v1, s[8:11], s40 offen sc1
    s_add_u32 s55, s40, 20480
    buffer_load_dwordx4 v[28:31], v1, s[8:11], s55 offen sc1
    s_add_u32 s40, s40, 1024
    buffer_load_dwordx4 v[32:35], v1, s[8:11], s40 offen sc1
    s_add_u32 s55, s40, 20480
    buffer_load_dwordx4 v[36:39], v1, s[8:11], s55 offen sc1
    s_add_u32 s40, s40, 1024
    buffer_load_dwordx4 v[40:43], v1, s[8:11], s40 offen sc1
    s_add_u32 s55, s40, 20480
    buffer_load_dwordx4 v[44:47], v1, s[8:11], s55 offen sc1
    s_add_u32 s40, s40, 1024
    s_cmp_eq_u32 s71, 0
    s_cbranch_scc1 e_146
    s_waitcnt vmcnt(24) lgkmcnt(0)
    s_barrier
    s_cmp_lg_u32 s36, 0
    s_cbranch_scc1 sg_147
    v_mov_b32 v14, 0
    v_mov_b32 v15, s83
    s_mov_b64 exec, 1
    buffer_atomic_add v15, v14, s[8:11], s85 offen
    s_mov_b64 exec, -1
sg_147:
e_146:
    s_waitcnt vmcnt(6)
    s_barrier
    ds_read_b64_tr_b16 v[56:57], v4 offset:0
    ds_read_b64_tr_b16 v[58:59], v4 offset:1024
    ds_read_b64_tr_b16 v[60:61], v5 offset:0
    ds_read_b64_tr_b16 v[62:63], v5 offset:1024
    ds_read_b64_tr_b16 v[64:65], v4 offset:2048
    ds_read_b64_tr_b16 v[66:67], v4 offset:3072
    ds_read_b64_tr_b16 v[68:69], v5 offset:2048
    ds_read_b64_tr_b16 v[70:71], v5 offset:3072
    ds_read_b64_tr_b16 v[72:73], v4 offset:4096
    ds_read_b64_tr_b16 v[74:75], v4 offset:5120
    ds_read_b64_tr_b16 v[76:77], v5 offset:4096
    ds_read_b64_tr_b16 v[78:79], v5 offset:5120
    s_waitcnt vmcnt(4)
    s_barrier
    s_waitcnt lgkmcnt(8)
    v_mfma_f32_16x16x32_bf16 v[128:131], v[56:59], v[16:19], 0
    ds_read_b64_tr_b16 v[80:81], v4 offset:6144
    ds_read_b64_tr_b16 v[82:83], v4 offset:7168
    v_mfma_f32_16x16x32_bf16 v[192:195], v[56:59], v[20:23], 0
    s_add_u32 m0, s42, 65536
    s_nop 0
    buffer_load_dwordx4 v8, s[12:15], s41 offen lds
    v_mfma_f32_16x16x32_bf16 v[132:135], v[60:63], v[16:19], 0
    ds_read_b64_tr_b16 v[84:85], v5 offset:6144
    ds_read_b64_tr_b16 v[86:87], v5 offset:7168
    v_mfma_f32_16x16x32_bf16 v[196:199], v[60:63], v[20:23], 0
    s_add_u32 m0, s42, 69632
    s_nop 0
    buffer_load_dwordx4 v9, s[12:15], s41 offen lds
    s_waitcnt lgkmcnt(8)
    v_mfma_f32_16x16x32_bf16 v[136:139], v[64:67], v[16:19], 0
    ds_read_b64_tr_b16 v[56:57], v4 offset:8192
    ds_read_b64_tr_b16 v[58:59], v4 offset:9216
    v_mfma_f32_16x16x32_bf16 v[200:203], v[64:67], v[20:23], 0
    s_add_u32 m0, s42, 73728
    s_nop 0
    buffer_load_dwordx4 v10, s[12:15], s41 offen lds
    v_mfma_f32_16x16x32_bf16 v[140:143], v[68:71], v[16:19], 0
    ds_read_b64_tr_b16 v[60:61], v5 offset:8192
    ds_read_b64_tr_b16 v[62:63], v5 offset:9216
    v_mfma_f32_16x16x32_bf16 v[204:207], v[68:71], v[20:23], 0
    s_add_u32 m0, s42, 77824
    s_nop 0
    buffer_load_dwordx4 v11, s[12:15], s41 offen lds
    s_waitcnt lgkmcnt(8)
    v_mfma_f32_16x16x32_bf16 v[144:147], v[72:75], v[16:19], 0
    ds_read_b64_tr_b16 v[64:65], v4 offset:10240
    ds_read_b64_tr_b16 v[66:67], v4 offset:11264
    v_mfma_f32_16x16x32_bf16 v[208:211], v[72:75], v[20:23], 0
    s_add_u32 s41, s41, 262144
    buffer_load_dwordx4 v[48:51], v1, s[8:11], s40 offen sc1
    v_mfma_f32_16x16x32_bf16 v[148:151], v[76:79], v[16:19], 0
    ds_read_b64_tr_b16 v[68:69], v5 offset:10240
    ds_read_b64_tr_b16 v[70:71], v5 offset:11264
    v_mfma_f32_16x16x32_bf16 v[212:215], v[76:79], v[20:23], 0
    s_add_u32 s55, s40, 20480
    buffer_load_dwordx4 v[52:55], v1, s[8:11], s55 offen sc1
    s_waitcnt lgkmcnt(8)
    v_mfma_f32_16x16x32_bf16 v[152:155], v[80:83], v[16:19], 0
    ds_read_b64_tr_b16 v[72:73], v4 offset:12288
    ds_read_b64_tr_b16 v[74:75], v4 offset:13312
    v_mfma_f32_16x16x32_bf16 v[216:219], v[80:83], v[20:23], 0
    s_add_u32 s40, s40, 1024
    v_mfma_f32_16x16x32_bf16 v[156:159], v[84:87], v[16:19], 0
    ds_read_b64_tr_b16 v[76:77], v5 offset:12288
    ds_read_b64_tr_b16 v[78:79], v5 offset:13312
    v_mfma_f32_16x16x32_bf16 v[220:223], v[84:87], v[20:23], 0
    s_waitcnt lgkmcnt(8)
    v_mfma_f32_16x16x32_bf16 v[160:163], v[56:59], v[16:19], 0
    ds_read_b64_tr_b16 v[80:81], v4 offset:14336
    ds_read_b64_tr_b16 v[82:83], v4 offset:15360
    v_mfma_f32_16x16x32_bf16 v[224:227], v[56:59], v[20:23], 0
    v_mfma_f32_16x16x32_bf16 v[164:167], v[60:63], v[16:19], 0
    ds_read_b64_tr_b16 v[84:85], v5 offset:14336
    ds_read_b64_tr_b16 v[86:87], v5 offset:15360
    v_mfma_f32_16x16x32_bf16 v[228:231], v[60:63], v[20:23], 0
    s_waitcnt lgkmcnt(8)
    v_mfma_f32_16x16x32_bf16 v[168:171], v[64:67], v[16:19], 0
    ds_read_b64_tr_b16 v[56:57], v4 offset:16384
    ds_read_b64_tr_b16 v[58:59], v4 offset:17408
    v_mfma_f32_16x16x32_bf16 v[232:235], v[64:67], v[20:23], 0
    v_mfma_f32_16x16x32_bf16 v[172:175], v[68:71], v[16:19], 0
    ds_read_b64_tr_b16 v[60:61], v5 offset:16384
    ds_read_b64_tr_b16 v[62:63], v5 offset:17408
    v_mfma_f32_16x16x32_bf16 v[236:239], v[68:71], v[20:23], 0
    s_waitcnt lgkmcnt(8)
    v_mfma_f32_16x16x32_bf16 v[176:179], v[72:75], v[16:19], 0
    ds_read_b64_tr_b16 v[64:65], v4 offset:18432
    ds_read_b64_tr_b16 v[66:67], v4 offset:19456
    v_mfma_f32_16x16x32_bf16 v[240:243], v[72:75], v[20:23], 0
    v_mfma_f32_16x16x32_bf16 v[180:183], v[76:79], v[16:19], 0
    ds_read_b64_tr_b16 v[68:69], v5 offset:18432
    ds_read_b64_tr_b16 v[70:71], v5 offset:19456
    v_mfma_f32_16x16x32_bf16 v[244:247], v[76:79], v[20:23], 0
    s_waitcnt lgkmcnt(8)
    v_mfma_f32_16x16x32_bf16 v[184:187], v[80:83], v[16:19], 0
    ds_read_b64_tr_b16 v[72:73], v4 offset:20480
    ds_read_b64_tr_b16 v[74:75], v4 offset:21504
    v_mfma_f32_16x16x32_bf16 v[248:251], v[80:83], v[20:23], 0
    v_mfma_f32_16x16x32_bf16 v[188:191], v[84:87], v[16:19], 0
    ds_read_b64_tr_b16 v[76:77], v5 offset:20480
    ds_read_b64_tr_b16 v[78:79], v5 offset:21504
    v_mfma_f32_16x16x32_bf16 v[252:255], v[84:87], v[20:23], 0
    s_waitcnt vmcnt(8)
    s_barrier
    s_waitcnt lgkmcnt(8)
    v_mfma_f32_16x16x32_bf16 v[128:131], v[56:59], v[24:27], v[128:131]
    ds_read_b64_tr_b16 v[80:81], v4 offset:22528
    ds_read_b64_tr_b16 v[82:83], v4 offset:23552
    v_mfma_f32_16x16x32_bf16 v[192:195], v[56:59], v[28:31], v[192:195]
    s_add_u32 m0, s42, 0
    s_nop 0
    buffer_load_dwordx4 v8, s[12:15], s41 offen lds
    v_mfma_f32_16x16x32_bf16 v[132:135], v[60:63], v[24:27], v[132:135]
    ds_read_b64_tr_b16 v[84:85], v5 offset:22528
    ds_read_b64_tr_b16 v[86:87], v5 offset:23552
    v_mfma_f32_16x16x32_bf16 v[196:199], v[60:63], v[28:31], v[196:199]
    s_add_u32 m0, s42, 4096
    s_nop 0
    buffer_load_dwordx4 v9, s[12:15], s41 offen lds
    s_waitcnt lgkmcnt(8)
    v_mfma_f32_16x16x32_bf16 v[136:139], v[64:67], v[24:27], v[136:139]
    ds_read_b64_tr_b16 v[56:57], v4 offset:24576
    ds_read_b64_tr_b16 v[58:59], v4 offset:25600
    v_mfma_f32_16x16x32_bf16 v[200:203], v[64:67], v[28:31], v[200:203]
    s_add_u32 m0, s42, 8192
    s_nop 0
    buffer_load_dwordx4 v10, s[12:15], s41 offen lds
    v_mfma_f32_16x16x32_bf16 v[140:143], v[68:71], v[24:27], v[140:143]
    ds_read_b64_tr_b16 v[60:61], v5 offset:24576
    ds_read_b64_tr_b16 v[62:63], v5 offset:25600
    v_mfma_f32_16x16x32_bf16 v[204:207], v[68:71], v[28:31], v[204:207]
    s_add_u32 m0, s42, 12288
    s_nop 0
    buffer_load_dwordx4 v11, s[12:15], s41 offen lds
    s_waitcnt lgkmcnt(8)
    v_mfma_f32_16x16x32_bf16 v[144:147], v[72:75], v[24:27], v[144:147]
    ds_read_b64_tr_b16 v[64:65], v4 offset:26624
    ds_read_b64_tr_b16 v[66:67], v4 offset:27648
    v_mfma_f32_16x16x32_bf16 v[208:211], v[72:75], v[28:31], v[208:211]
    s_add_u32 s41, s41, 262144
    buffer_load_dwordx4 v[16:19], v1, s[8:11], s40 offen sc1
    v_mfma_f32_16x16x32_bf16 v[148:151], v[76:79], v[24:27], v[148:151]
    ds_read_b64_tr_b16 v[68:69], v5 offset:26624
    ds_read_b64_tr_b16 v[70:71], v5 offset:27648
    v_mfma_f32_16x16x32_bf16 v[212:215], v[76:79], v[28:31], v[212:215]
    s_add_u32 s55, s40, 20480
    buffer_load_dwordx4 v[20:23], v1, s[8:11], s55 offen sc1
    s_waitcnt lgkmcnt(8)
    v_mfma_f32_16x16x32_bf16 v[152:155], v[80:83], v[24:27], v[152:155]
    ds_read_b64_tr_b16 v[72:73], v4 offset:28672
    ds_read_b64_tr_b16 v[74:75], v4 offset:29696
    v_mfma_f32_16x16x32_bf16 v[216:219], v[80:83], v[28:31], v[216:219]
    s_add_u32 s40, s40, 1024
    v_mfma_f32_16x16x32_bf16 v[156:159], v[84:87], v[24:27], v[156:159]
    ds_read_b64_tr_b16 v[76:77], v5 offset:28672
    ds_read_b64_tr_b16 v[78:79], v5 offset:29696
    v_mfma_f32_16x16x32_bf16 v[220:223], v[84:87], v[28:31], v[220:223]
    s_waitcnt lgkmcnt(8)
    v_mfma_f32_16x16x32_bf16 v[160:163], v[56:59], v[24:27], v[160:163]
    ds_read_b64_tr_b16 v[80:81], v4 offset:30720
    ds_read_b64_tr_b16 v[82:83], v4 offset:31744
    v_mfma_f32_16x16x32_bf16 v[224:227], v[56:59], v[28:31], v[224:227]
    v_mfma_f32_16x16x32_bf16 v[164:167], v[60:63], v[24:27], v[164:167]
    ds_read_b64_tr_b16 v[84:85], v5 offset:30720
    ds_read_b64_tr_b16 v[86:87], v5 offset:31744
    v_mfma_f32_16x16x32_bf16 v[228:231], v[60:63], v[28:31], v[228:231]
    s_waitcnt lgkmcnt(8)
    v_mfma_f32_16x16x32_bf16 v[168:171], v[64:67], v[24:27], v[168:171]
    ds_read_b64_tr_b16 v[56:57], v4 offset:32768
    ds_read_b64_tr_b16 v[58:59], v4 offset:33792
    v_mfma_f32_16x16x32_bf16 v[232:235], v[64:67], v[28:31], v[232:235]
    v_mfma_f32_16x16x32_bf16 v[172:175], v[68:71], v[24:27], v[172:175]
    ds_read_b64_tr_b16 v[60:61], v5 offset:32768
    ds_read_b64_tr_b16 v[62:63], v5 offset:33792
    v_mfma_f32_16x16x32_bf16 v[236:239], v[68:71], v[28:31], v[236:239]
    s_waitcnt lgkmcnt(8)
    v_mfma_f32_16x16x32_bf16 v[176:179], v[72:75], v[24:27], v[176:179]
    ds_read_b64_tr_b16 v[64:65], v4 offset:34816
    ds_read_b64_tr_b16 v[66:67], v4 offset:35840
    v_mfma_f32_16x16x32_bf16 v[240:243], v[72:75], v[28:31], v[240:243]
    v_mfma_f32_16x16x32_bf16 v[180:183], v[76:79], v[24:27], v[180:183]
    ds_read_b64_tr_b16 v[68:69], v5 offset:34816
    ds_read_b64_tr_b16 v[70:71], v5 offset:35840
    v_mfma_f32_16x16x32_bf16 v[244:247], v[76:79], v[28:31], v[244:247]
    s_waitcnt lgkmcnt(8)
    v_mfma_f32_16x16x32_bf16 v[184:187], v[80:83], v[24:27], v[184:187]
    ds_read_b64_tr_b16 v[72:73], v4 offset:36864
    ds_read_b64_tr_b16 v[74:75], v4 offset:37888
    v_mfma_f32_16x16x32_bf16 v[248:251], v[80:83], v[28:31], v[248:251]
    v_mfma_f32_16x16x32_bf16 v[188:191], v[84:87], v[24:27], v[188:191]
    ds_read_b64_tr_b16 v[76:77], v5 offset:36864
    ds_read_b64_tr_b16 v[78:79], v5 offset:37888
    v_mfma_f32_16x16x32_bf16 v[252:255], v[84:87], v[28:31], v[252:255]
    s_waitcnt vmcnt(12)
    s_barrier
    s_waitcnt lgkmcnt(8)
    v_mfma_f32_16x16x32_bf16 v[128:131], v[56:59], v[32:35], v[128:131]
    ds_read_b64_tr_b16 v[80:81], v4 offset:38912
    ds_read_b64_tr_b16 v[82:83], v4 offset:39936
    v_mfma_f32_16x16x32_bf16 v[192:195], v[56:59], v[36:39], v[192:195]
    s_add_u32 m0, s42, 16384
    s_nop 0
    buffer_load_dwordx4 v8, s[12:15], s41 offen lds
    v_mfma_f32_16x16x32_bf16 v[132:135], v[60:63], v[32:35], v[132:135]
    ds_read_b64_tr_b16 v[84:85], v5 offset:38912
    ds_read_b64_tr_b16 v[86:87], v5 offset:39936
    v_mfma_f32_16x16x32_bf16 v[196:199], v[60:63], v[36:39], v[196:199]
    s_add_u32 m0, s42, 20480
    s_nop 0
    buffer_load_dwordx4 v9, s[12:15], s41 offen lds
    s_waitcnt lgkmcnt(8)
    v_mfma_f32_16x16x32_bf16 v[136:139], v[64:67], v[32:35], v[136:139]
    ds_read_b64_tr_b16 v[56:57], v4 offset:40960
    ds_read_b64_tr_b16 v[58:59], v4 offset:41984
    v_mfma_f32_16x16x32_bf16 v[200:203], v[64:67], v[36:39], v[200:203]
    s_add_u32 m0, s42, 24576
    s_nop 0
    buffer_load_dwordx4 v10, s[12:15], s41 offen lds
    v_mfma_f32_16x16x32_bf16 v[140:143], v[68:71], v[32:35], v[140:143]
    ds_read_b64_tr_b16 v[60:61], v5 offset:40960
    ds_read_b64_tr_b16 v[62:63], v5 offset:41984
    v_mfma_f32_16x16x32_bf16 v[204:207], v[68:71], v[36:39], v[204:207]
    s_add_u32 m0, s42, 28672
    s_nop 0
    buffer_load_dwordx4 v11, s[12:15], s41 offen lds
    s_waitcnt lgkmcnt(8)
    v_mfma_f32_16x16x32_bf16 v[144:147], v[72:75], v[32:35], v[144:147]
    ds_read_b64_tr_b16 v[64:65], v4 offset:43008
    ds_read_b64_tr_b16 v[66:67], v4 offset:44032
    v_mfma_f32_16x16x32_bf16 v[208:211], v[72:75], v[36:39], v[208:211]
    s_add_u32 s41, s41, 262144
    buffer_load_dwordx4 v[24:27], v1, s[8:11], s40 offen sc1
    v_mfma_f32_16x16x32_bf16 v[148:151], v[76:79], v[32:35], v[148:151]
    ds_read_b64_tr_b16 v[68:69], v5 offset:43008
    ds_read_b64_tr_b16 v[70:71], v5 offset:44032
    v_mfma_f32_16x16x32_bf16 v[212:215], v[76:79], v[36:39], v[212:215]
    s_add_u32 s55, s40, 20480
    buffer_load_dwordx4 v[28:31], v1, s[8:11], s55 offen sc1
    s_waitcnt lgkmcnt(8)
    v_mfma_f32_16x16x32_bf16 v[152:155], v[80:83], v[32:35], v[152:155]
    ds_read_b64_tr_b16 v[72:73], v4 offset:45056
    ds_read_b64_tr_b16 v[74:75], v4 offset:46080
    v_mfma_f32_16x16x32_bf16 v[216:219], v[80:83], v[36:39], v[216:219]
    s_add_u32 s40, s40, 1024
    v_mfma_f32_16x16x32_bf16 v[156:159], v[84:87], v[32:35], v[156:159]
    ds_read_b64_tr_b16 v[76:77], v5 offset:45056
    ds_read_b64_tr_b16 v[78:79], v5 offset:46080
    v_mfma_f32_16x16x32_bf16 v[220:223], v[84:87], v[36:39], v[220:223]
    s_waitcnt lgkmcnt(8)
    v_mfma_f32_16x16x32_bf16 v[160:163], v[56:59], v[32:35], v[160:163]
    ds_read_b64_tr_b16 v[80:81], v4 offset:47104
    ds_read_b64_tr_b16 v[82:83], v4 offset:48128
    v_mfma_f32_16x16x32_bf16 v[224:227], v[56:59], v[36:39], v[224:227]
    v_mfma_f32_16x16x32_bf16 v[164:167], v[60:63], v[32:35], v[164:167]
    ds_read_b64_tr_b16 v[84:85], v5 offset:47104
    ds_read_b64_tr_b16 v[86:87], v5 offset:48128
    v_mfma_f32_16x16x32_bf16 v[228:231], v[60:63], v[36:39], v[228:231]
    s_waitcnt lgkmcnt(8)
    v_mfma_f32_16x16x32_bf16 v[168:171], v[64:67], v[32:35], v[168:171]
    ds_read_b64_tr_b16 v[56:57], v4 offset:49152
    ds_read_b64_tr_b16 v[58:59], v4 offset:50176
    v_mfma_f32_16x16x32_bf16 v[232:235], v[64:67], v[36:39], v[232:235]
    v_mfma_f32_16x16x32_bf16 v[172:175], v[68:71], v[32:35], v[172:175]
    ds_read_b64_tr_b16 v[60:61], v5 offset:49152
    ds_read_b64_tr_b16 v[62:63], v5 offset:50176
    v_mfma_f32_16x16x32_bf16 v[236:239], v[68:71], v[36:39], v[236:239]
    s_waitcnt lgkmcnt(8)
    v_mfma_f32_16x16x32_bf16 v[176:179], v[72:75], v[32:35], v[176:179]
    ds_read_b64_tr_b16 v[64:65], v4 offset:51200
    ds_read_b64_tr_b16 v[66:67], v4 offset:52224
    v_mfma_f32_16x16x32_bf16 v[240:243], v[72:75], v[36:39], v[240:243]
    v_mfma_f32_16x16x32_bf16 v[180:183], v[76:79], v[32:35], v[180:183]
    ds_read_b64_tr_b16 v[68:69], v5 offset:51200
    ds_read_b64_tr_b16 v[70:71], v5 offset:52224
    v_mfma_f32_16x16x32_bf16 v[244:247], v[76:79], v[36:39], v[244:247]
    s_waitcnt lgkmcnt(8)
    v_mfma_f32_16x16x32_bf16 v[184:187], v[80:83], v[32:35], v[184:187]
    ds_read_b64_tr_b16 v[72:73], v4 offset:53248
    ds_read_b64_tr_b16 v[74:75], v4 offset:54272
    v_mfma_f32_16x16x32_bf16 v[248:251], v[80:83], v[36:39], v[248:251]
    v_mfma_f32_16x16x32_bf16 v[188:191], v[84:87], v[32:35], v[188:191]
    ds_read_b64_tr_b16 v[76:77], v5 offset:53248
    ds_read_b64_tr_b16 v[78:79], v5 offset:54272
    v_mfma_f32_16x16x32_bf16 v[252:255], v[84:87], v[36:39], v[252:255]
    s_waitcnt vmcnt(12)
    s_barrier
    s_waitcnt lgkmcnt(8)
    v_mfma_f32_16x16x32_bf16 v[128:131], v[56:59], v[40:43], v[128:131]
    ds_read_b64_tr_b16 v[80:81], v4 offset:55296
    ds_read_b64_tr_b16 v[82:83], v4 offset:56320
    v_mfma_f32_16x16x32_bf16 v[192:195], v[56:59], v[44:47], v[192:195]
    s_add_u32 m0, s42, 32768
    s_nop 0
    buffer_load_dwordx4 v8, s[12:15], s41 offen lds
    v_mfma_f32_16x16x32_bf16 v[132:135], v[60:63], v[40:43], v[132:135]
    ds_read_b64_tr_b16 v[84:85], v5 offset:55296
    ds_read_b64_tr_b16 v[86:87], v5 offset:56320
    v_mfma_f32_16x16x32_bf16 v[196:199], v[60:63], v[44:47], v[196:199]
    s_add_u32 m0, s42, 36864
    s_nop 0
    buffer_load_dwordx4 v9, s[12:15], s41 offen lds
    s_waitcnt lgkmcnt(8)
    v_mfma_f32_16x16x32_bf16 v[136:139], v[64:67], v[40:43], v[136:139]
    ds_read_b64_tr_b16 v[56:57], v4 offset:57344
    ds_read_b64_tr_b16 v[58:59], v4 offset:58368
    v_mfma_f32_16x16x32_bf16 v[200:203], v[64:67], v[44:47], v[200:203]
    s_add_u32 m0, s42, 40960
    s_nop 0
    buffer_load_dwordx4 v10, s[12:15], s41 offen lds
    v_mfma_f32_16x16x32_bf16 v[140:143], v[68:71], v[40:43], v[140:143]
    ds_read_b64_tr_b16 v[60:61], v5 offset:57344
    ds_read_b64_tr_b16 v[62:63], v5 offset:58368
    v_mfma_f32_16x16x32_bf16 v[204:207], v[68:71], v[44:47], v[204:207]
    s_add_u32 m0, s42, 45056
    s_nop 0
    buffer_load_dwordx4 v11, s[12:15], s41 offen lds
    s_waitcnt lgkmcnt(8)
    v_mfma_f32_16x16x32_bf16 v[144:147], v[72:75], v[40:43], v[144:147]
    ds_read_b64_tr_b16 v[64:65], v4 offset:59392
    ds_read_b64_tr_b16 v[66:67], v4 offset:60416
    v_mfma_f32_16x16x32_bf16 v[208:211], v[72:75], v[44:47], v[208:211]
    s_add_u32 s41, s41, 262144
    buffer_load_dwordx4 v[32:35], v1, s[8:11], s40 offen sc1
    v_mfma_f32_16x16x32_bf16 v[148:151], v[76:79], v[40:43], v[148:151]
    ds_read_b64_tr_b16 v[68:69], v5 offset:59392
    ds_read_b64_tr_b16 v[70:71], v5 offset:60416
    v_mfma_f32_16x16x32_bf16 v[212:215], v[76:79], v[44:47], v[212:215]
    s_add_u32 s55, s40, 20480
    buffer_load_dwordx4 v[36:39], v1, s[8:11], s55 offen sc1
    s_waitcnt lgkmcnt(8)
    v_mfma_f32_16x16x32_bf16 v[152:155], v[80:83], v[40:43], v[152:155]
    ds_read_b64_tr_b16 v[72:73], v4 offset:61440
    ds_read_b64_tr_b16 v[74:75], v4 offset:62464
    v_mfma_f32_16x16x32_bf16 v[216:219], v[80:83], v[44:47], v[216:219]
    s_add_u32 s40, s40, 1024
    v_mfma_f32_16x16x32_bf16 v[156:159], v[84:87], v[40:43], v[156:159]
    ds_read_b64_tr_b16 v[76:77], v5 offset:61440
    ds_read_b64_tr_b16 v[78:79], v5 offset:62464
    v_mfma_f32_16x16x32_bf16 v[220:223], v[84:87], v[44:47], v[220:223]
    s_waitcnt lgkmcnt(8)
    v_mfma_f32_16x16x32_bf16 v[160:163], v[56:59], v[40:43], v[160:163]
    ds_read_b64_tr_b16 v[80:81], v4 offset:63488
    ds_read_b64_tr_b16 v[82:83], v4 offset:64512
    v_mfma_f32_16x16x32_bf16 v[224:227], v[56:59], v[44:47], v[224:227]
    v_mfma_f32_16x16x32_bf16 v[164:167], v[60:63], v[40:43], v[164:167]
    ds_read_b64_tr_b16 v[84:85], v5 offset:63488
    ds_read_b64_tr_b16 v[86:87], v5 offset:64512
    v_mfma_f32_16x16x32_bf16 v[228:231], v[60:63], v[44:47], v[228:231]
    s_waitcnt lgkmcnt(8)
    v_mfma_f32_16x16x32_bf16 v[168:171], v[64:67], v[40:43], v[168:171]
    ds_read_b64_tr_b16 v[56:57], v6 offset:0
    ds_read_b64_tr_b16 v[58:59], v6 offset:1024
    v_mfma_f32_16x16x32_bf16 v[232:235], v[64:67], v[44:47], v[232:235]
    v_mfma_f32_16x16x32_bf16 v[172:175], v[68:71], v[40:43], v[172:175]
    ds_read_b64_tr_b16 v[60:61], v7 offset:0
    ds_read_b64_tr_b16 v[62:63], v7 offset:1024
    v_mfma_f32_16x16x32_bf16 v[236:239], v[68:71], v[44:47], v[236:239]
    s_waitcnt lgkmcnt(8)
    v_mfma_f32_16x16x32_bf16 v[176:179], v[72:75], v[40:43], v[176:179]
    ds_read_b64_tr_b16 v[64:65], v6 offset:2048
    ds_read_b64_tr_b16 v[66:67], v6 offset:3072
    v_mfma_f32_16x16x32_bf16 v[240:243], v[72:75], v[44:47], v[240:243]
    v_mfma_f32_16x16x32_bf16 v[180:183], v[76:79], v[40:43], v[180:183]
    ds_read_b64_tr_b16 v[68:69], v7 offset:2048
    ds_read_b64_tr_b16 v[70:71], v7 offset:3072
    v_mfma_f32_16x16x32_bf16 v[244:247], v[76:79], v[44:47], v[244:247]
    s_waitcnt lgkmcnt(8)
    v_mfma_f32_16x16x32_bf16 v[184:187], v[80:83], v[40:43], v[184:187]
    ds_read_b64_tr_b16 v[72:73], v6 offset:4096
    ds_read_b64_tr_b16 v[74:75], v6 offset:5120
    v_mfma_f32_16x16x32_bf16 v[248:251], v[80:83], v[44:47], v[248:251]
    v_mfma_f32_16x16x32_bf16 v[188:191], v[84:87], v[40:43], v[188:191]
    ds_read_b64_tr_b16 v[76:77], v7 offset:4096
    ds_read_b64_tr_b16 v[78:79], v7 offset:5120
    v_mfma_f32_16x16x32_bf16 v[252:255], v[84:87], v[44:47], v[252:255]
    s_waitcnt vmcnt(12)
    s_barrier
    s_waitcnt lgkmcnt(8)
    v_mfma_f32_16x16x32_bf16 v[128:131], v[56:59], v[48:51], v[128:131]
    ds_read_b64_tr_b16 v[80:81], v6 offset:6144
    ds_read_b64_tr_b16 v[82:83], v6 offset:7168
    v_mfma_f32_16x16x32_bf16 v[192:195], v[56:59], v[52:55], v[192:195]
    s_add_u32 m0, s42, 49152
    s_nop 0
    buffer_load_dwordx4 v8, s[12:15], s41 offen lds
    v_mfma_f32_16x16x32_bf16 v[132:135], v[60:63], v[48:51], v[132:135]
    ds_read_b64_tr_b16 v[84:85], v7 offset:6144
    ds_read_b64_tr_b16 v[86:87], v7 offset:7168
    v_mfma_f32_16x16x32_bf16 v[196:199], v[60:63], v[52:55], v[196:199]
    s_add_u32 m0, s42, 53248
    s_nop 0
    buffer_load_dwordx4 v9, s[12:15], s41 offen lds
    s_waitcnt lgkmcnt(8)
    v_mfma_f32_16x16x32_bf16 v[136:139], v[64:67], v[48:51], v[136:139]
    ds_read_b64_tr_b16 v[56:57], v6 offset:8192
    ds_read_b64_tr_b16 v[58:59], v6 offset:9216
    v_mfma_f32_16x16x32_bf16 v[200:203], v[64:67], v[52:55], v[200:203]
    s_add_u32 m0, s42, 57344
    s_nop 0
    buffer_load_dwordx4 v10, s[12:15], s41 offen lds
    v_mfma_f32_16x16x32_bf16 v[140:143], v[68:71], v[48:51], v[140:143]
    ds_read_b64_tr_b16 v[60:61], v7 offset:8192
    ds_read_b64_tr_b16 v[62:63], v7 offset:9216
    v_mfma_f32_16x16x32_bf16 v[204:207], v[68:71], v[52:55], v[204:207]
    s_add_u32 m0, s42, 61440
    s_nop 0
    buffer_load_dwordx4 v11, s[12:15], s41 offen lds
    s_waitcnt lgkmcnt(8)
    v_mfma_f32_16x16x32_bf16 v[144:147], v[72:75], v[48:51], v[144:147]
    ds_read_b64_tr_b16 v[64:65], v6 offset:10240
    ds_read_b64_tr_b16 v[66:67], v6 offset:11264
    v_mfma_f32_16x16x32_bf16 v[208:211], v[72:75], v[52:55], v[208:211]
    s_add_u32 s41, s41, 262144
    buffer_load_dwordx4 v[40:43], v1, s[8:11], s40 offen sc1
    v_mfma_f32_16x16x32_bf16 v[148:151], v[76:79], v[48:51], v[148:151]
    ds_read_b64_tr_b16 v[68:69], v7 offset:10240
    ds_read_b64_tr_b16 v[70:71], v7 offset:11264
    v_mfma_f32_16x16x32_bf16 v[212:215], v[76:79], v[52:55], v[212:215]
    s_add_u32 s55, s40, 20480
    buffer_load_dwordx4 v[44:47], v1, s[8:11], s55 offen sc1
    s_waitcnt lgkmcnt(8)
    v_mfma_f32_16x16x32_bf16 v[152:155], v[80:83], v[48:51], v[152:155]
    ds_read_b64_tr_b16 v[72:73], v6 offset:12288
    ds_read_b64_tr_b16 v[74:75], v6 offset:13312
    v_mfma_f32_16x16x32_bf16 v[216:219], v[80:83], v[52:55], v[216:219]
    s_add_u32 s40, s40, 1024
    v_mfma_f32_16x16x32_bf16 v[156:159], v[84:87], v[48:51], v[156:159]
    ds_read_b64_tr_b16 v[76:77], v7 offset:12288
    ds_read_b64_tr_b16 v[78:79], v7 offset:13312
    v_mfma_f32_16x16x32_bf16 v[220:223], v[84:87], v[52:55], v[220:223]
    s_waitcnt lgkmcnt(8)
    v_mfma_f32_16x16x32_bf16 v[160:163], v[56:59], v[48:51], v[160:163]
    ds_read_b64_tr_b16 v[80:81], v6 offset:14336
    ds_read_b64_tr_b16 v[82:83], v6 offset:15360
    v_mfma_f32_16x16x32_bf16 v[224:227], v[56:59], v[52:55], v[224:227]
    v_mfma_f32_16x16x32_bf16 v[164:167], v[60:63], v[48:51], v[164:167]
    ds_read_b64_tr_b16 v[84:85], v7 offset:14336
    ds_read_b64_tr_b16 v[86:87], v7 offset:15360
    v_mfma_f32_16x16x32_bf16 v[228:231], v[60:63], v[52:55], v[228:231]
    s_waitcnt lgkmcnt(8)
    v_mfma_f32_16x16x32_bf16 v[168:171], v[64:67], v[48:51], v[168:171]
    ds_read_b64_tr_b16 v[56:57], v4 offset:0
    ds_read_b64_tr_b16 v[58:59], v4 offset:1024
    v_mfma_f32_16x16x32_bf16 v[232:235], v[64:67], v[52:55], v[232:235]
    v_mfma_f32_16x16x32_bf16 v[172:175], v[68:71], v[48:51], v[172:175]
    ds_read_b64_tr_b16 v[60:61], v5 offset:0
    ds_read_b64_tr_b16 v[62:63], v5 offset:1024
    v_mfma_f32_16x16x32_bf16 v[236:239], v[68:71], v[52:55], v[236:239]
    s_waitcnt lgkmcnt(8)
    v_mfma_f32_16x16x32_bf16 v[176:179], v[72:75], v[48:51], v[176:179]
    ds_read_b64_tr_b16 v[64:65], v4 offset:2048
    ds_read_b64_tr_b16 v[66:67], v4 offset:3072
    v_mfma_f32_16x16x32_bf16 v[240:243], v[72:75], v[52:55], v[240:243]
    v_mfma_f32_16x16x32_bf16 v[180:183], v[76:79], v[48:51], v[180:183]
    ds_read_b64_tr_b16 v[68:69], v5 offset:2048
    ds_read_b64_tr_b16 v[70:71], v5 offset:3072
    v_mfma_f32_16x16x32_bf16 v[244:247], v[76:79], v[52:55], v[244:247]
    s_waitcnt lgkmcnt(8)
    v_mfma_f32_16x16x32_bf16 v[184:187], v[80:83], v[48:51], v[184:187]
    ds_read_b64_tr_b16 v[72:73], v4 offset:4096
    ds_read_b64_tr_b16 v[74:75], v4 offset:5120
    v_mfma_f32_16x16x32_bf16 v[248:251], v[80:83], v[52:55], v[248:251]
    v_mfma_f32_16x16x32_bf16 v[188:191], v[84:87], v[48:51], v[188:191]
    ds_read_b64_tr_b16 v[76:77], v5 offset:4096
    ds_read_b64_tr_b16 v[78:79], v5 offset:5120
    v_mfma_f32_16x16x32_bf16 v[252:255], v[84:87], v[52:55], v[252:255]
    s_mov_b32 s43, 3
.p2align 3
gq_loop:
    s_waitcnt vmcnt(12)
    s_barrier
    s_waitcnt lgkmcnt(8)
    v_mfma_f32_16x16x32_bf16 v[128:131], v[56:59], v[16:19], v[128:131]
    ds_read_b64_tr_b16 v[80:81], v4 offset:6144
    ds_read_b64_tr_b16 v[82:83], v4 offset:7168
    v_mfma_f32_16x16x32_bf16 v[192:195], v[56:59], v[20:23], v[192:195]
    s_add_u32 m0, s42, 65536
    s_nop 0
    buffer_load_dwordx4 v8, s[12:15], s41 offen lds
    v_mfma_f32_16x16x32_bf16 v[132:135], v[60:63], v[16:19], v[132:135]
    ds_read_b64_tr_b16 v[84:85], v5 offset:6144
    ds_read_b64_tr_b16 v[86:87], v5 offset:7168
    v_mfma_f32_16x16x32_bf16 v[196:199], v[60:63], v[20:23], v[196:199]
    s_add_u32 m0, s42, 69632
    s_nop 0
    buffer_load_dwordx4 v9, s[12:15], s41 offen lds
    s_waitcnt lgkmcnt(8)
    v_mfma_f32_16x16x32_bf16 v[136:139], v[64:67], v[16:19], v[136:139]
    ds_read_b64_tr_b16 v[56:57], v4 offset:8192
    ds_read_b64_tr_b16 v[58:59], v4 offset:9216
    v_mfma_f32_16x16x32_bf16 v[200:203], v[64:67], v[20:23], v[200:203]
    s_add_u32 m0, s42, 73728
    s_nop 0
    buffer_load_dwordx4 v10, s[12:15], s41 offen lds
    v_mfma_f32_16x16x32_bf16 v[140:143], v[68:71], v[16:19], v[140:143]
    ds_read_b64_tr_b16 v[60:61], v5 offset:8192
    ds_read_b64_tr_b16 v[62:63], v5 offset:9216
    v_mfma_f32_16x16x32_bf16 v[204:207], v[68:71], v[20:23], v[204:207]
    s_add_u32 m0, s42, 77824
    s_nop 0
    buffer_load_dwordx4 v11, s[12:15], s41 offen lds
    s_waitcnt lgkmcnt(8)
    v_mfma_f32_16x16x32_bf16 v[144:147], v[72:75], v[16:19], v[144:147]
    ds_read_b64_tr_b16 v[64:65], v4 offset:10240
    ds_read_b64_tr_b16 v[66:67], v4 offset:11264
    v_mfma_f32_16x16x32_bf16 v[208:211], v[72:75], v[20:23], v[208:211]
    s_add_u32 s41, s41, 262144
    buffer_load_dwordx4 v[48:51], v1, s[8:11], s40 offen sc1
    v_mfma_f32_16x16x32_bf16 v[148:151], v[76:79], v[16:19], v[148:151]
    ds_read_b64_tr_b16 v[68:69], v5 offset:10240
    ds_read_b64_tr_b16 v[70:71], v5 offset:11264
    v_mfma_f32_16x16x32_bf16 v[212:215], v[76:79], v[20:23], v[212:215]
    s_add_u32 s55, s40, 20480
    buffer_load_dwordx4 v[52:55], v1, s[8:11], s55 offen sc1
    s_waitcnt lgkmcnt(8)
    v_mfma_f32_16x16x32_bf16 v[152:155], v[80:83], v[16:19], v[152:155]
    ds_read_b64_tr_b16 v[72:73], v4 offset:12288
    ds_read_b64_tr_b16 v[74:75], v4 offset:13312
    v_mfma_f32_16x16x32_bf16 v[216:219], v[80:83], v[20:23], v[216:219]
    s_add_u32 s40, s40, 1024
    v_mfma_f32_16x16x32_bf16 v[156:159], v[84:87], v[16:19], v[156:159]
    ds_read_b64_tr_b16 v[76:77], v5 offset:12288
    ds_read_b64_tr_b16 v[78:79], v5 offset:13312
    v_mfma_f32_16x16x32_bf16 v[220:223], v[84:87], v[20:23], v[220:223]
    s_waitcnt lgkmcnt(8)
    v_mfma_f32_16x16x32_bf16 v[160:163], v[56:59], v[16:19], v[160:163]
    ds_read_b64_tr_b16 v[80:81], v4 offset:14336
    ds_read_b64_tr_b16 v[82:83], v4 offset:15360
    v_mfma_f32_16x16x32_bf16 v[224:227], v[56:59], v[20:23], v[224:227]
    v_mfma_f32_16x16x32_bf16 v[164:167], v[60:63], v[16:19], v[164:167]
    ds_read_b64_tr_b16 v[84:85], v5 offset:14336
    ds_read_b64_tr_b16 v[86:87], v5 offset:15360
    v_mfma_f32_16x16x32_bf16 v[228:231], v[60:63], v[20:23], v[228:231]
    s_waitcnt lgkmcnt(8)
    v_mfma_f32_16x16x32_bf16 v[168:171], v[64:67], v[16:19], v[168:171]
    ds_read_b64_tr_b16 v[56:57], v4 offset:16384
    ds_read_b64_tr_b16 v[58:59], v4 offset:17408
    v_mfma_f32_16x16x32_bf16 v[232:235], v[64:67], v[20:23], v[232:235]
    v_mfma_f32_16x16x32_bf16 v[172:175], v[68:71], v[16:19], v[172:175]
    ds_read_b64_tr_b16 v[60:61], v5 offset:16384
    ds_read_b64_tr_b16 v[62:63], v5 offset:17408
    v_mfma_f32_16x16x32_bf16 v[236:239], v[68:71], v[20:23], v[236:239]
    s_waitcnt lgkmcnt(8)
    v_mfma_f32_16x16x32_bf16 v[176:179], v[72:75], v[16:19], v[176:179]
    ds_read_b64_tr_b16 v[64:65], v4 offset:18432
    ds_read_b64_tr_b16 v[66:67], v4 offset:19456
    v_mfma_f32_16x16x32_bf16 v[240:243], v[72:75], v[20:23], v[240:243]
    v_mfma_f32_16x16x32_bf16 v[180:183], v[76:79], v[16:19], v[180:183]
    ds_read_b64_tr_b16 v[68:69], v5 offset:18432
    ds_read_b64_tr_b16 v[70:71], v5 offset:19456
    v_mfma_f32_16x16x32_bf16 v[244:247], v[76:79], v[20:23], v[244:247]
    s_waitcnt lgkmcnt(8)
    v_mfma_f32_16x16x32_bf16 v[184:187], v[80:83], v[16:19], v[184:187]
    ds_read_b64_tr_b16 v[72:73], v4 offset:20480
    ds_read_b64_tr_b16 v[74:75], v4 offset:21504
    v_mfma_f32_16x16x32_bf16 v[248:251], v[80:83], v[20:23], v[248:251]
    v_mfma_f32_16x16x32_bf16 v[188:191], v[84:87], v[16:19], v[188:191]
    ds_read_b64_tr_b16 v[76:77], v5 offset:20480
    ds_read_b64_tr_b16 v[78:79], v5 offset:21504
    v_mfma_f32_16x16x32_bf16 v[252:255], v[84:87], v[20:23], v[252:255]
    s_waitcnt vmcnt(12)
    s_barrier
    s_waitcnt lgkmcnt(8)
    v_mfma_f32_16x16x32_bf16 v[128:131], v[56:59], v[24:27], v[128:131]
    ds_read_b64_tr_b16 v[80:81], v4 offset:22528
    ds_read_b64_tr_b16 v[82:83], v4 offset:23552
    v_mfma_f32_16x16x32_bf16 v[192:195], v[56:59], v[28:31], v[192:195]
    s_add_u32 m0, s42, 0
    s_nop 0
    buffer_load_dwordx4 v8, s[12:15], s41 offen lds
    v_mfma_f32_16x16x32_bf16 v[132:135], v[60:63], v[24:27], v[132:135]
    ds_read_b64_tr_b16 v[84:85], v5 offset:22528
    ds_read_b64_tr_b16 v[86:87], v5 offset:23552
    v_mfma_f32_16x16x32_bf16 v[196:199], v[60:63], v[28:31], v[196:199]
    s_add_u32 m0, s42, 4096
    s_nop 0
    buffer_load_dwordx4 v9, s[12:15], s41 offen lds
    s_waitcnt lgkmcnt(8)
    v_mfma_f32_16x16x32_bf16 v[136:139], v[64:67], v[24:27], v[136:139]
    ds_read_b64_tr_b16 v[56:57], v4 offset:24576
    ds_read_b64_tr_b16 v[58:59], v4 offset:25600
    v_mfma_f32_16x16x32_bf16 v[200:203], v[64:67], v[28:31], v[200:203]
    s_add_u32 m0, s42, 8192
    s_nop 0
    buffer_load_dwordx4 v10, s[12:15], s41 offen lds
    v_mfma_f32_16x16x32_bf16 v[140:143], v[68:71], v[24:27], v[140:143]
    ds_read_b64_tr_b16 v[60:61], v5 offset:24576
    ds_read_b64_tr_b16 v[62:63], v5 offset:25600
    v_mfma_f32_16x16x32_bf16 v[204:207], v[68:71], v[28:31], v[204:207]
    s_add_u32 m0, s42, 12288
    s_nop 0
    buffer_load_dwordx4 v11, s[12:15], s41 offen lds
    s_waitcnt lgkmcnt(8)
    v_mfma_f32_16x16x32_bf16 v[144:147], v[72:75], v[24:27], v[144:147]
    ds_read_b64_tr_b16 v[64:65], v4 offset:26624
    ds_read_b64_tr_b16 v[66:67], v4 offset:27648
    v_mfma_f32_16x16x32_bf16 v[208:211], v[72:75], v[28:31], v[208:211]
    s_add_u32 s41, s41, 262144
    buffer_load_dwordx4 v[16:19], v1, s[8:11], s40 offen sc1
    v_mfma_f32_16x16x32_bf16 v[148:151], v[76:79], v[24:27], v[148:151]
    ds_read_b64_tr_b16 v[68:69], v5 offset:26624
    ds_read_b64_tr_b16 v[70:71], v5 offset:27648
    v_mfma_f32_16x16x32_bf16 v[212:215], v[76:79], v[28:31], v[212:215]
    s_add_u32 s55, s40, 20480
    buffer_load_dwordx4 v[20:23], v1, s[8:11], s55 offen sc1
    s_waitcnt lgkmcnt(8)
    v_mfma_f32_16x16x32_bf16 v[152:155], v[80:83], v[24:27], v[152:155]
    ds_read_b64_tr_b16 v[72:73], v4 offset:28672
    ds_read_b64_tr_b16 v[74:75], v4 offset:29696
    v_mfma_f32_16x16x32_bf16 v[216:219], v[80:83], v[28:31], v[216:219]
    s_add_u32 s40, s40, 1024
    v_mfma_f32_16x16x32_bf16 v[156:159], v[84:87], v[24:27], v[156:159]
    ds_read_b64_tr_b16 v[76:77], v5 offset:28672
    ds_read_b64_tr_b16 v[78:79], v5 offset:29696
    v_mfma_f32_16x16x32_bf16 v[220:223], v[84:87], v[28:31], v[220:223]
    s_waitcnt lgkmcnt(8)
    v_mfma_f32_16x16x32_bf16 v[160:163], v[56:59], v[24:27], v[160:163]
    ds_read_b64_tr_b16 v[80:81], v4 offset:30720
    ds_read_b64_tr_b16 v[82:83], v4 offset:31744
    v_mfma_f32_16x16x32_bf16 v[224:227], v[56:59], v[28:31], v[224:227]
    v_mfma_f32_16x16x32_bf16 v[164:167], v[60:63], v[24:27], v[164:167]
    ds_read_b64_tr_b16 v[84:85], v5 offset:30720
    ds_read_b64_tr_b16 v[86:87], v5 offset:31744
    v_mfma_f32_16x16x32_bf16 v[228:231], v[60:63], v[28:31], v[228:231]
    s_waitcnt lgkmcnt(8)
    v_mfma_f32_16x16x32_bf16 v[168:171], v[64:67], v[24:27], v[168:171]
    ds_read_b64_tr_b16 v[56:57], v4 offset:32768
    ds_read_b64_tr_b16 v[58:59], v4 offset:33792
    v_mfma_f32_16x16x32_bf16 v[232:235], v[64:67], v[28:31], v[232:235]
    v_mfma_f32_16x16x32_bf16 v[172:175], v[68:71], v[24:27], v[172:175]
    ds_read_b64_tr_b16 v[60:61], v5 offset:32768
    ds_read_b64_tr_b16 v[62:63], v5 offset:33792
    v_mfma_f32_16x16x32_bf16 v[236:239], v[68:71], v[28:31], v[236:239]
    s_waitcnt lgkmcnt(8)
    v_mfma_f32_16x16x32_bf16 v[176:179], v[72:75], v[24:27], v[176:179]
    ds_read_b64_tr_b16 v[64:65], v4 offset:34816
    ds_read_b64_tr_b16 v[66:67], v4 offset:35840
    v_mfma_f32_16x16x32_bf16 v[240:243], v[72:75], v[28:31], v[240:243]
    v_mfma_f32_16x16x32_bf16 v[180:183], v[76:79], v[24:27], v[180:183]
    ds_read_b64_tr_b16 v[68:69], v5 offset:34816
    ds_read_b64_tr_b16 v[70:71], v5 offset:35840
    v_mfma_f32_16x16x32_bf16 v[244:247], v[76:79], v[28:31], v[244:247]
    s_waitcnt lgkmcnt(8)
    v_mfma_f32_16x16x32_bf16 v[184:187], v[80:83], v[24:27], v[184:187]
    ds_read_b64_tr_b16 v[72:73], v4 offset:36864
    ds_read_b64_tr_b16 v[74:75], v4 offset:37888
    v_mfma_f32_16x16x32_bf16 v[248:251], v[80:83], v[28:31], v[248:251]
    v_mfma_f32_16x16x32_bf16 v[188:191], v[84:87], v[24:27], v[188:191]
    ds_read_b64_tr_b16 v[76:77], v5 offset:36864
    ds_read_b64_tr_b16 v[78:79], v5 offset:37888
    v_mfma_f32_16x16x32_bf16 v[252:255], v[84:87], v[28:31], v[252:255]
    s_waitcnt vmcnt(12)
    s_barrier
    s_waitcnt lgkmcnt(8)
    v_mfma_f32_16x16x32_bf16 v[128:131], v[56:59], v[32:35], v[128:131]
    ds_read_b64_tr_b16 v[80:81], v4 offset:38912
    ds_read_b64_tr_b16 v[82:83], v4 offset:39936
    v_mfma_f32_16x16x32_bf16 v[192:195], v[56:59], v[36:39], v[192:195]
    s_add_u32 m0, s42, 16384
    s_nop 0
    buffer_load_dwordx4 v8, s[12:15], s41 offen lds
    v_mfma_f32_16x16x32_bf16 v[132:135], v[60:63], v[32:35], v[132:135]
    ds_read_b64_tr_b16 v[84:85], v5 offset:38912
    ds_read_b64_tr_b16 v[86:87], v5 offset:39936
    v_mfma_f32_16x16x32_bf16 v[196:199], v[60:63], v[36:39], v[196:199]
    s_add_u32 m0, s42, 20480
    s_nop 0
    buffer_load_dwordx4 v9, s[12:15], s41 offen lds
    s_waitcnt lgkmcnt(8)
    v_mfma_f32_16x16x32_bf16 v[136:139], v[64:67], v[32:35], v[136:139]
    ds_read_b64_tr_b16 v[56:57], v4 offset:40960
    ds_read_b64_tr_b16 v[58:59], v4 offset:41984
    v_mfma_f32_16x16x32_bf16 v[200:203], v[64:67], v[36:39], v[200:203]
    s_add_u32 m0, s42, 24576
    s_nop 0
    buffer_load_dwordx4 v10, s[12:15], s41 offen lds
    v_mfma_f32_16x16x32_bf16 v[140:143], v[68:71], v[32:35], v[140:143]
    ds_read_b64_tr_b16 v[60:61], v5 offset:40960
    ds_read_b64_tr_b16 v[62:63], v5 offset:41984
    v_mfma_f32_16x16x32_bf16 v[204:207], v[68:71], v[36:39], v[204:207]
    s_add_u32 m0, s42, 28672
    s_nop 0
    buffer_load_dwordx4 v11, s[12:15], s41 offen lds
    s_waitcnt lgkmcnt(8)
    v_mfma_f32_16x16x32_bf16 v[144:147], v[72:75], v[32:35], v[144:147]
    ds_read_b64_tr_b16 v[64:65], v4 offset:43008
    ds_read_b64_tr_b16 v[66:67], v4 offset:44032
    v_mfma_f32_16x16x32_bf16 v[208:211], v[72:75], v[36:39], v[208:211]
    s_add_u32 s41, s41, 262144
    buffer_load_dwordx4 v[24:27], v1, s[8:11], s40 offen sc1
    v_mfma_f32_16x16x32_bf16 v[148:151], v[76:79], v[32:35], v[148:151]
    ds_read_b64_tr_b16 v[68:69], v5 offset:43008
    ds_read_b64_tr_b16 v[70:71], v5 offset:44032
    v_mfma_f32_16x16x32_bf16 v[212:215], v[76:79], v[36:39], v[212:215]
    s_add_u32 s55, s40, 20480
    buffer_load_dwordx4 v[28:31], v1, s[8:11], s55 offen sc1
    s_waitcnt lgkmcnt(8)
    v_mfma_f32_16x16x32_bf16 v[152:155], v[80:83], v[32:35], v[152:155]
    ds_read_b64_tr_b16 v[72:73], v4 offset:45056
    ds_read_b64_tr_b16 v[74:75], v4 offset:46080
    v_mfma_f32_16x16x32_bf16 v[216:219], v[80:83], v[36:39], v[216:219]
    s_add_u32 s40, s40, 1024
    v_mfma_f32_16x16x32_bf16 v[156:159], v[84:87], v[32:35], v[156:159]
    ds_read_b64_tr_b16 v[76:77], v5 offset:45056
    ds_read_b64_tr_b16 v[78:79], v5 offset:46080
    v_mfma_f32_16x16x32_bf16 v[220:223], v[84:87], v[36:39], v[220:223]
    s_waitcnt lgkmcnt(8)
    v_mfma_f32_16x16x32_bf16 v[160:163], v[56:59], v[32:35], v[160:163]
    ds_read_b64_tr_b16 v[80:81], v4 offset:47104
    ds_read_b64_tr_b16 v[82:83], v4 offset:48128
    v_mfma_f32_16x16x32_bf16 v[224:227], v[56:59], v[36:39], v[224:227]
    v_mfma_f32_16x16x32_bf16 v[164:167], v[60:63], v[32:35], v[164:167]
    ds_read_b64_tr_b16 v[84:85], v5 offset:47104
    ds_read_b64_tr_b16 v[86:87], v5 offset:48128
    v_mfma_f32_16x16x32_bf16 v[228:231], v[60:63], v[36:39], v[228:231]
    s_waitcnt lgkmcnt(8)
    v_mfma_f32_16x16x32_bf16 v[168:171], v[64:67], v[32:35], v[168:171]
    ds_read_b64_tr_b16 v[56:57], v4 offset:49152
    ds_read_b64_tr_b16 v[58:59], v4 offset:50176
    v_mfma_f32_16x16x32_bf16 v[232:235], v[64:67], v[36:39], v[232:235]
    v_mfma_f32_16x16x32_bf16 v[172:175], v[68:71], v[32:35], v[172:175]
    ds_read_b64_tr_b16 v[60:61], v5 offset:49152
    ds_read_b64_tr_b16 v[62:63], v5 offset:50176
    v_mfma_f32_16x16x32_bf16 v[236:239], v[68:71], v[36:39], v[236:239]
    s_waitcnt lgkmcnt(8)
    v_mfma_f32_16x16x32_bf16 v[176:179], v[72:75], v[32:35], v[176:179]
    ds_read_b64_tr_b16 v[64:65], v4 offset:51200
    ds_read_b64_tr_b16 v[66:67], v4 offset:52224
    v_mfma_f32_16x16x32_bf16 v[240:243], v[72:75], v[36:39], v[240:243]
    v_mfma_f32_16x16x32_bf16 v[180:183], v[76:79], v[32:35], v[180:183]
    ds_read_b64_tr_b16 v[68:69], v5 offset:51200
    ds_read_b64_tr_b16 v[70:71], v5 offset:52224
    v_mfma_f32_16x16x32_bf16 v[244:247], v[76:79], v[36:39], v[244:247]
    s_waitcnt lgkmcnt(8)
    v_mfma_f32_16x16x32_bf16 v[184:187], v[80:83], v[32:35], v[184:187]
    ds_read_b64_tr_b16 v[72:73], v4 offset:53248
    ds_read_b64_tr_b16 v[74:75], v4 offset:54272
    v_mfma_f32_16x16x32_bf16 v[248:251], v[80:83], v[36:39], v[248:251]
    v_mfma_f32_16x16x32_bf16 v[188:191], v[84:87], v[32:35], v[188:191]
    ds_read_b64_tr_b16 v[76:77], v5 offset:53248
    ds_read_b64_tr_b16 v[78:79], v5 offset:54272
    v_mfma_f32_16x16x32_bf16 v[252:255], v[84:87], v[36:39], v[252:255]
    s_waitcnt vmcnt(12)
    s_barrier
    s_waitcnt lgkmcnt(8)
    v_mfma_f32_16x16x32_bf16 v[128:131], v[56:59], v[40:43], v[128:131]
    ds_read_b64_tr_b16 v[80:81], v4 offset:55296
    ds_read_b64_tr_b16 v[82:83], v4 offset:56320
    v_mfma_f32_16x16x32_bf16 v[192:195], v[56:59], v[44:47], v[192:195]
    s_add_u32 m0, s42, 32768
    s_nop 0
    buffer_load_dwordx4 v8, s[12:15], s41 offen lds
    v_mfma_f32_16x16x32_bf16 v[132:135], v[60:63], v[40:43], v[132:135]
    ds_read_b64_tr_b16 v[84:85], v5 offset:55296
    ds_read_b64_tr_b16 v[86:87], v5 offset:56320
    v_mfma_f32_16x16x32_bf16 v[196:199], v[60:63], v[44:47], v[196:199]
    s_add_u32 m0, s42, 36864
    s_nop 0
    buffer_load_dwordx4 v9, s[12:15], s41 offen lds
    s_waitcnt lgkmcnt(8)
    v_mfma_f32_16x16x32_bf16 v[136:139], v[64:67], v[40:43], v[136:139]
    ds_read_b64_tr_b16 v[56:57], v4 offset:57344
    ds_read_b64_tr_b16 v[58:59], v4 offset:58368
    v_mfma_f32_16x16x32_bf16 v[200:203], v[64:67], v[44:47], v[200:203]
    s_add_u32 m0, s42, 40960
    s_nop 0
    buffer_load_dwordx4 v10, s[12:15], s41 offen lds
    v_mfma_f32_16x16x32_bf16 v[140:143], v[68:71], v[40:43], v[140:143]
    ds_read_b64_tr_b16 v[60:61], v5 offset:57344
    ds_read_b64_tr_b16 v[62:63], v5 offset:58368
    v_mfma_f32_16x16x32_bf16 v[204:207], v[68:71], v[44:47], v[204:207]
    s_add_u32 m0, s42, 45056
    s_nop 0
    buffer_load_dwordx4 v11, s[12:15], s41 offen lds
    s_waitcnt lgkmcnt(8)
    v_mfma_f32_16x16x32_bf16 v[144:147], v[72:75], v[40:43], v[144:147]
    ds_read_b64_tr_b16 v[64:65], v4 offset:59392
    ds_read_b64_tr_b16 v[66:67], v4 offset:60416
    v_mfma_f32_16x16x32_bf16 v[208:211], v[72:75], v[44:47], v[208:211]
    s_add_u32 s41, s41, 262144
    buffer_load_dwordx4 v[32:35], v1, s[8:11], s40 offen sc1
    v_mfma_f32_16x16x32_bf16 v[148:151], v[76:79], v[40:43], v[148:151]
    ds_read_b64_tr_b16 v[68:69], v5 offset:59392
    ds_read_b64_tr_b16 v[70:71], v5 offset:60416
    v_mfma_f32_16x16x32_bf16 v[212:215], v[76:79], v[44:47], v[212:215]
    s_add_u32 s55, s40, 20480
    buffer_load_dwordx4 v[36:39], v1, s[8:11], s55 offen sc1
    s_waitcnt lgkmcnt(8)
    v_mfma_f32_16x16x32_bf16 v[152:155], v[80:83], v[40:43], v[152:155]
    ds_read_b64_tr_b16 v[72:73], v4 offset:61440
    ds_read_b64_tr_b16 v[74:75], v4 offset:62464
    v_mfma_f32_16x16x32_bf16 v[216:219], v[80:83], v[44:47], v[216:219]
    s_add_u32 s40, s40, 1024
    v_mfma_f32_16x16x32_bf16 v[156:159], v[84:87], v[40:43], v[156:159]
    ds_read_b64_tr_b16 v[76:77], v5 offset:61440
    ds_read_b64_tr_b16 v[78:79], v5 offset:62464
    v_mfma_f32_16x16x32_bf16 v[220:223], v[84:87], v[44:47], v[220:223]
    s_waitcnt lgkmcnt(8)
    v_mfma_f32_16x16x32_bf16 v[160:163], v[56:59], v[40:43], v[160:163]
    ds_read_b64_tr_b16 v[80:81], v4 offset:63488
    ds_read_b64_tr_b16 v[82:83], v4 offset:64512
    v_mfma_f32_16x16x32_bf16 v[224:227], v[56:59], v[44:47], v[224:227]
    v_mfma_f32_16x16x32_bf16 v[164:167], v[60:63], v[40:43], v[164:167]
    ds_read_b64_tr_b16 v[84:85], v5 offset:63488
    ds_read_b64_tr_b16 v[86:87], v5 offset:64512
    v_mfma_f32_16x16x32_bf16 v[228:231], v[60:63], v[44:47], v[228:231]
    s_waitcnt lgkmcnt(8)
    v_mfma_f32_16x16x32_bf16 v[168:171], v[64:67], v[40:43], v[168:171]
    ds_read_b64_tr_b16 v[56:57], v6 offset:0
    ds_read_b64_tr_b16 v[58:59], v6 offset:1024
    v_mfma_f32_16x16x32_bf16 v[232:235], v[64:67], v[44:47], v[232:235]
    v_mfma_f32_16x16x32_bf16 v[172:175], v[68:71], v[40:43], v[172:175]
    ds_read_b64_tr_b16 v[60:61], v7 offset:0
    ds_read_b64_tr_b16 v[62:63], v7 offset:1024
    v_mfma_f32_16x16x32_bf16 v[236:239], v[68:71], v[44:47], v[236:239]
    s_waitcnt lgkmcnt(8)
    v_mfma_f32_16x16x32_bf16 v[176:179], v[72:75], v[40:43], v[176:179]
    ds_read_b64_tr_b16 v[64:65], v6 offset:2048
    ds_read_b64_tr_b16 v[66:67], v6 offset:3072
    v_mfma_f32_16x16x32_bf16 v[240:243], v[72:75], v[44:47], v[240:243]
    v_mfma_f32_16x16x32_bf16 v[180:183], v[76:79], v[40:43], v[180:183]
    ds_read_b64_tr_b16 v[68:69], v7 offset:2048
    ds_read_b64_tr_b16 v[70:71], v7 offset:3072
    v_mfma_f32_16x16x32_bf16 v[244:247], v[76:79], v[44:47], v[244:247]
    s_waitcnt lgkmcnt(8)
    v_mfma_f32_16x16x32_bf16 v[184:187], v[80:83], v[40:43], v[184:187]
    ds_read_b64_tr_b16 v[72:73], v6 offset:4096
    ds_read_b64_tr_b16 v[74:75], v6 offset:5120
    v_mfma_f32_16x16x32_bf16 v[248:251], v[80:83], v[44:47], v[248:251]
    v_mfma_f32_16x16x32_bf16 v[188:191], v[84:87], v[40:43], v[188:191]
    ds_read_b64_tr_b16 v[76:77], v7 offset:4096
    ds_read_b64_tr_b16 v[78:79], v7 offset:5120
    v_mfma_f32_16x16x32_bf16 v[252:255], v[84:87], v[44:47], v[252:255]
    s_waitcnt vmcnt(12)
    s_barrier
    s_waitcnt lgkmcnt(8)
    v_mfma_f32_16x16x32_bf16 v[128:131], v[56:59], v[48:51], v[128:131]
    ds_read_b64_tr_b16 v[80:81], v6 offset:6144
    ds_read_b64_tr_b16 v[82:83], v6 offset:7168
    v_mfma_f32_16x16x32_bf16 v[192:195], v[56:59], v[52:55], v[192:195]
    s_add_u32 m0, s42, 49152
    s_nop 0
    buffer_load_dwordx4 v8, s[12:15], s41 offen lds
    v_mfma_f32_16x16x32_bf16 v[132:135], v[60:63], v[48:51], v[132:135]
    ds_read_b64_tr_b16 v[84:85], v7 offset:6144
    ds_read_b64_tr_b16 v[86:87], v7 offset:7168
    v_mfma_f32_16x16x32_bf16 v[196:199], v[60:63], v[52:55], v[196:199]
    s_add_u32 m0, s42, 53248
    s_nop 0
    buffer_load_dwordx4 v9, s[12:15], s41 offen lds
    s_waitcnt lgkmcnt(8)
    v_mfma_f32_16x16x32_bf16 v[136:139], v[64:67], v[48:51], v[136:139]
    ds_read_b64_tr_b16 v[56:57], v6 offset:8192
    ds_read_b64_tr_b16 v[58:59], v6 offset:9216
    v_mfma_f32_16x16x32_bf16 v[200:203], v[64:67], v[52:55], v[200:203]
    s_add_u32 m0, s42, 57344
    s_nop 0
    buffer_load_dwordx4 v10, s[12:15], s41 offen lds
    v_mfma_f32_16x16x32_bf16 v[140:143], v[68:71], v[48:51], v[140:143]
    ds_read_b64_tr_b16 v[60:61], v7 offset:8192
    ds_read_b64_tr_b16 v[62:63], v7 offset:9216
    v_mfma_f32_16x16x32_bf16 v[204:207], v[68:71], v[52:55], v[204:207]
    s_add_u32 m0, s42, 61440
    s_nop 0
    buffer_load_dwordx4 v11, s[12:15], s41 offen lds
    s_waitcnt lgkmcnt(8)
    v_mfma_f32_16x16x32_bf16 v[144:147], v[72:75], v[48:51], v[144:147]
    ds_read_b64_tr_b16 v[64:65], v6 offset:10240
    ds_read_b64_tr_b16 v[66:67], v6 offset:11264
    v_mfma_f32_16x16x32_bf16 v[208:211], v[72:75], v[52:55], v[208:211]
    s_add_u32 s41, s41, 262144
    buffer_load_dwordx4 v[40:43], v1, s[8:11], s40 offen sc1
    v_mfma_f32_16x16x32_bf16 v[148:151], v[76:79], v[48:51], v[148:151]
    ds_read_b64_tr_b16 v[68:69], v7 offset:10240
    ds_read_b64_tr_b16 v[70:71], v7 offset:11264
    v_mfma_f32_16x16x32_bf16 v[212:215], v[76:79], v[52:55], v[212:215]
    s_add_u32 s55, s40, 20480
    buffer_load_dwordx4 v[44:47], v1, s[8:11], s55 offen sc1
    s_waitcnt lgkmcnt(8)
    v_mfma_f32_16x16x32_bf16 v[152:155], v[80:83], v[48:51], v[152:155]
    ds_read_b64_tr_b16 v[72:73], v6 offset:12288
    ds_read_b64_tr_b16 v[74:75], v6 offset:13312
    v_mfma_f32_16x16x32_bf16 v[216:219], v[80:83], v[52:55], v[216:219]
    s_add_u32 s40, s40, 1024
    v_mfma_f32_16x16x32_bf16 v[156:159], v[84:87], v[48:51], v[156:159]
    ds_read_b64_tr_b16 v[76:77], v7 offset:12288
    ds_read_b64_tr_b16 v[78:79], v7 offset:13312
    v_mfma_f32_16x16x32_bf16 v[220:223], v[84:87], v[52:55], v[220:223]
    s_waitcnt lgkmcnt(8)
    v_mfma_f32_16x16x32_bf16 v[160:163], v[56:59], v[48:51], v[160:163]
    ds_read_b64_tr_b16 v[80:81], v6 offset:14336
    ds_read_b64_tr_b16 v[82:83], v6 offset:15360
    v_mfma_f32_16x16x32_bf16 v[224:227], v[56:59], v[52:55], v[224:227]
    v_mfma_f32_16x16x32_bf16 v[164:167], v[60:63], v[48:51], v[164:167]
    ds_read_b64_tr_b16 v[84:85], v7 offset:14336
    ds_read_b64_tr_b16 v[86:87], v7 offset:15360
    v_mfma_f32_16x16x32_bf16 v[228:231], v[60:63], v[52:55], v[228:231]
    s_waitcnt lgkmcnt(8)
    v_mfma_f32_16x16x32_bf16 v[168:171], v[64:67], v[48:51], v[168:171]
    ds_read_b64_tr_b16 v[56:57], v4 offset:0
    ds_read_b64_tr_b16 v[58:59], v4 offset:1024
    v_mfma_f32_16x16x32_bf16 v[232:235], v[64:67], v[52:55], v[232:235]
    v_mfma_f32_16x16x32_bf16 v[172:175], v[68:71], v[48:51], v[172:175]
    ds_read_b64_tr_b16 v[60:61], v5 offset:0
    ds_read_b64_tr_b16 v[62:63], v5 offset:1024
    v_mfma_f32_16x16x32_bf16 v[236:239], v[68:71], v[52:55], v[236:239]
    s_waitcnt lgkmcnt(8)
    v_mfma_f32_16x16x32_bf16 v[176:179], v[72:75], v[48:51], v[176:179]
    ds_read_b64_tr_b16 v[64:65], v4 offset:2048
    ds_read_b64_tr_b16 v[66:67], v4 offset:3072
    v_mfma_f32_16x16x32_bf16 v[240:243], v[72:75], v[52:55], v[240:243]
    v_mfma_f32_16x16x32_bf16 v[180:183], v[76:79], v[48:51], v[180:183]
    ds_read_b64_tr_b16 v[68:69], v5 offset:2048
    ds_read_b64_tr_b16 v[70:71], v5 offset:3072
    v_mfma_f32_16x16x32_bf16 v[244:247], v[76:79], v[52:55], v[244:247]
    s_waitcnt lgkmcnt(8)
    v_mfma_f32_16x16x32_bf16 v[184:187], v[80:83], v[48:51], v[184:187]
    ds_read_b64_tr_b16 v[72:73], v4 offset:4096
    ds_read_b64_tr_b16 v[74:75], v4 offset:5120
    v_mfma_f32_16x16x32_bf16 v[248:251], v[80:83], v[52:55], v[248:251]
    v_mfma_f32_16x16x32_bf16 v[188:191], v[84:87], v[48:51], v[188:191]
    ds_read_b64_tr_b16 v[76:77], v5 offset:4096
    ds_read_b64_tr_b16 v[78:79], v5 offset:5120
    v_mfma_f32_16x16x32_bf16 v[252:255], v[84:87], v[52:55], v[252:255]
    s_sub_u32 s43, s43, 1
    s_cmp_lg_u32 s43, 0
    s_cbranch_scc1 gq_loop
    s_waitcnt vmcnt(0) lgkmcnt(0)
    s_barrier
    s_lshl_b32 s84, s45, 18
    s_mul_i32 s55, s73, 16384
    s_add_u32 s84, s84, s55
    s_add_u32 s84, s84, 33554432
    v_cvt_pk_bf16_f32 v88, v128, v129
    v_cvt_pk_bf16_f32 v89, v130, v131
    v_cvt_pk_bf16_f32 v90, v132, v133
    v_cvt_pk_bf16_f32 v91, v134, v135
    buffer_store_dwordx4 v[88:91], v1, s[8:11], s84 offen offset:0 sc1
    v_cvt_pk_bf16_f32 v92, v136, v137
    v_cvt_pk_bf16_f32 v93, v138, v139
    v_cvt_pk_bf16_f32 v94, v140, v141
    v_cvt_pk_bf16_f32 v95, v142, v143
    buffer_store_dwordx4 v[92:95], v1, s[8:11], s84 offen offset:1024 sc1
    v_cvt_pk_bf16_f32 v96, v144, v145
    v_cvt_pk_bf16_f32 v97, v146, v147
    v_cvt_pk_bf16_f32 v98, v148, v149
    v_cvt_pk_bf16_f32 v99, v150, v151
    buffer_store_dwordx4 v[96:99], v1, s[8:11], s84 offen offset:2048 sc1
    v_cvt_pk_bf16_f32 v100, v152, v153
    v_cvt_pk_bf16_f32 v101, v154, v155
    v_cvt_pk_bf16_f32 v102, v156, v157
    v_cvt_pk_bf16_f32 v103, v158, v159
    buffer_store_dwordx4 v[100:103], v1, s[8:11], s84 offen offset:3072 sc1
    v_cvt_pk_bf16_f32 v104, v192, v193
    v_cvt_pk_bf16_f32 v105, v194, v195
    v_cvt_pk_bf16_f32 v106, v196, v197
    v_cvt_pk_bf16_f32 v107, v198, v199
    s_add_u32 s84, s84, 4096
    buffer_store_dwordx4 v[104:107], v1, s[8:11], s84 offen offset:0 sc1
    v_cvt_pk_bf16_f32 v108, v200, v201
    v_cvt_pk_bf16_f32 v109, v202, v203
    v_cvt_pk_bf16_f32 v110, v204, v205
    v_cvt_pk_bf16_f32 v111, v206, v207
    buffer_store_dwordx4 v[108:111], v1, s[8:11], s84 offen offset:1024 sc1
    v_cvt_pk_bf16_f32 v112, v208, v209
    v_cvt_pk_bf16_f32 v113, v210, v211
    v_cvt_pk_bf16_f32 v114, v212, v213
    v_cvt_pk_bf16_f32 v115, v214, v215
    buffer_store_dwordx4 v[112:115], v1, s[8:11], s84 offen offset:2048 sc1
    v_cvt_pk_bf16_f32 v116, v216, v217
    v_cvt_pk_bf16_f32 v117, v218, v219
    v_cvt_pk_bf16_f32 v118, v220, v221
    v_cvt_pk_bf16_f32 v119, v222, v223
    buffer_store_dwordx4 v[116:119], v1, s[8:11], s84 offen offset:3072 sc1
    v_cvt_pk_bf16_f32 v120, v160, v161
    v_cvt_pk_bf16_f32 v121, v162, v163
    v_cvt_pk_bf16_f32 v122, v164, v165
    v_cvt_pk_bf16_f32 v123, v166, v167
    s_add_u32 s84, s84, 4096
    buffer_store_dwordx4 v[120:123], v1, s[8:11], s84 offen offset:0 sc1
    v_cvt_pk_bf16_f32 v124, v168, v169
    v_cvt_pk_bf16_f32 v125, v170, v171
    v_cvt_pk_bf16_f32 v126, v172, v173
    v_cvt_pk_bf16_f32 v127, v174, v175
    buffer_store_dwordx4 v[124:127], v1, s[8:11], s84 offen offset:1024 sc1
    v_cvt_pk_bf16_f32 v88, v176, v177
    v_cvt_pk_bf16_f32 v89, v178, v179
    v_cvt_pk_bf16_f32 v90, v180, v181
    v_cvt_pk_bf16_f32 v91, v182, v183
    buffer_store_dwordx4 v[88:91], v1, s[8:11], s84 offen offset:2048 sc1
    v_cvt_pk_bf16_f32 v92, v184, v185
    v_cvt_pk_bf16_f32 v93, v186, v187
    v_cvt_pk_bf16_f32 v94, v188, v189
    v_cvt_pk_bf16_f32 v95, v190, v191
    buffer_store_dwordx4 v[92:95], v1, s[8:11], s84 offen offset:3072 sc1
    v_cvt_pk_bf16_f32 v96, v224, v225
    v_cvt_pk_bf16_f32 v97, v226, v227
    v_cvt_pk_bf16_f32 v98, v228, v229
    v_cvt_pk_bf16_f32 v99, v230, v231
    s_add_u32 s84, s84, 4096
    buffer_store_dwordx4 v[96:99], v1, s[8:11], s84 offen offset:0 sc1
    v_cvt_pk_bf16_f32 v100, v232, v233
    v_cvt_pk_bf16_f32 v101, v234, v235
    v_cvt_pk_bf16_f32 v102, v236, v237
    v_cvt_pk_bf16_f32 v103, v238, v239
    buffer_store_dwordx4 v[100:103], v1, s[8:11], s84 offen offset:1024 sc1
    v_cvt_pk_bf16_f32 v104, v240, v241
    v_cvt_pk_bf16_f32 v105, v242, v243
    v_cvt_pk_bf16_f32 v106, v244, v245
    v_cvt_pk_bf16_f32 v107, v246, v247
    buffer_store_dwordx4 v[104:107], v1, s[8:11], s84 offen offset:2048 sc1
    v_cvt_pk_bf16_f32 v108, v248, v249
    v_cvt_pk_bf16_f32 v109, v250, v251
    v_cvt_pk_bf16_f32 v110, v252, v253
    v_cvt_pk_bf16_f32 v111, v254, v255
    buffer_store_dwordx4 v[108:111], v1, s[8:11], s84 offen offset:3072 sc1
    s_lshl_b32 s85, s73, 7
    s_lshl_b32 s54, s72, 2
    s_add_u32 s85, s85, s54
    s_add_u32 s85, s85, 2367488
    s_mov_b32 s83, 2
    s_branch rnext_143
dokv_140:
    s_load_dwordx2 s[12:13], s[0:1], 24
    s_load_dwordx2 s[16:17], s[0:1], 32
    s_waitcnt lgkmcnt(0)
    s_and_b32 s13, s13, 0xffff
    s_mov_b32 s14, 5242880
    s_mov_b32 s15, 0x20000
    s_and_b32 s17, s17, 0xffff
    s_mov_b32 s18, 5242880
    s_mov_b32 s19, 0x20000
    s_lshl_b32 s45, s72, 2
    s_add_u32 s45, s45, s36
    s_mul_i32 s40, s45, 40960
    s_add_u32 s40, s40, 8388608
    s_lshl_b32 s41, s73, 8
    v_lshlrev_b32 v1, 4, v0
    v_bfe_u32 v2, v0, 4, 2
    v_lshlrev_b32 v8, 3, v2
    v_bfe_u32 v2, v0, 2, 2
    v_lshl_add_u32 v8, v2, 0, v8
    s_mov_b32 s55, 8192
    v_mul_lo_u32 v8, v8, s55
    v_lshrrev_b32 v2, 3, v0
    v_and_b32 v2, 2, v2
    v_xor_b32 v2, v2, v0
    v_and_b32 v2, 3, v2
    v_lshl_add_u32 v8, v2, 4, v8
    v_bfe_u32 v2, v0, 2, 4
    v_lshlrev_b32 v4, 6, v2
    v_bfe_u32 v2, v0, 4, 1
    v_lshl_add_u32 v4, v2, 5, v4
    v_bfe_u32 v2, v0, 0, 2
    v_lshl_add_u32 v4, v2, 3, v4
    v_xor_b32 v5, 32, v4
    v_add_u32 v6, 65536, v4
    v_add_u32 v7, 65536, v5
    s_and_b32 s54, s36, 1
    s_mul_i32 s54, s54, 32768
    s_lshr_b32 s55, s36, 1
    s_lshl_b32 s55, s55, 6
    s_add_u32 s54, s54, s55
    v_add_u32 v8, s54, v8
    v_add_u32 v11, 128, v8
    v_add_u32 v10, 0, v8
    v_add_u32 v9, 128, v8
    v_add_u32 v8, 0, v8
    s_lshl_b32 s42, s36, 10
    s_add_u32 m0, s42, 0
    s_nop 0
    buffer_load_dwordx4 v8, s[12:15], s41 offen lds
    s_add_u32 m0, s42, 4096
    s_nop 0
    buffer_load_dwordx4 v9, s[12:15], s41 offen lds
    s_add_u32 m0, s42, 8192
    s_nop 0
    buffer_load_dwordx4 v10, s[16:19], s41 offen lds
    s_add_u32 m0, s42, 12288
    s_nop 0
    buffer_load_dwordx4 v11, s[16:19], s41 offen lds
    s_add_u32 s41, s41, 262144
    s_add_u32 m0, s42, 16384
    s_nop 0
    buffer_load_dwordx4 v8, s[12:15], s41 offen lds
    s_add_u32 m0, s42, 20480
    s_nop 0
    buffer_load_dwordx4 v9, s[12:15], s41 offen lds
    s_add_u32 m0, s42, 24576
    s_nop 0
    buffer_load_dwordx4 v10, s[16:19], s41 offen lds
    s_add_u32 m0, s42, 28672
    s_nop 0
    buffer_load_dwordx4 v11, s[16:19], s41 offen lds
    s_add_u32 s41, s41, 262144
    s_add_u32 m0, s42, 32768
    s_nop 0
    buffer_load_dwordx4 v8, s[12:15], s41 offen lds
    s_add_u32 m0, s42, 36864
    s_nop 0
    buffer_load_dwordx4 v9, s[12:15], s41 offen lds
    s_add_u32 m0, s42, 40960
    s_nop 0
    buffer_load_dwordx4 v10, s[16:19], s41 offen lds
    s_add_u32 m0, s42, 45056
    s_nop 0
    buffer_load_dwordx4 v11, s[16:19], s41 offen lds
    s_add_u32 s41, s41, 262144
    s_add_u32 m0, s42, 49152
    s_nop 0
    buffer_load_dwordx4 v8, s[12:15], s41 offen lds
    s_add_u32 m0, s42, 53248
    s_nop 0
    buffer_load_dwordx4 v9, s[12:15], s41 offen lds
    s_add_u32 m0, s42, 57344
    s_nop 0
    buffer_load_dwordx4 v10, s[16:19], s41 offen lds
    s_add_u32 m0, s42, 61440
    s_nop 0
    buffer_load_dwordx4 v11, s[16:19], s41 offen lds
    s_add_u32 s41, s41, 262144
    buffer_load_dwordx4 v[16:19], v1, s[8:11], s40 offen sc1
    s_add_u32 s55, s40, 20480
    buffer_load_dwordx4 v[20:23], v1, s[8:11], s55 offen sc1
    s_add_u32 s40, s40, 1024
    buffer_load_dwordx4 v[24:27], v1, s[8:11], s40 offen sc1
    s_add_u32 s55, s40, 20480
    buffer_load_dwordx4 v[28:31], v1, s[8:11], s55 offen sc1
    s_add_u32 s40, s40, 1024
    buffer_load_dwordx4 v[32:35], v1, s[8:11], s40 offen sc1
    s_add_u32 s55, s40, 20480
    buffer_load_dwordx4 v[36:39], v1, s[8:11], s55 offen sc1
    s_add_u32 s40, s40, 1024
    buffer_load_dwordx4 v[40:43], v1, s[8:11], s40 offen sc1
    s_add_u32 s55, s40, 20480
    buffer_load_dwordx4 v[44:47], v1, s[8:11], s55 offen sc1
    s_add_u32 s40, s40, 1024
    s_cmp_eq_u32 s71, 0
    s_cbranch_scc1 e_148
    s_waitcnt vmcnt(24) lgkmcnt(0)
    s_barrier
    s_cmp_lg_u32 s36, 0
    s_cbranch_scc1 sg_149
    v_mov_b32 v14, 0
    v_mov_b32 v15, s83
    s_mov_b64 exec, 1
    buffer_atomic_add v15, v14, s[8:11], s85 offen
    s_mov_b64 exec, -1
sg_149:
e_148:
    s_waitcnt vmcnt(6)
    s_barrier
    ds_read_b64_tr_b16 v[56:57], v4 offset:0
    ds_read_b64_tr_b16 v[58:59], v4 offset:1024
    ds_read_b64_tr_b16 v[60:61], v5 offset:0
    ds_read_b64_tr_b16 v[62:63], v5 offset:1024
    ds_read_b64_tr_b16 v[64:65], v4 offset:2048
    ds_read_b64_tr_b16 v[66:67], v4 offset:3072
    ds_read_b64_tr_b16 v[68:69], v5 offset:2048
    ds_read_b64_tr_b16 v[70:71], v5 offset:3072
    ds_read_b64_tr_b16 v[72:73], v4 offset:4096
    ds_read_b64_tr_b16 v[74:75], v4 offset:5120
    ds_read_b64_tr_b16 v[76:77], v5 offset:4096
    ds_read_b64_tr_b16 v[78:79], v5 offset:5120
    s_waitcnt vmcnt(4)
    s_barrier
    s_waitcnt lgkmcnt(8)
    v_mfma_f32_16x16x32_bf16 v[128:131], v[56:59], v[16:19], 0
    ds_read_b64_tr_b16 v[80:81], v4 offset:6144
    ds_read_b64_tr_b16 v[82:83], v4 offset:7168
    v_mfma_f32_16x16x32_bf16 v[192:195], v[56:59], v[20:23], 0
    s_add_u32 m0, s42, 65536
    s_nop 0
    buffer_load_dwordx4 v8, s[12:15], s41 offen lds
    v_mfma_f32_16x16x32_bf16 v[132:135], v[60:63], v[16:19], 0
    ds_read_b64_tr_b16 v[84:85], v5 offset:6144
    ds_read_b64_tr_b16 v[86:87], v5 offset:7168
    v_mfma_f32_16x16x32_bf16 v[196:199], v[60:63], v[20:23], 0
    s_add_u32 m0, s42, 69632
    s_nop 0
    buffer_load_dwordx4 v9, s[12:15], s41 offen lds
    s_waitcnt lgkmcnt(8)
    v_mfma_f32_16x16x32_bf16 v[136:139], v[64:67], v[16:19], 0
    ds_read_b64_tr_b16 v[56:57], v4 offset:8192
    ds_read_b64_tr_b16 v[58:59], v4 offset:9216
    v_mfma_f32_16x16x32_bf16 v[200:203], v[64:67], v[20:23], 0
    s_add_u32 m0, s42, 73728
    s_nop 0
    buffer_load_dwordx4 v10, s[16:19], s41 offen lds
    v_mfma_f32_16x16x32_bf16 v[140:143], v[68:71], v[16:19], 0
    ds_read_b64_tr_b16 v[60:61], v5 offset:8192
    ds_read_b64_tr_b16 v[62:63], v5 offset:9216
    v_mfma_f32_16x16x32_bf16 v[204:207], v[68:71], v[20:23], 0
    s_add_u32 m0, s42, 77824
    s_nop 0
    buffer_load_dwordx4 v11, s[16:19], s41 offen lds
    s_waitcnt lgkmcnt(8)
    v_mfma_f32_16x16x32_bf16 v[144:147], v[72:75], v[16:19], 0
    ds_read_b64_tr_b16 v[64:65], v4 offset:10240
    ds_read_b64_tr_b16 v[66:67], v4 offset:11264
    v_mfma_f32_16x16x32_bf16 v[208:211], v[72:75], v[20:23], 0
    s_add_u32 s41, s41, 262144
    buffer_load_dwordx4 v[48:51], v1, s[8:11], s40 offen sc1
    v_mfma_f32_16x16x32_bf16 v[148:151], v[76:79], v[16:19], 0
    ds_read_b64_tr_b16 v[68:69], v5 offset:10240
    ds_read_b64_tr_b16 v[70:71], v5 offset:11264
    v_mfma_f32_16x16x32_bf16 v[212:215], v[76:79], v[20:23], 0
    s_add_u32 s55, s40, 20480
    buffer_load_dwordx4 v[52:55], v1, s[8:11], s55 offen sc1
    s_waitcnt lgkmcnt(8)
    v_mfma_f32_16x16x32_bf16 v[152:155], v[80:83], v[16:19], 0
    ds_read_b64_tr_b16 v[72:73], v4 offset:12288
    ds_read_b64_tr_b16 v[74:75], v4 offset:13312
    v_mfma_f32_16x16x32_bf16 v[216:219], v[80:83], v[20:23], 0
    s_add_u32 s40, s40, 1024
    v_mfma_f32_16x16x32_bf16 v[156:159], v[84:87], v[16:19], 0
    ds_read_b64_tr_b16 v[76:77], v5 offset:12288
    ds_read_b64_tr_b16 v[78:79], v5 offset:13312
    v_mfma_f32_16x16x32_bf16 v[220:223], v[84:87], v[20:23], 0
    s_waitcnt lgkmcnt(8)
    v_mfma_f32_16x16x32_bf16 v[160:163], v[16:19], v[56:59], 0
    ds_read_b64_tr_b16 v[80:81], v4 offset:14336
    ds_read_b64_tr_b16 v[82:83], v4 offset:15360
    v_mfma_f32_16x16x32_bf16 v[224:227], v[20:23], v[56:59], 0
    v_mfma_f32_16x16x32_bf16 v[164:167], v[16:19], v[60:63], 0
    ds_read_b64_tr_b16 v[84:85], v5 offset:14336
    ds_read_b64_tr_b16 v[86:87], v5 offset:15360
    v_mfma_f32_16x16x32_bf16 v[228:231], v[20:23], v[60:63], 0
    s_waitcnt lgkmcnt(8)
    v_mfma_f32_16x16x32_bf16 v[168:171], v[16:19], v[64:67], 0
    ds_read_b64_tr_b16 v[56:57], v4 offset:16384
    ds_read_b64_tr_b16 v[58:59], v4 offset:17408
    v_mfma_f32_16x16x32_bf16 v[232:235], v[20:23], v[64:67], 0
    v_mfma_f32_16x16x32_bf16 v[172:175], v[16:19], v[68:71], 0
    ds_read_b64_tr_b16 v[60:61], v5 offset:16384
    ds_read_b64_tr_b16 v[62:63], v5 offset:17408
    v_mfma_f32_16x16x32_bf16 v[236:239], v[20:23], v[68:71], 0
    s_waitcnt lgkmcnt(8)
    v_mfma_f32_16x16x32_bf16 v[176:179], v[16:19], v[72:75], 0
    ds_read_b64_tr_b16 v[64:65], v4 offset:18432
    ds_read_b64_tr_b16 v[66:67], v4 offset:19456
    v_mfma_f32_16x16x32_bf16 v[240:243], v[20:23], v[72:75], 0
    v_mfma_f32_16x16x32_bf16 v[180:183], v[16:19], v[76:79], 0
    ds_read_b64_tr_b16 v[68:69], v5 offset:18432
    ds_read_b64_tr_b16 v[70:71], v5 offset:19456
    v_mfma_f32_16x16x32_bf16 v[244:247], v[20:23], v[76:79], 0
    s_waitcnt lgkmcnt(8)
    v_mfma_f32_16x16x32_bf16 v[184:187], v[16:19], v[80:83], 0
    ds_read_b64_tr_b16 v[72:73], v4 offset:20480
    ds_read_b64_tr_b16 v[74:75], v4 offset:21504
    v_mfma_f32_16x16x32_bf16 v[248:251], v[20:23], v[80:83], 0
    v_mfma_f32_16x16x32_bf16 v[188:191], v[16:19], v[84:87], 0
    ds_read_b64_tr_b16 v[76:77], v5 offset:20480
    ds_read_b64_tr_b16 v[78:79], v5 offset:21504
    v_mfma_f32_16x16x32_bf16 v[252:255], v[20:23], v[84:87], 0
    s_waitcnt vmcnt(8)
    s_barrier
    s_waitcnt lgkmcnt(8)
    v_mfma_f32_16x16x32_bf16 v[128:131], v[56:59], v[24:27], v[128:131]
    ds_read_b64_tr_b16 v[80:81], v4 offset:22528
    ds_read_b64_tr_b16 v[82:83], v4 offset:23552
    v_mfma_f32_16x16x32_bf16 v[192:195], v[56:59], v[28:31], v[192:195]
    s_add_u32 m0, s42, 0
    s_nop 0
    buffer_load_dwordx4 v8, s[12:15], s41 offen lds
    v_mfma_f32_16x16x32_bf16 v[132:135], v[60:63], v[24:27], v[132:135]
    ds_read_b64_tr_b16 v[84:85], v5 offset:22528
    ds_read_b64_tr_b16 v[86:87], v5 offset:23552
    v_mfma_f32_16x16x32_bf16 v[196:199], v[60:63], v[28:31], v[196:199]
    s_add_u32 m0, s42, 4096
    s_nop 0
    buffer_load_dwordx4 v9, s[12:15], s41 offen lds
    s_waitcnt lgkmcnt(8)
    v_mfma_f32_16x16x32_bf16 v[136:139], v[64:67], v[24:27], v[136:139]
    ds_read_b64_tr_b16 v[56:57], v4 offset:24576
    ds_read_b64_tr_b16 v[58:59], v4 offset:25600
    v_mfma_f32_16x16x32_bf16 v[200:203], v[64:67], v[28:31], v[200:203]
    s_add_u32 m0, s42, 8192
    s_nop 0
    buffer_load_dwordx4 v10, s[16:19], s41 offen lds
    v_mfma_f32_16x16x32_bf16 v[140:143], v[68:71], v[24:27], v[140:143]
    ds_read_b64_tr_b16 v[60:61], v5 offset:24576
    ds_read_b64_tr_b16 v[62:63], v5 offset:25600
    v_mfma_f32_16x16x32_bf16 v[204:207], v[68:71], v[28:31], v[204:207]
    s_add_u32 m0, s42, 12288
    s_nop 0
    buffer_load_dwordx4 v11, s[16:19], s41 offen lds
    s_waitcnt lgkmcnt(8)
    v_mfma_f32_16x16x32_bf16 v[144:147], v[72:75], v[24:27], v[144:147]
    ds_read_b64_tr_b16 v[64:65], v4 offset:26624
    ds_read_b64_tr_b16 v[66:67], v4 offset:27648
    v_mfma_f32_16x16x32_bf16 v[208:211], v[72:75], v[28:31], v[208:211]
    s_add_u32 s41, s41, 262144
    buffer_load_dwordx4 v[16:19], v1, s[8:11], s40 offen sc1
    v_mfma_f32_16x16x32_bf16 v[148:151], v[76:79], v[24:27], v[148:151]
    ds_read_b64_tr_b16 v[68:69], v5 offset:26624
    ds_read_b64_tr_b16 v[70:71], v5 offset:27648
    v_mfma_f32_16x16x32_bf16 v[212:215], v[76:79], v[28:31], v[212:215]
    s_add_u32 s55, s40, 20480
    buffer_load_dwordx4 v[20:23], v1, s[8:11], s55 offen sc1
    s_waitcnt lgkmcnt(8)
    v_mfma_f32_16x16x32_bf16 v[152:155], v[80:83], v[24:27], v[152:155]
    ds_read_b64_tr_b16 v[72:73], v4 offset:28672
    ds_read_b64_tr_b16 v[74:75], v4 offset:29696
    v_mfma_f32_16x16x32_bf16 v[216:219], v[80:83], v[28:31], v[216:219]
    s_add_u32 s40, s40, 1024
    v_mfma_f32_16x16x32_bf16 v[156:159], v[84:87], v[24:27], v[156:159]
    ds_read_b64_tr_b16 v[76:77], v5 offset:28672
    ds_read_b64_tr_b16 v[78:79], v5 offset:29696
    v_mfma_f32_16x16x32_bf16 v[220:223], v[84:87], v[28:31], v[220:223]
    s_waitcnt lgkmcnt(8)
    v_mfma_f32_16x16x32_bf16 v[160:163], v[24:27], v[56:59], v[160:163]
    ds_read_b64_tr_b16 v[80:81], v4 offset:30720
    ds_read_b64_tr_b16 v[82:83], v4 offset:31744
    v_mfma_f32_16x16x32_bf16 v[224:227], v[28:31], v[56:59], v[224:227]
    v_mfma_f32_16x16x32_bf16 v[164:167], v[24:27], v[60:63], v[164:167]
    ds_read_b64_tr_b16 v[84:85], v5 offset:30720
    ds_read_b64_tr_b16 v[86:87], v5 offset:31744
    v_mfma_f32_16x16x32_bf16 v[228:231], v[28:31], v[60:63], v[228:231]
    s_waitcnt lgkmcnt(8)
    v_mfma_f32_16x16x32_bf16 v[168:171], v[24:27], v[64:67], v[168:171]
    ds_read_b64_tr_b16 v[56:57], v4 offset:32768
    ds_read_b64_tr_b16 v[58:59], v4 offset:33792
    v_mfma_f32_16x16x32_bf16 v[232:235], v[28:31], v[64:67], v[232:235]
    v_mfma_f32_16x16x32_bf16 v[172:175], v[24:27], v[68:71], v[172:175]
    ds_read_b64_tr_b16 v[60:61], v5 offset:32768
    ds_read_b64_tr_b16 v[62:63], v5 offset:33792
    v_mfma_f32_16x16x32_bf16 v[236:239], v[28:31], v[68:71], v[236:239]
    s_waitcnt lgkmcnt(8)
    v_mfma_f32_16x16x32_bf16 v[176:179], v[24:27], v[72:75], v[176:179]
    ds_read_b64_tr_b16 v[64:65], v4 offset:34816
    ds_read_b64_tr_b16 v[66:67], v4 offset:35840
    v_mfma_f32_16x16x32_bf16 v[240:243], v[28:31], v[72:75], v[240:243]
    v_mfma_f32_16x16x32_bf16 v[180:183], v[24:27], v[76:79], v[180:183]
    ds_read_b64_tr_b16 v[68:69], v5 offset:34816
    ds_read_b64_tr_b16 v[70:71], v5 offset:35840
    v_mfma_f32_16x16x32_bf16 v[244:247], v[28:31], v[76:79], v[244:247]
    s_waitcnt lgkmcnt(8)
    v_mfma_f32_16x16x32_bf16 v[184:187], v[24:27], v[80:83], v[184:187]
    ds_read_b64_tr_b16 v[72:73], v4 offset:36864
    ds_read_b64_tr_b16 v[74:75], v4 offset:37888
    v_mfma_f32_16x16x32_bf16 v[248:251], v[28:31], v[80:83], v[248:251]
    v_mfma_f32_16x16x32_bf16 v[188:191], v[24:27], v[84:87], v[188:191]
    ds_read_b64_tr_b16 v[76:77], v5 offset:36864
    ds_read_b64_tr_b16 v[78:79], v5 offset:37888
    v_mfma_f32_16x16x32_bf16 v[252:255], v[28:31], v[84:87], v[252:255]
    s_waitcnt vmcnt(12)
    s_barrier
    s_waitcnt lgkmcnt(8)
    v_mfma_f32_16x16x32_bf16 v[128:131], v[56:59], v[32:35], v[128:131]
    ds_read_b64_tr_b16 v[80:81], v4 offset:38912
    ds_read_b64_tr_b16 v[82:83], v4 offset:39936
    v_mfma_f32_16x16x32_bf16 v[192:195], v[56:59], v[36:39], v[192:195]
    s_add_u32 m0, s42, 16384
    s_nop 0
    buffer_load_dwordx4 v8, s[12:15], s41 offen lds
    v_mfma_f32_16x16x32_bf16 v[132:135], v[60:63], v[32:35], v[132:135]
    ds_read_b64_tr_b16 v[84:85], v5 offset:38912
    ds_read_b64_tr_b16 v[86:87], v5 offset:39936
    v_mfma_f32_16x16x32_bf16 v[196:199], v[60:63], v[36:39], v[196:199]
    s_add_u32 m0, s42, 20480
    s_nop 0
    buffer_load_dwordx4 v9, s[12:15], s41 offen lds
    s_waitcnt lgkmcnt(8)
    v_mfma_f32_16x16x32_bf16 v[136:139], v[64:67], v[32:35], v[136:139]
    ds_read_b64_tr_b16 v[56:57], v4 offset:40960
    ds_read_b64_tr_b16 v[58:59], v4 offset:41984
    v_mfma_f32_16x16x32_bf16 v[200:203], v[64:67], v[36:39], v[200:203]
    s_add_u32 m0, s42, 24576
    s_nop 0
    buffer_load_dwordx4 v10, s[16:19], s41 offen lds
    v_mfma_f32_16x16x32_bf16 v[140:143], v[68:71], v[32:35], v[140:143]
    ds_read_b64_tr_b16 v[60:61], v5 offset:40960
    ds_read_b64_tr_b16 v[62:63], v5 offset:41984
    v_mfma_f32_16x16x32_bf16 v[204:207], v[68:71], v[36:39], v[204:207]
    s_add_u32 m0, s42, 28672
    s_nop 0
    buffer_load_dwordx4 v11, s[16:19], s41 offen lds
    s_waitcnt lgkmcnt(8)
    v_mfma_f32_16x16x32_bf16 v[144:147], v[72:75], v[32:35], v[144:147]
    ds_read_b64_tr_b16 v[64:65], v4 offset:43008
    ds_read_b64_tr_b16 v[66:67], v4 offset:44032
    v_mfma_f32_16x16x32_bf16 v[208:211], v[72:75], v[36:39], v[208:211]
    s_add_u32 s41, s41, 262144
    buffer_load_dwordx4 v[24:27], v1, s[8:11], s40 offen sc1
    v_mfma_f32_16x16x32_bf16 v[148:151], v[76:79], v[32:35], v[148:151]
    ds_read_b64_tr_b16 v[68:69], v5 offset:43008
    ds_read_b64_tr_b16 v[70:71], v5 offset:44032
    v_mfma_f32_16x16x32_bf16 v[212:215], v[76:79], v[36:39], v[212:215]
    s_add_u32 s55, s40, 20480
    buffer_load_dwordx4 v[28:31], v1, s[8:11], s55 offen sc1
    s_waitcnt lgkmcnt(8)
    v_mfma_f32_16x16x32_bf16 v[152:155], v[80:83], v[32:35], v[152:155]
    ds_read_b64_tr_b16 v[72:73], v4 offset:45056
    ds_read_b64_tr_b16 v[74:75], v4 offset:46080
    v_mfma_f32_16x16x32_bf16 v[216:219], v[80:83], v[36:39], v[216:219]
    s_add_u32 s40, s40, 1024
    v_mfma_f32_16x16x32_bf16 v[156:159], v[84:87], v[32:35], v[156:159]
    ds_read_b64_tr_b16 v[76:77], v5 offset:45056
    ds_read_b64_tr_b16 v[78:79], v5 offset:46080
    v_mfma_f32_16x16x32_bf16 v[220:223], v[84:87], v[36:39], v[220:223]
    s_waitcnt lgkmcnt(8)
    v_mfma_f32_16x16x32_bf16 v[160:163], v[32:35], v[56:59], v[160:163]
    ds_read_b64_tr_b16 v[80:81], v4 offset:47104
    ds_read_b64_tr_b16 v[82:83], v4 offset:48128
    v_mfma_f32_16x16x32_bf16 v[224:227], v[36:39], v[56:59], v[224:227]
    v_mfma_f32_16x16x32_bf16 v[164:167], v[32:35], v[60:63], v[164:167]
    ds_read_b64_tr_b16 v[84:85], v5 offset:47104
    ds_read_b64_tr_b16 v[86:87], v5 offset:48128
    v_mfma_f32_16x16x32_bf16 v[228:231], v[36:39], v[60:63], v[228:231]
    s_waitcnt lgkmcnt(8)
    v_mfma_f32_16x16x32_bf16 v[168:171], v[32:35], v[64:67], v[168:171]
    ds_read_b64_tr_b16 v[56:57], v4 offset:49152
    ds_read_b64_tr_b16 v[58:59], v4 offset:50176
    v_mfma_f32_16x16x32_bf16 v[232:235], v[36:39], v[64:67], v[232:235]
    v_mfma_f32_16x16x32_bf16 v[172:175], v[32:35], v[68:71], v[172:175]
    ds_read_b64_tr_b16 v[60:61], v5 offset:49152
    ds_read_b64_tr_b16 v[62:63], v5 offset:50176
    v_mfma_f32_16x16x32_bf16 v[236:239], v[36:39], v[68:71], v[236:239]
    s_waitcnt lgkmcnt(8)
    v_mfma_f32_16x16x32_bf16 v[176:179], v[32:35], v[72:75], v[176:179]
    ds_read_b64_tr_b16 v[64:65], v4 offset:51200
    ds_read_b64_tr_b16 v[66:67], v4 offset:52224
    v_mfma_f32_16x16x32_bf16 v[240:243], v[36:39], v[72:75], v[240:243]
    v_mfma_f32_16x16x32_bf16 v[180:183], v[32:35], v[76:79], v[180:183]
    ds_read_b64_tr_b16 v[68:69], v5 offset:51200
    ds_read_b64_tr_b16 v[70:71], v5 offset:52224
    v_mfma_f32_16x16x32_bf16 v[244:247], v[36:39], v[76:79], v[244:247]
    s_waitcnt lgkmcnt(8)
    v_mfma_f32_16x16x32_bf16 v[184:187], v[32:35], v[80:83], v[184:187]
    ds_read_b64_tr_b16 v[72:73], v4 offset:53248
    ds_read_b64_tr_b16 v[74:75], v4 offset:54272
    v_mfma_f32_16x16x32_bf16 v[248:251], v[36:39], v[80:83], v[248:251]
    v_mfma_f32_16x16x32_bf16 v[188:191], v[32:35], v[84:87], v[188:191]
    ds_read_b64_tr_b16 v[76:77], v5 offset:53248
    ds_read_b64_tr_b16 v[78:79], v5 offset:54272
    v_mfma_f32_16x16x32_bf16 v[252:255], v[36:39], v[84:87], v[252:255]
    s_waitcnt vmcnt(12)
    s_barrier
    s_waitcnt lgkmcnt(8)
    v_mfma_f32_16x16x32_bf16 v[128:131], v[56:59], v[40:43], v[128:131]
    ds_read_b64_tr_b16 v[80:81], v4 offset:55296
    ds_read_b64_tr_b16 v[82:83], v4 offset:56320
    v_mfma_f32_16x16x32_bf16 v[192:195], v[56:59], v[44:47], v[192:195]
    s_add_u32 m0, s42, 32768
    s_nop 0
    buffer_load_dwordx4 v8, s[12:15], s41 offen lds
    v_mfma_f32_16x16x32_bf16 v[132:135], v[60:63], v[40:43], v[132:135]
    ds_read_b64_tr_b16 v[84:85], v5 offset:55296
    ds_read_b64_tr_b16 v[86:87], v5 offset:56320
    v_mfma_f32_16x16x32_bf16 v[196:199], v[60:63], v[44:47], v[196:199]
    s_add_u32 m0, s42, 36864
    s_nop 0
    buffer_load_dwordx4 v9, s[12:15], s41 offen lds
    s_waitcnt lgkmcnt(8)
    v_mfma_f32_16x16x32_bf16 v[136:139], v[64:67], v[40:43], v[136:139]
    ds_read_b64_tr_b16 v[56:57], v4 offset:57344
    ds_read_b64_tr_b16 v[58:59], v4 offset:58368
    v_mfma_f32_16x16x32_bf16 v[200:203], v[64:67], v[44:47], v[200:203]
    s_add_u32 m0, s42, 40960
    s_nop 0
    buffer_load_dwordx4 v10, s[16:19], s41 offen lds
    v_mfma_f32_16x16x32_bf16 v[140:143], v[68:71], v[40:43], v[140:143]
    ds_read_b64_tr_b16 v[60:61], v5 offset:57344
    ds_read_b64_tr_b16 v[62:63], v5 offset:58368
    v_mfma_f32_16x16x32_bf16 v[204:207], v[68:71], v[44:47], v[204:207]
    s_add_u32 m0, s42, 45056
    s_nop 0
    buffer_load_dwordx4 v11, s[16:19], s41 offen lds
    s_waitcnt lgkmcnt(8)
    v_mfma_f32_16x16x32_bf16 v[144:147], v[72:75], v[40:43], v[144:147]
    ds_read_b64_tr_b16 v[64:65], v4 offset:59392
    ds_read_b64_tr_b16 v[66:67], v4 offset:60416
    v_mfma_f32_16x16x32_bf16 v[208:211], v[72:75], v[44:47], v[208:211]
    s_add_u32 s41, s41, 262144
    buffer_load_dwordx4 v[32:35], v1, s[8:11], s40 offen sc1
    v_mfma_f32_16x16x32_bf16 v[148:151], v[76:79], v[40:43], v[148:151]
    ds_read_b64_tr_b16 v[68:69], v5 offset:59392
    ds_read_b64_tr_b16 v[70:71], v5 offset:60416
    v_mfma_f32_16x16x32_bf16 v[212:215], v[76:79], v[44:47], v[212:215]
    s_add_u32 s55, s40, 20480
    buffer_load_dwordx4 v[36:39], v1, s[8:11], s55 offen sc1
    s_waitcnt lgkmcnt(8)
    v_mfma_f32_16x16x32_bf16 v[152:155], v[80:83], v[40:43], v[152:155]
    ds_read_b64_tr_b16 v[72:73], v4 offset:61440
    ds_read_b64_tr_b16 v[74:75], v4 offset:62464
    v_mfma_f32_16x16x32_bf16 v[216:219], v[80:83], v[44:47], v[216:219]
    s_add_u32 s40, s40, 1024
    v_mfma_f32_16x16x32_bf16 v[156:159], v[84:87], v[40:43], v[156:159]
    ds_read_b64_tr_b16 v[76:77], v5 offset:61440
    ds_read_b64_tr_b16 v[78:79], v5 offset:62464
    v_mfma_f32_16x16x32_bf16 v[220:223], v[84:87], v[44:47], v[220:223]
    s_waitcnt lgkmcnt(8)
    v_mfma_f32_16x16x32_bf16 v[160:163], v[40:43], v[56:59], v[160:163]
    ds_read_b64_tr_b16 v[80:81], v4 offset:63488
    ds_read_b64_tr_b16 v[82:83], v4 offset:64512
    v_mfma_f32_16x16x32_bf16 v[224:227], v[44:47], v[56:59], v[224:227]
    v_mfma_f32_16x16x32_bf16 v[164:167], v[40:43], v[60:63], v[164:167]
    ds_read_b64_tr_b16 v[84:85], v5 offset:63488
    ds_read_b64_tr_b16 v[86:87], v5 offset:64512
    v_mfma_f32_16x16x32_bf16 v[228:231], v[44:47], v[60:63], v[228:231]
    s_waitcnt lgkmcnt(8)
    v_mfma_f32_16x16x32_bf16 v[168:171], v[40:43], v[64:67], v[168:171]
    ds_read_b64_tr_b16 v[56:57], v6 offset:0
    ds_read_b64_tr_b16 v[58:59], v6 offset:1024
    v_mfma_f32_16x16x32_bf16 v[232:235], v[44:47], v[64:67], v[232:235]
    v_mfma_f32_16x16x32_bf16 v[172:175], v[40:43], v[68:71], v[172:175]
    ds_read_b64_tr_b16 v[60:61], v7 offset:0
    ds_read_b64_tr_b16 v[62:63], v7 offset:1024
    v_mfma_f32_16x16x32_bf16 v[236:239], v[44:47], v[68:71], v[236:239]
    s_waitcnt lgkmcnt(8)
    v_mfma_f32_16x16x32_bf16 v[176:179], v[40:43], v[72:75], v[176:179]
    ds_read_b64_tr_b16 v[64:65], v6 offset:2048
    ds_read_b64_tr_b16 v[66:67], v6 offset:3072
    v_mfma_f32_16x16x32_bf16 v[240:243], v[44:47], v[72:75], v[240:243]
    v_mfma_f32_16x16x32_bf16 v[180:183], v[40:43], v[76:79], v[180:183]
    ds_read_b64_tr_b16 v[68:69], v7 offset:2048
    ds_read_b64_tr_b16 v[70:71], v7 offset:3072
    v_mfma_f32_16x16x32_bf16 v[244:247], v[44:47], v[76:79], v[244:247]
    s_waitcnt lgkmcnt(8)
    v_mfma_f32_16x16x32_bf16 v[184:187], v[40:43], v[80:83], v[184:187]
    ds_read_b64_tr_b16 v[72:73], v6 offset:4096
    ds_read_b64_tr_b16 v[74:75], v6 offset:5120
    v_mfma_f32_16x16x32_bf16 v[248:251], v[44:47], v[80:83], v[248:251]
    v_mfma_f32_16x16x32_bf16 v[188:191], v[40:43], v[84:87], v[188:191]
    ds_read_b64_tr_b16 v[76:77], v7 offset:4096
    ds_read_b64_tr_b16 v[78:79], v7 offset:5120
    v_mfma_f32_16x16x32_bf16 v[252:255], v[44:47], v[84:87], v[252:255]
    s_waitcnt vmcnt(12)
    s_barrier
    s_waitcnt lgkmcnt(8)
    v_mfma_f32_16x16x32_bf16 v[128:131], v[56:59], v[48:51], v[128:131]
    ds_read_b64_tr_b16 v[80:81], v6 offset:6144
    ds_read_b64_tr_b16 v[82:83], v6 offset:7168
    v_mfma_f32_16x16x32_bf16 v[192:195], v[56:59], v[52:55], v[192:195]
    s_add_u32 m0, s42, 49152
    s_nop 0
    buffer_load_dwordx4 v8, s[12:15], s41 offen lds
    v_mfma_f32_16x16x32_bf16 v[132:135], v[60:63], v[48:51], v[132:135]
    ds_read_b64_tr_b16 v[84:85], v7 offset:6144
    ds_read_b64_tr_b16 v[86:87], v7 offset:7168
    v_mfma_f32_16x16x32_bf16 v[196:199], v[60:63], v[52:55], v[196:199]
    s_add_u32 m0, s42, 53248
    s_nop 0
    buffer_load_dwordx4 v9, s[12:15], s41 offen lds
    s_waitcnt lgkmcnt(8)
    v_mfma_f32_16x16x32_bf16 v[136:139], v[64:67], v[48:51], v[136:139]
    ds_read_b64_tr_b16 v[56:57], v6 offset:8192
    ds_read_b64_tr_b16 v[58:59], v6 offset:9216
    v_mfma_f32_16x16x32_bf16 v[200:203], v[64:67], v[52:55], v[200:203]
    s_add_u32 m0, s42, 57344
    s_nop 0
    buffer_load_dwordx4 v10, s[16:19], s41 offen lds
    v_mfma_f32_16x16x32_bf16 v[140:143], v[68:71], v[48:51], v[140:143]
    ds_read_b64_tr_b16 v[60:61], v7 offset:8192
    ds_read_b64_tr_b16 v[62:63], v7 offset:9216
    v_mfma_f32_16x16x32_bf16 v[204:207], v[68:71], v[52:55], v[204:207]
    s_add_u32 m0, s42, 61440
    s_nop 0
    buffer_load_dwordx4 v11, s[16:19], s41 offen lds
    s_waitcnt lgkmcnt(8)
    v_mfma_f32_16x16x32_bf16 v[144:147], v[72:75], v[48:51], v[144:147]
    ds_read_b64_tr_b16 v[64:65], v6 offset:10240
    ds_read_b64_tr_b16 v[66:67], v6 offset:11264
    v_mfma_f32_16x16x32_bf16 v[208:211], v[72:75], v[52:55], v[208:211]
    s_add_u32 s41, s41, 262144
    buffer_load_dwordx4 v[40:43], v1, s[8:11], s40 offen sc1
    v_mfma_f32_16x16x32_bf16 v[148:151], v[76:79], v[48:51], v[148:151]
    ds_read_b64_tr_b16 v[68:69], v7 offset:10240
    ds_read_b64_tr_b16 v[70:71], v7 offset:11264
    v_mfma_f32_16x16x32_bf16 v[212:215], v[76:79], v[52:55], v[212:215]
    s_add_u32 s55, s40, 20480
    buffer_load_dwordx4 v[44:47], v1, s[8:11], s55 offen sc1
    s_waitcnt lgkmcnt(8)
    v_mfma_f32_16x16x32_bf16 v[152:155], v[80:83], v[48:51], v[152:155]
    ds_read_b64_tr_b16 v[72:73], v6 offset:12288
    ds_read_b64_tr_b16 v[74:75], v6 offset:13312
    v_mfma_f32_16x16x32_bf16 v[216:219], v[80:83], v[52:55], v[216:219]
    s_add_u32 s40, s40, 1024
    v_mfma_f32_16x16x32_bf16 v[156:159], v[84:87], v[48:51], v[156:159]
    ds_read_b64_tr_b16 v[76:77], v7 offset:12288
    ds_read_b64_tr_b16 v[78:79], v7 offset:13312
    v_mfma_f32_16x16x32_bf16 v[220:223], v[84:87], v[52:55], v[220:223]
    s_waitcnt lgkmcnt(8)
    v_mfma_f32_16x16x32_bf16 v[160:163], v[48:51], v[56:59], v[160:163]
    ds_read_b64_tr_b16 v[80:81], v6 offset:14336
    ds_read_b64_tr_b16 v[82:83], v6 offset:15360
    v_mfma_f32_16x16x32_bf16 v[224:227], v[52:55], v[56:59], v[224:227]
    v_mfma_f32_16x16x32_bf16 v[164:167], v[48:51], v[60:63], v[164:167]
    ds_read_b64_tr_b16 v[84:85], v7 offset:14336
    ds_read_b64_tr_b16 v[86:87], v7 offset:15360
    v_mfma_f32_16x16x32_bf16 v[228:231], v[52:55], v[60:63], v[228:231]
    s_waitcnt lgkmcnt(8)
    v_mfma_f32_16x16x32_bf16 v[168:171], v[48:51], v[64:67], v[168:171]
    ds_read_b64_tr_b16 v[56:57], v4 offset:0
    ds_read_b64_tr_b16 v[58:59], v4 offset:1024
    v_mfma_f32_16x16x32_bf16 v[232:235], v[52:55], v[64:67], v[232:235]
    v_mfma_f32_16x16x32_bf16 v[172:175], v[48:51], v[68:71], v[172:175]
    ds_read_b64_tr_b16 v[60:61], v5 offset:0
    ds_read_b64_tr_b16 v[62:63], v5 offset:1024
    v_mfma_f32_16x16x32_bf16 v[236:239], v[52:55], v[68:71], v[236:239]
    s_waitcnt lgkmcnt(8)
    v_mfma_f32_16x16x32_bf16 v[176:179], v[48:51], v[72:75], v[176:179]
    ds_read_b64_tr_b16 v[64:65], v4 offset:2048
    ds_read_b64_tr_b16 v[66:67], v4 offset:3072
    v_mfma_f32_16x16x32_bf16 v[240:243], v[52:55], v[72:75], v[240:243]
    v_mfma_f32_16x16x32_bf16 v[180:183], v[48:51], v[76:79], v[180:183]
    ds_read_b64_tr_b16 v[68:69], v5 offset:2048
    ds_read_b64_tr_b16 v[70:71], v5 offset:3072
    v_mfma_f32_16x16x32_bf16 v[244:247], v[52:55], v[76:79], v[244:247]
    s_waitcnt lgkmcnt(8)
    v_mfma_f32_16x16x32_bf16 v[184:187], v[48:51], v[80:83], v[184:187]
    ds_read_b64_tr_b16 v[72:73], v4 offset:4096
    ds_read_b64_tr_b16 v[74:75], v4 offset:5120
    v_mfma_f32_16x16x32_bf16 v[248:251], v[52:55], v[80:83], v[248:251]
    v_mfma_f32_16x16x32_bf16 v[188:191], v[48:51], v[84:87], v[188:191]
    ds_read_b64_tr_b16 v[76:77], v5 offset:4096
    ds_read_b64_tr_b16 v[78:79], v5 offset:5120
    v_mfma_f32_16x16x32_bf16 v[252:255], v[52:55], v[84:87], v[252:255]
    s_mov_b32 s43, 3
.p2align 3
gkv_loop:
    s_waitcnt vmcnt(12)
    s_barrier
    s_waitcnt lgkmcnt(8)
    v_mfma_f32_16x16x32_bf16 v[128:131], v[56:59], v[16:19], v[128:131]
    ds_read_b64_tr_b16 v[80:81], v4 offset:6144
    ds_read_b64_tr_b16 v[82:83], v4 offset:7168
    v_mfma_f32_16x16x32_bf16 v[192:195], v[56:59], v[20:23], v[192:195]
    s_add_u32 m0, s42, 65536
    s_nop 0
    buffer_load_dwordx4 v8, s[12:15], s41 offen lds
    v_mfma_f32_16x16x32_bf16 v[132:135], v[60:63], v[16:19], v[132:135]
    ds_read_b64_tr_b16 v[84:85], v5 offset:6144
    ds_read_b64_tr_b16 v[86:87], v5 offset:7168
    v_mfma_f32_16x16x32_bf16 v[196:199], v[60:63], v[20:23], v[196:199]
    s_add_u32 m0, s42, 69632
    s_nop 0
    buffer_load_dwordx4 v9, s[12:15], s41 offen lds
    s_waitcnt lgkmcnt(8)
    v_mfma_f32_16x16x32_bf16 v[136:139], v[64:67], v[16:19], v[136:139]
    ds_read_b64_tr_b16 v[56:57], v4 offset:8192
    ds_read_b64_tr_b16 v[58:59], v4 offset:9216
    v_mfma_f32_16x16x32_bf16 v[200:203], v[64:67], v[20:23], v[200:203]
    s_add_u32 m0, s42, 73728
    s_nop 0
    buffer_load_dwordx4 v10, s[16:19], s41 offen lds
    v_mfma_f32_16x16x32_bf16 v[140:143], v[68:71], v[16:19], v[140:143]
    ds_read_b64_tr_b16 v[60:61], v5 offset:8192
    ds_read_b64_tr_b16 v[62:63], v5 offset:9216
    v_mfma_f32_16x16x32_bf16 v[204:207], v[68:71], v[20:23], v[204:207]
    s_add_u32 m0, s42, 77824
    s_nop 0
    buffer_load_dwordx4 v11, s[16:19], s41 offen lds
    s_waitcnt lgkmcnt(8)
    v_mfma_f32_16x16x32_bf16 v[144:147], v[72:75], v[16:19], v[144:147]
    ds_read_b64_tr_b16 v[64:65], v4 offset:10240
    ds_read_b64_tr_b16 v[66:67], v4 offset:11264
    v_mfma_f32_16x16x32_bf16 v[208:211], v[72:75], v[20:23], v[208:211]
    s_add_u32 s41, s41, 262144
    buffer_load_dwordx4 v[48:51], v1, s[8:11], s40 offen sc1
    v_mfma_f32_16x16x32_bf16 v[148:151], v[76:79], v[16:19], v[148:151]
    ds_read_b64_tr_b16 v[68:69], v5 offset:10240
    ds_read_b64_tr_b16 v[70:71], v5 offset:11264
    v_mfma_f32_16x16x32_bf16 v[212:215], v[76:79], v[20:23], v[212:215]
    s_add_u32 s55, s40, 20480
    buffer_load_dwordx4 v[52:55], v1, s[8:11], s55 offen sc1
    s_waitcnt lgkmcnt(8)
    v_mfma_f32_16x16x32_bf16 v[152:155], v[80:83], v[16:19], v[152:155]
    ds_read_b64_tr_b16 v[72:73], v4 offset:12288
    ds_read_b64_tr_b16 v[74:75], v4 offset:13312
    v_mfma_f32_16x16x32_bf16 v[216:219], v[80:83], v[20:23], v[216:219]
    s_add_u32 s40, s40, 1024
    v_mfma_f32_16x16x32_bf16 v[156:159], v[84:87], v[16:19], v[156:159]
    ds_read_b64_tr_b16 v[76:77], v5 offset:12288
    ds_read_b64_tr_b16 v[78:79], v5 offset:13312
    v_mfma_f32_16x16x32_bf16 v[220:223], v[84:87], v[20:23], v[220:223]
    s_waitcnt lgkmcnt(8)
    v_mfma_f32_16x16x32_bf16 v[160:163], v[16:19], v[56:59], v[160:163]
    ds_read_b64_tr_b16 v[80:81], v4 offset:14336
    ds_read_b64_tr_b16 v[82:83], v4 offset:15360
    v_mfma_f32_16x16x32_bf16 v[224:227], v[20:23], v[56:59], v[224:227]
    v_mfma_f32_16x16x32_bf16 v[164:167], v[16:19], v[60:63], v[164:167]
    ds_read_b64_tr_b16 v[84:85], v5 offset:14336
    ds_read_b64_tr_b16 v[86:87], v5 offset:15360
    v_mfma_f32_16x16x32_bf16 v[228:231], v[20:23], v[60:63], v[228:231]
    s_waitcnt lgkmcnt(8)
    v_mfma_f32_16x16x32_bf16 v[168:171], v[16:19], v[64:67], v[168:171]
    ds_read_b64_tr_b16 v[56:57], v4 offset:16384
    ds_read_b64_tr_b16 v[58:59], v4 offset:17408
    v_mfma_f32_16x16x32_bf16 v[232:235], v[20:23], v[64:67], v[232:235]
    v_mfma_f32_16x16x32_bf16 v[172:175], v[16:19], v[68:71], v[172:175]
    ds_read_b64_tr_b16 v[60:61], v5 offset:16384
    ds_read_b64_tr_b16 v[62:63], v5 offset:17408
    v_mfma_f32_16x16x32_bf16 v[236:239], v[20:23], v[68:71], v[236:239]
    s_waitcnt lgkmcnt(8)
    v_mfma_f32_16x16x32_bf16 v[176:179], v[16:19], v[72:75], v[176:179]
    ds_read_b64_tr_b16 v[64:65], v4 offset:18432
    ds_read_b64_tr_b16 v[66:67], v4 offset:19456
    v_mfma_f32_16x16x32_bf16 v[240:243], v[20:23], v[72:75], v[240:243]
    v_mfma_f32_16x16x32_bf16 v[180:183], v[16:19], v[76:79], v[180:183]
    ds_read_b64_tr_b16 v[68:69], v5 offset:18432
    ds_read_b64_tr_b16 v[70:71], v5 offset:19456
    v_mfma_f32_16x16x32_bf16 v[244:247], v[20:23], v[76:79], v[244:247]
    s_waitcnt lgkmcnt(8)
    v_mfma_f32_16x16x32_bf16 v[184:187], v[16:19], v[80:83], v[184:187]
    ds_read_b64_tr_b16 v[72:73], v4 offset:20480
    ds_read_b64_tr_b16 v[74:75], v4 offset:21504
    v_mfma_f32_16x16x32_bf16 v[248:251], v[20:23], v[80:83], v[248:251]
    v_mfma_f32_16x16x32_bf16 v[188:191], v[16:19], v[84:87], v[188:191]
    ds_read_b64_tr_b16 v[76:77], v5 offset:20480
    ds_read_b64_tr_b16 v[78:79], v5 offset:21504
    v_mfma_f32_16x16x32_bf16 v[252:255], v[20:23], v[84:87], v[252:255]
    s_waitcnt vmcnt(12)
    s_barrier
    s_waitcnt lgkmcnt(8)
    v_mfma_f32_16x16x32_bf16 v[128:131], v[56:59], v[24:27], v[128:131]
    ds_read_b64_tr_b16 v[80:81], v4 offset:22528
    ds_read_b64_tr_b16 v[82:83], v4 offset:23552
    v_mfma_f32_16x16x32_bf16 v[192:195], v[56:59], v[28:31], v[192:195]
    s_add_u32 m0, s42, 0
    s_nop 0
    buffer_load_dwordx4 v8, s[12:15], s41 offen lds
    v_mfma_f32_16x16x32_bf16 v[132:135], v[60:63], v[24:27], v[132:135]
    ds_read_b64_tr_b16 v[84:85], v5 offset:22528
    ds_read_b64_tr_b16 v[86:87], v5 offset:23552
    v_mfma_f32_16x16x32_bf16 v[196:199], v[60:63], v[28:31], v[196:199]
    s_add_u32 m0, s42, 4096
    s_nop 0
    buffer_load_dwordx4 v9, s[12:15], s41 offen lds
    s_waitcnt lgkmcnt(8)
    v_mfma_f32_16x16x32_bf16 v[136:139], v[64:67], v[24:27], v[136:139]
    ds_read_b64_tr_b16 v[56:57], v4 offset:24576
    ds_read_b64_tr_b16 v[58:59], v4 offset:25600
    v_mfma_f32_16x16x32_bf16 v[200:203], v[64:67], v[28:31], v[200:203]
    s_add_u32 m0, s42, 8192
    s_nop 0
    buffer_load_dwordx4 v10, s[16:19], s41 offen lds
    v_mfma_f32_16x16x32_bf16 v[140:143], v[68:71], v[24:27], v[140:143]
    ds_read_b64_tr_b16 v[60:61], v5 offset:24576
    ds_read_b64_tr_b16 v[62:63], v5 offset:25600
    v_mfma_f32_16x16x32_bf16 v[204:207], v[68:71], v[28:31], v[204:207]
    s_add_u32 m0, s42, 12288
    s_nop 0
    buffer_load_dwordx4 v11, s[16:19], s41 offen lds
    s_waitcnt lgkmcnt(8)
    v_mfma_f32_16x16x32_bf16 v[144:147], v[72:75], v[24:27], v[144:147]
    ds_read_b64_tr_b16 v[64:65], v4 offset:26624
    ds_read_b64_tr_b16 v[66:67], v4 offset:27648
    v_mfma_f32_16x16x32_bf16 v[208:211], v[72:75], v[28:31], v[208:211]
    s_add_u32 s41, s41, 262144
    buffer_load_dwordx4 v[16:19], v1, s[8:11], s40 offen sc1
    v_mfma_f32_16x16x32_bf16 v[148:151], v[76:79], v[24:27], v[148:151]
    ds_read_b64_tr_b16 v[68:69], v5 offset:26624
    ds_read_b64_tr_b16 v[70:71], v5 offset:27648
    v_mfma_f32_16x16x32_bf16 v[212:215], v[76:79], v[28:31], v[212:215]
    s_add_u32 s55, s40, 20480
    buffer_load_dwordx4 v[20:23], v1, s[8:11], s55 offen sc1
    s_waitcnt lgkmcnt(8)
    v_mfma_f32_16x16x32_bf16 v[152:155], v[80:83], v[24:27], v[152:155]
    ds_read_b64_tr_b16 v[72:73], v4 offset:28672
    ds_read_b64_tr_b16 v[74:75], v4 offset:29696
    v_mfma_f32_16x16x32_bf16 v[216:219], v[80:83], v[28:31], v[216:219]
    s_add_u32 s40, s40, 1024
    v_mfma_f32_16x16x32_bf16 v[156:159], v[84:87], v[24:27], v[156:159]
    ds_read_b64_tr_b16 v[76:77], v5 offset:28672
    ds_read_b64_tr_b16 v[78:79], v5 offset:29696
    v_mfma_f32_16x16x32_bf16 v[220:223], v[84:87], v[28:31], v[220:223]
    s_waitcnt lgkmcnt(8)
    v_mfma_f32_16x16x32_bf16 v[160:163], v[24:27], v[56:59], v[160:163]
    ds_read_b64_tr_b16 v[80:81], v4 offset:30720
    ds_read_b64_tr_b16 v[82:83], v4 offset:31744
    v_mfma_f32_16x16x32_bf16 v[224:227], v[28:31], v[56:59], v[224:227]
    v_mfma_f32_16x16x32_bf16 v[164:167], v[24:27], v[60:63], v[164:167]
    ds_read_b64_tr_b16 v[84:85], v5 offset:30720
    ds_read_b64_tr_b16 v[86:87], v5 offset:31744
    v_mfma_f32_16x16x32_bf16 v[228:231], v[28:31], v[60:63], v[228:231]
    s_waitcnt lgkmcnt(8)
    v_mfma_f32_16x16x32_bf16 v[168:171], v[24:27], v[64:67], v[168:171]
    ds_read_b64_tr_b16 v[56:57], v4 offset:32768
    ds_read_b64_tr_b16 v[58:59], v4 offset:33792
    v_mfma_f32_16x16x32_bf16 v[232:235], v[28:31], v[64:67], v[232:235]
    v_mfma_f32_16x16x32_bf16 v[172:175], v[24:27], v[68:71], v[172:175]
    ds_read_b64_tr_b16 v[60:61], v5 offset:32768
    ds_read_b64_tr_b16 v[62:63], v5 offset:33792
    v_mfma_f32_16x16x32_bf16 v[236:239], v[28:31], v[68:71], v[236:239]
    s_waitcnt lgkmcnt(8)
    v_mfma_f32_16x16x32_bf16 v[176:179], v[24:27], v[72:75], v[176:179]
    ds_read_b64_tr_b16 v[64:65], v4 offset:34816
    ds_read_b64_tr_b16 v[66:67], v4 offset:35840
    v_mfma_f32_16x16x32_bf16 v[240:243], v[28:31], v[72:75], v[240:243]
    v_mfma_f32_16x16x32_bf16 v[180:183], v[24:27], v[76:79], v[180:183]
    ds_read_b64_tr_b16 v[68:69], v5 offset:34816
    ds_read_b64_tr_b16 v[70:71], v5 offset:35840
    v_mfma_f32_16x16x32_bf16 v[244:247], v[28:31], v[76:79], v[244:247]
    s_waitcnt lgkmcnt(8)
    v_mfma_f32_16x16x32_bf16 v[184:187], v[24:27], v[80:83], v[184:187]
    ds_read_b64_tr_b16 v[72:73], v4 offset:36864
    ds_read_b64_tr_b16 v[74:75], v4 offset:37888
    v_mfma_f32_16x16x32_bf16 v[248:251], v[28:31], v[80:83], v[248:251]
    v_mfma_f32_16x16x32_bf16 v[188:191], v[24:27], v[84:87], v[188:191]
    ds_read_b64_tr_b16 v[76:77], v5 offset:36864
    ds_read_b64_tr_b16 v[78:79], v5 offset:37888
    v_mfma_f32_16x16x32_bf16 v[252:255], v[28:31], v[84:87], v[252:255]
    s_waitcnt vmcnt(12)
    s_barrier
    s_waitcnt lgkmcnt(8)
    v_mfma_f32_16x16x32_bf16 v[128:131], v[56:59], v[32:35], v[128:131]
    ds_read_b64_tr_b16 v[80:81], v4 offset:38912
    ds_read_b64_tr_b16 v[82:83], v4 offset:39936
    v_mfma_f32_16x16x32_bf16 v[192:195], v[56:59], v[36:39], v[192:195]
    s_add_u32 m0, s42, 16384
    s_nop 0
    buffer_load_dwordx4 v8, s[12:15], s41 offen lds
    v_mfma_f32_16x16x32_bf16 v[132:135], v[60:63], v[32:35], v[132:135]
    ds_read_b64_tr_b16 v[84:85], v5 offset:38912
    ds_read_b64_tr_b16 v[86:87], v5 offset:39936
    v_mfma_f32_16x16x32_bf16 v[196:199], v[60:63], v[36:39], v[196:199]
    s_add_u32 m0, s42, 20480
    s_nop 0
    buffer_load_dwordx4 v9, s[12:15], s41 offen lds
    s_waitcnt lgkmcnt(8)
    v_mfma_f32_16x16x32_bf16 v[136:139], v[64:67], v[32:35], v[136:139]
    ds_read_b64_tr_b16 v[56:57], v4 offset:40960
    ds_read_b64_tr_b16 v[58:59], v4 offset:41984
    v_mfma_f32_16x16x32_bf16 v[200:203], v[64:67], v[36:39], v[200:203]
    s_add_u32 m0, s42, 24576
    s_nop 0
    buffer_load_dwordx4 v10, s[16:19], s41 offen lds
    v_mfma_f32_16x16x32_bf16 v[140:143], v[68:71], v[32:35], v[140:143]
    ds_read_b64_tr_b16 v[60:61], v5 offset:40960
    ds_read_b64_tr_b16 v[62:63], v5 offset:41984
    v_mfma_f32_16x16x32_bf16 v[204:207], v[68:71], v[36:39], v[204:207]
    s_add_u32 m0, s42, 28672
    s_nop 0
    buffer_load_dwordx4 v11, s[16:19], s41 offen lds
    s_waitcnt lgkmcnt(8)
    v_mfma_f32_16x16x32_bf16 v[144:147], v[72:75], v[32:35], v[144:147]
    ds_read_b64_tr_b16 v[64:65], v4 offset:43008
    ds_read_b64_tr_b16 v[66:67], v4 offset:44032
    v_mfma_f32_16x16x32_bf16 v[208:211], v[72:75], v[36:39], v[208:211]
    s_add_u32 s41, s41, 262144
    buffer_load_dwordx4 v[24:27], v1, s[8:11], s40 offen sc1
    v_mfma_f32_16x16x32_bf16 v[148:151], v[76:79], v[32:35], v[148:151]
    ds_read_b64_tr_b16 v[68:69], v5 offset:43008
    ds_read_b64_tr_b16 v[70:71], v5 offset:44032
    v_mfma_f32_16x16x32_bf16 v[212:215], v[76:79], v[36:39], v[212:215]
    s_add_u32 s55, s40, 20480
    buffer_load_dwordx4 v[28:31], v1, s[8:11], s55 offen sc1
    s_waitcnt lgkmcnt(8)
    v_mfma_f32_16x16x32_bf16 v[152:155], v[80:83], v[32:35], v[152:155]
    ds_read_b64_tr_b16 v[72:73], v4 offset:45056
    ds_read_b64_tr_b16 v[74:75], v4 offset:46080
    v_mfma_f32_16x16x32_bf16 v[216:219], v[80:83], v[36:39], v[216:219]
    s_add_u32 s40, s40, 1024
    v_mfma_f32_16x16x32_bf16 v[156:159], v[84:87], v[32:35], v[156:159]
    ds_read_b64_tr_b16 v[76:77], v5 offset:45056
    ds_read_b64_tr_b16 v[78:79], v5 offset:46080
    v_mfma_f32_16x16x32_bf16 v[220:223], v[84:87], v[36:39], v[220:223]
    s_waitcnt lgkmcnt(8)
    v_mfma_f32_16x16x32_bf16 v[160:163], v[32:35], v[56:59], v[160:163]
    ds_read_b64_tr_b16 v[80:81], v4 offset:47104
    ds_read_b64_tr_b16 v[82:83], v4 offset:48128
    v_mfma_f32_16x16x32_bf16 v[224:227], v[36:39], v[56:59], v[224:227]
    v_mfma_f32_16x16x32_bf16 v[164:167], v[32:35], v[60:63], v[164:167]
    ds_read_b64_tr_b16 v[84:85], v5 offset:47104
    ds_read_b64_tr_b16 v[86:87], v5 offset:48128
    v_mfma_f32_16x16x32_bf16 v[228:231], v[36:39], v[60:63], v[228:231]
    s_waitcnt lgkmcnt(8)
    v_mfma_f32_16x16x32_bf16 v[168:171], v[32:35], v[64:67], v[168:171]
    ds_read_b64_tr_b16 v[56:57], v4 offset:49152
    ds_read_b64_tr_b16 v[58:59], v4 offset:50176
    v_mfma_f32_16x16x32_bf16 v[232:235], v[36:39], v[64:67], v[232:235]
    v_mfma_f32_16x16x32_bf16 v[172:175], v[32:35], v[68:71], v[172:175]
    ds_read_b64_tr_b16 v[60:61], v5 offset:49152
    ds_read_b64_tr_b16 v[62:63], v5 offset:50176
    v_mfma_f32_16x16x32_bf16 v[236:239], v[36:39], v[68:71], v[236:239]
    s_waitcnt lgkmcnt(8)
    v_mfma_f32_16x16x32_bf16 v[176:179], v[32:35], v[72:75], v[176:179]
    ds_read_b64_tr_b16 v[64:65], v4 offset:51200
    ds_read_b64_tr_b16 v[66:67], v4 offset:52224
    v_mfma_f32_16x16x32_bf16 v[240:243], v[36:39], v[72:75], v[240:243]
    v_mfma_f32_16x16x32_bf16 v[180:183], v[32:35], v[76:79], v[180:183]
    ds_read_b64_tr_b16 v[68:69], v5 offset:51200
    ds_read_b64_tr_b16 v[70:71], v5 offset:52224
    v_mfma_f32_16x16x32_bf16 v[244:247], v[36:39], v[76:79], v[244:247]
    s_waitcnt lgkmcnt(8)
    v_mfma_f32_16x16x32_bf16 v[184:187], v[32:35], v[80:83], v[184:187]
    ds_read_b64_tr_b16 v[72:73], v4 offset:53248
    ds_read_b64_tr_b16 v[74:75], v4 offset:54272
    v_mfma_f32_16x16x32_bf16 v[248:251], v[36:39], v[80:83], v[248:251]
    v_mfma_f32_16x16x32_bf16 v[188:191], v[32:35], v[84:87], v[188:191]
    ds_read_b64_tr_b16 v[76:77], v5 offset:53248
    ds_read_b64_tr_b16 v[78:79], v5 offset:54272
    v_mfma_f32_16x16x32_bf16 v[252:255], v[36:39], v[84:87], v[252:255]
    s_waitcnt vmcnt(12)
    s_barrier
    s_waitcnt lgkmcnt(8)
    v_mfma_f32_16x16x32_bf16 v[128:131], v[56:59], v[40:43], v[128:131]
    ds_read_b64_tr_b16 v[80:81], v4 offset:55296
    ds_read_b64_tr_b16 v[82:83], v4 offset:56320
    v_mfma_f32_16x16x32_bf16 v[192:195], v[56:59], v[44:47], v[192:195]
    s_add_u32 m0, s42, 32768
    s_nop 0
    buffer_load_dwordx4 v8, s[12:15], s41 offen lds
    v_mfma_f32_16x16x32_bf16 v[132:135], v[60:63], v[40:43], v[132:135]
    ds_read_b64_tr_b16 v[84:85], v5 offset:55296
    ds_read_b64_tr_b16 v[86:87], v5 offset:56320
    v_mfma_f32_16x16x32_bf16 v[196:199], v[60:63], v[44:47], v[196:199]
    s_add_u32 m0, s42, 36864
    s_nop 0
    buffer_load_dwordx4 v9, s[12:15], s41 offen lds
    s_waitcnt lgkmcnt(8)
    v_mfma_f32_16x16x32_bf16 v[136:139], v[64:67], v[40:43], v[136:139]
    ds_read_b64_tr_b16 v[56:57], v4 offset:57344
    ds_read_b64_tr_b16 v[58:59], v4 offset:58368
    v_mfma_f32_16x16x32_bf16 v[200:203], v[64:67], v[44:47], v[200:203]
    s_add_u32 m0, s42, 40960
    s_nop 0
    buffer_load_dwordx4 v10, s[16:19], s41 offen lds
    v_mfma_f32_16x16x32_bf16 v[140:143], v[68:71], v[40:43], v[140:143]
    ds_read_b64_tr_b16 v[60:61], v5 offset:57344
    ds_read_b64_tr_b16 v[62:63], v5 offset:58368
    v_mfma_f32_16x16x32_bf16 v[204:207], v[68:71], v[44:47], v[204:207]
    s_add_u32 m0, s42, 45056
    s_nop 0
    buffer_load_dwordx4 v11, s[16:19], s41 offen lds
    s_waitcnt lgkmcnt(8)
    v_mfma_f32_16x16x32_bf16 v[144:147], v[72:75], v[40:43], v[144:147]
    ds_read_b64_tr_b16 v[64:65], v4 offset:59392
    ds_read_b64_tr_b16 v[66:67], v4 offset:60416
    v_mfma_f32_16x16x32_bf16 v[208:211], v[72:75], v[44:47], v[208:211]
    s_add_u32 s41, s41, 262144
    buffer_load_dwordx4 v[32:35], v1, s[8:11], s40 offen sc1
    v_mfma_f32_16x16x32_bf16 v[148:151], v[76:79], v[40:43], v[148:151]
    ds_read_b64_tr_b16 v[68:69], v5 offset:59392
    ds_read_b64_tr_b16 v[70:71], v5 offset:60416
    v_mfma_f32_16x16x32_bf16 v[212:215], v[76:79], v[44:47], v[212:215]
    s_add_u32 s55, s40, 20480
    buffer_load_dwordx4 v[36:39], v1, s[8:11], s55 offen sc1
    s_waitcnt lgkmcnt(8)
    v_mfma_f32_16x16x32_bf16 v[152:155], v[80:83], v[40:43], v[152:155]
    ds_read_b64_tr_b16 v[72:73], v4 offset:61440
    ds_read_b64_tr_b16 v[74:75], v4 offset:62464
    v_mfma_f32_16x16x32_bf16 v[216:219], v[80:83], v[44:47], v[216:219]
    s_add_u32 s40, s40, 1024
    v_mfma_f32_16x16x32_bf16 v[156:159], v[84:87], v[40:43], v[156:159]
    ds_read_b64_tr_b16 v[76:77], v5 offset:61440
    ds_read_b64_tr_b16 v[78:79], v5 offset:62464
    v_mfma_f32_16x16x32_bf16 v[220:223], v[84:87], v[44:47], v[220:223]
    s_waitcnt lgkmcnt(8)
    v_mfma_f32_16x16x32_bf16 v[160:163], v[40:43], v[56:59], v[160:163]
    ds_read_b64_tr_b16 v[80:81], v4 offset:63488
    ds_read_b64_tr_b16 v[82:83], v4 offset:64512
    v_mfma_f32_16x16x32_bf16 v[224:227], v[44:47], v[56:59], v[224:227]
    v_mfma_f32_16x16x32_bf16 v[164:167], v[40:43], v[60:63], v[164:167]
    ds_read_b64_tr_b16 v[84:85], v5 offset:63488
    ds_read_b64_tr_b16 v[86:87], v5 offset:64512
    v_mfma_f32_16x16x32_bf16 v[228:231], v[44:47], v[60:63], v[228:231]
    s_waitcnt lgkmcnt(8)
    v_mfma_f32_16x16x32_bf16 v[168:171], v[40:43], v[64:67], v[168:171]
    ds_read_b64_tr_b16 v[56:57], v6 offset:0
    ds_read_b64_tr_b16 v[58:59], v6 offset:1024
    v_mfma_f32_16x16x32_bf16 v[232:235], v[44:47], v[64:67], v[232:235]
    v_mfma_f32_16x16x32_bf16 v[172:175], v[40:43], v[68:71], v[172:175]
    ds_read_b64_tr_b16 v[60:61], v7 offset:0
    ds_read_b64_tr_b16 v[62:63], v7 offset:1024
    v_mfma_f32_16x16x32_bf16 v[236:239], v[44:47], v[68:71], v[236:239]
    s_waitcnt lgkmcnt(8)
    v_mfma_f32_16x16x32_bf16 v[176:179], v[40:43], v[72:75], v[176:179]
    ds_read_b64_tr_b16 v[64:65], v6 offset:2048
    ds_read_b64_tr_b16 v[66:67], v6 offset:3072
    v_mfma_f32_16x16x32_bf16 v[240:243], v[44:47], v[72:75], v[240:243]
    v_mfma_f32_16x16x32_bf16 v[180:183], v[40:43], v[76:79], v[180:183]
    ds_read_b64_tr_b16 v[68:69], v7 offset:2048
    ds_read_b64_tr_b16 v[70:71], v7 offset:3072
    v_mfma_f32_16x16x32_bf16 v[244:247], v[44:47], v[76:79], v[244:247]
    s_waitcnt lgkmcnt(8)
    v_mfma_f32_16x16x32_bf16 v[184:187], v[40:43], v[80:83], v[184:187]
    ds_read_b64_tr_b16 v[72:73], v6 offset:4096
    ds_read_b64_tr_b16 v[74:75], v6 offset:5120
    v_mfma_f32_16x16x32_bf16 v[248:251], v[44:47], v[80:83], v[248:251]
    v_mfma_f32_16x16x32_bf16 v[188:191], v[40:43], v[84:87], v[188:191]
    ds_read_b64_tr_b16 v[76:77], v7 offset:4096
    ds_read_b64_tr_b16 v[78:79], v7 offset:5120
    v_mfma_f32_16x16x32_bf16 v[252:255], v[44:47], v[84:87], v[252:255]
    s_waitcnt vmcnt(12)
    s_barrier
    s_waitcnt lgkmcnt(8)
    v_mfma_f32_16x16x32_bf16 v[128:131], v[56:59], v[48:51], v[128:131]
    ds_read_b64_tr_b16 v[80:81], v6 offset:6144
    ds_read_b64_tr_b16 v[82:83], v6 offset:7168
    v_mfma_f32_16x16x32_bf16 v[192:195], v[56:59], v[52:55], v[192:195]
    s_add_u32 m0, s42, 49152
    s_nop 0
    buffer_load_dwordx4 v8, s[12:15], s41 offen lds
    v_mfma_f32_16x16x32_bf16 v[132:135], v[60:63], v[48:51], v[132:135]
    ds_read_b64_tr_b16 v[84:85], v7 offset:6144
    ds_read_b64_tr_b16 v[86:87], v7 offset:7168
    v_mfma_f32_16x16x32_bf16 v[196:199], v[60:63], v[52:55], v[196:199]
    s_add_u32 m0, s42, 53248
    s_nop 0
    buffer_load_dwordx4 v9, s[12:15], s41 offen lds
    s_waitcnt lgkmcnt(8)
    v_mfma_f32_16x16x32_bf16 v[136:139], v[64:67], v[48:51], v[136:139]
    ds_read_b64_tr_b16 v[56:57], v6 offset:8192
    ds_read_b64_tr_b16 v[58:59], v6 offset:9216
    v_mfma_f32_16x16x32_bf16 v[200:203], v[64:67], v[52:55], v[200:203]
    s_add_u32 m0, s42, 57344
    s_nop 0
    buffer_load_dwordx4 v10, s[16:19], s41 offen lds
    v_mfma_f32_16x16x32_bf16 v[140:143], v[68:71], v[48:51], v[140:143]
    ds_read_b64_tr_b16 v[60:61], v7 offset:8192
    ds_read_b64_tr_b16 v[62:63], v7 offset:9216
    v_mfma_f32_16x16x32_bf16 v[204:207], v[68:71], v[52:55], v[204:207]
    s_add_u32 m0, s42, 61440
    s_nop 0
    buffer_load_dwordx4 v11, s[16:19], s41 offen lds
    s_waitcnt lgkmcnt(8)
    v_mfma_f32_16x16x32_bf16 v[144:147], v[72:75], v[48:51], v[144:147]
    ds_read_b64_tr_b16 v[64:65], v6 offset:10240
    ds_read_b64_tr_b16 v[66:67], v6 offset:11264
    v_mfma_f32_16x16x32_bf16 v[208:211], v[72:75], v[52:55], v[208:211]
    s_add_u32 s41, s41, 262144
    buffer_load_dwordx4 v[40:43], v1, s[8:11], s40 offen sc1
    v_mfma_f32_16x16x32_bf16 v[148:151], v[76:79], v[48:51], v[148:151]
    ds_read_b64_tr_b16 v[68:69], v7 offset:10240
    ds_read_b64_tr_b16 v[70:71], v7 offset:11264
    v_mfma_f32_16x16x32_bf16 v[212:215], v[76:79], v[52:55], v[212:215]
    s_add_u32 s55, s40, 20480
    buffer_load_dwordx4 v[44:47], v1, s[8:11], s55 offen sc1
    s_waitcnt lgkmcnt(8)
    v_mfma_f32_16x16x32_bf16 v[152:155], v[80:83], v[48:51], v[152:155]
    ds_read_b64_tr_b16 v[72:73], v6 offset:12288
    ds_read_b64_tr_b16 v[74:75], v6 offset:13312
    v_mfma_f32_16x16x32_bf16 v[216:219], v[80:83], v[52:55], v[216:219]
    s_add_u32 s40, s40, 1024
    v_mfma_f32_16x16x32_bf16 v[156:159], v[84:87], v[48:51], v[156:159]
    ds_read_b64_tr_b16 v[76:77], v7 offset:12288
    ds_read_b64_tr_b16 v[78:79], v7 offset:13312
    v_mfma_f32_16x16x32_bf16 v[220:223], v[84:87], v[52:55], v[220:223]
    s_waitcnt lgkmcnt(8)
    v_mfma_f32_16x16x32_bf16 v[160:163], v[48:51], v[56:59], v[160:163]
    ds_read_b64_tr_b16 v[80:81], v6 offset:14336
    ds_read_b64_tr_b16 v[82:83], v6 offset:15360
    v_mfma_f32_16x16x32_bf16 v[224:227], v[52:55], v[56:59], v[224:227]
    v_mfma_f32_16x16x32_bf16 v[164:167], v[48:51], v[60:63], v[164:167]
    ds_read_b64_tr_b16 v[84:85], v7 offset:14336
    ds_read_b64_tr_b16 v[86:87], v7 offset:15360
    v_mfma_f32_16x16x32_bf16 v[228:231], v[52:55], v[60:63], v[228:231]
    s_waitcnt lgkmcnt(8)
    v_mfma_f32_16x16x32_bf16 v[168:171], v[48:51], v[64:67], v[168:171]
    ds_read_b64_tr_b16 v[56:57], v4 offset:0
    ds_read_b64_tr_b16 v[58:59], v4 offset:1024
    v_mfma_f32_16x16x32_bf16 v[232:235], v[52:55], v[64:67], v[232:235]
    v_mfma_f32_16x16x32_bf16 v[172:175], v[48:51], v[68:71], v[172:175]
    ds_read_b64_tr_b16 v[60:61], v5 offset:0
    ds_read_b64_tr_b16 v[62:63], v5 offset:1024
    v_mfma_f32_16x16x32_bf16 v[236:239], v[52:55], v[68:71], v[236:239]
    s_waitcnt lgkmcnt(8)
    v_mfma_f32_16x16x32_bf16 v[176:179], v[48:51], v[72:75], v[176:179]
    ds_read_b64_tr_b16 v[64:65], v4 offset:2048
    ds_read_b64_tr_b16 v[66:67], v4 offset:3072
    v_mfma_f32_16x16x32_bf16 v[240:243], v[52:55], v[72:75], v[240:243]
    v_mfma_f32_16x16x32_bf16 v[180:183], v[48:51], v[76:79], v[180:183]
    ds_read_b64_tr_b16 v[68:69], v5 offset:2048
    ds_read_b64_tr_b16 v[70:71], v5 offset:3072
    v_mfma_f32_16x16x32_bf16 v[244:247], v[52:55], v[76:79], v[244:247]
    s_waitcnt lgkmcnt(8)
    v_mfma_f32_16x16x32_bf16 v[184:187], v[48:51], v[80:83], v[184:187]
    ds_read_b64_tr_b16 v[72:73], v4 offset:4096
    ds_read_b64_tr_b16 v[74:75], v4 offset:5120
    v_mfma_f32_16x16x32_bf16 v[248:251], v[52:55], v[80:83], v[248:251]
    v_mfma_f32_16x16x32_bf16 v[188:191], v[48:51], v[84:87], v[188:191]
    ds_read_b64_tr_b16 v[76:77], v5 offset:4096
    ds_read_b64_tr_b16 v[78:79], v5 offset:5120
    v_mfma_f32_16x16x32_bf16 v[252:255], v[52:55], v[84:87], v[252:255]
    s_sub_u32 s43, s43, 1
    s_cmp_lg_u32 s43, 0
    s_cbranch_scc1 gkv_loop
    s_waitcnt vmcnt(0) lgkmcnt(0)
    s_barrier
    s_lshl_b32 s84, s45, 14
    s_mul_i32 s55, s73, 1064960
    s_add_u32 s84, s84, s55
    s_add_u32 s84, s84, 50331648
    v_cvt_pk_bf16_f32 v88, v128, v129
    v_cvt_pk_bf16_f32 v89, v130, v131
    v_cvt_pk_bf16_f32 v90, v132, v133
    v_cvt_pk_bf16_f32 v91, v134, v135
    buffer_store_dwordx4 v[88:91], v1, s[8:11], s84 offen offset:0 sc1
    v_cvt_pk_bf16_f32 v92, v136, v137
    v_cvt_pk_bf16_f32 v93, v138, v139
    v_cvt_pk_bf16_f32 v94, v140, v141
    v_cvt_pk_bf16_f32 v95, v142, v143
    buffer_store_dwordx4 v[92:95], v1, s[8:11], s84 offen offset:1024 sc1
    v_cvt_pk_bf16_f32 v96, v144, v145
    v_cvt_pk_bf16_f32 v97, v146, v147
    v_cvt_pk_bf16_f32 v98, v148, v149
    v_cvt_pk_bf16_f32 v99, v150, v151
    buffer_store_dwordx4 v[96:99], v1, s[8:11], s84 offen offset:2048 sc1
    v_cvt_pk_bf16_f32 v100, v152, v153
    v_cvt_pk_bf16_f32 v101, v154, v155
    v_cvt_pk_bf16_f32 v102, v156, v157
    v_cvt_pk_bf16_f32 v103, v158, v159
    buffer_store_dwordx4 v[100:103], v1, s[8:11], s84 offen offset:3072 sc1
    v_cvt_pk_bf16_f32 v104, v192, v193
    v_cvt_pk_bf16_f32 v105, v194, v195
    v_cvt_pk_bf16_f32 v106, v196, v197
    v_cvt_pk_bf16_f32 v107, v198, v199
    s_add_u32 s84, s84, 4096
    buffer_store_dwordx4 v[104:107], v1, s[8:11], s84 offen offset:0 sc1
    v_cvt_pk_bf16_f32 v108, v200, v201
    v_cvt_pk_bf16_f32 v109, v202, v203
    v_cvt_pk_bf16_f32 v110, v204, v205
    v_cvt_pk_bf16_f32 v111, v206, v207
    buffer_store_dwordx4 v[108:111], v1, s[8:11], s84 offen offset:1024 sc1
    v_cvt_pk_bf16_f32 v112, v208, v209
    v_cvt_pk_bf16_f32 v113, v210, v211
    v_cvt_pk_bf16_f32 v114, v212, v213
    v_cvt_pk_bf16_f32 v115, v214, v215
    buffer_store_dwordx4 v[112:115], v1, s[8:11], s84 offen offset:2048 sc1
    v_cvt_pk_bf16_f32 v116, v216, v217
    v_cvt_pk_bf16_f32 v117, v218, v219
    v_cvt_pk_bf16_f32 v118, v220, v221
    v_cvt_pk_bf16_f32 v119, v222, v223
    buffer_store_dwordx4 v[116:119], v1, s[8:11], s84 offen offset:3072 sc1
    v_cvt_pk_bf16_f32 v120, v160, v161
    v_cvt_pk_bf16_f32 v121, v162, v163
    v_cvt_pk_bf16_f32 v122, v224, v225
    v_cvt_pk_bf16_f32 v123, v226, v227
    s_add_u32 s84, s84, 4096
    buffer_store_dwordx4 v[120:123], v1, s[8:11], s84 offen offset:0 sc1
    v_cvt_pk_bf16_f32 v124, v164, v165
    v_cvt_pk_bf16_f32 v125, v166, v167
    v_cvt_pk_bf16_f32 v126, v228, v229
    v_cvt_pk_bf16_f32 v127, v230, v231
    buffer_store_dwordx4 v[124:127], v1, s[8:11], s84 offen offset:1024 sc1
    v_cvt_pk_bf16_f32 v88, v168, v169
    v_cvt_pk_bf16_f32 v89, v170, v171
    v_cvt_pk_bf16_f32 v90, v232, v233
    v_cvt_pk_bf16_f32 v91, v234, v235
    buffer_store_dwordx4 v[88:91], v1, s[8:11], s84 offen offset:2048 sc1
    v_cvt_pk_bf16_f32 v92, v172, v173
    v_cvt_pk_bf16_f32 v93, v174, v175
    v_cvt_pk_bf16_f32 v94, v236, v237
    v_cvt_pk_bf16_f32 v95, v238, v239
    buffer_store_dwordx4 v[92:95], v1, s[8:11], s84 offen offset:3072 sc1
    v_cvt_pk_bf16_f32 v96, v176, v177
    v_cvt_pk_bf16_f32 v97, v178, v179
    v_cvt_pk_bf16_f32 v98, v240, v241
    v_cvt_pk_bf16_f32 v99, v242, v243
    s_add_u32 s84, s84, 4096
    buffer_store_dwordx4 v[96:99], v1, s[8:11], s84 offen offset:0 sc1
    v_cvt_pk_bf16_f32 v100, v180, v181
    v_cvt_pk_bf16_f32 v101, v182, v183
    v_cvt_pk_bf16_f32 v102, v244, v245
    v_cvt_pk_bf16_f32 v103, v246, v247
    buffer_store_dwordx4 v[100:103], v1, s[8:11], s84 offen offset:1024 sc1
    v_cvt_pk_bf16_f32 v104, v184, v185
    v_cvt_pk_bf16_f32 v105, v186, v187
    v_cvt_pk_bf16_f32 v106, v248, v249
    v_cvt_pk_bf16_f32 v107, v250, v251
    buffer_store_dwordx4 v[104:107], v1, s[8:11], s84 offen offset:2048 sc1
    v_cvt_pk_bf16_f32 v108, v188, v189
    v_cvt_pk_bf16_f32 v109, v190, v191
    v_cvt_pk_bf16_f32 v110, v252, v253
    v_cvt_pk_bf16_f32 v111, v254, v255
    buffer_store_dwordx4 v[108:111], v1, s[8:11], s84 offen offset:3072 sc1
    s_sub_u32 s54, s84, 50343936
    s_lshr_b32 s54, s54, 2
    s_add_u32 s54, s54, 88080384
    v_mov_b64 v[128:129], -1
    v_mov_b64 v[130:131], -1
    buffer_store_dwordx4 v[128:131], v1, s[8:11], s54 offen offset:0 sc1
    buffer_store_dwordx4 v[128:131], v1, s[8:11], s54 offen offset:1024 sc1
    buffer_store_dwordx4 v[128:131], v1, s[8:11], s54 offen offset:2048 sc1
    buffer_store_dwordx4 v[128:131], v1, s[8:11], s54 offen offset:3072 sc1
    s_lshl_b32 s85, s73, 7
    s_lshl_b32 s54, s72, 2
    s_add_u32 s85, s85, s54
    s_add_u32 s85, s85, 2363392
    s_mov_b32 s83, 2
    s_branch rnext_143
half_145:
    s_and_b32 s54, s72, 1
    s_lshr_b32 s72, s72, 1
    s_mul_i32 s55, s71, 3
    s_add_u32 s72, s72, s55
    s_cmp_eq_u32 s54, 1
    s_cbranch_scc1 dov_142
dok_141:
    s_load_dwordx2 s[12:13], s[0:1], 24
    s_waitcnt lgkmcnt(0)
    s_and_b32 s13, s13, 0xffff
    s_mov_b32 s14, 5242880
    s_mov_b32 s15, 0x20000
    s_lshl_b32 s45, s72, 2
    s_add_u32 s45, s45, s36
    s_mul_i32 s40, s45, 40960
    s_add_u32 s40, s40, 8388608
    s_lshl_b32 s41, s73, 8
    v_lshlrev_b32 v1, 4, v0
    v_bfe_u32 v2, v0, 4, 2
    v_lshlrev_b32 v8, 3, v2
    v_bfe_u32 v2, v0, 2, 2
    v_lshl_add_u32 v8, v2, 0, v8
    s_mov_b32 s55, 8192
    v_mul_lo_u32 v8, v8, s55
    v_lshrrev_b32 v2, 3, v0
    v_and_b32 v2, 2, v2
    v_xor_b32 v2, v2, v0
    v_and_b32 v2, 3, v2
    v_lshl_add_u32 v8, v2, 4, v8
    v_bfe_u32 v2, v0, 2, 4
    v_lshlrev_b32 v4, 6, v2
    v_bfe_u32 v2, v0, 4, 1
    v_lshl_add_u32 v4, v2, 5, v4
    v_bfe_u32 v2, v0, 0, 2
    v_lshl_add_u32 v4, v2, 3, v4
    v_xor_b32 v5, 32, v4
    v_add_u32 v6, 65536, v4
    v_add_u32 v7, 65536, v5
    s_and_b32 s54, s36, 1
    s_mul_i32 s54, s54, 32768
    s_lshr_b32 s55, s36, 1
    s_lshl_b32 s55, s55, 6
    s_add_u32 s54, s54, s55
    v_add_u32 v8, s54, v8
    v_add_u32 v9, 128, v8
    v_add_u32 v8, 0, v8
    s_lshl_b32 s42, s36, 10
    s_add_u32 m0, s42, 0
    s_nop 0
    buffer_load_dwordx4 v8, s[12:15], s41 offen lds
    s_add_u32 m0, s42, 4096
    s_nop 0
    buffer_load_dwordx4 v9, s[12:15], s41 offen lds
    s_add_u32 s41, s41, 262144
    s_add_u32 m0, s42, 8192
    s_nop 0
    buffer_load_dwordx4 v8, s[12:15], s41 offen lds
    s_add_u32 m0, s42, 12288
    s_nop 0
    buffer_load_dwordx4 v9, s[12:15], s41 offen lds
    s_add_u32 s41, s41, 262144
    s_add_u32 m0, s42, 16384
    s_nop 0
    buffer_load_dwordx4 v8, s[12:15], s41 offen lds
    s_add_u32 m0, s42, 20480
    s_nop 0
    buffer_load_dwordx4 v9, s[12:15], s41 offen lds
    s_add_u32 s41, s41, 262144
    s_add_u32 m0, s42, 24576
    s_nop 0
    buffer_load_dwordx4 v8, s[12:15], s41 offen lds
    s_add_u32 m0, s42, 28672
    s_nop 0
    buffer_load_dwordx4 v9, s[12:15], s41 offen lds
    s_add_u32 s41, s41, 262144
    s_add_u32 m0, s42, 32768
    s_nop 0
    buffer_load_dwordx4 v8, s[12:15], s41 offen lds
    s_add_u32 m0, s42, 36864
    s_nop 0
    buffer_load_dwordx4 v9, s[12:15], s41 offen lds
    s_add_u32 s41, s41, 262144
    s_add_u32 m0, s42, 40960
    s_nop 0
    buffer_load_dwordx4 v8, s[12:15], s41 offen lds
    s_add_u32 m0, s42, 45056
    s_nop 0
    buffer_load_dwordx4 v9, s[12:15], s41 offen lds
    s_add_u32 s41, s41, 262144
    s_add_u32 m0, s42, 49152
    s_nop 0
    buffer_load_dwordx4 v8, s[12:15], s41 offen lds
    s_add_u32 m0, s42, 53248
    s_nop 0
    buffer_load_dwordx4 v9, s[12:15], s41 offen lds
    s_add_u32 s41, s41, 262144
    s_add_u32 m0, s42, 57344
    s_nop 0
    buffer_load_dwordx4 v8, s[12:15], s41 offen lds
    s_add_u32 m0, s42, 61440
    s_nop 0
    buffer_load_dwordx4 v9, s[12:15], s41 offen lds
    s_add_u32 s41, s41, 262144
    s_add_u32 m0, s42, 65536
    s_nop 0
    buffer_load_dwordx4 v8, s[12:15], s41 offen lds
    s_add_u32 m0, s42, 69632
    s_nop 0
    buffer_load_dwordx4 v9, s[12:15], s41 offen lds
    s_add_u32 s41, s41, 262144
    s_cmp_eq_u32 s71, 0
    s_cbranch_scc1 e_150
    s_waitcnt vmcnt(18) lgkmcnt(0)
    s_barrier
    s_cmp_lg_u32 s36, 0
    s_cbranch_scc1 sg_151
    v_mov_b32 v14, 0
    v_mov_b32 v15, s83
    s_mov_b64 exec, 1
    buffer_atomic_add v15, v14, s[8:11], s85 offen
    s_mov_b64 exec, -1
sg_151:
e_150:
    s_lshl_b32 s75, s72, 7
    s_cmp_eq_u32 s71, 0
    s_cselect_b32 s75, s75, 0
    s_cselect_b32 s56, 0, 15
    s_add_u32 s75, s75, 2360320
    v_min_u32 v13, s56, v0
    s_cmp_lg_u32 s36, 0
    s_cbranch_scc1 wd_153
    v_min_u32 v14, 15, v13
    v_mul_u32_u24 v14, 128, v14
wt_152:
    buffer_load_dword v15, v14, s[8:11], s75 offen sc1
    s_waitcnt vmcnt(0)
    v_cmp_gt_u32 vcc, 8, v15
    s_nop 0
    s_cbranch_vccz wd_153
    s_sleep 3
    s_sub_u32 s53, s53, 1
    s_cbranch_scc0 wt_152
    s_mov_b32 s53, 0
wd_153:
    s_barrier
    buffer_load_dwordx4 v[16:19], v1, s[8:11], s40 offen sc1
    s_add_u32 s55, s40, 20480
    buffer_load_dwordx4 v[20:23], v1, s[8:11], s55 offen sc1
    s_add_u32 s40, s40, 1024
    buffer_load_dwordx4 v[24:27], v1, s[8:11], s40 offen sc1
    s_add_u32 s55, s40, 20480
    buffer_load_dwordx4 v[28:31], v1, s[8:11], s55 offen sc1
    s_add_u32 s40, s40, 1024
    buffer_load_dwordx4 v[32:35], v1, s[8:11], s40 offen sc1
    s_add_u32 s55, s40, 20480
    buffer_load_dwordx4 v[36:39], v1, s[8:11], s55 offen sc1
    s_add_u32 s40, s40, 1024
    buffer_load_dwordx4 v[40:43], v1, s[8:11], s40 offen sc1
    s_add_u32 s55, s40, 20480
    buffer_load_dwordx4 v[44:47], v1, s[8:11], s55 offen sc1
    s_add_u32 s40, s40, 1024
    buffer_load_dwordx4 v[48:51], v1, s[8:11], s40 offen sc1
    s_add_u32 s55, s40, 20480
    buffer_load_dwordx4 v[52:55], v1, s[8:11], s55 offen sc1
    s_add_u32 s40, s40, 1024
    buffer_load_dwordx4 v[56:59], v1, s[8:11], s40 offen sc1
    s_add_u32 s55, s40, 20480
    buffer_load_dwordx4 v[60:63], v1, s[8:11], s55 offen sc1
    s_add_u32 s40, s40, 1024
    buffer_load_dwordx4 v[64:67], v1, s[8:11], s40 offen sc1
    s_add_u32 s55, s40, 20480
    buffer_load_dwordx4 v[68:71], v1, s[8:11], s55 offen sc1
    s_add_u32 s40, s40, 1024
    buffer_load_dwordx4 v[72:75], v1, s[8:11], s40 offen sc1
    s_add_u32 s55, s40, 20480
    buffer_load_dwordx4 v[76:79], v1, s[8:11], s55 offen sc1
    s_add_u32 s40, s40, 1024
    buffer_load_dwordx4 v[80:83], v1, s[8:11], s40 offen sc1
    s_add_u32 s55, s40, 20480
    buffer_load_dwordx4 v[84:87], v1, s[8:11], s55 offen sc1
    s_add_u32 s40, s40, 1024
    s_waitcnt vmcnt(16)
    s_barrier
    ds_read_b64_tr_b16 v[96:97], v4 offset:0
    ds_read_b64_tr_b16 v[98:99], v4 offset:1024
    ds_read_b64_tr_b16 v[100:101], v5 offset:0
    ds_read_b64_tr_b16 v[102:103], v5 offset:1024
    ds_read_b64_tr_b16 v[104:105], v4 offset:2048
    ds_read_b64_tr_b16 v[106:107], v4 offset:3072
    ds_read_b64_tr_b16 v[108:109], v5 offset:2048
    ds_read_b64_tr_b16 v[110:111], v5 offset:3072
    ds_read_b64_tr_b16 v[112:113], v4 offset:4096
    ds_read_b64_tr_b16 v[114:115], v4 offset:5120
    ds_read_b64_tr_b16 v[116:117], v5 offset:4096
    ds_read_b64_tr_b16 v[118:119], v5 offset:5120
    s_waitcnt vmcnt(14)
    s_barrier
    s_waitcnt lgkmcnt(8)
    v_mfma_f32_16x16x32_bf16 v[128:131], v[96:99], v[16:19], 0
    ds_read_b64_tr_b16 v[120:121], v4 offset:6144
    ds_read_b64_tr_b16 v[122:123], v4 offset:7168
    v_mfma_f32_16x16x32_bf16 v[160:163], v[96:99], v[20:23], 0
    s_add_u32 m0, s42, 73728
    s_nop 0
    buffer_load_dwordx4 v8, s[12:15], s41 offen lds
    v_mfma_f32_16x16x32_bf16 v[132:135], v[100:103], v[16:19], 0
    ds_read_b64_tr_b16 v[124:125], v5 offset:6144
    ds_read_b64_tr_b16 v[126:127], v5 offset:7168
    v_mfma_f32_16x16x32_bf16 v[164:167], v[100:103], v[20:23], 0
    s_add_u32 m0, s42, 77824
    s_nop 0
    buffer_load_dwordx4 v9, s[12:15], s41 offen lds
    s_waitcnt lgkmcnt(8)
    v_mfma_f32_16x16x32_bf16 v[136:139], v[104:107], v[16:19], 0
    ds_read_b64_tr_b16 v[96:97], v4 offset:8192
    ds_read_b64_tr_b16 v[98:99], v4 offset:9216
    v_mfma_f32_16x16x32_bf16 v[168:171], v[104:107], v[20:23], 0
    s_add_u32 s41, s41, 262144
    buffer_load_dwordx4 v[88:91], v1, s[8:11], s40 offen sc1
    v_mfma_f32_16x16x32_bf16 v[140:143], v[108:111], v[16:19], 0
    ds_read_b64_tr_b16 v[100:101], v5 offset:8192
    ds_read_b64_tr_b16 v[102:103], v5 offset:9216
    v_mfma_f32_16x16x32_bf16 v[172:175], v[108:111], v[20:23], 0
    s_add_u32 s55, s40, 20480
    buffer_load_dwordx4 v[92:95], v1, s[8:11], s55 offen sc1
    s_waitcnt lgkmcnt(8)
    v_mfma_f32_16x16x32_bf16 v[144:147], v[112:115], v[16:19], 0
    ds_read_b64_tr_b16 v[104:105], v4 offset:10240
    ds_read_b64_tr_b16 v[106:107], v4 offset:11264
    v_mfma_f32_16x16x32_bf16 v[176:179], v[112:115], v[20:23], 0
    s_add_u32 s40, s40, 1024
    v_mfma_f32_16x16x32_bf16 v[148:151], v[116:119], v[16:19], 0
    ds_read_b64_tr_b16 v[108:109], v5 offset:10240
    ds_read_b64_tr_b16 v[110:111], v5 offset:11264
    v_mfma_f32_16x16x32_bf16 v[180:183], v[116:119], v[20:23], 0
    s_waitcnt lgkmcnt(8)
    v_mfma_f32_16x16x32_bf16 v[152:155], v[120:123], v[16:19], 0
    ds_read_b64_tr_b16 v[112:113], v4 offset:12288
    ds_read_b64_tr_b16 v[114:115], v4 offset:13312
    v_mfma_f32_16x16x32_bf16 v[184:187], v[120:123], v[20:23], 0
    v_mfma_f32_16x16x32_bf16 v[156:159], v[124:127], v[16:19], 0
    ds_read_b64_tr_b16 v[116:117], v5 offset:12288
    ds_read_b64_tr_b16 v[118:119], v5 offset:13312
    v_mfma_f32_16x16x32_bf16 v[188:191], v[124:127], v[20:23], 0
    s_waitcnt vmcnt(16)
    s_barrier
    s_waitcnt lgkmcnt(8)
    v_mfma_f32_16x16x32_bf16 v[128:131], v[96:99], v[24:27], v[128:131]
    ds_read_b64_tr_b16 v[120:121], v4 offset:14336
    ds_read_b64_tr_b16 v[122:123], v4 offset:15360
    v_mfma_f32_16x16x32_bf16 v[160:163], v[96:99], v[28:31], v[160:163]
    s_add_u32 m0, s42, 0
    s_nop 0
    buffer_load_dwordx4 v8, s[12:15], s41 offen lds
    v_mfma_f32_16x16x32_bf16 v[132:135], v[100:103], v[24:27], v[132:135]
    ds_read_b64_tr_b16 v[124:125], v5 offset:14336
    ds_read_b64_tr_b16 v[126:127], v5 offset:15360
    v_mfma_f32_16x16x32_bf16 v[164:167], v[100:103], v[28:31], v[164:167]
    s_add_u32 m0, s42, 4096
    s_nop 0
    buffer_load_dwordx4 v9, s[12:15], s41 offen lds
    s_waitcnt lgkmcnt(8)
    v_mfma_f32_16x16x32_bf16 v[136:139], v[104:107], v[24:27], v[136:139]
    ds_read_b64_tr_b16 v[96:97], v4 offset:16384
    ds_read_b64_tr_b16 v[98:99], v4 offset:17408
    v_mfma_f32_16x16x32_bf16 v[168:171], v[104:107], v[28:31], v[168:171]
    s_add_u32 s41, s41, 262144
    buffer_load_dwordx4 v[16:19], v1, s[8:11], s40 offen sc1
    v_mfma_f32_16x16x32_bf16 v[140:143], v[108:111], v[24:27], v[140:143]
    ds_read_b64_tr_b16 v[100:101], v5 offset:16384
    ds_read_b64_tr_b16 v[102:103], v5 offset:17408
    v_mfma_f32_16x16x32_bf16 v[172:175], v[108:111], v[28:31], v[172:175]
    s_add_u32 s55, s40, 20480
    buffer_load_dwordx4 v[20:23], v1, s[8:11], s55 offen sc1
    s_waitcnt lgkmcnt(8)
    v_mfma_f32_16x16x32_bf16 v[144:147], v[112:115], v[24:27], v[144:147]
    ds_read_b64_tr_b16 v[104:105], v4 offset:18432
    ds_read_b64_tr_b16 v[106:107], v4 offset:19456
    v_mfma_f32_16x16x32_bf16 v[176:179], v[112:115], v[28:31], v[176:179]
    s_add_u32 s40, s40, 1024
    v_mfma_f32_16x16x32_bf16 v[148:151], v[116:119], v[24:27], v[148:151]
    ds_read_b64_tr_b16 v[108:109], v5 offset:18432
    ds_read_b64_tr_b16 v[110:111], v5 offset:19456
    v_mfma_f32_16x16x32_bf16 v[180:183], v[116:119], v[28:31], v[180:183]
    s_waitcnt lgkmcnt(8)
    v_mfma_f32_16x16x32_bf16 v[152:155], v[120:123], v[24:27], v[152:155]
    ds_read_b64_tr_b16 v[112:113], v4 offset:20480
    ds_read_b64_tr_b16 v[114:115], v4 offset:21504
    v_mfma_f32_16x16x32_bf16 v[184:187], v[120:123], v[28:31], v[184:187]
    v_mfma_f32_16x16x32_bf16 v[156:159], v[124:127], v[24:27], v[156:159]
    ds_read_b64_tr_b16 v[116:117], v5 offset:20480
    ds_read_b64_tr_b16 v[118:119], v5 offset:21504
    v_mfma_f32_16x16x32_bf16 v[188:191], v[124:127], v[28:31], v[188:191]
    s_waitcnt vmcnt(18)
    s_barrier
    s_waitcnt lgkmcnt(8)
    v_mfma_f32_16x16x32_bf16 v[128:131], v[96:99], v[32:35], v[128:131]
    ds_read_b64_tr_b16 v[120:121], v4 offset:22528
    ds_read_b64_tr_b16 v[122:123], v4 offset:23552
    v_mfma_f32_16x16x32_bf16 v[160:163], v[96:99], v[36:39], v[160:163]
    s_add_u32 m0, s42, 8192
    s_nop 0
    buffer_load_dwordx4 v8, s[12:15], s41 offen lds
    v_mfma_f32_16x16x32_bf16 v[132:135], v[100:103], v[32:35], v[132:135]
    ds_read_b64_tr_b16 v[124:125], v5 offset:22528
    ds_read_b64_tr_b16 v[126:127], v5 offset:23552
    v_mfma_f32_16x16x32_bf16 v[164:167], v[100:103], v[36:39], v[164:167]
    s_add_u32 m0, s42, 12288
    s_nop 0
    buffer_load_dwordx4 v9, s[12:15], s41 offen lds
    s_waitcnt lgkmcnt(8)
    v_mfma_f32_16x16x32_bf16 v[136:139], v[104:107], v[32:35], v[136:139]
    ds_read_b64_tr_b16 v[96:97], v4 offset:24576
    ds_read_b64_tr_b16 v[98:99], v4 offset:25600
    v_mfma_f32_16x16x32_bf16 v[168:171], v[104:107], v[36:39], v[168:171]
    s_add_u32 s41, s41, 262144
    buffer_load_dwordx4 v[24:27], v1, s[8:11], s40 offen sc1
    v_mfma_f32_16x16x32_bf16 v[140:143], v[108:111], v[32:35], v[140:143]
    ds_read_b64_tr_b16 v[100:101], v5 offset:24576
    ds_read_b64_tr_b16 v[102:103], v5 offset:25600
    v_mfma_f32_16x16x32_bf16 v[172:175], v[108:111], v[36:39], v[172:175]
    s_add_u32 s55, s40, 20480
    buffer_load_dwordx4 v[28:31], v1, s[8:11], s55 offen sc1
    s_waitcnt lgkmcnt(8)
    v_mfma_f32_16x16x32_bf16 v[144:147], v[112:115], v[32:35], v[144:147]
    ds_read_b64_tr_b16 v[104:105], v4 offset:26624
    ds_read_b64_tr_b16 v[106:107], v4 offset:27648
    v_mfma_f32_16x16x32_bf16 v[176:179], v[112:115], v[36:39], v[176:179]
    s_add_u32 s40, s40, 1024
    v_mfma_f32_16x16x32_bf16 v[148:151], v[116:119], v[32:35], v[148:151]
    ds_read_b64_tr_b16 v[108:109], v5 offset:26624
    ds_read_b64_tr_b16 v[110:111], v5 offset:27648
    v_mfma_f32_16x16x32_bf16 v[180:183], v[116:119], v[36:39], v[180:183]
    s_waitcnt lgkmcnt(8)
    v_mfma_f32_16x16x32_bf16 v[152:155], v[120:123], v[32:35], v[152:155]
    ds_read_b64_tr_b16 v[112:113], v4 offset:28672
    ds_read_b64_tr_b16 v[114:115], v4 offset:29696
    v_mfma_f32_16x16x32_bf16 v[184:187], v[120:123], v[36:39], v[184:187]
    v_mfma_f32_16x16x32_bf16 v[156:159], v[124:127], v[32:35], v[156:159]
    ds_read_b64_tr_b16 v[116:117], v5 offset:28672
    ds_read_b64_tr_b16 v[118:119], v5 offset:29696
    v_mfma_f32_16x16x32_bf16 v[188:191], v[124:127], v[36:39], v[188:191]
    s_waitcnt vmcnt(20)
    s_barrier
    s_waitcnt lgkmcnt(8)
    v_mfma_f32_16x16x32_bf16 v[128:131], v[96:99], v[40:43], v[128:131]
    ds_read_b64_tr_b16 v[120:121], v4 offset:30720
    ds_read_b64_tr_b16 v[122:123], v4 offset:31744
    v_mfma_f32_16x16x32_bf16 v[160:163], v[96:99], v[44:47], v[160:163]
    s_add_u32 m0, s42, 16384
    s_nop 0
    buffer_load_dwordx4 v8, s[12:15], s41 offen lds
    v_mfma_f32_16x16x32_bf16 v[132:135], v[100:103], v[40:43], v[132:135]
    ds_read_b64_tr_b16 v[124:125], v5 offset:30720
    ds_read_b64_tr_b16 v[126:127], v5 offset:31744
    v_mfma_f32_16x16x32_bf16 v[164:167], v[100:103], v[44:47], v[164:167]
    s_add_u32 m0, s42, 20480
    s_nop 0
    buffer_load_dwordx4 v9, s[12:15], s41 offen lds
    s_waitcnt lgkmcnt(8)
    v_mfma_f32_16x16x32_bf16 v[136:139], v[104:107], v[40:43], v[136:139]
    ds_read_b64_tr_b16 v[96:97], v4 offset:32768
    ds_read_b64_tr_b16 v[98:99], v4 offset:33792
    v_mfma_f32_16x16x32_bf16 v[168:171], v[104:107], v[44:47], v[168:171]
    s_add_u32 s41, s41, 262144
    buffer_load_dwordx4 v[32:35], v1, s[8:11], s40 offen sc1
    v_mfma_f32_16x16x32_bf16 v[140:143], v[108:111], v[40:43], v[140:143]
    ds_read_b64_tr_b16 v[100:101], v5 offset:32768
    ds_read_b64_tr_b16 v[102:103], v5 offset:33792
    v_mfma_f32_16x16x32_bf16 v[172:175], v[108:111], v[44:47], v[172:175]
    s_add_u32 s55, s40, 20480
    buffer_load_dwordx4 v[36:39], v1, s[8:11], s55 offen sc1
    s_waitcnt lgkmcnt(8)
    v_mfma_f32_16x16x32_bf16 v[144:147], v[112:115], v[40:43], v[144:147]
    ds_read_b64_tr_b16 v[104:105], v4 offset:34816
    ds_read_b64_tr_b16 v[106:107], v4 offset:35840
    v_mfma_f32_16x16x32_bf16 v[176:179], v[112:115], v[44:47], v[176:179]
    s_add_u32 s40, s40, 1024
    v_mfma_f32_16x16x32_bf16 v[148:151], v[116:119], v[40:43], v[148:151]
    ds_read_b64_tr_b16 v[108:109], v5 offset:34816
    ds_read_b64_tr_b16 v[110:111], v5 offset:35840
    v_mfma_f32_16x16x32_bf16 v[180:183], v[116:119], v[44:47], v[180:183]
    s_waitcnt lgkmcnt(8)
    v_mfma_f32_16x16x32_bf16 v[152:155], v[120:123], v[40:43], v[152:155]
    ds_read_b64_tr_b16 v[112:113], v4 offset:36864
    ds_read_b64_tr_b16 v[114:115], v4 offset:37888
    v_mfma_f32_16x16x32_bf16 v[184:187], v[120:123], v[44:47], v[184:187]
    v_mfma_f32_16x16x32_bf16 v[156:159], v[124:127], v[40:43], v[156:159]
    ds_read_b64_tr_b16 v[116:117], v5 offset:36864
    ds_read_b64_tr_b16 v[118:119], v5 offset:37888
    v_mfma_f32_16x16x32_bf16 v[188:191], v[124:127], v[44:47], v[188:191]
    s_waitcnt vmcnt(22)
    s_barrier
    s_waitcnt lgkmcnt(8)
    v_mfma_f32_16x16x32_bf16 v[128:131], v[96:99], v[48:51], v[128:131]
    ds_read_b64_tr_b16 v[120:121], v4 offset:38912
    ds_read_b64_tr_b16 v[122:123], v4 offset:39936
    v_mfma_f32_16x16x32_bf16 v[160:163], v[96:99], v[52:55], v[160:163]
    s_add_u32 m0, s42, 24576
    s_nop 0
    buffer_load_dwordx4 v8, s[12:15], s41 offen lds
    v_mfma_f32_16x16x32_bf16 v[132:135], v[100:103], v[48:51], v[132:135]
    ds_read_b64_tr_b16 v[124:125], v5 offset:38912
    ds_read_b64_tr_b16 v[126:127], v5 offset:39936
    v_mfma_f32_16x16x32_bf16 v[164:167], v[100:103], v[52:55], v[164:167]
    s_add_u32 m0, s42, 28672
    s_nop 0
    buffer_load_dwordx4 v9, s[12:15], s41 offen lds
    s_waitcnt lgkmcnt(8)
    v_mfma_f32_16x16x32_bf16 v[136:139], v[104:107], v[48:51], v[136:139]
    ds_read_b64_tr_b16 v[96:97], v4 offset:40960
    ds_read_b64_tr_b16 v[98:99], v4 offset:41984
    v_mfma_f32_16x16x32_bf16 v[168:171], v[104:107], v[52:55], v[168:171]
    s_add_u32 s41, s41, 262144
    buffer_load_dwordx4 v[40:43], v1, s[8:11], s40 offen sc1
    v_mfma_f32_16x16x32_bf16 v[140:143], v[108:111], v[48:51], v[140:143]
    ds_read_b64_tr_b16 v[100:101], v5 offset:40960
    ds_read_b64_tr_b16 v[102:103], v5 offset:41984
    v_mfma_f32_16x16x32_bf16 v[172:175], v[108:111], v[52:55], v[172:175]
    s_add_u32 s55, s40, 20480
    buffer_load_dwordx4 v[44:47], v1, s[8:11], s55 offen sc1
    s_waitcnt lgkmcnt(8)
    v_mfma_f32_16x16x32_bf16 v[144:147], v[112:115], v[48:51], v[144:147]
    ds_read_b64_tr_b16 v[104:105], v4 offset:43008
    ds_read_b64_tr_b16 v[106:107], v4 offset:44032
    v_mfma_f32_16x16x32_bf16 v[176:179], v[112:115], v[52:55], v[176:179]
    s_add_u32 s40, s40, 1024
    v_mfma_f32_16x16x32_bf16 v[148:151], v[116:119], v[48:51], v[148:151]
    ds_read_b64_tr_b16 v[108:109], v5 offset:43008
    ds_read_b64_tr_b16 v[110:111], v5 offset:44032
    v_mfma_f32_16x16x32_bf16 v[180:183], v[116:119], v[52:55], v[180:183]
    s_waitcnt lgkmcnt(8)
    v_mfma_f32_16x16x32_bf16 v[152:155], v[120:123], v[48:51], v[152:155]
    ds_read_b64_tr_b16 v[112:113], v4 offset:45056
    ds_read_b64_tr_b16 v[114:115], v4 offset:46080
    v_mfma_f32_16x16x32_bf16 v[184:187], v[120:123], v[52:55], v[184:187]
    v_mfma_f32_16x16x32_bf16 v[156:159], v[124:127], v[48:51], v[156:159]
    ds_read_b64_tr_b16 v[116:117], v5 offset:45056
    ds_read_b64_tr_b16 v[118:119], v5 offset:46080
    v_mfma_f32_16x16x32_bf16 v[188:191], v[124:127], v[52:55], v[188:191]
    s_waitcnt vmcnt(24)
    s_barrier
    s_waitcnt lgkmcnt(8)
    v_mfma_f32_16x16x32_bf16 v[128:131], v[96:99], v[56:59], v[128:131]
    ds_read_b64_tr_b16 v[120:121], v4 offset:47104
    ds_read_b64_tr_b16 v[122:123], v4 offset:48128
    v_mfma_f32_16x16x32_bf16 v[160:163], v[96:99], v[60:63], v[160:163]
    s_add_u32 m0, s42, 32768
    s_nop 0
    buffer_load_dwordx4 v8, s[12:15], s41 offen lds
    v_mfma_f32_16x16x32_bf16 v[132:135], v[100:103], v[56:59], v[132:135]
    ds_read_b64_tr_b16 v[124:125], v5 offset:47104
    ds_read_b64_tr_b16 v[126:127], v5 offset:48128
    v_mfma_f32_16x16x32_bf16 v[164:167], v[100:103], v[60:63], v[164:167]
    s_add_u32 m0, s42, 36864
    s_nop 0
    buffer_load_dwordx4 v9, s[12:15], s41 offen lds
    s_waitcnt lgkmcnt(8)
    v_mfma_f32_16x16x32_bf16 v[136:139], v[104:107], v[56:59], v[136:139]
    ds_read_b64_tr_b16 v[96:97], v4 offset:49152
    ds_read_b64_tr_b16 v[98:99], v4 offset:50176
    v_mfma_f32_16x16x32_bf16 v[168:171], v[104:107], v[60:63], v[168:171]
    s_add_u32 s41, s41, 262144
    buffer_load_dwordx4 v[48:51], v1, s[8:11], s40 offen sc1
    v_mfma_f32_16x16x32_bf16 v[140:143], v[108:111], v[56:59], v[140:143]
    ds_read_b64_tr_b16 v[100:101], v5 offset:49152
    ds_read_b64_tr_b16 v[102:103], v5 offset:50176
    v_mfma_f32_16x16x32_bf16 v[172:175], v[108:111], v[60:63], v[172:175]
    s_add_u32 s55, s40, 20480
    buffer_load_dwordx4 v[52:55], v1, s[8:11], s55 offen sc1
    s_waitcnt lgkmcnt(8)
    v_mfma_f32_16x16x32_bf16 v[144:147], v[112:115], v[56:59], v[144:147]
    ds_read_b64_tr_b16 v[104:105], v4 offset:51200
    ds_read_b64_tr_b16 v[106:107], v4 offset:52224
    v_mfma_f32_16x16x32_bf16 v[176:179], v[112:115], v[60:63], v[176:179]
    s_add_u32 s40, s40, 1024
    v_mfma_f32_16x16x32_bf16 v[148:151], v[116:119], v[56:59], v[148:151]
    ds_read_b64_tr_b16 v[108:109], v5 offset:51200
    ds_read_b64_tr_b16 v[110:111], v5 offset:52224
    v_mfma_f32_16x16x32_bf16 v[180:183], v[116:119], v[60:63], v[180:183]
    s_waitcnt lgkmcnt(8)
    v_mfma_f32_16x16x32_bf16 v[152:155], v[120:123], v[56:59], v[152:155]
    ds_read_b64_tr_b16 v[112:113], v4 offset:53248
    ds_read_b64_tr_b16 v[114:115], v4 offset:54272
    v_mfma_f32_16x16x32_bf16 v[184:187], v[120:123], v[60:63], v[184:187]
    v_mfma_f32_16x16x32_bf16 v[156:159], v[124:127], v[56:59], v[156:159]
    ds_read_b64_tr_b16 v[116:117], v5 offset:53248
    ds_read_b64_tr_b16 v[118:119], v5 offset:54272
    v_mfma_f32_16x16x32_bf16 v[188:191], v[124:127], v[60:63], v[188:191]
    s_waitcnt vmcnt(26)
    s_barrier
    s_waitcnt lgkmcnt(8)
    v_mfma_f32_16x16x32_bf16 v[128:131], v[96:99], v[64:67], v[128:131]
    ds_read_b64_tr_b16 v[120:121], v4 offset:55296
    ds_read_b64_tr_b16 v[122:123], v4 offset:56320
    v_mfma_f32_16x16x32_bf16 v[160:163], v[96:99], v[68:71], v[160:163]
    s_add_u32 m0, s42, 40960
    s_nop 0
    buffer_load_dwordx4 v8, s[12:15], s41 offen lds
    v_mfma_f32_16x16x32_bf16 v[132:135], v[100:103], v[64:67], v[132:135]
    ds_read_b64_tr_b16 v[124:125], v5 offset:55296
    ds_read_b64_tr_b16 v[126:127], v5 offset:56320
    v_mfma_f32_16x16x32_bf16 v[164:167], v[100:103], v[68:71], v[164:167]
    s_add_u32 m0, s42, 45056
    s_nop 0
    buffer_load_dwordx4 v9, s[12:15], s41 offen lds
    s_waitcnt lgkmcnt(8)
    v_mfma_f32_16x16x32_bf16 v[136:139], v[104:107], v[64:67], v[136:139]
    ds_read_b64_tr_b16 v[96:97], v4 offset:57344
    ds_read_b64_tr_b16 v[98:99], v4 offset:58368
    v_mfma_f32_16x16x32_bf16 v[168:171], v[104:107], v[68:71], v[168:171]
    s_add_u32 s41, s41, 262144
    buffer_load_dwordx4 v[56:59], v1, s[8:11], s40 offen sc1
    v_mfma_f32_16x16x32_bf16 v[140:143], v[108:111], v[64:67], v[140:143]
    ds_read_b64_tr_b16 v[100:101], v5 offset:57344
    ds_read_b64_tr_b16 v[102:103], v5 offset:58368
    v_mfma_f32_16x16x32_bf16 v[172:175], v[108:111], v[68:71], v[172:175]
    s_add_u32 s55, s40, 20480
    buffer_load_dwordx4 v[60:63], v1, s[8:11], s55 offen sc1
    s_waitcnt lgkmcnt(8)
    v_mfma_f32_16x16x32_bf16 v[144:147], v[112:115], v[64:67], v[144:147]
    ds_read_b64_tr_b16 v[104:105], v4 offset:59392
    ds_read_b64_tr_b16 v[106:107], v4 offset:60416
    v_mfma_f32_16x16x32_bf16 v[176:179], v[112:115], v[68:71], v[176:179]
    s_add_u32 s40, s40, 1024
    v_mfma_f32_16x16x32_bf16 v[148:151], v[116:119], v[64:67], v[148:151]
    ds_read_b64_tr_b16 v[108:109], v5 offset:59392
    ds_read_b64_tr_b16 v[110:111], v5 offset:60416
    v_mfma_f32_16x16x32_bf16 v[180:183], v[116:119], v[68:71], v[180:183]
    s_waitcnt lgkmcnt(8)
    v_mfma_f32_16x16x32_bf16 v[152:155], v[120:123], v[64:67], v[152:155]
    ds_read_b64_tr_b16 v[112:113], v4 offset:61440
    ds_read_b64_tr_b16 v[114:115], v4 offset:62464
    v_mfma_f32_16x16x32_bf16 v[184:187], v[120:123], v[68:71], v[184:187]
    v_mfma_f32_16x16x32_bf16 v[156:159], v[124:127], v[64:67], v[156:159]
    ds_read_b64_tr_b16 v[116:117], v5 offset:61440
    ds_read_b64_tr_b16 v[118:119], v5 offset:62464
    v_mfma_f32_16x16x32_bf16 v[188:191], v[124:127], v[68:71], v[188:191]
    s_waitcnt vmcnt(28)
    s_barrier
    s_waitcnt lgkmcnt(8)
    v_mfma_f32_16x16x32_bf16 v[128:131], v[96:99], v[72:75], v[128:131]
    ds_read_b64_tr_b16 v[120:121], v4 offset:63488
    ds_read_b64_tr_b16 v[122:123], v4 offset:64512
    v_mfma_f32_16x16x32_bf16 v[160:163], v[96:99], v[76:79], v[160:163]
    s_add_u32 m0, s42, 49152
    s_nop 0
    buffer_load_dwordx4 v8, s[12:15], s41 offen lds
    v_mfma_f32_16x16x32_bf16 v[132:135], v[100:103], v[72:75], v[132:135]
    ds_read_b64_tr_b16 v[124:125], v5 offset:63488
    ds_read_b64_tr_b16 v[126:127], v5 offset:64512
    v_mfma_f32_16x16x32_bf16 v[164:167], v[100:103], v[76:79], v[164:167]
    s_add_u32 m0, s42, 53248
    s_nop 0
    buffer_load_dwordx4 v9, s[12:15], s41 offen lds
    s_waitcnt lgkmcnt(8)
    v_mfma_f32_16x16x32_bf16 v[136:139], v[104:107], v[72:75], v[136:139]
    ds_read_b64_tr_b16 v[96:97], v6 offset:0
    ds_read_b64_tr_b16 v[98:99], v6 offset:1024
    v_mfma_f32_16x16x32_bf16 v[168:171], v[104:107], v[76:79], v[168:171]
    s_add_u32 s41, s41, 262144
    buffer_load_dwordx4 v[64:67], v1, s[8:11], s40 offen sc1
    v_mfma_f32_16x16x32_bf16 v[140:143], v[108:111], v[72:75], v[140:143]
    ds_read_b64_tr_b16 v[100:101], v7 offset:0
    ds_read_b64_tr_b16 v[102:103], v7 offset:1024
    v_mfma_f32_16x16x32_bf16 v[172:175], v[108:111], v[76:79], v[172:175]
    s_add_u32 s55, s40, 20480
    buffer_load_dwordx4 v[68:71], v1, s[8:11], s55 offen sc1
    s_waitcnt lgkmcnt(8)
    v_mfma_f32_16x16x32_bf16 v[144:147], v[112:115], v[72:75], v[144:147]
    ds_read_b64_tr_b16 v[104:105], v6 offset:2048
    ds_read_b64_tr_b16 v[106:107], v6 offset:3072
    v_mfma_f32_16x16x32_bf16 v[176:179], v[112:115], v[76:79], v[176:179]
    s_add_u32 s40, s40, 1024
    v_mfma_f32_16x16x32_bf16 v[148:151], v[116:119], v[72:75], v[148:151]
    ds_read_b64_tr_b16 v[108:109], v7 offset:2048
    ds_read_b64_tr_b16 v[110:111], v7 offset:3072
    v_mfma_f32_16x16x32_bf16 v[180:183], v[116:119], v[76:79], v[180:183]
    s_waitcnt lgkmcnt(8)
    v_mfma_f32_16x16x32_bf16 v[152:155], v[120:123], v[72:75], v[152:155]
    ds_read_b64_tr_b16 v[112:113], v6 offset:4096
    ds_read_b64_tr_b16 v[114:115], v6 offset:5120
    v_mfma_f32_16x16x32_bf16 v[184:187], v[120:123], v[76:79], v[184:187]
    v_mfma_f32_16x16x32_bf16 v[156:159], v[124:127], v[72:75], v[156:159]
    ds_read_b64_tr_b16 v[116:117], v7 offset:4096
    ds_read_b64_tr_b16 v[118:119], v7 offset:5120
    v_mfma_f32_16x16x32_bf16 v[188:191], v[124:127], v[76:79], v[188:191]
    s_waitcnt vmcnt(28)
    s_barrier
    s_waitcnt lgkmcnt(8)
    v_mfma_f32_16x16x32_bf16 v[128:131], v[96:99], v[80:83], v[128:131]
    ds_read_b64_tr_b16 v[120:121], v6 offset:6144
    ds_read_b64_tr_b16 v[122:123], v6 offset:7168
    v_mfma_f32_16x16x32_bf16 v[160:163], v[96:99], v[84:87], v[160:163]
    s_add_u32 m0, s42, 57344
    s_nop 0
    buffer_load_dwordx4 v8, s[12:15], s41 offen lds
    v_mfma_f32_16x16x32_bf16 v[132:135], v[100:103], v[80:83], v[132:135]
    ds_read_b64_tr_b16 v[124:125], v7 offset:6144
    ds_read_b64_tr_b16 v[126:127], v7 offset:7168
    v_mfma_f32_16x16x32_bf16 v[164:167], v[100:103], v[84:87], v[164:167]
    s_add_u32 m0, s42, 61440
    s_nop 0
    buffer_load_dwordx4 v9, s[12:15], s41 offen lds
    s_waitcnt lgkmcnt(8)
    v_mfma_f32_16x16x32_bf16 v[136:139], v[104:107], v[80:83], v[136:139]
    ds_read_b64_tr_b16 v[96:97], v6 offset:8192
    ds_read_b64_tr_b16 v[98:99], v6 offset:9216
    v_mfma_f32_16x16x32_bf16 v[168:171], v[104:107], v[84:87], v[168:171]
    s_add_u32 s41, s41, 262144
    buffer_load_dwordx4 v[72:75], v1, s[8:11], s40 offen sc1
    v_mfma_f32_16x16x32_bf16 v[140:143], v[108:111], v[80:83], v[140:143]
    ds_read_b64_tr_b16 v[100:101], v7 offset:8192
    ds_read_b64_tr_b16 v[102:103], v7 offset:9216
    v_mfma_f32_16x16x32_bf16 v[172:175], v[108:111], v[84:87], v[172:175]
    s_add_u32 s55, s40, 20480
    buffer_load_dwordx4 v[76:79], v1, s[8:11], s55 offen sc1
    s_waitcnt lgkmcnt(8)
    v_mfma_f32_16x16x32_bf16 v[144:147], v[112:115], v[80:83], v[144:147]
    ds_read_b64_tr_b16 v[104:105], v6 offset:10240
    ds_read_b64_tr_b16 v[106:107], v6 offset:11264
    v_mfma_f32_16x16x32_bf16 v[176:179], v[112:115], v[84:87], v[176:179]
    s_add_u32 s40, s40, 1024
    v_mfma_f32_16x16x32_bf16 v[148:151], v[116:119], v[80:83], v[148:151]
    ds_read_b64_tr_b16 v[108:109], v7 offset:10240
    ds_read_b64_tr_b16 v[110:111], v7 offset:11264
    v_mfma_f32_16x16x32_bf16 v[180:183], v[116:119], v[84:87], v[180:183]
    s_waitcnt lgkmcnt(8)
    v_mfma_f32_16x16x32_bf16 v[152:155], v[120:123], v[80:83], v[152:155]
    ds_read_b64_tr_b16 v[112:113], v6 offset:12288
    ds_read_b64_tr_b16 v[114:115], v6 offset:13312
    v_mfma_f32_16x16x32_bf16 v[184:187], v[120:123], v[84:87], v[184:187]
    v_mfma_f32_16x16x32_bf16 v[156:159], v[124:127], v[80:83], v[156:159]
    ds_read_b64_tr_b16 v[116:117], v7 offset:12288
    ds_read_b64_tr_b16 v[118:119], v7 offset:13312
    v_mfma_f32_16x16x32_bf16 v[188:191], v[124:127], v[84:87], v[188:191]
    s_waitcnt vmcnt(28)
    s_barrier
    s_waitcnt lgkmcnt(8)
    v_mfma_f32_16x16x32_bf16 v[128:131], v[96:99], v[88:91], v[128:131]
    ds_read_b64_tr_b16 v[120:121], v6 offset:14336
    ds_read_b64_tr_b16 v[122:123], v6 offset:15360
    v_mfma_f32_16x16x32_bf16 v[160:163], v[96:99], v[92:95], v[160:163]
    s_add_u32 m0, s42, 65536
    s_nop 0
    buffer_load_dwordx4 v8, s[12:15], s41 offen lds
    v_mfma_f32_16x16x32_bf16 v[132:135], v[100:103], v[88:91], v[132:135]
    ds_read_b64_tr_b16 v[124:125], v7 offset:14336
    ds_read_b64_tr_b16 v[126:127], v7 offset:15360
    v_mfma_f32_16x16x32_bf16 v[164:167], v[100:103], v[92:95], v[164:167]
    s_add_u32 m0, s42, 69632
    s_nop 0
    buffer_load_dwordx4 v9, s[12:15], s41 offen lds
    s_waitcnt lgkmcnt(8)
    v_mfma_f32_16x16x32_bf16 v[136:139], v[104:107], v[88:91], v[136:139]
    ds_read_b64_tr_b16 v[96:97], v4 offset:0
    ds_read_b64_tr_b16 v[98:99], v4 offset:1024
    v_mfma_f32_16x16x32_bf16 v[168:171], v[104:107], v[92:95], v[168:171]
    s_add_u32 s41, s41, 262144
    buffer_load_dwordx4 v[80:83], v1, s[8:11], s40 offen sc1
    v_mfma_f32_16x16x32_bf16 v[140:143], v[108:111], v[88:91], v[140:143]
    ds_read_b64_tr_b16 v[100:101], v5 offset:0
    ds_read_b64_tr_b16 v[102:103], v5 offset:1024
    v_mfma_f32_16x16x32_bf16 v[172:175], v[108:111], v[92:95], v[172:175]
    s_add_u32 s55, s40, 20480
    buffer_load_dwordx4 v[84:87], v1, s[8:11], s55 offen sc1
    s_waitcnt lgkmcnt(8)
    v_mfma_f32_16x16x32_bf16 v[144:147], v[112:115], v[88:91], v[144:147]
    ds_read_b64_tr_b16 v[104:105], v4 offset:2048
    ds_read_b64_tr_b16 v[106:107], v4 offset:3072
    v_mfma_f32_16x16x32_bf16 v[176:179], v[112:115], v[92:95], v[176:179]
    s_add_u32 s40, s40, 1024
    v_mfma_f32_16x16x32_bf16 v[148:151], v[116:119], v[88:91], v[148:151]
    ds_read_b64_tr_b16 v[108:109], v5 offset:2048
    ds_read_b64_tr_b16 v[110:111], v5 offset:3072
    v_mfma_f32_16x16x32_bf16 v[180:183], v[116:119], v[92:95], v[180:183]
    s_waitcnt lgkmcnt(8)
    v_mfma_f32_16x16x32_bf16 v[152:155], v[120:123], v[88:91], v[152:155]
    ds_read_b64_tr_b16 v[112:113], v4 offset:4096
    ds_read_b64_tr_b16 v[114:115], v4 offset:5120
    v_mfma_f32_16x16x32_bf16 v[184:187], v[120:123], v[92:95], v[184:187]
    v_mfma_f32_16x16x32_bf16 v[156:159], v[124:127], v[88:91], v[156:159]
    ds_read_b64_tr_b16 v[116:117], v5 offset:4096
    ds_read_b64_tr_b16 v[118:119], v5 offset:5120
    v_mfma_f32_16x16x32_bf16 v[188:191], v[124:127], v[92:95], v[188:191]
    s_mov_b32 s43, 1
.p2align 3
gk_loop:
    s_waitcnt vmcnt(28)
    s_barrier
    s_waitcnt lgkmcnt(8)
    v_mfma_f32_16x16x32_bf16 v[128:131], v[96:99], v[16:19], v[128:131]
    ds_read_b64_tr_b16 v[120:121], v4 offset:6144
    ds_read_b64_tr_b16 v[122:123], v4 offset:7168
    v_mfma_f32_16x16x32_bf16 v[160:163], v[96:99], v[20:23], v[160:163]
    s_add_u32 m0, s42, 73728
    s_nop 0
    buffer_load_dwordx4 v8, s[12:15], s41 offen lds
    v_mfma_f32_16x16x32_bf16 v[132:135], v[100:103], v[16:19], v[132:135]
    ds_read_b64_tr_b16 v[124:125], v5 offset:6144
    ds_read_b64_tr_b16 v[126:127], v5 offset:7168
    v_mfma_f32_16x16x32_bf16 v[164:167], v[100:103], v[20:23], v[164:167]
    s_add_u32 m0, s42, 77824
    s_nop 0
    buffer_load_dwordx4 v9, s[12:15], s41 offen lds
    s_waitcnt lgkmcnt(8)
    v_mfma_f32_16x16x32_bf16 v[136:139], v[104:107], v[16:19], v[136:139]
    ds_read_b64_tr_b16 v[96:97], v4 offset:8192
    ds_read_b64_tr_b16 v[98:99], v4 offset:9216
    v_mfma_f32_16x16x32_bf16 v[168:171], v[104:107], v[20:23], v[168:171]
    s_add_u32 s41, s41, 262144
    buffer_load_dwordx4 v[88:91], v1, s[8:11], s40 offen sc1
    v_mfma_f32_16x16x32_bf16 v[140:143], v[108:111], v[16:19], v[140:143]
    ds_read_b64_tr_b16 v[100:101], v5 offset:8192
    ds_read_b64_tr_b16 v[102:103], v5 offset:9216
    v_mfma_f32_16x16x32_bf16 v[172:175], v[108:111], v[20:23], v[172:175]
    s_add_u32 s55, s40, 20480
    buffer_load_dwordx4 v[92:95], v1, s[8:11], s55 offen sc1
    s_waitcnt lgkmcnt(8)
    v_mfma_f32_16x16x32_bf16 v[144:147], v[112:115], v[16:19], v[144:147]
    ds_read_b64_tr_b16 v[104:105], v4 offset:10240
    ds_read_b64_tr_b16 v[106:107], v4 offset:11264
    v_mfma_f32_16x16x32_bf16 v[176:179], v[112:115], v[20:23], v[176:179]
    s_add_u32 s40, s40, 1024
    v_mfma_f32_16x16x32_bf16 v[148:151], v[116:119], v[16:19], v[148:151]
    ds_read_b64_tr_b16 v[108:109], v5 offset:10240
    ds_read_b64_tr_b16 v[110:111], v5 offset:11264
    v_mfma_f32_16x16x32_bf16 v[180:183], v[116:119], v[20:23], v[180:183]
    s_waitcnt lgkmcnt(8)
    v_mfma_f32_16x16x32_bf16 v[152:155], v[120:123], v[16:19], v[152:155]
    ds_read_b64_tr_b16 v[112:113], v4 offset:12288
    ds_read_b64_tr_b16 v[114:115], v4 offset:13312
    v_mfma_f32_16x16x32_bf16 v[184:187], v[120:123], v[20:23], v[184:187]
    v_mfma_f32_16x16x32_bf16 v[156:159], v[124:127], v[16:19], v[156:159]
    ds_read_b64_tr_b16 v[116:117], v5 offset:12288
    ds_read_b64_tr_b16 v[118:119], v5 offset:13312
    v_mfma_f32_16x16x32_bf16 v[188:191], v[124:127], v[20:23], v[188:191]
    s_waitcnt vmcnt(28)
    s_barrier
    s_waitcnt lgkmcnt(8)
    v_mfma_f32_16x16x32_bf16 v[128:131], v[96:99], v[24:27], v[128:131]
    ds_read_b64_tr_b16 v[120:121], v4 offset:14336
    ds_read_b64_tr_b16 v[122:123], v4 offset:15360
    v_mfma_f32_16x16x32_bf16 v[160:163], v[96:99], v[28:31], v[160:163]
    s_add_u32 m0, s42, 0
    s_nop 0
    buffer_load_dwordx4 v8, s[12:15], s41 offen lds
    v_mfma_f32_16x16x32_bf16 v[132:135], v[100:103], v[24:27], v[132:135]
    ds_read_b64_tr_b16 v[124:125], v5 offset:14336
    ds_read_b64_tr_b16 v[126:127], v5 offset:15360
    v_mfma_f32_16x16x32_bf16 v[164:167], v[100:103], v[28:31], v[164:167]
    s_add_u32 m0, s42, 4096
    s_nop 0
    buffer_load_dwordx4 v9, s[12:15], s41 offen lds
    s_waitcnt lgkmcnt(8)
    v_mfma_f32_16x16x32_bf16 v[136:139], v[104:107], v[24:27], v[136:139]
    ds_read_b64_tr_b16 v[96:97], v4 offset:16384
    ds_read_b64_tr_b16 v[98:99], v4 offset:17408
    v_mfma_f32_16x16x32_bf16 v[168:171], v[104:107], v[28:31], v[168:171]
    s_add_u32 s41, s41, 262144
    buffer_load_dwordx4 v[16:19], v1, s[8:11], s40 offen sc1
    v_mfma_f32_16x16x32_bf16 v[140:143], v[108:111], v[24:27], v[140:143]
    ds_read_b64_tr_b16 v[100:101], v5 offset:16384
    ds_read_b64_tr_b16 v[102:103], v5 offset:17408
    v_mfma_f32_16x16x32_bf16 v[172:175], v[108:111], v[28:31], v[172:175]
    s_add_u32 s55, s40, 20480
    buffer_load_dwordx4 v[20:23], v1, s[8:11], s55 offen sc1
    s_waitcnt lgkmcnt(8)
    v_mfma_f32_16x16x32_bf16 v[144:147], v[112:115], v[24:27], v[144:147]
    ds_read_b64_tr_b16 v[104:105], v4 offset:18432
    ds_read_b64_tr_b16 v[106:107], v4 offset:19456
    v_mfma_f32_16x16x32_bf16 v[176:179], v[112:115], v[28:31], v[176:179]
    s_add_u32 s40, s40, 1024
    v_mfma_f32_16x16x32_bf16 v[148:151], v[116:119], v[24:27], v[148:151]
    ds_read_b64_tr_b16 v[108:109], v5 offset:18432
    ds_read_b64_tr_b16 v[110:111], v5 offset:19456
    v_mfma_f32_16x16x32_bf16 v[180:183], v[116:119], v[28:31], v[180:183]
    s_waitcnt lgkmcnt(8)
    v_mfma_f32_16x16x32_bf16 v[152:155], v[120:123], v[24:27], v[152:155]
    ds_read_b64_tr_b16 v[112:113], v4 offset:20480
    ds_read_b64_tr_b16 v[114:115], v4 offset:21504
    v_mfma_f32_16x16x32_bf16 v[184:187], v[120:123], v[28:31], v[184:187]
    v_mfma_f32_16x16x32_bf16 v[156:159], v[124:127], v[24:27], v[156:159]
    ds_read_b64_tr_b16 v[116:117], v5 offset:20480
    ds_read_b64_tr_b16 v[118:119], v5 offset:21504
    v_mfma_f32_16x16x32_bf16 v[188:191], v[124:127], v[28:31], v[188:191]
    s_waitcnt vmcnt(28)
    s_barrier
    s_waitcnt lgkmcnt(8)
    v_mfma_f32_16x16x32_bf16 v[128:131], v[96:99], v[32:35], v[128:131]
    ds_read_b64_tr_b16 v[120:121], v4 offset:22528
    ds_read_b64_tr_b16 v[122:123], v4 offset:23552
    v_mfma_f32_16x16x32_bf16 v[160:163], v[96:99], v[36:39], v[160:163]
    s_add_u32 m0, s42, 8192
    s_nop 0
    buffer_load_dwordx4 v8, s[12:15], s41 offen lds
    v_mfma_f32_16x16x32_bf16 v[132:135], v[100:103], v[32:35], v[132:135]
    ds_read_b64_tr_b16 v[124:125], v5 offset:22528
    ds_read_b64_tr_b16 v[126:127], v5 offset:23552
    v_mfma_f32_16x16x32_bf16 v[164:167], v[100:103], v[36:39], v[164:167]
    s_add_u32 m0, s42, 12288
    s_nop 0
    buffer_load_dwordx4 v9, s[12:15], s41 offen lds
    s_waitcnt lgkmcnt(8)
    v_mfma_f32_16x16x32_bf16 v[136:139], v[104:107], v[32:35], v[136:139]
    ds_read_b64_tr_b16 v[96:97], v4 offset:24576
    ds_read_b64_tr_b16 v[98:99], v4 offset:25600
    v_mfma_f32_16x16x32_bf16 v[168:171], v[104:107], v[36:39], v[168:171]
    s_add_u32 s41, s41, 262144
    buffer_load_dwordx4 v[24:27], v1, s[8:11], s40 offen sc1
    v_mfma_f32_16x16x32_bf16 v[140:143], v[108:111], v[32:35], v[140:143]
    ds_read_b64_tr_b16 v[100:101], v5 offset:24576
    ds_read_b64_tr_b16 v[102:103], v5 offset:25600
    v_mfma_f32_16x16x32_bf16 v[172:175], v[108:111], v[36:39], v[172:175]
    s_add_u32 s55, s40, 20480
    buffer_load_dwordx4 v[28:31], v1, s[8:11], s55 offen sc1
    s_waitcnt lgkmcnt(8)
    v_mfma_f32_16x16x32_bf16 v[144:147], v[112:115], v[32:35], v[144:147]
    ds_read_b64_tr_b16 v[104:105], v4 offset:26624
    ds_read_b64_tr_b16 v[106:107], v4 offset:27648
    v_mfma_f32_16x16x32_bf16 v[176:179], v[112:115], v[36:39], v[176:179]
    s_add_u32 s40, s40, 1024
    v_mfma_f32_16x16x32_bf16 v[148:151], v[116:119], v[32:35], v[148:151]
    ds_read_b64_tr_b16 v[108:109], v5 offset:26624
    ds_read_b64_tr_b16 v[110:111], v5 offset:27648
    v_mfma_f32_16x16x32_bf16 v[180:183], v[116:119], v[36:39], v[180:183]
    s_waitcnt lgkmcnt(8)
    v_mfma_f32_16x16x32_bf16 v[152:155], v[120:123], v[32:35], v[152:155]
    ds_read_b64_tr_b16 v[112:113], v4 offset:28672
    ds_read_b64_tr_b16 v[114:115], v4 offset:29696
    v_mfma_f32_16x16x32_bf16 v[184:187], v[120:123], v[36:39], v[184:187]
    v_mfma_f32_16x16x32_bf16 v[156:159], v[124:127], v[32:35], v[156:159]
    ds_read_b64_tr_b16 v[116:117], v5 offset:28672
    ds_read_b64_tr_b16 v[118:119], v5 offset:29696
    v_mfma_f32_16x16x32_bf16 v[188:191], v[124:127], v[36:39], v[188:191]
    s_waitcnt vmcnt(28)
    s_barrier
    s_waitcnt lgkmcnt(8)
    v_mfma_f32_16x16x32_bf16 v[128:131], v[96:99], v[40:43], v[128:131]
    ds_read_b64_tr_b16 v[120:121], v4 offset:30720
    ds_read_b64_tr_b16 v[122:123], v4 offset:31744
    v_mfma_f32_16x16x32_bf16 v[160:163], v[96:99], v[44:47], v[160:163]
    s_add_u32 m0, s42, 16384
    s_nop 0
    buffer_load_dwordx4 v8, s[12:15], s41 offen lds
    v_mfma_f32_16x16x32_bf16 v[132:135], v[100:103], v[40:43], v[132:135]
    ds_read_b64_tr_b16 v[124:125], v5 offset:30720
    ds_read_b64_tr_b16 v[126:127], v5 offset:31744
    v_mfma_f32_16x16x32_bf16 v[164:167], v[100:103], v[44:47], v[164:167]
    s_add_u32 m0, s42, 20480
    s_nop 0
    buffer_load_dwordx4 v9, s[12:15], s41 offen lds
    s_waitcnt lgkmcnt(8)
    v_mfma_f32_16x16x32_bf16 v[136:139], v[104:107], v[40:43], v[136:139]
    ds_read_b64_tr_b16 v[96:97], v4 offset:32768
    ds_read_b64_tr_b16 v[98:99], v4 offset:33792
    v_mfma_f32_16x16x32_bf16 v[168:171], v[104:107], v[44:47], v[168:171]
    s_add_u32 s41, s41, 262144
    buffer_load_dwordx4 v[32:35], v1, s[8:11], s40 offen sc1
    v_mfma_f32_16x16x32_bf16 v[140:143], v[108:111], v[40:43], v[140:143]
    ds_read_b64_tr_b16 v[100:101], v5 offset:32768
    ds_read_b64_tr_b16 v[102:103], v5 offset:33792
    v_mfma_f32_16x16x32_bf16 v[172:175], v[108:111], v[44:47], v[172:175]
    s_add_u32 s55, s40, 20480
    buffer_load_dwordx4 v[36:39], v1, s[8:11], s55 offen sc1
    s_waitcnt lgkmcnt(8)
    v_mfma_f32_16x16x32_bf16 v[144:147], v[112:115], v[40:43], v[144:147]
    ds_read_b64_tr_b16 v[104:105], v4 offset:34816
    ds_read_b64_tr_b16 v[106:107], v4 offset:35840
    v_mfma_f32_16x16x32_bf16 v[176:179], v[112:115], v[44:47], v[176:179]
    s_add_u32 s40, s40, 1024
    v_mfma_f32_16x16x32_bf16 v[148:151], v[116:119], v[40:43], v[148:151]
    ds_read_b64_tr_b16 v[108:109], v5 offset:34816
    ds_read_b64_tr_b16 v[110:111], v5 offset:35840
    v_mfma_f32_16x16x32_bf16 v[180:183], v[116:119], v[44:47], v[180:183]
    s_waitcnt lgkmcnt(8)
    v_mfma_f32_16x16x32_bf16 v[152:155], v[120:123], v[40:43], v[152:155]
    ds_read_b64_tr_b16 v[112:113], v4 offset:36864
    ds_read_b64_tr_b16 v[114:115], v4 offset:37888
    v_mfma_f32_16x16x32_bf16 v[184:187], v[120:123], v[44:47], v[184:187]
    v_mfma_f32_16x16x32_bf16 v[156:159], v[124:127], v[40:43], v[156:159]
    ds_read_b64_tr_b16 v[116:117], v5 offset:36864
    ds_read_b64_tr_b16 v[118:119], v5 offset:37888
    v_mfma_f32_16x16x32_bf16 v[188:191], v[124:127], v[44:47], v[188:191]
    s_waitcnt vmcnt(28)
    s_barrier
    s_waitcnt lgkmcnt(8)
    v_mfma_f32_16x16x32_bf16 v[128:131], v[96:99], v[48:51], v[128:131]
    ds_read_b64_tr_b16 v[120:121], v4 offset:38912
    ds_read_b64_tr_b16 v[122:123], v4 offset:39936
    v_mfma_f32_16x16x32_bf16 v[160:163], v[96:99], v[52:55], v[160:163]
    s_add_u32 m0, s42, 24576
    s_nop 0
    buffer_load_dwordx4 v8, s[12:15], s41 offen lds
    v_mfma_f32_16x16x32_bf16 v[132:135], v[100:103], v[48:51], v[132:135]
    ds_read_b64_tr_b16 v[124:125], v5 offset:38912
    ds_read_b64_tr_b16 v[126:127], v5 offset:39936
    v_mfma_f32_16x16x32_bf16 v[164:167], v[100:103], v[52:55], v[164:167]
    s_add_u32 m0, s42, 28672
    s_nop 0
    buffer_load_dwordx4 v9, s[12:15], s41 offen lds
    s_waitcnt lgkmcnt(8)
    v_mfma_f32_16x16x32_bf16 v[136:139], v[104:107], v[48:51], v[136:139]
    ds_read_b64_tr_b16 v[96:97], v4 offset:40960
    ds_read_b64_tr_b16 v[98:99], v4 offset:41984
    v_mfma_f32_16x16x32_bf16 v[168:171], v[104:107], v[52:55], v[168:171]
    s_add_u32 s41, s41, 262144
    buffer_load_dwordx4 v[40:43], v1, s[8:11], s40 offen sc1
    v_mfma_f32_16x16x32_bf16 v[140:143], v[108:111], v[48:51], v[140:143]
    ds_read_b64_tr_b16 v[100:101], v5 offset:40960
    ds_read_b64_tr_b16 v[102:103], v5 offset:41984
    v_mfma_f32_16x16x32_bf16 v[172:175], v[108:111], v[52:55], v[172:175]
    s_add_u32 s55, s40, 20480
    buffer_load_dwordx4 v[44:47], v1, s[8:11], s55 offen sc1
    s_waitcnt lgkmcnt(8)
    v_mfma_f32_16x16x32_bf16 v[144:147], v[112:115], v[48:51], v[144:147]
    ds_read_b64_tr_b16 v[104:105], v4 offset:43008
    ds_read_b64_tr_b16 v[106:107], v4 offset:44032
    v_mfma_f32_16x16x32_bf16 v[176:179], v[112:115], v[52:55], v[176:179]
    s_add_u32 s40, s40, 1024
    v_mfma_f32_16x16x32_bf16 v[148:151], v[116:119], v[48:51], v[148:151]
    ds_read_b64_tr_b16 v[108:109], v5 offset:43008
    ds_read_b64_tr_b16 v[110:111], v5 offset:44032
    v_mfma_f32_16x16x32_bf16 v[180:183], v[116:119], v[52:55], v[180:183]
    s_waitcnt lgkmcnt(8)
    v_mfma_f32_16x16x32_bf16 v[152:155], v[120:123], v[48:51], v[152:155]
    ds_read_b64_tr_b16 v[112:113], v4 offset:45056
    ds_read_b64_tr_b16 v[114:115], v4 offset:46080
    v_mfma_f32_16x16x32_bf16 v[184:187], v[120:123], v[52:55], v[184:187]
    v_mfma_f32_16x16x32_bf16 v[156:159], v[124:127], v[48:51], v[156:159]
    ds_read_b64_tr_b16 v[116:117], v5 offset:45056
    ds_read_b64_tr_b16 v[118:119], v5 offset:46080
    v_mfma_f32_16x16x32_bf16 v[188:191], v[124:127], v[52:55], v[188:191]
    s_waitcnt vmcnt(28)
    s_barrier
    s_waitcnt lgkmcnt(8)
    v_mfma_f32_16x16x32_bf16 v[128:131], v[96:99], v[56:59], v[128:131]
    ds_read_b64_tr_b16 v[120:121], v4 offset:47104
    ds_read_b64_tr_b16 v[122:123], v4 offset:48128
    v_mfma_f32_16x16x32_bf16 v[160:163], v[96:99], v[60:63], v[160:163]
    s_add_u32 m0, s42, 32768
    s_nop 0
    buffer_load_dwordx4 v8, s[12:15], s41 offen lds
    v_mfma_f32_16x16x32_bf16 v[132:135], v[100:103], v[56:59], v[132:135]
    ds_read_b64_tr_b16 v[124:125], v5 offset:47104
    ds_read_b64_tr_b16 v[126:127], v5 offset:48128
    v_mfma_f32_16x16x32_bf16 v[164:167], v[100:103], v[60:63], v[164:167]
    s_add_u32 m0, s42, 36864
    s_nop 0
    buffer_load_dwordx4 v9, s[12:15], s41 offen lds
    s_waitcnt lgkmcnt(8)
    v_mfma_f32_16x16x32_bf16 v[136:139], v[104:107], v[56:59], v[136:139]
    ds_read_b64_tr_b16 v[96:97], v4 offset:49152
    ds_read_b64_tr_b16 v[98:99], v4 offset:50176
    v_mfma_f32_16x16x32_bf16 v[168:171], v[104:107], v[60:63], v[168:171]
    s_add_u32 s41, s41, 262144
    buffer_load_dwordx4 v[48:51], v1, s[8:11], s40 offen sc1
    v_mfma_f32_16x16x32_bf16 v[140:143], v[108:111], v[56:59], v[140:143]
    ds_read_b64_tr_b16 v[100:101], v5 offset:49152
    ds_read_b64_tr_b16 v[102:103], v5 offset:50176
    v_mfma_f32_16x16x32_bf16 v[172:175], v[108:111], v[60:63], v[172:175]
    s_add_u32 s55, s40, 20480
    buffer_load_dwordx4 v[52:55], v1, s[8:11], s55 offen sc1
    s_waitcnt lgkmcnt(8)
    v_mfma_f32_16x16x32_bf16 v[144:147], v[112:115], v[56:59], v[144:147]
    ds_read_b64_tr_b16 v[104:105], v4 offset:51200
    ds_read_b64_tr_b16 v[106:107], v4 offset:52224
    v_mfma_f32_16x16x32_bf16 v[176:179], v[112:115], v[60:63], v[176:179]
    s_add_u32 s40, s40, 1024
    v_mfma_f32_16x16x32_bf16 v[148:151], v[116:119], v[56:59], v[148:151]
    ds_read_b64_tr_b16 v[108:109], v5 offset:51200
    ds_read_b64_tr_b16 v[110:111], v5 offset:52224
    v_mfma_f32_16x16x32_bf16 v[180:183], v[116:119], v[60:63], v[180:183]
    s_waitcnt lgkmcnt(8)
    v_mfma_f32_16x16x32_bf16 v[152:155], v[120:123], v[56:59], v[152:155]
    ds_read_b64_tr_b16 v[112:113], v4 offset:53248
    ds_read_b64_tr_b16 v[114:115], v4 offset:54272
    v_mfma_f32_16x16x32_bf16 v[184:187], v[120:123], v[60:63], v[184:187]
    v_mfma_f32_16x16x32_bf16 v[156:159], v[124:127], v[56:59], v[156:159]
    ds_read_b64_tr_b16 v[116:117], v5 offset:53248
    ds_read_b64_tr_b16 v[118:119], v5 offset:54272
    v_mfma_f32_16x16x32_bf16 v[188:191], v[124:127], v[60:63], v[188:191]
    s_waitcnt vmcnt(28)
    s_barrier
    s_waitcnt lgkmcnt(8)
    v_mfma_f32_16x16x32_bf16 v[128:131], v[96:99], v[64:67], v[128:131]
    ds_read_b64_tr_b16 v[120:121], v4 offset:55296
    ds_read_b64_tr_b16 v[122:123], v4 offset:56320
    v_mfma_f32_16x16x32_bf16 v[160:163], v[96:99], v[68:71], v[160:163]
    s_add_u32 m0, s42, 40960
    s_nop 0
    buffer_load_dwordx4 v8, s[12:15], s41 offen lds
    v_mfma_f32_16x16x32_bf16 v[132:135], v[100:103], v[64:67], v[132:135]
    ds_read_b64_tr_b16 v[124:125], v5 offset:55296
    ds_read_b64_tr_b16 v[126:127], v5 offset:56320
    v_mfma_f32_16x16x32_bf16 v[164:167], v[100:103], v[68:71], v[164:167]
    s_add_u32 m0, s42, 45056
    s_nop 0
    buffer_load_dwordx4 v9, s[12:15], s41 offen lds
    s_waitcnt lgkmcnt(8)
    v_mfma_f32_16x16x32_bf16 v[136:139], v[104:107], v[64:67], v[136:139]
    ds_read_b64_tr_b16 v[96:97], v4 offset:57344
    ds_read_b64_tr_b16 v[98:99], v4 offset:58368
    v_mfma_f32_16x16x32_bf16 v[168:171], v[104:107], v[68:71], v[168:171]
    s_add_u32 s41, s41, 262144
    buffer_load_dwordx4 v[56:59], v1, s[8:11], s40 offen sc1
    v_mfma_f32_16x16x32_bf16 v[140:143], v[108:111], v[64:67], v[140:143]
    ds_read_b64_tr_b16 v[100:101], v5 offset:57344
    ds_read_b64_tr_b16 v[102:103], v5 offset:58368
    v_mfma_f32_16x16x32_bf16 v[172:175], v[108:111], v[68:71], v[172:175]
    s_add_u32 s55, s40, 20480
    buffer_load_dwordx4 v[60:63], v1, s[8:11], s55 offen sc1
    s_waitcnt lgkmcnt(8)
    v_mfma_f32_16x16x32_bf16 v[144:147], v[112:115], v[64:67], v[144:147]
    ds_read_b64_tr_b16 v[104:105], v4 offset:59392
    ds_read_b64_tr_b16 v[106:107], v4 offset:60416
    v_mfma_f32_16x16x32_bf16 v[176:179], v[112:115], v[68:71], v[176:179]
    s_add_u32 s40, s40, 1024
    v_mfma_f32_16x16x32_bf16 v[148:151], v[116:119], v[64:67], v[148:151]
    ds_read_b64_tr_b16 v[108:109], v5 offset:59392
    ds_read_b64_tr_b16 v[110:111], v5 offset:60416
    v_mfma_f32_16x16x32_bf16 v[180:183], v[116:119], v[68:71], v[180:183]
    s_waitcnt lgkmcnt(8)
    v_mfma_f32_16x16x32_bf16 v[152:155], v[120:123], v[64:67], v[152:155]
    ds_read_b64_tr_b16 v[112:113], v4 offset:61440
    ds_read_b64_tr_b16 v[114:115], v4 offset:62464
    v_mfma_f32_16x16x32_bf16 v[184:187], v[120:123], v[68:71], v[184:187]
    v_mfma_f32_16x16x32_bf16 v[156:159], v[124:127], v[64:67], v[156:159]
    ds_read_b64_tr_b16 v[116:117], v5 offset:61440
    ds_read_b64_tr_b16 v[118:119], v5 offset:62464
    v_mfma_f32_16x16x32_bf16 v[188:191], v[124:127], v[68:71], v[188:191]
    s_waitcnt vmcnt(28)
    s_barrier
    s_waitcnt lgkmcnt(8)
    v_mfma_f32_16x16x32_bf16 v[128:131], v[96:99], v[72:75], v[128:131]
    ds_read_b64_tr_b16 v[120:121], v4 offset:63488
    ds_read_b64_tr_b16 v[122:123], v4 offset:64512
    v_mfma_f32_16x16x32_bf16 v[160:163], v[96:99], v[76:79], v[160:163]
    s_add_u32 m0, s42, 49152
    s_nop 0
    buffer_load_dwordx4 v8, s[12:15], s41 offen lds
    v_mfma_f32_16x16x32_bf16 v[132:135], v[100:103], v[72:75], v[132:135]
    ds_read_b64_tr_b16 v[124:125], v5 offset:63488
    ds_read_b64_tr_b16 v[126:127], v5 offset:64512
    v_mfma_f32_16x16x32_bf16 v[164:167], v[100:103], v[76:79], v[164:167]
    s_add_u32 m0, s42, 53248
    s_nop 0
    buffer_load_dwordx4 v9, s[12:15], s41 offen lds
    s_waitcnt lgkmcnt(8)
    v_mfma_f32_16x16x32_bf16 v[136:139], v[104:107], v[72:75], v[136:139]
    ds_read_b64_tr_b16 v[96:97], v6 offset:0
    ds_read_b64_tr_b16 v[98:99], v6 offset:1024
    v_mfma_f32_16x16x32_bf16 v[168:171], v[104:107], v[76:79], v[168:171]
    s_add_u32 s41, s41, 262144
    buffer_load_dwordx4 v[64:67], v1, s[8:11], s40 offen sc1
    v_mfma_f32_16x16x32_bf16 v[140:143], v[108:111], v[72:75], v[140:143]
    ds_read_b64_tr_b16 v[100:101], v7 offset:0
    ds_read_b64_tr_b16 v[102:103], v7 offset:1024
    v_mfma_f32_16x16x32_bf16 v[172:175], v[108:111], v[76:79], v[172:175]
    s_add_u32 s55, s40, 20480
    buffer_load_dwordx4 v[68:71], v1, s[8:11], s55 offen sc1
    s_waitcnt lgkmcnt(8)
    v_mfma_f32_16x16x32_bf16 v[144:147], v[112:115], v[72:75], v[144:147]
    ds_read_b64_tr_b16 v[104:105], v6 offset:2048
    ds_read_b64_tr_b16 v[106:107], v6 offset:3072
    v_mfma_f32_16x16x32_bf16 v[176:179], v[112:115], v[76:79], v[176:179]
    s_add_u32 s40, s40, 1024
    v_mfma_f32_16x16x32_bf16 v[148:151], v[116:119], v[72:75], v[148:151]
    ds_read_b64_tr_b16 v[108:109], v7 offset:2048
    ds_read_b64_tr_b16 v[110:111], v7 offset:3072
    v_mfma_f32_16x16x32_bf16 v[180:183], v[116:119], v[76:79], v[180:183]
    s_waitcnt lgkmcnt(8)
    v_mfma_f32_16x16x32_bf16 v[152:155], v[120:123], v[72:75], v[152:155]
    ds_read_b64_tr_b16 v[112:113], v6 offset:4096
    ds_read_b64_tr_b16 v[114:115], v6 offset:5120
    v_mfma_f32_16x16x32_bf16 v[184:187], v[120:123], v[76:79], v[184:187]
    v_mfma_f32_16x16x32_bf16 v[156:159], v[124:127], v[72:75], v[156:159]
    ds_read_b64_tr_b16 v[116:117], v7 offset:4096
    ds_read_b64_tr_b16 v[118:119], v7 offset:5120
    v_mfma_f32_16x16x32_bf16 v[188:191], v[124:127], v[76:79], v[188:191]
    s_waitcnt vmcnt(28)
    s_barrier
    s_waitcnt lgkmcnt(8)
    v_mfma_f32_16x16x32_bf16 v[128:131], v[96:99], v[80:83], v[128:131]
    ds_read_b64_tr_b16 v[120:121], v6 offset:6144
    ds_read_b64_tr_b16 v[122:123], v6 offset:7168
    v_mfma_f32_16x16x32_bf16 v[160:163], v[96:99], v[84:87], v[160:163]
    s_add_u32 m0, s42, 57344
    s_nop 0
    buffer_load_dwordx4 v8, s[12:15], s41 offen lds
    v_mfma_f32_16x16x32_bf16 v[132:135], v[100:103], v[80:83], v[132:135]
    ds_read_b64_tr_b16 v[124:125], v7 offset:6144
    ds_read_b64_tr_b16 v[126:127], v7 offset:7168
    v_mfma_f32_16x16x32_bf16 v[164:167], v[100:103], v[84:87], v[164:167]
    s_add_u32 m0, s42, 61440
    s_nop 0
    buffer_load_dwordx4 v9, s[12:15], s41 offen lds
    s_waitcnt lgkmcnt(8)
    v_mfma_f32_16x16x32_bf16 v[136:139], v[104:107], v[80:83], v[136:139]
    ds_read_b64_tr_b16 v[96:97], v6 offset:8192
    ds_read_b64_tr_b16 v[98:99], v6 offset:9216
    v_mfma_f32_16x16x32_bf16 v[168:171], v[104:107], v[84:87], v[168:171]
    s_add_u32 s41, s41, 262144
    buffer_load_dwordx4 v[72:75], v1, s[8:11], s40 offen sc1
    v_mfma_f32_16x16x32_bf16 v[140:143], v[108:111], v[80:83], v[140:143]
    ds_read_b64_tr_b16 v[100:101], v7 offset:8192
    ds_read_b64_tr_b16 v[102:103], v7 offset:9216
    v_mfma_f32_16x16x32_bf16 v[172:175], v[108:111], v[84:87], v[172:175]
    s_add_u32 s55, s40, 20480
    buffer_load_dwordx4 v[76:79], v1, s[8:11], s55 offen sc1
    s_waitcnt lgkmcnt(8)
    v_mfma_f32_16x16x32_bf16 v[144:147], v[112:115], v[80:83], v[144:147]
    ds_read_b64_tr_b16 v[104:105], v6 offset:10240
    ds_read_b64_tr_b16 v[106:107], v6 offset:11264
    v_mfma_f32_16x16x32_bf16 v[176:179], v[112:115], v[84:87], v[176:179]
    s_add_u32 s40, s40, 1024
    v_mfma_f32_16x16x32_bf16 v[148:151], v[116:119], v[80:83], v[148:151]
    ds_read_b64_tr_b16 v[108:109], v7 offset:10240
    ds_read_b64_tr_b16 v[110:111], v7 offset:11264
    v_mfma_f32_16x16x32_bf16 v[180:183], v[116:119], v[84:87], v[180:183]
    s_waitcnt lgkmcnt(8)
    v_mfma_f32_16x16x32_bf16 v[152:155], v[120:123], v[80:83], v[152:155]
    ds_read_b64_tr_b16 v[112:113], v6 offset:12288
    ds_read_b64_tr_b16 v[114:115], v6 offset:13312
    v_mfma_f32_16x16x32_bf16 v[184:187], v[120:123], v[84:87], v[184:187]
    v_mfma_f32_16x16x32_bf16 v[156:159], v[124:127], v[80:83], v[156:159]
    ds_read_b64_tr_b16 v[116:117], v7 offset:12288
    ds_read_b64_tr_b16 v[118:119], v7 offset:13312
    v_mfma_f32_16x16x32_bf16 v[188:191], v[124:127], v[84:87], v[188:191]
    s_waitcnt vmcnt(28)
    s_barrier
    s_waitcnt lgkmcnt(8)
    v_mfma_f32_16x16x32_bf16 v[128:131], v[96:99], v[88:91], v[128:131]
    ds_read_b64_tr_b16 v[120:121], v6 offset:14336
    ds_read_b64_tr_b16 v[122:123], v6 offset:15360
    v_mfma_f32_16x16x32_bf16 v[160:163], v[96:99], v[92:95], v[160:163]
    s_add_u32 m0, s42, 65536
    s_nop 0
    buffer_load_dwordx4 v8, s[12:15], s41 offen lds
    v_mfma_f32_16x16x32_bf16 v[132:135], v[100:103], v[88:91], v[132:135]
    ds_read_b64_tr_b16 v[124:125], v7 offset:14336
    ds_read_b64_tr_b16 v[126:127], v7 offset:15360
    v_mfma_f32_16x16x32_bf16 v[164:167], v[100:103], v[92:95], v[164:167]
    s_add_u32 m0, s42, 69632
    s_nop 0
    buffer_load_dwordx4 v9, s[12:15], s41 offen lds
    s_waitcnt lgkmcnt(8)
    v_mfma_f32_16x16x32_bf16 v[136:139], v[104:107], v[88:91], v[136:139]
    ds_read_b64_tr_b16 v[96:97], v4 offset:0
    ds_read_b64_tr_b16 v[98:99], v4 offset:1024
    v_mfma_f32_16x16x32_bf16 v[168:171], v[104:107], v[92:95], v[168:171]
    s_add_u32 s41, s41, 262144
    buffer_load_dwordx4 v[80:83], v1, s[8:11], s40 offen sc1
    v_mfma_f32_16x16x32_bf16 v[140:143], v[108:111], v[88:91], v[140:143]
    ds_read_b64_tr_b16 v[100:101], v5 offset:0
    ds_read_b64_tr_b16 v[102:103], v5 offset:1024
    v_mfma_f32_16x16x32_bf16 v[172:175], v[108:111], v[92:95], v[172:175]
    s_add_u32 s55, s40, 20480
    buffer_load_dwordx4 v[84:87], v1, s[8:11], s55 offen sc1
    s_waitcnt lgkmcnt(8)
    v_mfma_f32_16x16x32_bf16 v[144:147], v[112:115], v[88:91], v[144:147]
    ds_read_b64_tr_b16 v[104:105], v4 offset:2048
    ds_read_b64_tr_b16 v[106:107], v4 offset:3072
    v_mfma_f32_16x16x32_bf16 v[176:179], v[112:115], v[92:95], v[176:179]
    s_add_u32 s40, s40, 1024
    v_mfma_f32_16x16x32_bf16 v[148:151], v[116:119], v[88:91], v[148:151]
    ds_read_b64_tr_b16 v[108:109], v5 offset:2048
    ds_read_b64_tr_b16 v[110:111], v5 offset:3072
    v_mfma_f32_16x16x32_bf16 v[180:183], v[116:119], v[92:95], v[180:183]
    s_waitcnt lgkmcnt(8)
    v_mfma_f32_16x16x32_bf16 v[152:155], v[120:123], v[88:91], v[152:155]
    ds_read_b64_tr_b16 v[112:113], v4 offset:4096
    ds_read_b64_tr_b16 v[114:115], v4 offset:5120
    v_mfma_f32_16x16x32_bf16 v[184:187], v[120:123], v[92:95], v[184:187]
    v_mfma_f32_16x16x32_bf16 v[156:159], v[124:127], v[88:91], v[156:159]
    ds_read_b64_tr_b16 v[116:117], v5 offset:4096
    ds_read_b64_tr_b16 v[118:119], v5 offset:5120
    v_mfma_f32_16x16x32_bf16 v[188:191], v[124:127], v[92:95], v[188:191]
    s_sub_u32 s43, s43, 1
    s_cmp_lg_u32 s43, 0
    s_cbranch_scc1 gk_loop
    s_waitcnt vmcnt(0) lgkmcnt(0)
    s_barrier
    s_lshl_b32 s84, s45, 14
    s_mul_i32 s55, s73, 1064960
    s_add_u32 s84, s84, s55
    s_add_u32 s84, s84, 50331648
    v_cvt_pk_bf16_f32 v88, v128, v129
    v_cvt_pk_bf16_f32 v89, v130, v131
    v_cvt_pk_bf16_f32 v90, v132, v133
    v_cvt_pk_bf16_f32 v91, v134, v135
    buffer_store_dwordx4 v[88:91], v1, s[8:11], s84 offen offset:0 sc1
    v_cvt_pk_bf16_f32 v92, v136, v137
    v_cvt_pk_bf16_f32 v93, v138, v139
    v_cvt_pk_bf16_f32 v94, v140, v141
    v_cvt_pk_bf16_f32 v95, v142, v143
    buffer_store_dwordx4 v[92:95], v1, s[8:11], s84 offen offset:1024 sc1
    v_cvt_pk_bf16_f32 v96, v144, v145
    v_cvt_pk_bf16_f32 v97, v146, v147
    v_cvt_pk_bf16_f32 v98, v148, v149
    v_cvt_pk_bf16_f32 v99, v150, v151
    buffer_store_dwordx4 v[96:99], v1, s[8:11], s84 offen offset:2048 sc1
    v_cvt_pk_bf16_f32 v100, v152, v153
    v_cvt_pk_bf16_f32 v101, v154, v155
    v_cvt_pk_bf16_f32 v102, v156, v157
    v_cvt_pk_bf16_f32 v103, v158, v159
    buffer_store_dwordx4 v[100:103], v1, s[8:11], s84 offen offset:3072 sc1
    v_cvt_pk_bf16_f32 v104, v160, v161
    v_cvt_pk_bf16_f32 v105, v162, v163
    v_cvt_pk_bf16_f32 v106, v164, v165
    v_cvt_pk_bf16_f32 v107, v166, v167
    s_add_u32 s84, s84, 4096
    buffer_store_dwordx4 v[104:107], v1, s[8:11], s84 offen offset:0 sc1
    v_cvt_pk_bf16_f32 v108, v168, v169
    v_cvt_pk_bf16_f32 v109, v170, v171
    v_cvt_pk_bf16_f32 v110, v172, v173
    v_cvt_pk_bf16_f32 v111, v174, v175
    buffer_store_dwordx4 v[108:111], v1, s[8:11], s84 offen offset:1024 sc1
    v_cvt_pk_bf16_f32 v112, v176, v177
    v_cvt_pk_bf16_f32 v113, v178, v179
    v_cvt_pk_bf16_f32 v114, v180, v181
    v_cvt_pk_bf16_f32 v115, v182, v183
    buffer_store_dwordx4 v[112:115], v1, s[8:11], s84 offen offset:2048 sc1
    v_cvt_pk_bf16_f32 v116, v184, v185
    v_cvt_pk_bf16_f32 v117, v186, v187
    v_cvt_pk_bf16_f32 v118, v188, v189
    v_cvt_pk_bf16_f32 v119, v190, v191
    buffer_store_dwordx4 v[116:119], v1, s[8:11], s84 offen offset:3072 sc1
    s_sub_u32 s54, s84, 50335744
    s_lshr_b32 s54, s54, 2
    s_add_u32 s54, s54, 88080384
    v_mov_b64 v[128:129], -1
    v_mov_b64 v[130:131], -1
    buffer_store_dwordx4 v[128:131], v1, s[8:11], s54 offen offset:0 sc1
    buffer_store_dwordx4 v[128:131], v1, s[8:11], s54 offen offset:1024 sc1
    buffer_store_dwordx4 v[128:131], v1, s[8:11], s54 offen offset:2048 sc1
    buffer_store_dwordx4 v[128:131], v1, s[8:11], s54 offen offset:3072 sc1
    s_lshl_b32 s85, s73, 7
    s_lshl_b32 s54, s72, 2
    s_add_u32 s85, s85, s54
    s_add_u32 s85, s85, 2363392
    s_mov_b32 s83, 1
    s_branch rnext_143
dov_142:
    s_load_dwordx2 s[12:13], s[0:1], 32
    s_waitcnt lgkmcnt(0)
    s_and_b32 s13, s13, 0xffff
    s_mov_b32 s14, 5242880
    s_mov_b32 s15, 0x20000
    s_lshl_b32 s45, s72, 2
    s_add_u32 s45, s45, s36
    s_mul_i32 s40, s45, 40960
    s_add_u32 s40, s40, 8388608
    s_lshl_b32 s41, s73, 8
    v_lshlrev_b32 v1, 4, v0
    v_bfe_u32 v2, v0, 4, 2
    v_lshlrev_b32 v8, 3, v2
    v_bfe_u32 v2, v0, 2, 2
    v_lshl_add_u32 v8, v2, 0, v8
    s_mov_b32 s55, 8192
    v_mul_lo_u32 v8, v8, s55
    v_lshrrev_b32 v2, 3, v0
    v_and_b32 v2, 2, v2
    v_xor_b32 v2, v2, v0
    v_and_b32 v2, 3, v2
    v_lshl_add_u32 v8, v2, 4, v8
    v_bfe_u32 v2, v0, 2, 4
    v_lshlrev_b32 v4, 6, v2
    v_bfe_u32 v2, v0, 4, 1
    v_lshl_add_u32 v4, v2, 5, v4
    v_bfe_u32 v2, v0, 0, 2
    v_lshl_add_u32 v4, v2, 3, v4
    v_xor_b32 v5, 32, v4
    v_add_u32 v6, 65536, v4
    v_add_u32 v7, 65536, v5
    s_and_b32 s54, s36, 1
    s_mul_i32 s54, s54, 32768
    s_lshr_b32 s55, s36, 1
    s_lshl_b32 s55, s55, 6
    s_add_u32 s54, s54, s55
    v_add_u32 v8, s54, v8
    v_add_u32 v9, 128, v8
    v_add_u32 v8, 0, v8
    s_lshl_b32 s42, s36, 10
    s_add_u32 m0, s42, 0
    s_nop 0
    buffer_load_dwordx4 v8, s[12:15], s41 offen lds
    s_add_u32 m0, s42, 4096
    s_nop 0
    buffer_load_dwordx4 v9, s[12:15], s41 offen lds
    s_add_u32 s41, s41, 262144
    s_add_u32 m0, s42, 8192
    s_nop 0
    buffer_load_dwordx4 v8, s[12:15], s41 offen lds
    s_add_u32 m0, s42, 12288
    s_nop 0
    buffer_load_dwordx4 v9, s[12:15], s41 offen lds
    s_add_u32 s41, s41, 262144
    s_add_u32 m0, s42, 16384
    s_nop 0
    buffer_load_dwordx4 v8, s[12:15], s41 offen lds
    s_add_u32 m0, s42, 20480
    s_nop 0
    buffer_load_dwordx4 v9, s[12:15], s41 offen lds
    s_add_u32 s41, s41, 262144
    s_add_u32 m0, s42, 24576
    s_nop 0
    buffer_load_dwordx4 v8, s[12:15], s41 offen lds
    s_add_u32 m0, s42, 28672
    s_nop 0
    buffer_load_dwordx4 v9, s[12:15], s41 offen lds
    s_add_u32 s41, s41, 262144
    s_add_u32 m0, s42, 32768
    s_nop 0
    buffer_load_dwordx4 v8, s[12:15], s41 offen lds
    s_add_u32 m0, s42, 36864
    s_nop 0
    buffer_load_dwordx4 v9, s[12:15], s41 offen lds
    s_add_u32 s41, s41, 262144
    s_add_u32 m0, s42, 40960
    s_nop 0
    buffer_load_dwordx4 v8, s[12:15], s41 offen lds
    s_add_u32 m0, s42, 45056
    s_nop 0
    buffer_load_dwordx4 v9, s[12:15], s41 offen lds
    s_add_u32 s41, s41, 262144
    s_add_u32 m0, s42, 49152
    s_nop 0
    buffer_load_dwordx4 v8, s[12:15], s41 offen lds
    s_add_u32 m0, s42, 53248
    s_nop 0
    buffer_load_dwordx4 v9, s[12:15], s41 offen lds
    s_add_u32 s41, s41, 262144
    s_add_u32 m0, s42, 57344
    s_nop 0
    buffer_load_dwordx4 v8, s[12:15], s41 offen lds
    s_add_u32 m0, s42, 61440
    s_nop 0
    buffer_load_dwordx4 v9, s[12:15], s41 offen lds
    s_add_u32 s41, s41, 262144
    s_add_u32 m0, s42, 65536
    s_nop 0
    buffer_load_dwordx4 v8, s[12:15], s41 offen lds
    s_add_u32 m0, s42, 69632
    s_nop 0
    buffer_load_dwordx4 v9, s[12:15], s41 offen lds
    s_add_u32 s41, s41, 262144
    s_cmp_eq_u32 s71, 0
    s_cbranch_scc1 e_154
    s_waitcnt vmcnt(18) lgkmcnt(0)
    s_barrier
    s_cmp_lg_u32 s36, 0
    s_cbranch_scc1 sg_155
    v_mov_b32 v14, 0
    v_mov_b32 v15, s83
    s_mov_b64 exec, 1
    buffer_atomic_add v15, v14, s[8:11], s85 offen
    s_mov_b64 exec, -1
sg_155:
e_154:
    s_lshl_b32 s75, s72, 7
    s_cmp_eq_u32 s71, 0
    s_cselect_b32 s75, s75, 0
    s_cselect_b32 s56, 0, 15
    s_add_u32 s75, s75, 2360320
    v_min_u32 v13, s56, v0
    s_cmp_lg_u32 s36, 0
    s_cbranch_scc1 wd_157
    v_min_u32 v14, 15, v13
    v_mul_u32_u24 v14, 128, v14
wt_156:
    buffer_load_dword v15, v14, s[8:11], s75 offen sc1
    s_waitcnt vmcnt(0)
    v_cmp_gt_u32 vcc, 8, v15
    s_nop 0
    s_cbranch_vccz wd_157
    s_sleep 3
    s_sub_u32 s53, s53, 1
    s_cbranch_scc0 wt_156
    s_mov_b32 s53, 0
wd_157:
    s_barrier
    buffer_load_dwordx4 v[16:19], v1, s[8:11], s40 offen sc1
    s_add_u32 s55, s40, 20480
    buffer_load_dwordx4 v[20:23], v1, s[8:11], s55 offen sc1
    s_add_u32 s40, s40, 1024
    buffer_load_dwordx4 v[24:27], v1, s[8:11], s40 offen sc1
    s_add_u32 s55, s40, 20480
    buffer_load_dwordx4 v[28:31], v1, s[8:11], s55 offen sc1
    s_add_u32 s40, s40, 1024
    buffer_load_dwordx4 v[32:35], v1, s[8:11], s40 offen sc1
    s_add_u32 s55, s40, 20480
    buffer_load_dwordx4 v[36:39], v1, s[8:11], s55 offen sc1
    s_add_u32 s40, s40, 1024
    buffer_load_dwordx4 v[40:43], v1, s[8:11], s40 offen sc1
    s_add_u32 s55, s40, 20480
    buffer_load_dwordx4 v[44:47], v1, s[8:11], s55 offen sc1
    s_add_u32 s40, s40, 1024
    buffer_load_dwordx4 v[48:51], v1, s[8:11], s40 offen sc1
    s_add_u32 s55, s40, 20480
    buffer_load_dwordx4 v[52:55], v1, s[8:11], s55 offen sc1
    s_add_u32 s40, s40, 1024
    buffer_load_dwordx4 v[56:59], v1, s[8:11], s40 offen sc1
    s_add_u32 s55, s40, 20480
    buffer_load_dwordx4 v[60:63], v1, s[8:11], s55 offen sc1
    s_add_u32 s40, s40, 1024
    buffer_load_dwordx4 v[64:67], v1, s[8:11], s40 offen sc1
    s_add_u32 s55, s40, 20480
    buffer_load_dwordx4 v[68:71], v1, s[8:11], s55 offen sc1
    s_add_u32 s40, s40, 1024
    buffer_load_dwordx4 v[72:75], v1, s[8:11], s40 offen sc1
    s_add_u32 s55, s40, 20480
    buffer_load_dwordx4 v[76:79], v1, s[8:11], s55 offen sc1
    s_add_u32 s40, s40, 1024
    buffer_load_dwordx4 v[80:83], v1, s[8:11], s40 offen sc1
    s_add_u32 s55, s40, 20480
    buffer_load_dwordx4 v[84:87], v1, s[8:11], s55 offen sc1
    s_add_u32 s40, s40, 1024
    s_waitcnt vmcnt(16)
    s_barrier
    ds_read_b64_tr_b16 v[96:97], v4 offset:0
    ds_read_b64_tr_b16 v[98:99], v4 offset:1024
    ds_read_b64_tr_b16 v[100:101], v5 offset:0
    ds_read_b64_tr_b16 v[102:103], v5 offset:1024
    ds_read_b64_tr_b16 v[104:105], v4 offset:2048
    ds_read_b64_tr_b16 v[106:107], v4 offset:3072
    ds_read_b64_tr_b16 v[108:109], v5 offset:2048
    ds_read_b64_tr_b16 v[110:111], v5 offset:3072
    ds_read_b64_tr_b16 v[112:113], v4 offset:4096
    ds_read_b64_tr_b16 v[114:115], v4 offset:5120
    ds_read_b64_tr_b16 v[116:117], v5 offset:4096
    ds_read_b64_tr_b16 v[118:119], v5 offset:5120
    s_waitcnt vmcnt(14)
    s_barrier
    s_waitcnt lgkmcnt(8)
    v_mfma_f32_16x16x32_bf16 v[128:131], v[16:19], v[96:99], 0
    ds_read_b64_tr_b16 v[120:121], v4 offset:6144
    ds_read_b64_tr_b16 v[122:123], v4 offset:7168
    v_mfma_f32_16x16x32_bf16 v[160:163], v[20:23], v[96:99], 0
    s_add_u32 m0, s42, 73728
    s_nop 0
    buffer_load_dwordx4 v8, s[12:15], s41 offen lds
    v_mfma_f32_16x16x32_bf16 v[132:135], v[16:19], v[100:103], 0
    ds_read_b64_tr_b16 v[124:125], v5 offset:6144
    ds_read_b64_tr_b16 v[126:127], v5 offset:7168
    v_mfma_f32_16x16x32_bf16 v[164:167], v[20:23], v[100:103], 0
    s_add_u32 m0, s42, 77824
    s_nop 0
    buffer_load_dwordx4 v9, s[12:15], s41 offen lds
    s_waitcnt lgkmcnt(8)
    v_mfma_f32_16x16x32_bf16 v[136:139], v[16:19], v[104:107], 0
    ds_read_b64_tr_b16 v[96:97], v4 offset:8192
    ds_read_b64_tr_b16 v[98:99], v4 offset:9216
    v_mfma_f32_16x16x32_bf16 v[168:171], v[20:23], v[104:107], 0
    s_add_u32 s41, s41, 262144
    buffer_load_dwordx4 v[88:91], v1, s[8:11], s40 offen sc1
    v_mfma_f32_16x16x32_bf16 v[140:143], v[16:19], v[108:111], 0
    ds_read_b64_tr_b16 v[100:101], v5 offset:8192
    ds_read_b64_tr_b16 v[102:103], v5 offset:9216
    v_mfma_f32_16x16x32_bf16 v[172:175], v[20:23], v[108:111], 0
    s_add_u32 s55, s40, 20480
    buffer_load_dwordx4 v[92:95], v1, s[8:11], s55 offen sc1
    s_waitcnt lgkmcnt(8)
    v_mfma_f32_16x16x32_bf16 v[144:147], v[16:19], v[112:115], 0
    ds_read_b64_tr_b16 v[104:105], v4 offset:10240
    ds_read_b64_tr_b16 v[106:107], v4 offset:11264
    v_mfma_f32_16x16x32_bf16 v[176:179], v[20:23], v[112:115], 0
    s_add_u32 s40, s40, 1024
    v_mfma_f32_16x16x32_bf16 v[148:151], v[16:19], v[116:119], 0
    ds_read_b64_tr_b16 v[108:109], v5 offset:10240
    ds_read_b64_tr_b16 v[110:111], v5 offset:11264
    v_mfma_f32_16x16x32_bf16 v[180:183], v[20:23], v[116:119], 0
    s_waitcnt lgkmcnt(8)
    v_mfma_f32_16x16x32_bf16 v[152:155], v[16:19], v[120:123], 0
    ds_read_b64_tr_b16 v[112:113], v4 offset:12288
    ds_read_b64_tr_b16 v[114:115], v4 offset:13312
    v_mfma_f32_16x16x32_bf16 v[184:187], v[20:23], v[120:123], 0
    v_mfma_f32_16x16x32_bf16 v[156:159], v[16:19], v[124:127], 0
    ds_read_b64_tr_b16 v[116:117], v5 offset:12288
    ds_read_b64_tr_b16 v[118:119], v5 offset:13312
    v_mfma_f32_16x16x32_bf16 v[188:191], v[20:23], v[124:127], 0
    s_waitcnt vmcnt(16)
    s_barrier
    s_waitcnt lgkmcnt(8)
    v_mfma_f32_16x16x32_bf16 v[128:131], v[24:27], v[96:99], v[128:131]
    ds_read_b64_tr_b16 v[120:121], v4 offset:14336
    ds_read_b64_tr_b16 v[122:123], v4 offset:15360
    v_mfma_f32_16x16x32_bf16 v[160:163], v[28:31], v[96:99], v[160:163]
    s_add_u32 m0, s42, 0
    s_nop 0
    buffer_load_dwordx4 v8, s[12:15], s41 offen lds
    v_mfma_f32_16x16x32_bf16 v[132:135], v[24:27], v[100:103], v[132:135]
    ds_read_b64_tr_b16 v[124:125], v5 offset:14336
    ds_read_b64_tr_b16 v[126:127], v5 offset:15360
    v_mfma_f32_16x16x32_bf16 v[164:167], v[28:31], v[100:103], v[164:167]
    s_add_u32 m0, s42, 4096
    s_nop 0
    buffer_load_dwordx4 v9, s[12:15], s41 offen lds
    s_waitcnt lgkmcnt(8)
    v_mfma_f32_16x16x32_bf16 v[136:139], v[24:27], v[104:107], v[136:139]
    ds_read_b64_tr_b16 v[96:97], v4 offset:16384
    ds_read_b64_tr_b16 v[98:99], v4 offset:17408
    v_mfma_f32_16x16x32_bf16 v[168:171], v[28:31], v[104:107], v[168:171]
    s_add_u32 s41, s41, 262144
    buffer_load_dwordx4 v[16:19], v1, s[8:11], s40 offen sc1
    v_mfma_f32_16x16x32_bf16 v[140:143], v[24:27], v[108:111], v[140:143]
    ds_read_b64_tr_b16 v[100:101], v5 offset:16384
    ds_read_b64_tr_b16 v[102:103], v5 offset:17408
    v_mfma_f32_16x16x32_bf16 v[172:175], v[28:31], v[108:111], v[172:175]
    s_add_u32 s55, s40, 20480
    buffer_load_dwordx4 v[20:23], v1, s[8:11], s55 offen sc1
    s_waitcnt lgkmcnt(8)
    v_mfma_f32_16x16x32_bf16 v[144:147], v[24:27], v[112:115], v[144:147]
    ds_read_b64_tr_b16 v[104:105], v4 offset:18432
    ds_read_b64_tr_b16 v[106:107], v4 offset:19456
    v_mfma_f32_16x16x32_bf16 v[176:179], v[28:31], v[112:115], v[176:179]
    s_add_u32 s40, s40, 1024
    v_mfma_f32_16x16x32_bf16 v[148:151], v[24:27], v[116:119], v[148:151]
    ds_read_b64_tr_b16 v[108:109], v5 offset:18432
    ds_read_b64_tr_b16 v[110:111], v5 offset:19456
    v_mfma_f32_16x16x32_bf16 v[180:183], v[28:31], v[116:119], v[180:183]
    s_waitcnt lgkmcnt(8)
    v_mfma_f32_16x16x32_bf16 v[152:155], v[24:27], v[120:123], v[152:155]
    ds_read_b64_tr_b16 v[112:113], v4 offset:20480
    ds_read_b64_tr_b16 v[114:115], v4 offset:21504
    v_mfma_f32_16x16x32_bf16 v[184:187], v[28:31], v[120:123], v[184:187]
    v_mfma_f32_16x16x32_bf16 v[156:159], v[24:27], v[124:127], v[156:159]
    ds_read_b64_tr_b16 v[116:117], v5 offset:20480
    ds_read_b64_tr_b16 v[118:119], v5 offset:21504
    v_mfma_f32_16x16x32_bf16 v[188:191], v[28:31], v[124:127], v[188:191]
    s_waitcnt vmcnt(18)
    s_barrier
    s_waitcnt lgkmcnt(8)
    v_mfma_f32_16x16x32_bf16 v[128:131], v[32:35], v[96:99], v[128:131]
    ds_read_b64_tr_b16 v[120:121], v4 offset:22528
    ds_read_b64_tr_b16 v[122:123], v4 offset:23552
    v_mfma_f32_16x16x32_bf16 v[160:163], v[36:39], v[96:99], v[160:163]
    s_add_u32 m0, s42, 8192
    s_nop 0
    buffer_load_dwordx4 v8, s[12:15], s41 offen lds
    v_mfma_f32_16x16x32_bf16 v[132:135], v[32:35], v[100:103], v[132:135]
    ds_read_b64_tr_b16 v[124:125], v5 offset:22528
    ds_read_b64_tr_b16 v[126:127], v5 offset:23552
    v_mfma_f32_16x16x32_bf16 v[164:167], v[36:39], v[100:103], v[164:167]
    s_add_u32 m0, s42, 12288
    s_nop 0
    buffer_load_dwordx4 v9, s[12:15], s41 offen lds
    s_waitcnt lgkmcnt(8)
    v_mfma_f32_16x16x32_bf16 v[136:139], v[32:35], v[104:107], v[136:139]
    ds_read_b64_tr_b16 v[96:97], v4 offset:24576
    ds_read_b64_tr_b16 v[98:99], v4 offset:25600
    v_mfma_f32_16x16x32_bf16 v[168:171], v[36:39], v[104:107], v[168:171]
    s_add_u32 s41, s41, 262144
    buffer_load_dwordx4 v[24:27], v1, s[8:11], s40 offen sc1
    v_mfma_f32_16x16x32_bf16 v[140:143], v[32:35], v[108:111], v[140:143]
    ds_read_b64_tr_b16 v[100:101], v5 offset:24576
    ds_read_b64_tr_b16 v[102:103], v5 offset:25600
    v_mfma_f32_16x16x32_bf16 v[172:175], v[36:39], v[108:111], v[172:175]
    s_add_u32 s55, s40, 20480
    buffer_load_dwordx4 v[28:31], v1, s[8:11], s55 offen sc1
    s_waitcnt lgkmcnt(8)
    v_mfma_f32_16x16x32_bf16 v[144:147], v[32:35], v[112:115], v[144:147]
    ds_read_b64_tr_b16 v[104:105], v4 offset:26624
    ds_read_b64_tr_b16 v[106:107], v4 offset:27648
    v_mfma_f32_16x16x32_bf16 v[176:179], v[36:39], v[112:115], v[176:179]
    s_add_u32 s40, s40, 1024
    v_mfma_f32_16x16x32_bf16 v[148:151], v[32:35], v[116:119], v[148:151]
    ds_read_b64_tr_b16 v[108:109], v5 offset:26624
    ds_read_b64_tr_b16 v[110:111], v5 offset:27648
    v_mfma_f32_16x16x32_bf16 v[180:183], v[36:39], v[116:119], v[180:183]
    s_waitcnt lgkmcnt(8)
    v_mfma_f32_16x16x32_bf16 v[152:155], v[32:35], v[120:123], v[152:155]
    ds_read_b64_tr_b16 v[112:113], v4 offset:28672
    ds_read_b64_tr_b16 v[114:115], v4 offset:29696
    v_mfma_f32_16x16x32_bf16 v[184:187], v[36:39], v[120:123], v[184:187]
    v_mfma_f32_16x16x32_bf16 v[156:159], v[32:35], v[124:127], v[156:159]
    ds_read_b64_tr_b16 v[116:117], v5 offset:28672
    ds_read_b64_tr_b16 v[118:119], v5 offset:29696
    v_mfma_f32_16x16x32_bf16 v[188:191], v[36:39], v[124:127], v[188:191]
    s_waitcnt vmcnt(20)
    s_barrier
    s_waitcnt lgkmcnt(8)
    v_mfma_f32_16x16x32_bf16 v[128:131], v[40:43], v[96:99], v[128:131]
    ds_read_b64_tr_b16 v[120:121], v4 offset:30720
    ds_read_b64_tr_b16 v[122:123], v4 offset:31744
    v_mfma_f32_16x16x32_bf16 v[160:163], v[44:47], v[96:99], v[160:163]
    s_add_u32 m0, s42, 16384
    s_nop 0
    buffer_load_dwordx4 v8, s[12:15], s41 offen lds
    v_mfma_f32_16x16x32_bf16 v[132:135], v[40:43], v[100:103], v[132:135]
    ds_read_b64_tr_b16 v[124:125], v5 offset:30720
    ds_read_b64_tr_b16 v[126:127], v5 offset:31744
    v_mfma_f32_16x16x32_bf16 v[164:167], v[44:47], v[100:103], v[164:167]
    s_add_u32 m0, s42, 20480
    s_nop 0
    buffer_load_dwordx4 v9, s[12:15], s41 offen lds
    s_waitcnt lgkmcnt(8)
    v_mfma_f32_16x16x32_bf16 v[136:139], v[40:43], v[104:107], v[136:139]
    ds_read_b64_tr_b16 v[96:97], v4 offset:32768
    ds_read_b64_tr_b16 v[98:99], v4 offset:33792
    v_mfma_f32_16x16x32_bf16 v[168:171], v[44:47], v[104:107], v[168:171]
    s_add_u32 s41, s41, 262144
    buffer_load_dwordx4 v[32:35], v1, s[8:11], s40 offen sc1
    v_mfma_f32_16x16x32_bf16 v[140:143], v[40:43], v[108:111], v[140:143]
    ds_read_b64_tr_b16 v[100:101], v5 offset:32768
    ds_read_b64_tr_b16 v[102:103], v5 offset:33792
    v_mfma_f32_16x16x32_bf16 v[172:175], v[44:47], v[108:111], v[172:175]
    s_add_u32 s55, s40, 20480
    buffer_load_dwordx4 v[36:39], v1, s[8:11], s55 offen sc1
    s_waitcnt lgkmcnt(8)
    v_mfma_f32_16x16x32_bf16 v[144:147], v[40:43], v[112:115], v[144:147]
    ds_read_b64_tr_b16 v[104:105], v4 offset:34816
    ds_read_b64_tr_b16 v[106:107], v4 offset:35840
    v_mfma_f32_16x16x32_bf16 v[176:179], v[44:47], v[112:115], v[176:179]
    s_add_u32 s40, s40, 1024
    v_mfma_f32_16x16x32_bf16 v[148:151], v[40:43], v[116:119], v[148:151]
    ds_read_b64_tr_b16 v[108:109], v5 offset:34816
    ds_read_b64_tr_b16 v[110:111], v5 offset:35840
    v_mfma_f32_16x16x32_bf16 v[180:183], v[44:47], v[116:119], v[180:183]
    s_waitcnt lgkmcnt(8)
    v_mfma_f32_16x16x32_bf16 v[152:155], v[40:43], v[120:123], v[152:155]
    ds_read_b64_tr_b16 v[112:113], v4 offset:36864
    ds_read_b64_tr_b16 v[114:115], v4 offset:37888
    v_mfma_f32_16x16x32_bf16 v[184:187], v[44:47], v[120:123], v[184:187]
    v_mfma_f32_16x16x32_bf16 v[156:159], v[40:43], v[124:127], v[156:159]
    ds_read_b64_tr_b16 v[116:117], v5 offset:36864
    ds_read_b64_tr_b16 v[118:119], v5 offset:37888
    v_mfma_f32_16x16x32_bf16 v[188:191], v[44:47], v[124:127], v[188:191]
    s_waitcnt vmcnt(22)
    s_barrier
    s_waitcnt lgkmcnt(8)
    v_mfma_f32_16x16x32_bf16 v[128:131], v[48:51], v[96:99], v[128:131]
    ds_read_b64_tr_b16 v[120:121], v4 offset:38912
    ds_read_b64_tr_b16 v[122:123], v4 offset:39936
    v_mfma_f32_16x16x32_bf16 v[160:163], v[52:55], v[96:99], v[160:163]
    s_add_u32 m0, s42, 24576
    s_nop 0
    buffer_load_dwordx4 v8, s[12:15], s41 offen lds
    v_mfma_f32_16x16x32_bf16 v[132:135], v[48:51], v[100:103], v[132:135]
    ds_read_b64_tr_b16 v[124:125], v5 offset:38912
    ds_read_b64_tr_b16 v[126:127], v5 offset:39936
    v_mfma_f32_16x16x32_bf16 v[164:167], v[52:55], v[100:103], v[164:167]
    s_add_u32 m0, s42, 28672
    s_nop 0
    buffer_load_dwordx4 v9, s[12:15], s41 offen lds
    s_waitcnt lgkmcnt(8)
    v_mfma_f32_16x16x32_bf16 v[136:139], v[48:51], v[104:107], v[136:139]
    ds_read_b64_tr_b16 v[96:97], v4 offset:40960
    ds_read_b64_tr_b16 v[98:99], v4 offset:41984
    v_mfma_f32_16x16x32_bf16 v[168:171], v[52:55], v[104:107], v[168:171]
    s_add_u32 s41, s41, 262144
    buffer_load_dwordx4 v[40:43], v1, s[8:11], s40 offen sc1
    v_mfma_f32_16x16x32_bf16 v[140:143], v[48:51], v[108:111], v[140:143]
    ds_read_b64_tr_b16 v[100:101], v5 offset:40960
    ds_read_b64_tr_b16 v[102:103], v5 offset:41984
    v_mfma_f32_16x16x32_bf16 v[172:175], v[52:55], v[108:111], v[172:175]
    s_add_u32 s55, s40, 20480
    buffer_load_dwordx4 v[44:47], v1, s[8:11], s55 offen sc1
    s_waitcnt lgkmcnt(8)
    v_mfma_f32_16x16x32_bf16 v[144:147], v[48:51], v[112:115], v[144:147]
    ds_read_b64_tr_b16 v[104:105], v4 offset:43008
    ds_read_b64_tr_b16 v[106:107], v4 offset:44032
    v_mfma_f32_16x16x32_bf16 v[176:179], v[52:55], v[112:115], v[176:179]
    s_add_u32 s40, s40, 1024
    v_mfma_f32_16x16x32_bf16 v[148:151], v[48:51], v[116:119], v[148:151]
    ds_read_b64_tr_b16 v[108:109], v5 offset:43008
    ds_read_b64_tr_b16 v[110:111], v5 offset:44032
    v_mfma_f32_16x16x32_bf16 v[180:183], v[52:55], v[116:119], v[180:183]
    s_waitcnt lgkmcnt(8)
    v_mfma_f32_16x16x32_bf16 v[152:155], v[48:51], v[120:123], v[152:155]
    ds_read_b64_tr_b16 v[112:113], v4 offset:45056
    ds_read_b64_tr_b16 v[114:115], v4 offset:46080
    v_mfma_f32_16x16x32_bf16 v[184:187], v[52:55], v[120:123], v[184:187]
    v_mfma_f32_16x16x32_bf16 v[156:159], v[48:51], v[124:127], v[156:159]
    ds_read_b64_tr_b16 v[116:117], v5 offset:45056
    ds_read_b64_tr_b16 v[118:119], v5 offset:46080
    v_mfma_f32_16x16x32_bf16 v[188:191], v[52:55], v[124:127], v[188:191]
    s_waitcnt vmcnt(24)
    s_barrier
    s_waitcnt lgkmcnt(8)
    v_mfma_f32_16x16x32_bf16 v[128:131], v[56:59], v[96:99], v[128:131]
    ds_read_b64_tr_b16 v[120:121], v4 offset:47104
    ds_read_b64_tr_b16 v[122:123], v4 offset:48128
    v_mfma_f32_16x16x32_bf16 v[160:163], v[60:63], v[96:99], v[160:163]
    s_add_u32 m0, s42, 32768
    s_nop 0
    buffer_load_dwordx4 v8, s[12:15], s41 offen lds
    v_mfma_f32_16x16x32_bf16 v[132:135], v[56:59], v[100:103], v[132:135]
    ds_read_b64_tr_b16 v[124:125], v5 offset:47104
    ds_read_b64_tr_b16 v[126:127], v5 offset:48128
    v_mfma_f32_16x16x32_bf16 v[164:167], v[60:63], v[100:103], v[164:167]
    s_add_u32 m0, s42, 36864
    s_nop 0
    buffer_load_dwordx4 v9, s[12:15], s41 offen lds
    s_waitcnt lgkmcnt(8)
    v_mfma_f32_16x16x32_bf16 v[136:139], v[56:59], v[104:107], v[136:139]
    ds_read_b64_tr_b16 v[96:97], v4 offset:49152
    ds_read_b64_tr_b16 v[98:99], v4 offset:50176
    v_mfma_f32_16x16x32_bf16 v[168:171], v[60:63], v[104:107], v[168:171]
    s_add_u32 s41, s41, 262144
    buffer_load_dwordx4 v[48:51], v1, s[8:11], s40 offen sc1
    v_mfma_f32_16x16x32_bf16 v[140:143], v[56:59], v[108:111], v[140:143]
    ds_read_b64_tr_b16 v[100:101], v5 offset:49152
    ds_read_b64_tr_b16 v[102:103], v5 offset:50176
    v_mfma_f32_16x16x32_bf16 v[172:175], v[60:63], v[108:111], v[172:175]
    s_add_u32 s55, s40, 20480
    buffer_load_dwordx4 v[52:55], v1, s[8:11], s55 offen sc1
    s_waitcnt lgkmcnt(8)
    v_mfma_f32_16x16x32_bf16 v[144:147], v[56:59], v[112:115], v[144:147]
    ds_read_b64_tr_b16 v[104:105], v4 offset:51200
    ds_read_b64_tr_b16 v[106:107], v4 offset:52224
    v_mfma_f32_16x16x32_bf16 v[176:179], v[60:63], v[112:115], v[176:179]
    s_add_u32 s40, s40, 1024
    v_mfma_f32_16x16x32_bf16 v[148:151], v[56:59], v[116:119], v[148:151]
    ds_read_b64_tr_b16 v[108:109], v5 offset:51200
    ds_read_b64_tr_b16 v[110:111], v5 offset:52224
    v_mfma_f32_16x16x32_bf16 v[180:183], v[60:63], v[116:119], v[180:183]
    s_waitcnt lgkmcnt(8)
    v_mfma_f32_16x16x32_bf16 v[152:155], v[56:59], v[120:123], v[152:155]
    ds_read_b64_tr_b16 v[112:113], v4 offset:53248
    ds_read_b64_tr_b16 v[114:115], v4 offset:54272
    v_mfma_f32_16x16x32_bf16 v[184:187], v[60:63], v[120:123], v[184:187]
    v_mfma_f32_16x16x32_bf16 v[156:159], v[56:59], v[124:127], v[156:159]
    ds_read_b64_tr_b16 v[116:117], v5 offset:53248
    ds_read_b64_tr_b16 v[118:119], v5 offset:54272
    v_mfma_f32_16x16x32_bf16 v[188:191], v[60:63], v[124:127], v[188:191]
    s_waitcnt vmcnt(26)
    s_barrier
    s_waitcnt lgkmcnt(8)
    v_mfma_f32_16x16x32_bf16 v[128:131], v[64:67], v[96:99], v[128:131]
    ds_read_b64_tr_b16 v[120:121], v4 offset:55296
    ds_read_b64_tr_b16 v[122:123], v4 offset:56320
    v_mfma_f32_16x16x32_bf16 v[160:163], v[68:71], v[96:99], v[160:163]
    s_add_u32 m0, s42, 40960
    s_nop 0
    buffer_load_dwordx4 v8, s[12:15], s41 offen lds
    v_mfma_f32_16x16x32_bf16 v[132:135], v[64:67], v[100:103], v[132:135]
    ds_read_b64_tr_b16 v[124:125], v5 offset:55296
    ds_read_b64_tr_b16 v[126:127], v5 offset:56320
    v_mfma_f32_16x16x32_bf16 v[164:167], v[68:71], v[100:103], v[164:167]
    s_add_u32 m0, s42, 45056
    s_nop 0
    buffer_load_dwordx4 v9, s[12:15], s41 offen lds
    s_waitcnt lgkmcnt(8)
    v_mfma_f32_16x16x32_bf16 v[136:139], v[64:67], v[104:107], v[136:139]
    ds_read_b64_tr_b16 v[96:97], v4 offset:57344
    ds_read_b64_tr_b16 v[98:99], v4 offset:58368
    v_mfma_f32_16x16x32_bf16 v[168:171], v[68:71], v[104:107], v[168:171]
    s_add_u32 s41, s41, 262144
    buffer_load_dwordx4 v[56:59], v1, s[8:11], s40 offen sc1
    v_mfma_f32_16x16x32_bf16 v[140:143], v[64:67], v[108:111], v[140:143]
    ds_read_b64_tr_b16 v[100:101], v5 offset:57344
    ds_read_b64_tr_b16 v[102:103], v5 offset:58368
    v_mfma_f32_16x16x32_bf16 v[172:175], v[68:71], v[108:111], v[172:175]
    s_add_u32 s55, s40, 20480
    buffer_load_dwordx4 v[60:63], v1, s[8:11], s55 offen sc1
    s_waitcnt lgkmcnt(8)
    v_mfma_f32_16x16x32_bf16 v[144:147], v[64:67], v[112:115], v[144:147]
    ds_read_b64_tr_b16 v[104:105], v4 offset:59392
    ds_read_b64_tr_b16 v[106:107], v4 offset:60416
    v_mfma_f32_16x16x32_bf16 v[176:179], v[68:71], v[112:115], v[176:179]
    s_add_u32 s40, s40, 1024
    v_mfma_f32_16x16x32_bf16 v[148:151], v[64:67], v[116:119], v[148:151]
    ds_read_b64_tr_b16 v[108:109], v5 offset:59392
    ds_read_b64_tr_b16 v[110:111], v5 offset:60416
    v_mfma_f32_16x16x32_bf16 v[180:183], v[68:71], v[116:119], v[180:183]
    s_waitcnt lgkmcnt(8)
    v_mfma_f32_16x16x32_bf16 v[152:155], v[64:67], v[120:123], v[152:155]
    ds_read_b64_tr_b16 v[112:113], v4 offset:61440
    ds_read_b64_tr_b16 v[114:115], v4 offset:62464
    v_mfma_f32_16x16x32_bf16 v[184:187], v[68:71], v[120:123], v[184:187]
    v_mfma_f32_16x16x32_bf16 v[156:159], v[64:67], v[124:127], v[156:159]
    ds_read_b64_tr_b16 v[116:117], v5 offset:61440
    ds_read_b64_tr_b16 v[118:119], v5 offset:62464
    v_mfma_f32_16x16x32_bf16 v[188:191], v[68:71], v[124:127], v[188:191]
    s_waitcnt vmcnt(28)
    s_barrier
    s_waitcnt lgkmcnt(8)
    v_mfma_f32_16x16x32_bf16 v[128:131], v[72:75], v[96:99], v[128:131]
    ds_read_b64_tr_b16 v[120:121], v4 offset:63488
    ds_read_b64_tr_b16 v[122:123], v4 offset:64512
    v_mfma_f32_16x16x32_bf16 v[160:163], v[76:79], v[96:99], v[160:163]
    s_add_u32 m0, s42, 49152
    s_nop 0
    buffer_load_dwordx4 v8, s[12:15], s41 offen lds
    v_mfma_f32_16x16x32_bf16 v[132:135], v[72:75], v[100:103], v[132:135]
    ds_read_b64_tr_b16 v[124:125], v5 offset:63488
    ds_read_b64_tr_b16 v[126:127], v5 offset:64512
    v_mfma_f32_16x16x32_bf16 v[164:167], v[76:79], v[100:103], v[164:167]
    s_add_u32 m0, s42, 53248
    s_nop 0
    buffer_load_dwordx4 v9, s[12:15], s41 offen lds
    s_waitcnt lgkmcnt(8)
    v_mfma_f32_16x16x32_bf16 v[136:139], v[72:75], v[104:107], v[136:139]
    ds_read_b64_tr_b16 v[96:97], v6 offset:0
    ds_read_b64_tr_b16 v[98:99], v6 offset:1024
    v_mfma_f32_16x16x32_bf16 v[168:171], v[76:79], v[104:107], v[168:171]
    s_add_u32 s41, s41, 262144
    buffer_load_dwordx4 v[64:67], v1, s[8:11], s40 offen sc1
    v_mfma_f32_16x16x32_bf16 v[140:143], v[72:75], v[108:111], v[140:143]
    ds_read_b64_tr_b16 v[100:101], v7 offset:0
    ds_read_b64_tr_b16 v[102:103], v7 offset:1024
    v_mfma_f32_16x16x32_bf16 v[172:175], v[76:79], v[108:111], v[172:175]
    s_add_u32 s55, s40, 20480
    buffer_load_dwordx4 v[68:71], v1, s[8:11], s55 offen sc1
    s_waitcnt lgkmcnt(8)
    v_mfma_f32_16x16x32_bf16 v[144:147], v[72:75], v[112:115], v[144:147]
    ds_read_b64_tr_b16 v[104:105], v6 offset:2048
    ds_read_b64_tr_b16 v[106:107], v6 offset:3072
    v_mfma_f32_16x16x32_bf16 v[176:179], v[76:79], v[112:115], v[176:179]
    s_add_u32 s40, s40, 1024
    v_mfma_f32_16x16x32_bf16 v[148:151], v[72:75], v[116:119], v[148:151]
    ds_read_b64_tr_b16 v[108:109], v7 offset:2048
    ds_read_b64_tr_b16 v[110:111], v7 offset:3072
    v_mfma_f32_16x16x32_bf16 v[180:183], v[76:79], v[116:119], v[180:183]
    s_waitcnt lgkmcnt(8)
    v_mfma_f32_16x16x32_bf16 v[152:155], v[72:75], v[120:123], v[152:155]
    ds_read_b64_tr_b16 v[112:113], v6 offset:4096
    ds_read_b64_tr_b16 v[114:115], v6 offset:5120
    v_mfma_f32_16x16x32_bf16 v[184:187], v[76:79], v[120:123], v[184:187]
    v_mfma_f32_16x16x32_bf16 v[156:159], v[72:75], v[124:127], v[156:159]
    ds_read_b64_tr_b16 v[116:117], v7 offset:4096
    ds_read_b64_tr_b16 v[118:119], v7 offset:5120
    v_mfma_f32_16x16x32_bf16 v[188:191], v[76:79], v[124:127], v[188:191]
    s_waitcnt vmcnt(28)
    s_barrier
    s_waitcnt lgkmcnt(8)
    v_mfma_f32_16x16x32_bf16 v[128:131], v[80:83], v[96:99], v[128:131]
    ds_read_b64_tr_b16 v[120:121], v6 offset:6144
    ds_read_b64_tr_b16 v[122:123], v6 offset:7168
    v_mfma_f32_16x16x32_bf16 v[160:163], v[84:87], v[96:99], v[160:163]
    s_add_u32 m0, s42, 57344
    s_nop 0
    buffer_load_dwordx4 v8, s[12:15], s41 offen lds
    v_mfma_f32_16x16x32_bf16 v[132:135], v[80:83], v[100:103], v[132:135]
    ds_read_b64_tr_b16 v[124:125], v7 offset:6144
    ds_read_b64_tr_b16 v[126:127], v7 offset:7168
    v_mfma_f32_16x16x32_bf16 v[164:167], v[84:87], v[100:103], v[164:167]
    s_add_u32 m0, s42, 61440
    s_nop 0
    buffer_load_dwordx4 v9, s[12:15], s41 offen lds
    s_waitcnt lgkmcnt(8)
    v_mfma_f32_16x16x32_bf16 v[136:139], v[80:83], v[104:107], v[136:139]
    ds_read_b64_tr_b16 v[96:97], v6 offset:8192
    ds_read_b64_tr_b16 v[98:99], v6 offset:9216
    v_mfma_f32_16x16x32_bf16 v[168:171], v[84:87], v[104:107], v[168:171]
    s_add_u32 s41, s41, 262144
    buffer_load_dwordx4 v[72:75], v1, s[8:11], s40 offen sc1
    v_mfma_f32_16x16x32_bf16 v[140:143], v[80:83], v[108:111], v[140:143]
    ds_read_b64_tr_b16 v[100:101], v7 offset:8192
    ds_read_b64_tr_b16 v[102:103], v7 offset:9216
    v_mfma_f32_16x16x32_bf16 v[172:175], v[84:87], v[108:111], v[172:175]
    s_add_u32 s55, s40, 20480
    buffer_load_dwordx4 v[76:79], v1, s[8:11], s55 offen sc1
    s_waitcnt lgkmcnt(8)
    v_mfma_f32_16x16x32_bf16 v[144:147], v[80:83], v[112:115], v[144:147]
    ds_read_b64_tr_b16 v[104:105], v6 offset:10240
    ds_read_b64_tr_b16 v[106:107], v6 offset:11264
    v_mfma_f32_16x16x32_bf16 v[176:179], v[84:87], v[112:115], v[176:179]
    s_add_u32 s40, s40, 1024
    v_mfma_f32_16x16x32_bf16 v[148:151], v[80:83], v[116:119], v[148:151]
    ds_read_b64_tr_b16 v[108:109], v7 offset:10240
    ds_read_b64_tr_b16 v[110:111], v7 offset:11264
    v_mfma_f32_16x16x32_bf16 v[180:183], v[84:87], v[116:119], v[180:183]
    s_waitcnt lgkmcnt(8)
    v_mfma_f32_16x16x32_bf16 v[152:155], v[80:83], v[120:123], v[152:155]
    ds_read_b64_tr_b16 v[112:113], v6 offset:12288
    ds_read_b64_tr_b16 v[114:115], v6 offset:13312
    v_mfma_f32_16x16x32_bf16 v[184:187], v[84:87], v[120:123], v[184:187]
    v_mfma_f32_16x16x32_bf16 v[156:159], v[80:83], v[124:127], v[156:159]
    ds_read_b64_tr_b16 v[116:117], v7 offset:12288
    ds_read_b64_tr_b16 v[118:119], v7 offset:13312
    v_mfma_f32_16x16x32_bf16 v[188:191], v[84:87], v[124:127], v[188:191]
    s_waitcnt vmcnt(28)
    s_barrier
    s_waitcnt lgkmcnt(8)
    v_mfma_f32_16x16x32_bf16 v[128:131], v[88:91], v[96:99], v[128:131]
    ds_read_b64_tr_b16 v[120:121], v6 offset:14336
    ds_read_b64_tr_b16 v[122:123], v6 offset:15360
    v_mfma_f32_16x16x32_bf16 v[160:163], v[92:95], v[96:99], v[160:163]
    s_add_u32 m0, s42, 65536
    s_nop 0
    buffer_load_dwordx4 v8, s[12:15], s41 offen lds
    v_mfma_f32_16x16x32_bf16 v[132:135], v[88:91], v[100:103], v[132:135]
    ds_read_b64_tr_b16 v[124:125], v7 offset:14336
    ds_read_b64_tr_b16 v[126:127], v7 offset:15360
    v_mfma_f32_16x16x32_bf16 v[164:167], v[92:95], v[100:103], v[164:167]
    s_add_u32 m0, s42, 69632
    s_nop 0
    buffer_load_dwordx4 v9, s[12:15], s41 offen lds
    s_waitcnt lgkmcnt(8)
    v_mfma_f32_16x16x32_bf16 v[136:139], v[88:91], v[104:107], v[136:139]
    ds_read_b64_tr_b16 v[96:97], v4 offset:0
    ds_read_b64_tr_b16 v[98:99], v4 offset:1024
    v_mfma_f32_16x16x32_bf16 v[168:171], v[92:95], v[104:107], v[168:171]
    s_add_u32 s41, s41, 262144
    buffer_load_dwordx4 v[80:83], v1, s[8:11], s40 offen sc1
    v_mfma_f32_16x16x32_bf16 v[140:143], v[88:91], v[108:111], v[140:143]
    ds_read_b64_tr_b16 v[100:101], v5 offset:0
    ds_read_b64_tr_b16 v[102:103], v5 offset:1024
    v_mfma_f32_16x16x32_bf16 v[172:175], v[92:95], v[108:111], v[172:175]
    s_add_u32 s55, s40, 20480
    buffer_load_dwordx4 v[84:87], v1, s[8:11], s55 offen sc1
    s_waitcnt lgkmcnt(8)
    v_mfma_f32_16x16x32_bf16 v[144:147], v[88:91], v[112:115], v[144:147]
    ds_read_b64_tr_b16 v[104:105], v4 offset:2048
    ds_read_b64_tr_b16 v[106:107], v4 offset:3072
    v_mfma_f32_16x16x32_bf16 v[176:179], v[92:95], v[112:115], v[176:179]
    s_add_u32 s40, s40, 1024
    v_mfma_f32_16x16x32_bf16 v[148:151], v[88:91], v[116:119], v[148:151]
    ds_read_b64_tr_b16 v[108:109], v5 offset:2048
    ds_read_b64_tr_b16 v[110:111], v5 offset:3072
    v_mfma_f32_16x16x32_bf16 v[180:183], v[92:95], v[116:119], v[180:183]
    s_waitcnt lgkmcnt(8)
    v_mfma_f32_16x16x32_bf16 v[152:155], v[88:91], v[120:123], v[152:155]
    ds_read_b64_tr_b16 v[112:113], v4 offset:4096
    ds_read_b64_tr_b16 v[114:115], v4 offset:5120
    v_mfma_f32_16x16x32_bf16 v[184:187], v[92:95], v[120:123], v[184:187]
    v_mfma_f32_16x16x32_bf16 v[156:159], v[88:91], v[124:127], v[156:159]
    ds_read_b64_tr_b16 v[116:117], v5 offset:4096
    ds_read_b64_tr_b16 v[118:119], v5 offset:5120
    v_mfma_f32_16x16x32_bf16 v[188:191], v[92:95], v[124:127], v[188:191]
    s_mov_b32 s43, 1
.p2align 3
gv_loop:
    s_waitcnt vmcnt(28)
    s_barrier
    s_waitcnt lgkmcnt(8)
    v_mfma_f32_16x16x32_bf16 v[128:131], v[16:19], v[96:99], v[128:131]
    ds_read_b64_tr_b16 v[120:121], v4 offset:6144
    ds_read_b64_tr_b16 v[122:123], v4 offset:7168
    v_mfma_f32_16x16x32_bf16 v[160:163], v[20:23], v[96:99], v[160:163]
    s_add_u32 m0, s42, 73728
    s_nop 0
    buffer_load_dwordx4 v8, s[12:15], s41 offen lds
    v_mfma_f32_16x16x32_bf16 v[132:135], v[16:19], v[100:103], v[132:135]
    ds_read_b64_tr_b16 v[124:125], v5 offset:6144
    ds_read_b64_tr_b16 v[126:127], v5 offset:7168
    v_mfma_f32_16x16x32_bf16 v[164:167], v[20:23], v[100:103], v[164:167]
    s_add_u32 m0, s42, 77824
    s_nop 0
    buffer_load_dwordx4 v9, s[12:15], s41 offen lds
    s_waitcnt lgkmcnt(8)
    v_mfma_f32_16x16x32_bf16 v[136:139], v[16:19], v[104:107], v[136:139]
    ds_read_b64_tr_b16 v[96:97], v4 offset:8192
    ds_read_b64_tr_b16 v[98:99], v4 offset:9216
    v_mfma_f32_16x16x32_bf16 v[168:171], v[20:23], v[104:107], v[168:171]
    s_add_u32 s41, s41, 262144
    buffer_load_dwordx4 v[88:91], v1, s[8:11], s40 offen sc1
    v_mfma_f32_16x16x32_bf16 v[140:143], v[16:19], v[108:111], v[140:143]
    ds_read_b64_tr_b16 v[100:101], v5 offset:8192
    ds_read_b64_tr_b16 v[102:103], v5 offset:9216
    v_mfma_f32_16x16x32_bf16 v[172:175], v[20:23], v[108:111], v[172:175]
    s_add_u32 s55, s40, 20480
    buffer_load_dwordx4 v[92:95], v1, s[8:11], s55 offen sc1
    s_waitcnt lgkmcnt(8)
    v_mfma_f32_16x16x32_bf16 v[144:147], v[16:19], v[112:115], v[144:147]
    ds_read_b64_tr_b16 v[104:105], v4 offset:10240
    ds_read_b64_tr_b16 v[106:107], v4 offset:11264
    v_mfma_f32_16x16x32_bf16 v[176:179], v[20:23], v[112:115], v[176:179]
    s_add_u32 s40, s40, 1024
    v_mfma_f32_16x16x32_bf16 v[148:151], v[16:19], v[116:119], v[148:151]
    ds_read_b64_tr_b16 v[108:109], v5 offset:10240
    ds_read_b64_tr_b16 v[110:111], v5 offset:11264
    v_mfma_f32_16x16x32_bf16 v[180:183], v[20:23], v[116:119], v[180:183]
    s_waitcnt lgkmcnt(8)
    v_mfma_f32_16x16x32_bf16 v[152:155], v[16:19], v[120:123], v[152:155]
    ds_read_b64_tr_b16 v[112:113], v4 offset:12288
    ds_read_b64_tr_b16 v[114:115], v4 offset:13312
    v_mfma_f32_16x16x32_bf16 v[184:187], v[20:23], v[120:123], v[184:187]
    v_mfma_f32_16x16x32_bf16 v[156:159], v[16:19], v[124:127], v[156:159]
    ds_read_b64_tr_b16 v[116:117], v5 offset:12288
    ds_read_b64_tr_b16 v[118:119], v5 offset:13312
    v_mfma_f32_16x16x32_bf16 v[188:191], v[20:23], v[124:127], v[188:191]
    s_waitcnt vmcnt(28)
    s_barrier
    s_waitcnt lgkmcnt(8)
    v_mfma_f32_16x16x32_bf16 v[128:131], v[24:27], v[96:99], v[128:131]
    ds_read_b64_tr_b16 v[120:121], v4 offset:14336
    ds_read_b64_tr_b16 v[122:123], v4 offset:15360
    v_mfma_f32_16x16x32_bf16 v[160:163], v[28:31], v[96:99], v[160:163]
    s_add_u32 m0, s42, 0
    s_nop 0
    buffer_load_dwordx4 v8, s[12:15], s41 offen lds
    v_mfma_f32_16x16x32_bf16 v[132:135], v[24:27], v[100:103], v[132:135]
    ds_read_b64_tr_b16 v[124:125], v5 offset:14336
    ds_read_b64_tr_b16 v[126:127], v5 offset:15360
    v_mfma_f32_16x16x32_bf16 v[164:167], v[28:31], v[100:103], v[164:167]
    s_add_u32 m0, s42, 4096
    s_nop 0
    buffer_load_dwordx4 v9, s[12:15], s41 offen lds
    s_waitcnt lgkmcnt(8)
    v_mfma_f32_16x16x32_bf16 v[136:139], v[24:27], v[104:107], v[136:139]
    ds_read_b64_tr_b16 v[96:97], v4 offset:16384
    ds_read_b64_tr_b16 v[98:99], v4 offset:17408
    v_mfma_f32_16x16x32_bf16 v[168:171], v[28:31], v[104:107], v[168:171]
    s_add_u32 s41, s41, 262144
    buffer_load_dwordx4 v[16:19], v1, s[8:11], s40 offen sc1
    v_mfma_f32_16x16x32_bf16 v[140:143], v[24:27], v[108:111], v[140:143]
    ds_read_b64_tr_b16 v[100:101], v5 offset:16384
    ds_read_b64_tr_b16 v[102:103], v5 offset:17408
    v_mfma_f32_16x16x32_bf16 v[172:175], v[28:31], v[108:111], v[172:175]
    s_add_u32 s55, s40, 20480
    buffer_load_dwordx4 v[20:23], v1, s[8:11], s55 offen sc1
    s_waitcnt lgkmcnt(8)
    v_mfma_f32_16x16x32_bf16 v[144:147], v[24:27], v[112:115], v[144:147]
    ds_read_b64_tr_b16 v[104:105], v4 offset:18432
    ds_read_b64_tr_b16 v[106:107], v4 offset:19456
    v_mfma_f32_16x16x32_bf16 v[176:179], v[28:31], v[112:115], v[176:179]
    s_add_u32 s40, s40, 1024
    v_mfma_f32_16x16x32_bf16 v[148:151], v[24:27], v[116:119], v[148:151]
    ds_read_b64_tr_b16 v[108:109], v5 offset:18432
    ds_read_b64_tr_b16 v[110:111], v5 offset:19456
    v_mfma_f32_16x16x32_bf16 v[180:183], v[28:31], v[116:119], v[180:183]
    s_waitcnt lgkmcnt(8)
    v_mfma_f32_16x16x32_bf16 v[152:155], v[24:27], v[120:123], v[152:155]
    ds_read_b64_tr_b16 v[112:113], v4 offset:20480
    ds_read_b64_tr_b16 v[114:115], v4 offset:21504
    v_mfma_f32_16x16x32_bf16 v[184:187], v[28:31], v[120:123], v[184:187]
    v_mfma_f32_16x16x32_bf16 v[156:159], v[24:27], v[124:127], v[156:159]
    ds_read_b64_tr_b16 v[116:117], v5 offset:20480
    ds_read_b64_tr_b16 v[118:119], v5 offset:21504
    v_mfma_f32_16x16x32_bf16 v[188:191], v[28:31], v[124:127], v[188:191]
    s_waitcnt vmcnt(28)
    s_barrier
    s_waitcnt lgkmcnt(8)
    v_mfma_f32_16x16x32_bf16 v[128:131], v[32:35], v[96:99], v[128:131]
    ds_read_b64_tr_b16 v[120:121], v4 offset:22528
    ds_read_b64_tr_b16 v[122:123], v4 offset:23552
    v_mfma_f32_16x16x32_bf16 v[160:163], v[36:39], v[96:99], v[160:163]
    s_add_u32 m0, s42, 8192
    s_nop 0
    buffer_load_dwordx4 v8, s[12:15], s41 offen lds
    v_mfma_f32_16x16x32_bf16 v[132:135], v[32:35], v[100:103], v[132:135]
    ds_read_b64_tr_b16 v[124:125], v5 offset:22528
    ds_read_b64_tr_b16 v[126:127], v5 offset:23552
    v_mfma_f32_16x16x32_bf16 v[164:167], v[36:39], v[100:103], v[164:167]
    s_add_u32 m0, s42, 12288
    s_nop 0
    buffer_load_dwordx4 v9, s[12:15], s41 offen lds
    s_waitcnt lgkmcnt(8)
    v_mfma_f32_16x16x32_bf16 v[136:139], v[32:35], v[104:107], v[136:139]
    ds_read_b64_tr_b16 v[96:97], v4 offset:24576
    ds_read_b64_tr_b16 v[98:99], v4 offset:25600
    v_mfma_f32_16x16x32_bf16 v[168:171], v[36:39], v[104:107], v[168:171]
    s_add_u32 s41, s41, 262144
    buffer_load_dwordx4 v[24:27], v1, s[8:11], s40 offen sc1
    v_mfma_f32_16x16x32_bf16 v[140:143], v[32:35], v[108:111], v[140:143]
    ds_read_b64_tr_b16 v[100:101], v5 offset:24576
    ds_read_b64_tr_b16 v[102:103], v5 offset:25600
    v_mfma_f32_16x16x32_bf16 v[172:175], v[36:39], v[108:111], v[172:175]
    s_add_u32 s55, s40, 20480
    buffer_load_dwordx4 v[28:31], v1, s[8:11], s55 offen sc1
    s_waitcnt lgkmcnt(8)
    v_mfma_f32_16x16x32_bf16 v[144:147], v[32:35], v[112:115], v[144:147]
    ds_read_b64_tr_b16 v[104:105], v4 offset:26624
    ds_read_b64_tr_b16 v[106:107], v4 offset:27648
    v_mfma_f32_16x16x32_bf16 v[176:179], v[36:39], v[112:115], v[176:179]
    s_add_u32 s40, s40, 1024
    v_mfma_f32_16x16x32_bf16 v[148:151], v[32:35], v[116:119], v[148:151]
    ds_read_b64_tr_b16 v[108:109], v5 offset:26624
    ds_read_b64_tr_b16 v[110:111], v5 offset:27648
    v_mfma_f32_16x16x32_bf16 v[180:183], v[36:39], v[116:119], v[180:183]
    s_waitcnt lgkmcnt(8)
    v_mfma_f32_16x16x32_bf16 v[152:155], v[32:35], v[120:123], v[152:155]
    ds_read_b64_tr_b16 v[112:113], v4 offset:28672
    ds_read_b64_tr_b16 v[114:115], v4 offset:29696
    v_mfma_f32_16x16x32_bf16 v[184:187], v[36:39], v[120:123], v[184:187]
    v_mfma_f32_16x16x32_bf16 v[156:159], v[32:35], v[124:127], v[156:159]
    ds_read_b64_tr_b16 v[116:117], v5 offset:28672
    ds_read_b64_tr_b16 v[118:119], v5 offset:29696
    v_mfma_f32_16x16x32_bf16 v[188:191], v[36:39], v[124:127], v[188:191]
    s_waitcnt vmcnt(28)
    s_barrier
    s_waitcnt lgkmcnt(8)
    v_mfma_f32_16x16x32_bf16 v[128:131], v[40:43], v[96:99], v[128:131]
    ds_read_b64_tr_b16 v[120:121], v4 offset:30720
    ds_read_b64_tr_b16 v[122:123], v4 offset:31744
    v_mfma_f32_16x16x32_bf16 v[160:163], v[44:47], v[96:99], v[160:163]
    s_add_u32 m0, s42, 16384
    s_nop 0
    buffer_load_dwordx4 v8, s[12:15], s41 offen lds
    v_mfma_f32_16x16x32_bf16 v[132:135], v[40:43], v[100:103], v[132:135]
    ds_read_b64_tr_b16 v[124:125], v5 offset:30720
    ds_read_b64_tr_b16 v[126:127], v5 offset:31744
    v_mfma_f32_16x16x32_bf16 v[164:167], v[44:47], v[100:103], v[164:167]
    s_add_u32 m0, s42, 20480
    s_nop 0
    buffer_load_dwordx4 v9, s[12:15], s41 offen lds
    s_waitcnt lgkmcnt(8)
    v_mfma_f32_16x16x32_bf16 v[136:139], v[40:43], v[104:107], v[136:139]
    ds_read_b64_tr_b16 v[96:97], v4 offset:32768
    ds_read_b64_tr_b16 v[98:99], v4 offset:33792
    v_mfma_f32_16x16x32_bf16 v[168:171], v[44:47], v[104:107], v[168:171]
    s_add_u32 s41, s41, 262144
    buffer_load_dwordx4 v[32:35], v1, s[8:11], s40 offen sc1
    v_mfma_f32_16x16x32_bf16 v[140:143], v[40:43], v[108:111], v[140:143]
    ds_read_b64_tr_b16 v[100:101], v5 offset:32768
    ds_read_b64_tr_b16 v[102:103], v5 offset:33792
    v_mfma_f32_16x16x32_bf16 v[172:175], v[44:47], v[108:111], v[172:175]
    s_add_u32 s55, s40, 20480
    buffer_load_dwordx4 v[36:39], v1, s[8:11], s55 offen sc1
    s_waitcnt lgkmcnt(8)
    v_mfma_f32_16x16x32_bf16 v[144:147], v[40:43], v[112:115], v[144:147]
    ds_read_b64_tr_b16 v[104:105], v4 offset:34816
    ds_read_b64_tr_b16 v[106:107], v4 offset:35840
    v_mfma_f32_16x16x32_bf16 v[176:179], v[44:47], v[112:115], v[176:179]
    s_add_u32 s40, s40, 1024
    v_mfma_f32_16x16x32_bf16 v[148:151], v[40:43], v[116:119], v[148:151]
    ds_read_b64_tr_b16 v[108:109], v5 offset:34816
    ds_read_b64_tr_b16 v[110:111], v5 offset:35840
    v_mfma_f32_16x16x32_bf16 v[180:183], v[44:47], v[116:119], v[180:183]
    s_waitcnt lgkmcnt(8)
    v_mfma_f32_16x16x32_bf16 v[152:155], v[40:43], v[120:123], v[152:155]
    ds_read_b64_tr_b16 v[112:113], v4 offset:36864
    ds_read_b64_tr_b16 v[114:115], v4 offset:37888
    v_mfma_f32_16x16x32_bf16 v[184:187], v[44:47], v[120:123], v[184:187]
    v_mfma_f32_16x16x32_bf16 v[156:159], v[40:43], v[124:127], v[156:159]
    ds_read_b64_tr_b16 v[116:117], v5 offset:36864
    ds_read_b64_tr_b16 v[118:119], v5 offset:37888
    v_mfma_f32_16x16x32_bf16 v[188:191], v[44:47], v[124:127], v[188:191]
    s_waitcnt vmcnt(28)
    s_barrier
    s_waitcnt lgkmcnt(8)
    v_mfma_f32_16x16x32_bf16 v[128:131], v[48:51], v[96:99], v[128:131]
    ds_read_b64_tr_b16 v[120:121], v4 offset:38912
    ds_read_b64_tr_b16 v[122:123], v4 offset:39936
    v_mfma_f32_16x16x32_bf16 v[160:163], v[52:55], v[96:99], v[160:163]
    s_add_u32 m0, s42, 24576
    s_nop 0
    buffer_load_dwordx4 v8, s[12:15], s41 offen lds
    v_mfma_f32_16x16x32_bf16 v[132:135], v[48:51], v[100:103], v[132:135]
    ds_read_b64_tr_b16 v[124:125], v5 offset:38912
    ds_read_b64_tr_b16 v[126:127], v5 offset:39936
    v_mfma_f32_16x16x32_bf16 v[164:167], v[52:55], v[100:103], v[164:167]
    s_add_u32 m0, s42, 28672
    s_nop 0
    buffer_load_dwordx4 v9, s[12:15], s41 offen lds
    s_waitcnt lgkmcnt(8)
    v_mfma_f32_16x16x32_bf16 v[136:139], v[48:51], v[104:107], v[136:139]
    ds_read_b64_tr_b16 v[96:97], v4 offset:40960
    ds_read_b64_tr_b16 v[98:99], v4 offset:41984
    v_mfma_f32_16x16x32_bf16 v[168:171], v[52:55], v[104:107], v[168:171]
    s_add_u32 s41, s41, 262144
    buffer_load_dwordx4 v[40:43], v1, s[8:11], s40 offen sc1
    v_mfma_f32_16x16x32_bf16 v[140:143], v[48:51], v[108:111], v[140:143]
    ds_read_b64_tr_b16 v[100:101], v5 offset:40960
    ds_read_b64_tr_b16 v[102:103], v5 offset:41984
    v_mfma_f32_16x16x32_bf16 v[172:175], v[52:55], v[108:111], v[172:175]
    s_add_u32 s55, s40, 20480
    buffer_load_dwordx4 v[44:47], v1, s[8:11], s55 offen sc1
    s_waitcnt lgkmcnt(8)
    v_mfma_f32_16x16x32_bf16 v[144:147], v[48:51], v[112:115], v[144:147]
    ds_read_b64_tr_b16 v[104:105], v4 offset:43008
    ds_read_b64_tr_b16 v[106:107], v4 offset:44032
    v_mfma_f32_16x16x32_bf16 v[176:179], v[52:55], v[112:115], v[176:179]
    s_add_u32 s40, s40, 1024
    v_mfma_f32_16x16x32_bf16 v[148:151], v[48:51], v[116:119], v[148:151]
    ds_read_b64_tr_b16 v[108:109], v5 offset:43008
    ds_read_b64_tr_b16 v[110:111], v5 offset:44032
    v_mfma_f32_16x16x32_bf16 v[180:183], v[52:55], v[116:119], v[180:183]
    s_waitcnt lgkmcnt(8)
    v_mfma_f32_16x16x32_bf16 v[152:155], v[48:51], v[120:123], v[152:155]
    ds_read_b64_tr_b16 v[112:113], v4 offset:45056
    ds_read_b64_tr_b16 v[114:115], v4 offset:46080
    v_mfma_f32_16x16x32_bf16 v[184:187], v[52:55], v[120:123], v[184:187]
    v_mfma_f32_16x16x32_bf16 v[156:159], v[48:51], v[124:127], v[156:159]
    ds_read_b64_tr_b16 v[116:117], v5 offset:45056
    ds_read_b64_tr_b16 v[118:119], v5 offset:46080
    v_mfma_f32_16x16x32_bf16 v[188:191], v[52:55], v[124:127], v[188:191]
    s_waitcnt vmcnt(28)
    s_barrier
    s_waitcnt lgkmcnt(8)
    v_mfma_f32_16x16x32_bf16 v[128:131], v[56:59], v[96:99], v[128:131]
    ds_read_b64_tr_b16 v[120:121], v4 offset:47104
    ds_read_b64_tr_b16 v[122:123], v4 offset:48128
    v_mfma_f32_16x16x32_bf16 v[160:163], v[60:63], v[96:99], v[160:163]
    s_add_u32 m0, s42, 32768
    s_nop 0
    buffer_load_dwordx4 v8, s[12:15], s41 offen lds
    v_mfma_f32_16x16x32_bf16 v[132:135], v[56:59], v[100:103], v[132:135]
    ds_read_b64_tr_b16 v[124:125], v5 offset:47104
    ds_read_b64_tr_b16 v[126:127], v5 offset:48128
    v_mfma_f32_16x16x32_bf16 v[164:167], v[60:63], v[100:103], v[164:167]
    s_add_u32 m0, s42, 36864
    s_nop 0
    buffer_load_dwordx4 v9, s[12:15], s41 offen lds
    s_waitcnt lgkmcnt(8)
    v_mfma_f32_16x16x32_bf16 v[136:139], v[56:59], v[104:107], v[136:139]
    ds_read_b64_tr_b16 v[96:97], v4 offset:49152
    ds_read_b64_tr_b16 v[98:99], v4 offset:50176
    v_mfma_f32_16x16x32_bf16 v[168:171], v[60:63], v[104:107], v[168:171]
    s_add_u32 s41, s41, 262144
    buffer_load_dwordx4 v[48:51], v1, s[8:11], s40 offen sc1
    v_mfma_f32_16x16x32_bf16 v[140:143], v[56:59], v[108:111], v[140:143]
    ds_read_b64_tr_b16 v[100:101], v5 offset:49152
    ds_read_b64_tr_b16 v[102:103], v5 offset:50176
    v_mfma_f32_16x16x32_bf16 v[172:175], v[60:63], v[108:111], v[172:175]
    s_add_u32 s55, s40, 20480
    buffer_load_dwordx4 v[52:55], v1, s[8:11], s55 offen sc1
    s_waitcnt lgkmcnt(8)
    v_mfma_f32_16x16x32_bf16 v[144:147], v[56:59], v[112:115], v[144:147]
    ds_read_b64_tr_b16 v[104:105], v4 offset:51200
    ds_read_b64_tr_b16 v[106:107], v4 offset:52224
    v_mfma_f32_16x16x32_bf16 v[176:179], v[60:63], v[112:115], v[176:179]
    s_add_u32 s40, s40, 1024
    v_mfma_f32_16x16x32_bf16 v[148:151], v[56:59], v[116:119], v[148:151]
    ds_read_b64_tr_b16 v[108:109], v5 offset:51200
    ds_read_b64_tr_b16 v[110:111], v5 offset:52224
    v_mfma_f32_16x16x32_bf16 v[180:183], v[60:63], v[116:119], v[180:183]
    s_waitcnt lgkmcnt(8)
    v_mfma_f32_16x16x32_bf16 v[152:155], v[56:59], v[120:123], v[152:155]
    ds_read_b64_tr_b16 v[112:113], v4 offset:53248
    ds_read_b64_tr_b16 v[114:115], v4 offset:54272
    v_mfma_f32_16x16x32_bf16 v[184:187], v[60:63], v[120:123], v[184:187]
    v_mfma_f32_16x16x32_bf16 v[156:159], v[56:59], v[124:127], v[156:159]
    ds_read_b64_tr_b16 v[116:117], v5 offset:53248
    ds_read_b64_tr_b16 v[118:119], v5 offset:54272
    v_mfma_f32_16x16x32_bf16 v[188:191], v[60:63], v[124:127], v[188:191]
    s_waitcnt vmcnt(28)
    s_barrier
    s_waitcnt lgkmcnt(8)
    v_mfma_f32_16x16x32_bf16 v[128:131], v[64:67], v[96:99], v[128:131]
    ds_read_b64_tr_b16 v[120:121], v4 offset:55296
    ds_read_b64_tr_b16 v[122:123], v4 offset:56320
    v_mfma_f32_16x16x32_bf16 v[160:163], v[68:71], v[96:99], v[160:163]
    s_add_u32 m0, s42, 40960
    s_nop 0
    buffer_load_dwordx4 v8, s[12:15], s41 offen lds
    v_mfma_f32_16x16x32_bf16 v[132:135], v[64:67], v[100:103], v[132:135]
    ds_read_b64_tr_b16 v[124:125], v5 offset:55296
    ds_read_b64_tr_b16 v[126:127], v5 offset:56320
    v_mfma_f32_16x16x32_bf16 v[164:167], v[68:71], v[100:103], v[164:167]
    s_add_u32 m0, s42, 45056
    s_nop 0
    buffer_load_dwordx4 v9, s[12:15], s41 offen lds
    s_waitcnt lgkmcnt(8)
    v_mfma_f32_16x16x32_bf16 v[136:139], v[64:67], v[104:107], v[136:139]
    ds_read_b64_tr_b16 v[96:97], v4 offset:57344
    ds_read_b64_tr_b16 v[98:99], v4 offset:58368
    v_mfma_f32_16x16x32_bf16 v[168:171], v[68:71], v[104:107], v[168:171]
    s_add_u32 s41, s41, 262144
    buffer_load_dwordx4 v[56:59], v1, s[8:11], s40 offen sc1
    v_mfma_f32_16x16x32_bf16 v[140:143], v[64:67], v[108:111], v[140:143]
    ds_read_b64_tr_b16 v[100:101], v5 offset:57344
    ds_read_b64_tr_b16 v[102:103], v5 offset:58368
    v_mfma_f32_16x16x32_bf16 v[172:175], v[68:71], v[108:111], v[172:175]
    s_add_u32 s55, s40, 20480
    buffer_load_dwordx4 v[60:63], v1, s[8:11], s55 offen sc1
    s_waitcnt lgkmcnt(8)
    v_mfma_f32_16x16x32_bf16 v[144:147], v[64:67], v[112:115], v[144:147]
    ds_read_b64_tr_b16 v[104:105], v4 offset:59392
    ds_read_b64_tr_b16 v[106:107], v4 offset:60416
    v_mfma_f32_16x16x32_bf16 v[176:179], v[68:71], v[112:115], v[176:179]
    s_add_u32 s40, s40, 1024
    v_mfma_f32_16x16x32_bf16 v[148:151], v[64:67], v[116:119], v[148:151]
    ds_read_b64_tr_b16 v[108:109], v5 offset:59392
    ds_read_b64_tr_b16 v[110:111], v5 offset:60416
    v_mfma_f32_16x16x32_bf16 v[180:183], v[68:71], v[116:119], v[180:183]
    s_waitcnt lgkmcnt(8)
    v_mfma_f32_16x16x32_bf16 v[152:155], v[64:67], v[120:123], v[152:155]
    ds_read_b64_tr_b16 v[112:113], v4 offset:61440
    ds_read_b64_tr_b16 v[114:115], v4 offset:62464
    v_mfma_f32_16x16x32_bf16 v[184:187], v[68:71], v[120:123], v[184:187]
    v_mfma_f32_16x16x32_bf16 v[156:159], v[64:67], v[124:127], v[156:159]
    ds_read_b64_tr_b16 v[116:117], v5 offset:61440
    ds_read_b64_tr_b16 v[118:119], v5 offset:62464
    v_mfma_f32_16x16x32_bf16 v[188:191], v[68:71], v[124:127], v[188:191]
    s_waitcnt vmcnt(28)
    s_barrier
    s_waitcnt lgkmcnt(8)
    v_mfma_f32_16x16x32_bf16 v[128:131], v[72:75], v[96:99], v[128:131]
    ds_read_b64_tr_b16 v[120:121], v4 offset:63488
    ds_read_b64_tr_b16 v[122:123], v4 offset:64512
    v_mfma_f32_16x16x32_bf16 v[160:163], v[76:79], v[96:99], v[160:163]
    s_add_u32 m0, s42, 49152
    s_nop 0
    buffer_load_dwordx4 v8, s[12:15], s41 offen lds
    v_mfma_f32_16x16x32_bf16 v[132:135], v[72:75], v[100:103], v[132:135]
    ds_read_b64_tr_b16 v[124:125], v5 offset:63488
    ds_read_b64_tr_b16 v[126:127], v5 offset:64512
    v_mfma_f32_16x16x32_bf16 v[164:167], v[76:79], v[100:103], v[164:167]
    s_add_u32 m0, s42, 53248
    s_nop 0
    buffer_load_dwordx4 v9, s[12:15], s41 offen lds
    s_waitcnt lgkmcnt(8)
    v_mfma_f32_16x16x32_bf16 v[136:139], v[72:75], v[104:107], v[136:139]
    ds_read_b64_tr_b16 v[96:97], v6 offset:0
    ds_read_b64_tr_b16 v[98:99], v6 offset:1024
    v_mfma_f32_16x16x32_bf16 v[168:171], v[76:79], v[104:107], v[168:171]
    s_add_u32 s41, s41, 262144
    buffer_load_dwordx4 v[64:67], v1, s[8:11], s40 offen sc1
    v_mfma_f32_16x16x32_bf16 v[140:143], v[72:75], v[108:111], v[140:143]
    ds_read_b64_tr_b16 v[100:101], v7 offset:0
    ds_read_b64_tr_b16 v[102:103], v7 offset:1024
    v_mfma_f32_16x16x32_bf16 v[172:175], v[76:79], v[108:111], v[172:175]
    s_add_u32 s55, s40, 20480
    buffer_load_dwordx4 v[68:71], v1, s[8:11], s55 offen sc1
    s_waitcnt lgkmcnt(8)
    v_mfma_f32_16x16x32_bf16 v[144:147], v[72:75], v[112:115], v[144:147]
    ds_read_b64_tr_b16 v[104:105], v6 offset:2048
    ds_read_b64_tr_b16 v[106:107], v6 offset:3072
    v_mfma_f32_16x16x32_bf16 v[176:179], v[76:79], v[112:115], v[176:179]
    s_add_u32 s40, s40, 1024
    v_mfma_f32_16x16x32_bf16 v[148:151], v[72:75], v[116:119], v[148:151]
    ds_read_b64_tr_b16 v[108:109], v7 offset:2048
    ds_read_b64_tr_b16 v[110:111], v7 offset:3072
    v_mfma_f32_16x16x32_bf16 v[180:183], v[76:79], v[116:119], v[180:183]
    s_waitcnt lgkmcnt(8)
    v_mfma_f32_16x16x32_bf16 v[152:155], v[72:75], v[120:123], v[152:155]
    ds_read_b64_tr_b16 v[112:113], v6 offset:4096
    ds_read_b64_tr_b16 v[114:115], v6 offset:5120
    v_mfma_f32_16x16x32_bf16 v[184:187], v[76:79], v[120:123], v[184:187]
    v_mfma_f32_16x16x32_bf16 v[156:159], v[72:75], v[124:127], v[156:159]
    ds_read_b64_tr_b16 v[116:117], v7 offset:4096
    ds_read_b64_tr_b16 v[118:119], v7 offset:5120
    v_mfma_f32_16x16x32_bf16 v[188:191], v[76:79], v[124:127], v[188:191]
    s_waitcnt vmcnt(28)
    s_barrier
    s_waitcnt lgkmcnt(8)
    v_mfma_f32_16x16x32_bf16 v[128:131], v[80:83], v[96:99], v[128:131]
    ds_read_b64_tr_b16 v[120:121], v6 offset:6144
    ds_read_b64_tr_b16 v[122:123], v6 offset:7168
    v_mfma_f32_16x16x32_bf16 v[160:163], v[84:87], v[96:99], v[160:163]
    s_add_u32 m0, s42, 57344
    s_nop 0
    buffer_load_dwordx4 v8, s[12:15], s41 offen lds
    v_mfma_f32_16x16x32_bf16 v[132:135], v[80:83], v[100:103], v[132:135]
    ds_read_b64_tr_b16 v[124:125], v7 offset:6144
    ds_read_b64_tr_b16 v[126:127], v7 offset:7168
    v_mfma_f32_16x16x32_bf16 v[164:167], v[84:87], v[100:103], v[164:167]
    s_add_u32 m0, s42, 61440
    s_nop 0
    buffer_load_dwordx4 v9, s[12:15], s41 offen lds
    s_waitcnt lgkmcnt(8)
    v_mfma_f32_16x16x32_bf16 v[136:139], v[80:83], v[104:107], v[136:139]
    ds_read_b64_tr_b16 v[96:97], v6 offset:8192
    ds_read_b64_tr_b16 v[98:99], v6 offset:9216
    v_mfma_f32_16x16x32_bf16 v[168:171], v[84:87], v[104:107], v[168:171]
    s_add_u32 s41, s41, 262144
    buffer_load_dwordx4 v[72:75], v1, s[8:11], s40 offen sc1
    v_mfma_f32_16x16x32_bf16 v[140:143], v[80:83], v[108:111], v[140:143]
    ds_read_b64_tr_b16 v[100:101], v7 offset:8192
    ds_read_b64_tr_b16 v[102:103], v7 offset:9216
    v_mfma_f32_16x16x32_bf16 v[172:175], v[84:87], v[108:111], v[172:175]
    s_add_u32 s55, s40, 20480
    buffer_load_dwordx4 v[76:79], v1, s[8:11], s55 offen sc1
    s_waitcnt lgkmcnt(8)
    v_mfma_f32_16x16x32_bf16 v[144:147], v[80:83], v[112:115], v[144:147]
    ds_read_b64_tr_b16 v[104:105], v6 offset:10240
    ds_read_b64_tr_b16 v[106:107], v6 offset:11264
    v_mfma_f32_16x16x32_bf16 v[176:179], v[84:87], v[112:115], v[176:179]
    s_add_u32 s40, s40, 1024
    v_mfma_f32_16x16x32_bf16 v[148:151], v[80:83], v[116:119], v[148:151]
    ds_read_b64_tr_b16 v[108:109], v7 offset:10240
    ds_read_b64_tr_b16 v[110:111], v7 offset:11264
    v_mfma_f32_16x16x32_bf16 v[180:183], v[84:87], v[116:119], v[180:183]
    s_waitcnt lgkmcnt(8)
    v_mfma_f32_16x16x32_bf16 v[152:155], v[80:83], v[120:123], v[152:155]
    ds_read_b64_tr_b16 v[112:113], v6 offset:12288
    ds_read_b64_tr_b16 v[114:115], v6 offset:13312
    v_mfma_f32_16x16x32_bf16 v[184:187], v[84:87], v[120:123], v[184:187]
    v_mfma_f32_16x16x32_bf16 v[156:159], v[80:83], v[124:127], v[156:159]
    ds_read_b64_tr_b16 v[116:117], v7 offset:12288
    ds_read_b64_tr_b16 v[118:119], v7 offset:13312
    v_mfma_f32_16x16x32_bf16 v[188:191], v[84:87], v[124:127], v[188:191]
    s_waitcnt vmcnt(28)
    s_barrier
    s_waitcnt lgkmcnt(8)
    v_mfma_f32_16x16x32_bf16 v[128:131], v[88:91], v[96:99], v[128:131]
    ds_read_b64_tr_b16 v[120:121], v6 offset:14336
    ds_read_b64_tr_b16 v[122:123], v6 offset:15360
    v_mfma_f32_16x16x32_bf16 v[160:163], v[92:95], v[96:99], v[160:163]
    s_add_u32 m0, s42, 65536
    s_nop 0
    buffer_load_dwordx4 v8, s[12:15], s41 offen lds
    v_mfma_f32_16x16x32_bf16 v[132:135], v[88:91], v[100:103], v[132:135]
    ds_read_b64_tr_b16 v[124:125], v7 offset:14336
    ds_read_b64_tr_b16 v[126:127], v7 offset:15360
    v_mfma_f32_16x16x32_bf16 v[164:167], v[92:95], v[100:103], v[164:167]
    s_add_u32 m0, s42, 69632
    s_nop 0
    buffer_load_dwordx4 v9, s[12:15], s41 offen lds
    s_waitcnt lgkmcnt(8)
    v_mfma_f32_16x16x32_bf16 v[136:139], v[88:91], v[104:107], v[136:139]
    ds_read_b64_tr_b16 v[96:97], v4 offset:0
    ds_read_b64_tr_b16 v[98:99], v4 offset:1024
    v_mfma_f32_16x16x32_bf16 v[168:171], v[92:95], v[104:107], v[168:171]
    s_add_u32 s41, s41, 262144
    buffer_load_dwordx4 v[80:83], v1, s[8:11], s40 offen sc1
    v_mfma_f32_16x16x32_bf16 v[140:143], v[88:91], v[108:111], v[140:143]
    ds_read_b64_tr_b16 v[100:101], v5 offset:0
    ds_read_b64_tr_b16 v[102:103], v5 offset:1024
    v_mfma_f32_16x16x32_bf16 v[172:175], v[92:95], v[108:111], v[172:175]
    s_add_u32 s55, s40, 20480
    buffer_load_dwordx4 v[84:87], v1, s[8:11], s55 offen sc1
    s_waitcnt lgkmcnt(8)
    v_mfma_f32_16x16x32_bf16 v[144:147], v[88:91], v[112:115], v[144:147]
    ds_read_b64_tr_b16 v[104:105], v4 offset:2048
    ds_read_b64_tr_b16 v[106:107], v4 offset:3072
    v_mfma_f32_16x16x32_bf16 v[176:179], v[92:95], v[112:115], v[176:179]
    s_add_u32 s40, s40, 1024
    v_mfma_f32_16x16x32_bf16 v[148:151], v[88:91], v[116:119], v[148:151]
    ds_read_b64_tr_b16 v[108:109], v5 offset:2048
    ds_read_b64_tr_b16 v[110:111], v5 offset:3072
    v_mfma_f32_16x16x32_bf16 v[180:183], v[92:95], v[116:119], v[180:183]
    s_waitcnt lgkmcnt(8)
    v_mfma_f32_16x16x32_bf16 v[152:155], v[88:91], v[120:123], v[152:155]
    ds_read_b64_tr_b16 v[112:113], v4 offset:4096
    ds_read_b64_tr_b16 v[114:115], v4 offset:5120
    v_mfma_f32_16x16x32_bf16 v[184:187], v[92:95], v[120:123], v[184:187]
    v_mfma_f32_16x16x32_bf16 v[156:159], v[88:91], v[124:127], v[156:159]
    ds_read_b64_tr_b16 v[116:117], v5 offset:4096
    ds_read_b64_tr_b16 v[118:119], v5 offset:5120
    v_mfma_f32_16x16x32_bf16 v[188:191], v[92:95], v[124:127], v[188:191]
    s_sub_u32 s43, s43, 1
    s_cmp_lg_u32 s43, 0
    s_cbranch_scc1 gv_loop
    s_waitcnt vmcnt(0) lgkmcnt(0)
    s_barrier
    s_lshl_b32 s84, s45, 14
    s_mul_i32 s55, s73, 1064960
    s_add_u32 s84, s84, s55
    s_add_u32 s84, s84, 50331648
    v_cvt_pk_bf16_f32 v88, v128, v129
    v_cvt_pk_bf16_f32 v89, v130, v131
    v_cvt_pk_bf16_f32 v90, v160, v161
    v_cvt_pk_bf16_f32 v91, v162, v163
    s_add_u32 s84, s84, 8192
    buffer_store_dwordx4 v[88:91], v1, s[8:11], s84 offen offset:0 sc1
    v_cvt_pk_bf16_f32 v92, v132, v133
    v_cvt_pk_bf16_f32 v93, v134, v135
    v_cvt_pk_bf16_f32 v94, v164, v165
    v_cvt_pk_bf16_f32 v95, v166, v167
    buffer_store_dwordx4 v[92:95], v1, s[8:11], s84 offen offset:1024 sc1
    v_cvt_pk_bf16_f32 v96, v136, v137
    v_cvt_pk_bf16_f32 v97, v138, v139
    v_cvt_pk_bf16_f32 v98, v168, v169
    v_cvt_pk_bf16_f32 v99, v170, v171
    buffer_store_dwordx4 v[96:99], v1, s[8:11], s84 offen offset:2048 sc1
    v_cvt_pk_bf16_f32 v100, v140, v141
    v_cvt_pk_bf16_f32 v101, v142, v143
    v_cvt_pk_bf16_f32 v102, v172, v173
    v_cvt_pk_bf16_f32 v103, v174, v175
    buffer_store_dwordx4 v[100:103], v1, s[8:11], s84 offen offset:3072 sc1
    v_cvt_pk_bf16_f32 v104, v144, v145
    v_cvt_pk_bf16_f32 v105, v146, v147
    v_cvt_pk_bf16_f32 v106, v176, v177
    v_cvt_pk_bf16_f32 v107, v178, v179
    s_add_u32 s84, s84, 4096
    buffer_store_dwordx4 v[104:107], v1, s[8:11], s84 offen offset:0 sc1
    v_cvt_pk_bf16_f32 v108, v148, v149
    v_cvt_pk_bf16_f32 v109, v150, v151
    v_cvt_pk_bf16_f32 v110, v180, v181
    v_cvt_pk_bf16_f32 v111, v182, v183
    buffer_store_dwordx4 v[108:111], v1, s[8:11], s84 offen offset:1024 sc1
    v_cvt_pk_bf16_f32 v112, v152, v153
    v_cvt_pk_bf16_f32 v113, v154, v155
    v_cvt_pk_bf16_f32 v114, v184, v185
    v_cvt_pk_bf16_f32 v115, v186, v187
    buffer_store_dwordx4 v[112:115], v1, s[8:11], s84 offen offset:2048 sc1
    v_cvt_pk_bf16_f32 v116, v156, v157
    v_cvt_pk_bf16_f32 v117, v158, v159
    v_cvt_pk_bf16_f32 v118, v188, v189
    v_cvt_pk_bf16_f32 v119, v190, v191
    buffer_store_dwordx4 v[116:119], v1, s[8:11], s84 offen offset:3072 sc1
    s_lshl_b32 s85, s73, 7
    s_lshl_b32 s54, s72, 2
    s_add_u32 s85, s85, s54
    s_add_u32 s85, s85, 2363392
    s_mov_b32 s83, 1
    s_branch rnext_143
rnext_143:
    s_add_u32 s71, s71, 1
    s_cmp_lt_u32 s71, 5
    s_cbranch_scc1 rtop_138
    s_cmp_eq_u32 s71, 0
    s_cbranch_scc1 e_158
    s_waitcnt vmcnt(0) lgkmcnt(0)
    s_barrier
    s_cmp_lg_u32 s36, 0
    s_cbranch_scc1 sg_159
    v_mov_b32 v14, 0
    v_mov_b32 v15, s83
    s_mov_b64 exec, 1
    buffer_atomic_add v15, v14, s[8:11], s85 offen
    s_mov_b64 exec, -1
sg_159:
e_158:
    s_and_b32 s76, s38, 1
    s_cmp_ge_u32 s38, 6
    s_cbranch_scc1 rff2_162
    s_cmp_ge_u32 s38, 4
    s_cbranch_scc1 rff1_161
    s_load_dwordx2 s[12:13], s[0:1], 40
    s_waitcnt lgkmcnt(0)
    s_and_b32 s13, s13, 0xffff
    s_mov_b32 s14, 5242880
    s_mov_b32 s15, 0x20000
    s_lshr_b32 s73, s37, 2
    s_and_b32 s72, s37, 3
    s_mul_i32 s41, s73, 655360
    s_mul_i32 s55, s72, 320
    s_add_u32 s41, s41, s55
    v_lshrrev_b32 v3, 2, v0
    s_mov_b32 s55, 1280
    v_mul_lo_u32 v3, v3, s55
    v_lshrrev_b32 v2, 3, v0
    v_and_b32 v2, 2, v2
    v_xor_b32 v2, v2, v0
    v_and_b32 v2, 3, v2
    v_lshl_add_u32 v3, v2, 4, v3
    v_bfe_u32 v2, v0, 2, 4
    v_lshlrev_b32 v4, 6, v2
    v_bfe_u32 v2, v0, 4, 1
    v_lshl_add_u32 v4, v2, 5, v4
    v_bfe_u32 v2, v0, 0, 2
    v_lshl_add_u32 v4, v2, 3, v4
    v_xor_b32 v5, 32, v4
    s_mul_i32 s54, s36, 40960
    s_add_u32 s41, s41, s54
    s_mul_i32 s42, s36, 10240
    s_add_u32 m0, s42, 0
    s_add_u32 s54, s41, 0
    buffer_load_dwordx4 v3, s[12:15], s54 offen lds
    s_add_u32 m0, s42, 1024
    s_add_u32 s54, s41, 20480
    buffer_load_dwordx4 v3, s[12:15], s54 offen lds
    s_add_u32 m0, s42, 2048
    s_add_u32 s54, s41, 64
    buffer_load_dwordx4 v3, s[12:15], s54 offen lds
    s_add_u32 m0, s42, 3072
    s_add_u32 s54, s41, 20544
    buffer_load_dwordx4 v3, s[12:15], s54 offen lds
    s_add_u32 m0, s42, 4096
    s_add_u32 s54, s41, 128
    buffer_load_dwordx4 v3, s[12:15], s54 offen lds
    s_add_u32 m0, s42, 5120
    s_add_u32 s54, s41, 20608
    buffer_load_dwordx4 v3, s[12:15], s54 offen lds
    s_add_u32 m0, s42, 6144
    s_add_u32 s54, s41, 192
    buffer_load_dwordx4 v3, s[12:15], s54 offen lds
    s_add_u32 m0, s42, 7168
    s_add_u32 s54, s41, 20672
    buffer_load_dwordx4 v3, s[12:15], s54 offen lds
    s_add_u32 m0, s42, 8192
    s_add_u32 s54, s41, 256
    buffer_load_dwordx4 v3, s[12:15], s54 offen lds
    s_add_u32 m0, s42, 9216
    s_add_u32 s54, s41, 20736
    buffer_load_dwordx4 v3, s[12:15], s54 offen lds
    s_add_u32 m0, s42, 40960
    s_add_u32 s54, s41, 163840
    buffer_load_dwordx4 v3, s[12:15], s54 offen lds
    s_add_u32 m0, s42, 41984
    s_add_u32 s54, s41, 184320
    buffer_load_dwordx4 v3, s[12:15], s54 offen lds
    s_add_u32 m0, s42, 43008
    s_add_u32 s54, s41, 163904
    buffer_load_dwordx4 v3, s[12:15], s54 offen lds
    s_add_u32 m0, s42, 44032
    s_add_u32 s54, s41, 184384
    buffer_load_dwordx4 v3, s[12:15], s54 offen lds
    s_add_u32 m0, s42, 45056
    s_add_u32 s54, s41, 163968
    buffer_load_dwordx4 v3, s[12:15], s54 offen lds
    s_add_u32 m0, s42, 46080
    s_add_u32 s54, s41, 184448
    buffer_load_dwordx4 v3, s[12:15], s54 offen lds
    s_add_u32 m0, s42, 47104
    s_add_u32 s54, s41, 164032
    buffer_load_dwordx4 v3, s[12:15], s54 offen lds
    s_add_u32 m0, s42, 48128
    s_add_u32 s54, s41, 184512
    buffer_load_dwordx4 v3, s[12:15], s54 offen lds
    s_add_u32 m0, s42, 49152
    s_add_u32 s54, s41, 164096
    buffer_load_dwordx4 v3, s[12:15], s54 offen lds
    s_add_u32 m0, s42, 50176
    s_add_u32 s54, s41, 184576
    buffer_load_dwordx4 v3, s[12:15], s54 offen lds
    s_add_u32 m0, s42, 81920
    s_add_u32 s54, s41, 327680
    buffer_load_dwordx4 v3, s[12:15], s54 offen lds
    s_add_u32 m0, s42, 82944
    s_add_u32 s54, s41, 348160
    buffer_load_dwordx4 v3, s[12:15], s54 offen lds
    s_add_u32 m0, s42, 83968
    s_add_u32 s54, s41, 327744
    buffer_load_dwordx4 v3, s[12:15], s54 offen lds
    s_add_u32 m0, s42, 84992
    s_add_u32 s54, s41, 348224
    buffer_load_dwordx4 v3, s[12:15], s54 offen lds
    s_add_u32 m0, s42, 86016
    s_add_u32 s54, s41, 327808
    buffer_load_dwordx4 v3, s[12:15], s54 offen lds
    s_add_u32 m0, s42, 87040
    s_add_u32 s54, s41, 348288
    buffer_load_dwordx4 v3, s[12:15], s54 offen lds
    s_add_u32 m0, s42, 88064
    s_add_u32 s54, s41, 327872
    buffer_load_dwordx4 v3, s[12:15], s54 offen lds
    s_add_u32 m0, s42, 89088
    s_add_u32 s54, s41, 348352
    buffer_load_dwordx4 v3, s[12:15], s54 offen lds
    s_add_u32 m0, s42, 90112
    s_add_u32 s54, s41, 327936
    buffer_load_dwordx4 v3, s[12:15], s54 offen lds
    s_add_u32 m0, s42, 91136
    s_add_u32 s54, s41, 348416
    buffer_load_dwordx4 v3, s[12:15], s54 offen lds
    s_add_u32 m0, s42, 122880
    s_add_u32 s54, s41, 491520
    buffer_load_dwordx4 v3, s[12:15], s54 offen lds
    s_add_u32 m0, s42, 123904
    s_add_u32 s54, s41, 512000
    buffer_load_dwordx4 v3, s[12:15], s54 offen lds
    s_add_u32 m0, s42, 124928
    s_add_u32 s54, s41, 491584
    buffer_load_dwordx4 v3, s[12:15], s54 offen lds
    s_add_u32 m0, s42, 125952
    s_add_u32 s54, s41, 512064
    buffer_load_dwordx4 v3, s[12:15], s54 offen lds
    s_add_u32 m0, s42, 126976
    s_add_u32 s54, s41, 491648
    buffer_load_dwordx4 v3, s[12:15], s54 offen lds
    s_add_u32 m0, s42, 128000
    s_add_u32 s54, s41, 512128
    buffer_load_dwordx4 v3, s[12:15], s54 offen lds
    s_add_u32 m0, s42, 129024
    s_add_u32 s54, s41, 491712
    buffer_load_dwordx4 v3, s[12:15], s54 offen lds
    s_add_u32 m0, s42, 130048
    s_add_u32 s54, s41, 512192
    buffer_load_dwordx4 v3, s[12:15], s54 offen lds
    s_add_u32 m0, s42, 131072
    s_add_u32 s54, s41, 491776
    buffer_load_dwordx4 v3, s[12:15], s54 offen lds
    s_add_u32 m0, s42, 132096
    s_add_u32 s54, s41, 512256
    buffer_load_dwordx4 v3, s[12:15], s54 offen lds
    s_waitcnt vmcnt(0)
    v_lshrrev_b32 v3, 2, v0
    s_mov_b32 s55, 16
    v_mul_lo_u32 v3, v3, s55
    v_lshrrev_b32 v2, 3, v0
    v_and_b32 v2, 2, v2
    v_xor_b32 v2, v2, v0
    v_and_b32 v2, 3, v2
    v_lshl_add_u32 v3, v2, 4, v3
    v_bfe_u32 v2, v0, 2, 4
    v_lshlrev_b32 v4, 6, v2
    v_bfe_u32 v2, v0, 4, 1
    v_lshl_add_u32 v4, v2, 5, v4
    v_bfe_u32 v2, v0, 0, 2
    v_lshl_add_u32 v4, v2, 3, v4
    v_xor_b32 v5, 32, v4
    s_mul_i32 s54, s36, 10240
    s_add_u32 s54, s54, 0
    v_add_u32 v4, s54, v4
    v_add_u32 v5, s54, v5
    v_lshlrev_b32 v6, 4, v0
    v_add_u32 v6, s54, v6
    s_mov_b32 s43, 4
cv_164:
    ds_read_b64_tr_b16 v[16:17], v4 offset:0
    ds_read_b64_tr_b16 v[18:19], v4 offset:1024
    ds_read_b64_tr_b16 v[20:21], v5 offset:0
    ds_read_b64_tr_b16 v[22:23], v5 offset:1024
    ds_read_b64_tr_b16 v[24:25], v4 offset:2048
    ds_read_b64_tr_b16 v[26:27], v4 offset:3072
    ds_read_b64_tr_b16 v[28:29], v5 offset:2048
    ds_read_b64_tr_b16 v[30:31], v5 offset:3072
    s_waitcnt lgkmcnt(0)
    ds_read_b64_tr_b16 v[32:33], v4 offset:4096
    ds_read_b64_tr_b16 v[34:35], v4 offset:5120
    ds_read_b64_tr_b16 v[36:37], v5 offset:4096
    ds_read_b64_tr_b16 v[38:39], v5 offset:5120
    ds_read_b64_tr_b16 v[40:41], v4 offset:6144
    ds_read_b64_tr_b16 v[42:43], v4 offset:7168
    ds_read_b64_tr_b16 v[44:45], v5 offset:6144
    ds_read_b64_tr_b16 v[46:47], v5 offset:7168
    s_waitcnt lgkmcnt(0)
    ds_read_b64_tr_b16 v[48:49], v4 offset:8192
    ds_read_b64_tr_b16 v[50:51], v4 offset:9216
    ds_read_b64_tr_b16 v[52:53], v5 offset:8192
    ds_read_b64_tr_b16 v[54:55], v5 offset:9216
    s_waitcnt lgkmcnt(0)
    ds_write_b128 v6, v[16:19] offset:0
    ds_write_b128 v6, v[20:23] offset:1024
    ds_write_b128 v6, v[24:27] offset:2048
    ds_write_b128 v6, v[28:31] offset:3072
    ds_write_b128 v6, v[32:35] offset:4096
    ds_write_b128 v6, v[36:39] offset:5120
    ds_write_b128 v6, v[40:43] offset:6144
    ds_write_b128 v6, v[44:47] offset:7168
    ds_write_b128 v6, v[48:51] offset:8192
    ds_write_b128 v6, v[52:55] offset:9216
    v_add_u32 v4, 40960, v4
    v_add_u32 v5, 40960, v5
    v_add_u32 v6, 40960, v6
    s_waitcnt lgkmcnt(0)
    s_sub_u32 s43, s43, 1
    s_cmp_lg_u32 s43, 0
    s_cbranch_scc1 cv_164
    s_barrier
wotop_165:
    s_lshl_b32 s45, s76, 1
    s_and_b32 s54, s36, 1
    s_add_u32 s45, s45, s54
    s_lshl_b32 s40, s45, 17
    s_mul_i32 s55, s73, 16384
    s_add_u32 s40, s40, s55
    s_add_u32 s40, s40, 117440512
    s_lshr_b32 s46, s36, 1
    s_lshl_b32 s46, s46, 12
    s_mul_i32 s44, s73, 5242880
    s_mul_i32 s55, s72, 1280
    s_add_u32 s44, s44, s55
    s_lshr_b32 s55, s46, 3
    s_add_u32 s44, s44, s55
    s_mul_i32 s55, s45, 40960
    s_add_u32 s44, s44, s55
    s_add_u32 s44, s44, 134217728
    v_lshlrev_b32 v1, 4, v0
    v_add_u32 v4, s46, v1
    v_add_u32 v5, 0x10000, v4
    v_add_u32 v6, 0x20000, v4
    ds_read_b128 v[80:83], v4 offset:0
    ds_read_b128 v[84:87], v4 offset:1024
    ds_read_b128 v[88:91], v4 offset:2048
    ds_read_b128 v[92:95], v4 offset:3072
    ds_read_b128 v[96:99], v4 offset:4096
    ds_read_b128 v[100:103], v4 offset:5120
    v_bfe_u32 v12, v0, 1, 3
    v_mul_u32_u24 v12, 5120, v12
    v_bfe_u32 v2, v0, 4, 2
    v_lshl_add_u32 v12, v2, 5, v12
    v_bfe_u32 v2, v0, 0, 1
    v_lshl_add_u32 v12, v2, 4, v12
    s_lshl_b32 s75, s76, 5
    s_lshl_b32 s54, s73, 2
    s_add_u32 s75, s75, s54
    s_add_u32 s75, s75, 2371584
    s_cmp_lg_u32 s36, 0
    s_cbranch_scc1 wd_167
    v_min_u32 v14, 0, v0
    v_mul_u32_u24 v14, 0, v14
wt_166:
    buffer_load_dword v15, v14, s[8:11], s75 offen sc1
    s_waitcnt vmcnt(0)
    v_cmp_gt_u32 vcc, 1, v15
    s_nop 0
    s_cbranch_vccz wd_167
    s_sleep 2
    s_sub_u32 s53, s53, 1
    s_cbranch_scc0 wt_166
    s_mov_b32 s53, 0
wd_167:
    s_barrier
    buffer_load_dwordx4 v[16:19], v1, s[8:11], s40 offen offset:0 sc1
    buffer_load_dwordx4 v[20:23], v1, s[8:11], s40 offen offset:1024 sc1
    buffer_load_dwordx4 v[24:27], v1, s[8:11], s40 offen offset:2048 sc1
    buffer_load_dwordx4 v[28:31], v1, s[8:11], s40 offen offset:3072 sc1
    s_add_u32 s40, s40, 4096
    buffer_load_dwordx4 v[32:35], v1, s[8:11], s40 offen offset:0 sc1
    buffer_load_dwordx4 v[36:39], v1, s[8:11], s40 offen offset:1024 sc1
    buffer_load_dwordx4 v[40:43], v1, s[8:11], s40 offen offset:2048 sc1
    buffer_load_dwordx4 v[44:47], v1, s[8:11], s40 offen offset:3072 sc1
    s_add_u32 s40, s40, 4096
    buffer_load_dwordx4 v[48:51], v1, s[8:11], s40 offen offset:0 sc1
    buffer_load_dwordx4 v[52:55], v1, s[8:11], s40 offen offset:1024 sc1
    buffer_load_dwordx4 v[56:59], v1, s[8:11], s40 offen offset:2048 sc1
    buffer_load_dwordx4 v[60:63], v1, s[8:11], s40 offen offset:3072 sc1
    s_add_u32 s40, s40, 4096
    buffer_load_dwordx4 v[64:67], v1, s[8:11], s40 offen offset:0 sc1
    buffer_load_dwordx4 v[68:71], v1, s[8:11], s40 offen offset:1024 sc1
    buffer_load_dwordx4 v[72:75], v1, s[8:11], s40 offen offset:2048 sc1
    buffer_load_dwordx4 v[76:79], v1, s[8:11], s40 offen offset:3072 sc1
    s_waitcnt vmcnt(15) lgkmcnt(4)
    v_mfma_f32_16x16x32_bf16 v[112:115], v[80:83], v[16:19], 0
    ds_read_b128 v[104:107], v4 offset:10240
    v_mfma_f32_16x16x32_bf16 v[116:119], v[84:87], v[16:19], 0
    ds_read_b128 v[108:111], v4 offset:11264
    s_waitcnt lgkmcnt(4)
    v_mfma_f32_16x16x32_bf16 v[120:123], v[88:91], v[16:19], 0
    ds_read_b128 v[80:83], v4 offset:12288
    v_mfma_f32_16x16x32_bf16 v[124:127], v[92:95], v[16:19], 0
    ds_read_b128 v[84:87], v4 offset:13312
    s_waitcnt lgkmcnt(4)
    v_mfma_f32_16x16x32_bf16 v[128:131], v[96:99], v[16:19], 0
    ds_read_b128 v[88:91], v4 offset:14336
    v_mfma_f32_16x16x32_bf16 v[132:135], v[100:103], v[16:19], 0
    ds_read_b128 v[92:95], v4 offset:15360
    s_waitcnt vmcnt(14) lgkmcnt(4)
    v_mfma_f32_16x16x32_bf16 v[112:115], v[104:107], v[20:23], v[112:115]
    ds_read_b128 v[96:99], v4 offset:20480
    v_mfma_f32_16x16x32_bf16 v[116:119], v[108:111], v[20:23], v[116:119]
    ds_read_b128 v[100:103], v4 offset:21504
    s_waitcnt lgkmcnt(4)
    v_mfma_f32_16x16x32_bf16 v[120:123], v[80:83], v[20:23], v[120:123]
    ds_read_b128 v[104:107], v4 offset:22528
    v_mfma_f32_16x16x32_bf16 v[124:127], v[84:87], v[20:23], v[124:127]
    ds_read_b128 v[108:111], v4 offset:23552
    s_waitcnt lgkmcnt(4)
    v_mfma_f32_16x16x32_bf16 v[128:131], v[88:91], v[20:23], v[128:131]
    ds_read_b128 v[80:83], v4 offset:24576
    v_mfma_f32_16x16x32_bf16 v[132:135], v[92:95], v[20:23], v[132:135]
    ds_read_b128 v[84:87], v4 offset:25600
    s_waitcnt vmcnt(13) lgkmcnt(4)
    v_mfma_f32_16x16x32_bf16 v[112:115], v[96:99], v[24:27], v[112:115]
    ds_read_b128 v[88:91], v4 offset:30720
    v_mfma_f32_16x16x32_bf16 v[116:119], v[100:103], v[24:27], v[116:119]
    ds_read_b128 v[92:95], v4 offset:31744
    s_waitcnt lgkmcnt(4)
    v_mfma_f32_16x16x32_bf16 v[120:123], v[104:107], v[24:27], v[120:123]
    ds_read_b128 v[96:99], v4 offset:32768
    v_mfma_f32_16x16x32_bf16 v[124:127], v[108:111], v[24:27], v[124:127]
    ds_read_b128 v[100:103], v4 offset:33792
    s_waitcnt lgkmcnt(4)
    v_mfma_f32_16x16x32_bf16 v[128:131], v[80:83], v[24:27], v[128:131]
    ds_read_b128 v[104:107], v4 offset:34816
    v_mfma_f32_16x16x32_bf16 v[132:135], v[84:87], v[24:27], v[132:135]
    ds_read_b128 v[108:111], v4 offset:35840
    s_waitcnt vmcnt(12) lgkmcnt(4)
    v_mfma_f32_16x16x32_bf16 v[112:115], v[88:91], v[28:31], v[112:115]
    ds_read_b128 v[80:83], v4 offset:40960
    v_mfma_f32_16x16x32_bf16 v[116:119], v[92:95], v[28:31], v[116:119]
    ds_read_b128 v[84:87], v4 offset:41984
    s_waitcnt lgkmcnt(4)
    v_mfma_f32_16x16x32_bf16 v[120:123], v[96:99], v[28:31], v[120:123]
    ds_read_b128 v[88:91], v4 offset:43008
    v_mfma_f32_16x16x32_bf16 v[124:127], v[100:103], v[28:31], v[124:127]
    ds_read_b128 v[92:95], v4 offset:44032
    s_waitcnt lgkmcnt(4)
    v_mfma_f32_16x16x32_bf16 v[128:131], v[104:107], v[28:31], v[128:131]
    ds_read_b128 v[96:99], v4 offset:45056
    v_mfma_f32_16x16x32_bf16 v[132:135], v[108:111], v[28:31], v[132:135]
    ds_read_b128 v[100:103], v4 offset:46080
    s_waitcnt vmcnt(11) lgkmcnt(4)
    v_mfma_f32_16x16x32_bf16 v[112:115], v[80:83], v[32:35], v[112:115]
    ds_read_b128 v[104:107], v4 offset:51200
    v_mfma_f32_16x16x32_bf16 v[116:119], v[84:87], v[32:35], v[116:119]
    ds_read_b128 v[108:111], v4 offset:52224
    s_waitcnt lgkmcnt(4)
    v_mfma_f32_16x16x32_bf16 v[120:123], v[88:91], v[32:35], v[120:123]
    ds_read_b128 v[80:83], v4 offset:53248
    v_mfma_f32_16x16x32_bf16 v[124:127], v[92:95], v[32:35], v[124:127]
    ds_read_b128 v[84:87], v4 offset:54272
    s_waitcnt lgkmcnt(4)
    v_mfma_f32_16x16x32_bf16 v[128:131], v[96:99], v[32:35], v[128:131]
    ds_read_b128 v[88:91], v4 offset:55296
    v_mfma_f32_16x16x32_bf16 v[132:135], v[100:103], v[32:35], v[132:135]
    ds_read_b128 v[92:95], v4 offset:56320
    s_waitcnt vmcnt(10) lgkmcnt(4)
    v_mfma_f32_16x16x32_bf16 v[112:115], v[104:107], v[36:39], v[112:115]
    ds_read_b128 v[96:99], v4 offset:61440
    v_mfma_f32_16x16x32_bf16 v[116:119], v[108:111], v[36:39], v[116:119]
    ds_read_b128 v[100:103], v4 offset:62464
    s_waitcnt lgkmcnt(4)
    v_mfma_f32_16x16x32_bf16 v[120:123], v[80:83], v[36:39], v[120:123]
    ds_read_b128 v[104:107], v4 offset:63488
    v_mfma_f32_16x16x32_bf16 v[124:127], v[84:87], v[36:39], v[124:127]
    ds_read_b128 v[108:111], v4 offset:64512
    s_waitcnt lgkmcnt(4)
    v_mfma_f32_16x16x32_bf16 v[128:131], v[88:91], v[36:39], v[128:131]
    ds_read_b128 v[80:83], v5 offset:0
    v_mfma_f32_16x16x32_bf16 v[132:135], v[92:95], v[36:39], v[132:135]
    ds_read_b128 v[84:87], v5 offset:1024
    s_waitcnt vmcnt(9) lgkmcnt(4)
    v_mfma_f32_16x16x32_bf16 v[112:115], v[96:99], v[40:43], v[112:115]
    ds_read_b128 v[88:91], v5 offset:6144
    v_mfma_f32_16x16x32_bf16 v[116:119], v[100:103], v[40:43], v[116:119]
    ds_read_b128 v[92:95], v5 offset:7168
    s_waitcnt lgkmcnt(4)
    v_mfma_f32_16x16x32_bf16 v[120:123], v[104:107], v[40:43], v[120:123]
    ds_read_b128 v[96:99], v5 offset:8192
    v_mfma_f32_16x16x32_bf16 v[124:127], v[108:111], v[40:43], v[124:127]
    ds_read_b128 v[100:103], v5 offset:9216
    s_waitcnt lgkmcnt(4)
    v_mfma_f32_16x16x32_bf16 v[128:131], v[80:83], v[40:43], v[128:131]
    ds_read_b128 v[104:107], v5 offset:10240
    v_mfma_f32_16x16x32_bf16 v[132:135], v[84:87], v[40:43], v[132:135]
    ds_read_b128 v[108:111], v5 offset:11264
    s_waitcnt vmcnt(8) lgkmcnt(4)
    v_mfma_f32_16x16x32_bf16 v[112:115], v[88:91], v[44:47], v[112:115]
    ds_read_b128 v[80:83], v5 offset:16384
    v_mfma_f32_16x16x32_bf16 v[116:119], v[92:95], v[44:47], v[116:119]
    ds_read_b128 v[84:87], v5 offset:17408
    s_waitcnt lgkmcnt(4)
    v_mfma_f32_16x16x32_bf16 v[120:123], v[96:99], v[44:47], v[120:123]
    ds_read_b128 v[88:91], v5 offset:18432
    v_mfma_f32_16x16x32_bf16 v[124:127], v[100:103], v[44:47], v[124:127]
    ds_read_b128 v[92:95], v5 offset:19456
    s_waitcnt lgkmcnt(4)
    v_mfma_f32_16x16x32_bf16 v[128:131], v[104:107], v[44:47], v[128:131]
    ds_read_b128 v[96:99], v5 offset:20480
    v_mfma_f32_16x16x32_bf16 v[132:135], v[108:111], v[44:47], v[132:135]
    ds_read_b128 v[100:103], v5 offset:21504
    s_waitcnt vmcnt(7) lgkmcnt(4)
    v_mfma_f32_16x16x32_bf16 v[112:115], v[80:83], v[48:51], v[112:115]
    ds_read_b128 v[104:107], v5 offset:26624
    v_mfma_f32_16x16x32_bf16 v[116:119], v[84:87], v[48:51], v[116:119]
    ds_read_b128 v[108:111], v5 offset:27648
    s_waitcnt lgkmcnt(4)
    v_mfma_f32_16x16x32_bf16 v[120:123], v[88:91], v[48:51], v[120:123]
    ds_read_b128 v[80:83], v5 offset:28672
    v_mfma_f32_16x16x32_bf16 v[124:127], v[92:95], v[48:51], v[124:127]
    ds_read_b128 v[84:87], v5 offset:29696
    s_waitcnt lgkmcnt(4)
    v_mfma_f32_16x16x32_bf16 v[128:131], v[96:99], v[48:51], v[128:131]
    ds_read_b128 v[88:91], v5 offset:30720
    v_mfma_f32_16x16x32_bf16 v[132:135], v[100:103], v[48:51], v[132:135]
    ds_read_b128 v[92:95], v5 offset:31744
    s_waitcnt vmcnt(6) lgkmcnt(4)
    v_mfma_f32_16x16x32_bf16 v[112:115], v[104:107], v[52:55], v[112:115]
    ds_read_b128 v[96:99], v5 offset:36864
    v_mfma_f32_16x16x32_bf16 v[116:119], v[108:111], v[52:55], v[116:119]
    ds_read_b128 v[100:103], v5 offset:37888
    s_waitcnt lgkmcnt(4)
    v_mfma_f32_16x16x32_bf16 v[120:123], v[80:83], v[52:55], v[120:123]
    ds_read_b128 v[104:107], v5 offset:38912
    v_mfma_f32_16x16x32_bf16 v[124:127], v[84:87], v[52:55], v[124:127]
    ds_read_b128 v[108:111], v5 offset:39936
    s_waitcnt lgkmcnt(4)
    v_mfma_f32_16x16x32_bf16 v[128:131], v[88:91], v[52:55], v[128:131]
    ds_read_b128 v[80:83], v5 offset:40960
    v_mfma_f32_16x16x32_bf16 v[132:135], v[92:95], v[52:55], v[132:135]
    ds_read_b128 v[84:87], v5 offset:41984
    s_waitcnt vmcnt(5) lgkmcnt(4)
    v_mfma_f32_16x16x32_bf16 v[112:115], v[96:99], v[56:59], v[112:115]
    ds_read_b128 v[88:91], v5 offset:47104
    v_mfma_f32_16x16x32_bf16 v[116:119], v[100:103], v[56:59], v[116:119]
    ds_read_b128 v[92:95], v5 offset:48128
    s_waitcnt lgkmcnt(4)
    v_mfma_f32_16x16x32_bf16 v[120:123], v[104:107], v[56:59], v[120:123]
    ds_read_b128 v[96:99], v5 offset:49152
    v_mfma_f32_16x16x32_bf16 v[124:127], v[108:111], v[56:59], v[124:127]
    ds_read_b128 v[100:103], v5 offset:50176
    s_waitcnt lgkmcnt(4)
    v_mfma_f32_16x16x32_bf16 v[128:131], v[80:83], v[56:59], v[128:131]
    ds_read_b128 v[104:107], v5 offset:51200
    v_mfma_f32_16x16x32_bf16 v[132:135], v[84:87], v[56:59], v[132:135]
    ds_read_b128 v[108:111], v5 offset:52224
    s_waitcnt vmcnt(4) lgkmcnt(4)
    v_mfma_f32_16x16x32_bf16 v[112:115], v[88:91], v[60:63], v[112:115]
    ds_read_b128 v[80:83], v5 offset:57344
    v_mfma_f32_16x16x32_bf16 v[116:119], v[92:95], v[60:63], v[116:119]
    ds_read_b128 v[84:87], v5 offset:58368
    s_waitcnt lgkmcnt(4)
    v_mfma_f32_16x16x32_bf16 v[120:123], v[96:99], v[60:63], v[120:123]
    ds_read_b128 v[88:91], v5 offset:59392
    v_mfma_f32_16x16x32_bf16 v[124:127], v[100:103], v[60:63], v[124:127]
    ds_read_b128 v[92:95], v5 offset:60416
    s_waitcnt lgkmcnt(4)
    v_mfma_f32_16x16x32_bf16 v[128:131], v[104:107], v[60:63], v[128:131]
    ds_read_b128 v[96:99], v5 offset:61440
    v_mfma_f32_16x16x32_bf16 v[132:135], v[108:111], v[60:63], v[132:135]
    ds_read_b128 v[100:103], v5 offset:62464
    s_waitcnt vmcnt(3) lgkmcnt(4)
    v_mfma_f32_16x16x32_bf16 v[112:115], v[80:83], v[64:67], v[112:115]
    ds_read_b128 v[104:107], v6 offset:2048
    v_mfma_f32_16x16x32_bf16 v[116:119], v[84:87], v[64:67], v[116:119]
    ds_read_b128 v[108:111], v6 offset:3072
    s_waitcnt lgkmcnt(4)
    v_mfma_f32_16x16x32_bf16 v[120:123], v[88:91], v[64:67], v[120:123]
    ds_read_b128 v[80:83], v6 offset:4096
    v_mfma_f32_16x16x32_bf16 v[124:127], v[92:95], v[64:67], v[124:127]
    ds_read_b128 v[84:87], v6 offset:5120
    s_waitcnt lgkmcnt(4)
    v_mfma_f32_16x16x32_bf16 v[128:131], v[96:99], v[64:67], v[128:131]
    ds_read_b128 v[88:91], v6 offset:6144
    v_mfma_f32_16x16x32_bf16 v[132:135], v[100:103], v[64:67], v[132:135]
    ds_read_b128 v[92:95], v6 offset:7168
    s_waitcnt vmcnt(2) lgkmcnt(4)
    v_mfma_f32_16x16x32_bf16 v[112:115], v[104:107], v[68:71], v[112:115]
    ds_read_b128 v[96:99], v6 offset:12288
    v_mfma_f32_16x16x32_bf16 v[116:119], v[108:111], v[68:71], v[116:119]
    ds_read_b128 v[100:103], v6 offset:13312
    s_waitcnt lgkmcnt(4)
    v_mfma_f32_16x16x32_bf16 v[120:123], v[80:83], v[68:71], v[120:123]
    ds_read_b128 v[104:107], v6 offset:14336
    v_mfma_f32_16x16x32_bf16 v[124:127], v[84:87], v[68:71], v[124:127]
    ds_read_b128 v[108:111], v6 offset:15360
    s_waitcnt lgkmcnt(4)
    v_mfma_f32_16x16x32_bf16 v[128:131], v[88:91], v[68:71], v[128:131]
    ds_read_b128 v[80:83], v6 offset:16384
    v_mfma_f32_16x16x32_bf16 v[132:135], v[92:95], v[68:71], v[132:135]
    ds_read_b128 v[84:87], v6 offset:17408
    s_waitcnt vmcnt(1) lgkmcnt(4)
    v_mfma_f32_16x16x32_bf16 v[112:115], v[96:99], v[72:75], v[112:115]
    ds_read_b128 v[88:91], v6 offset:22528
    v_mfma_f32_16x16x32_bf16 v[116:119], v[100:103], v[72:75], v[116:119]
    ds_read_b128 v[92:95], v6 offset:23552
    s_waitcnt lgkmcnt(4)
    v_mfma_f32_16x16x32_bf16 v[120:123], v[104:107], v[72:75], v[120:123]
    ds_read_b128 v[96:99], v6 offset:24576
    v_mfma_f32_16x16x32_bf16 v[124:127], v[108:111], v[72:75], v[124:127]
    ds_read_b128 v[100:103], v6 offset:25600
    s_waitcnt lgkmcnt(4)
    v_mfma_f32_16x16x32_bf16 v[128:131], v[80:83], v[72:75], v[128:131]
    ds_read_b128 v[104:107], v6 offset:26624
    v_mfma_f32_16x16x32_bf16 v[132:135], v[84:87], v[72:75], v[132:135]
    ds_read_b128 v[108:111], v6 offset:27648
    s_waitcnt vmcnt(0) lgkmcnt(4)
    v_mfma_f32_16x16x32_bf16 v[112:115], v[88:91], v[76:79], v[112:115]
    v_mfma_f32_16x16x32_bf16 v[116:119], v[92:95], v[76:79], v[116:119]
    s_waitcnt lgkmcnt(2)
    v_mfma_f32_16x16x32_bf16 v[120:123], v[96:99], v[76:79], v[120:123]
    v_mfma_f32_16x16x32_bf16 v[124:127], v[100:103], v[76:79], v[124:127]
    s_waitcnt lgkmcnt(0)
    v_mfma_f32_16x16x32_bf16 v[128:131], v[104:107], v[76:79], v[128:131]
    v_mfma_f32_16x16x32_bf16 v[132:135], v[108:111], v[76:79], v[132:135]
    buffer_store_dwordx4 v[116:119], v12, s[8:11], s44 offen offset:128 sc1
    buffer_store_dwordx4 v[120:123], v12, s[8:11], s44 offen offset:256 sc1
    buffer_store_dwordx4 v[124:127], v12, s[8:11], s44 offen offset:384 sc1
    s_nop 0
    buffer_store_dwordx4 v[128:131], v12, s[8:11], s44 offen offset:512 sc1
    s_cmp_lg_u32 s46, 0
    s_cbranch_scc1 woh_168
    buffer_store_dwordx4 v[112:115], v12, s[8:11], s44 offen sc1
    s_branch wod_169
woh_168:
    s_nop 0
    buffer_store_dwordx4 v[132:135], v12, s[8:11], s44 offen offset:640 sc1
wod_169:
    s_lshl_b32 s75, s76, 7
    s_add_u32 s75, s75, 2375680
    s_waitcnt vmcnt(0) lgkmcnt(0)
    s_barrier
    s_cmp_lg_u32 s36, 0
    s_cbranch_scc1 sg_170
    v_mov_b32 v4, 0
    v_mov_b32 v5, 1
    s_mov_b64 exec, 1
    buffer_atomic_add v5, v4, s[8:11], s75 offen
    s_mov_b64 exec, -1
sg_170:
    s_add_u32 s76, s76, 2
    s_cmp_lt_u32 s76, 64
    s_cbranch_scc1 wotop_165
    s_branch main_end
rff1_161:
    s_cmp_eq_u32 s38, 5
    s_cbranch_scc1 g5_171
    s_cmp_ge_u32 s37, 27
    s_cbranch_scc1 main_end
    s_load_dwordx2 s[12:13], s[0:1], 64
    s_waitcnt lgkmcnt(0)
    s_and_b32 s13, s13, 0xffff
    s_mov_b32 s14, 2211840
    s_mov_b32 s15, 0x20000
    s_lshl_b32 s41, s37, 7
    v_bfe_u32 v2, v0, 4, 2
    v_lshlrev_b32 v3, 3, v2
    v_bfe_u32 v2, v0, 2, 2
    v_lshl_add_u32 v3, v2, 0, v3
    s_mov_b32 s55, 3456
    v_mul_lo_u32 v3, v3, s55
    v_lshrrev_b32 v2, 3, v0
    v_and_b32 v2, 2, v2
    v_xor_b32 v2, v2, v0
    v_and_b32 v2, 3, v2
    v_lshl_add_u32 v3, v2, 4, v3
    v_bfe_u32 v2, v0, 2, 4
    v_lshlrev_b32 v4, 6, v2
    v_bfe_u32 v2, v0, 4, 1
    v_lshl_add_u32 v4, v2, 5, v4
    v_bfe_u32 v2, v0, 0, 2
    v_lshl_add_u32 v4, v2, 3, v4
    v_xor_b32 v5, 32, v4
    s_mul_i32 s54, s36, 110592
    s_add_u32 s41, s41, s54
    s_mul_i32 s42, s36, 4096
    s_add_u32 m0, s42, 0
    s_add_u32 s54, s41, 0
    buffer_load_dwordx4 v3, s[12:15], s54 offen lds
    s_add_u32 m0, s42, 1024
    s_add_u32 s54, s41, 13824
    buffer_load_dwordx4 v3, s[12:15], s54 offen lds
    s_add_u32 m0, s42, 2048
    s_add_u32 s54, s41, 64
    buffer_load_dwordx4 v3, s[12:15], s54 offen lds
    s_add_u32 m0, s42, 3072
    s_add_u32 s54, s41, 13888
    buffer_load_dwordx4 v3, s[12:15], s54 offen lds
    s_add_u32 m0, s42, 16384
    s_add_u32 s54, s41, 442368
    buffer_load_dwordx4 v3, s[12:15], s54 offen lds
    s_add_u32 m0, s42, 17408
    s_add_u32 s54, s41, 456192
    buffer_load_dwordx4 v3, s[12:15], s54 offen lds
    s_add_u32 m0, s42, 18432
    s_add_u32 s54, s41, 442432
    buffer_load_dwordx4 v3, s[12:15], s54 offen lds
    s_add_u32 m0, s42, 19456
    s_add_u32 s54, s41, 456256
    buffer_load_dwordx4 v3, s[12:15], s54 offen lds
    s_add_u32 m0, s42, 32768
    s_add_u32 s54, s41, 884736
    buffer_load_dwordx4 v3, s[12:15], s54 offen lds
    s_add_u32 m0, s42, 33792
    s_add_u32 s54, s41, 898560
    buffer_load_dwordx4 v3, s[12:15], s54 offen lds
    s_add_u32 m0, s42, 34816
    s_add_u32 s54, s41, 884800
    buffer_load_dwordx4 v3, s[12:15], s54 offen lds
    s_add_u32 m0, s42, 35840
    s_add_u32 s54, s41, 898624
    buffer_load_dwordx4 v3, s[12:15], s54 offen lds
    s_add_u32 m0, s42, 49152
    s_add_u32 s54, s41, 1327104
    buffer_load_dwordx4 v3, s[12:15], s54 offen lds
    s_add_u32 m0, s42, 50176
    s_add_u32 s54, s41, 1340928
    buffer_load_dwordx4 v3, s[12:15], s54 offen lds
    s_add_u32 m0, s42, 51200
    s_add_u32 s54, s41, 1327168
    buffer_load_dwordx4 v3, s[12:15], s54 offen lds
    s_add_u32 m0, s42, 52224
    s_add_u32 s54, s41, 1340992
    buffer_load_dwordx4 v3, s[12:15], s54 offen lds
    s_add_u32 m0, s42, 65536
    s_add_u32 s54, s41, 1769472
    buffer_load_dwordx4 v3, s[12:15], s54 offen lds
    s_add_u32 m0, s42, 66560
    s_add_u32 s54, s41, 1783296
    buffer_load_dwordx4 v3, s[12:15], s54 offen lds
    s_add_u32 m0, s42, 67584
    s_add_u32 s54, s41, 1769536
    buffer_load_dwordx4 v3, s[12:15], s54 offen lds
    s_add_u32 m0, s42, 68608
    s_add_u32 s54, s41, 1783360
    buffer_load_dwordx4 v3, s[12:15], s54 offen lds
    s_waitcnt vmcnt(0)
    v_lshrrev_b32 v3, 2, v0
    s_mov_b32 s55, 16
    v_mul_lo_u32 v3, v3, s55
    v_lshrrev_b32 v2, 3, v0
    v_and_b32 v2, 2, v2
    v_xor_b32 v2, v2, v0
    v_and_b32 v2, 3, v2
    v_lshl_add_u32 v3, v2, 4, v3
    v_bfe_u32 v2, v0, 2, 4
    v_lshlrev_b32 v4, 6, v2
    v_bfe_u32 v2, v0, 4, 1
    v_lshl_add_u32 v4, v2, 5, v4
    v_bfe_u32 v2, v0, 0, 2
    v_lshl_add_u32 v4, v2, 3, v4
    v_xor_b32 v5, 32, v4
    s_mul_i32 s54, s36, 4096
    s_add_u32 s54, s54, 0
    v_add_u32 v4, s54, v4
    v_add_u32 v5, s54, v5
    v_lshlrev_b32 v6, 4, v0
    v_add_u32 v6, s54, v6
    s_mov_b32 s43, 5
cv_172:
    ds_read_b64_tr_b16 v[16:17], v4 offset:0
    ds_read_b64_tr_b16 v[18:19], v4 offset:1024
    ds_read_b64_tr_b16 v[20:21], v5 offset:0
    ds_read_b64_tr_b16 v[22:23], v5 offset:1024
    ds_read_b64_tr_b16 v[24:25], v4 offset:2048
    ds_read_b64_tr_b16 v[26:27], v4 offset:3072
    ds_read_b64_tr_b16 v[28:29], v5 offset:2048
    ds_read_b64_tr_b16 v[30:31], v5 offset:3072
    s_waitcnt lgkmcnt(0)
    s_waitcnt lgkmcnt(0)
    ds_write_b128 v6, v[16:19] offset:0
    ds_write_b128 v6, v[20:23] offset:1024
    ds_write_b128 v6, v[24:27] offset:2048
    ds_write_b128 v6, v[28:31] offset:3072
    v_add_u32 v4, 16384, v4
    v_add_u32 v5, 16384, v5
    v_add_u32 v6, 16384, v6
    s_waitcnt lgkmcnt(0)
    s_sub_u32 s43, s43, 1
    s_cmp_lg_u32 s43, 0
    s_cbranch_scc1 cv_172
    s_barrier
f1top_173:
    s_lshl_b32 s45, s76, 2
    s_add_u32 s45, s45, s36
    s_mul_i32 s40, s45, 20480
    s_add_u32 s40, s40, 16777216
    s_mul_i32 s44, s45, 55296
    s_mul_i32 s55, s37, 2048
    s_add_u32 s44, s44, s55
    s_add_u32 s44, s44, 20971520
    v_lshlrev_b32 v1, 4, v0
    v_mov_b32 v4, v1
    v_add_u32 v5, 0x10000, v4
    v_add_u32 v6, 0x20000, v4
    ds_read_b128 v[96:99], v4 offset:0
    ds_read_b128 v[100:103], v4 offset:1024
    ds_read_b128 v[104:107], v4 offset:2048
    ds_read_b128 v[108:111], v4 offset:3072
    ds_read_b128 v[112:115], v4 offset:4096
    ds_read_b128 v[116:119], v4 offset:5120
    s_lshl_b32 s75, s45, 7
    s_add_u32 s75, s75, 2392064
    v_min_u32 v14, 0, v0
    v_mul_u32_u24 v14, 0, v14
wt_174:
    buffer_load_dword v15, v14, s[8:11], s75 offen sc1
    s_waitcnt vmcnt(0)
    v_cmp_gt_u32 vcc, 8, v15
    s_nop 0
    s_cbranch_vccz wd_175
    s_sleep 3
    s_sub_u32 s53, s53, 1
    s_cbranch_scc0 wt_174
    s_mov_b32 s53, 0
wd_175:
    buffer_load_dwordx4 v[16:19], v1, s[8:11], s40 offen offset:0 sc1
    buffer_load_dwordx4 v[20:23], v1, s[8:11], s40 offen offset:1024 sc1
    buffer_load_dwordx4 v[24:27], v1, s[8:11], s40 offen offset:2048 sc1
    buffer_load_dwordx4 v[28:31], v1, s[8:11], s40 offen offset:3072 sc1
    s_add_u32 s40, s40, 4096
    buffer_load_dwordx4 v[32:35], v1, s[8:11], s40 offen offset:0 sc1
    buffer_load_dwordx4 v[36:39], v1, s[8:11], s40 offen offset:1024 sc1
    buffer_load_dwordx4 v[40:43], v1, s[8:11], s40 offen offset:2048 sc1
    buffer_load_dwordx4 v[44:47], v1, s[8:11], s40 offen offset:3072 sc1
    s_add_u32 s40, s40, 4096
    buffer_load_dwordx4 v[48:51], v1, s[8:11], s40 offen offset:0 sc1
    buffer_load_dwordx4 v[52:55], v1, s[8:11], s40 offen offset:1024 sc1
    buffer_load_dwordx4 v[56:59], v1, s[8:11], s40 offen offset:2048 sc1
    buffer_load_dwordx4 v[60:63], v1, s[8:11], s40 offen offset:3072 sc1
    s_add_u32 s40, s40, 4096
    buffer_load_dwordx4 v[64:67], v1, s[8:11], s40 offen offset:0 sc1
    buffer_load_dwordx4 v[68:71], v1, s[8:11], s40 offen offset:1024 sc1
    buffer_load_dwordx4 v[72:75], v1, s[8:11], s40 offen offset:2048 sc1
    buffer_load_dwordx4 v[76:79], v1, s[8:11], s40 offen offset:3072 sc1
    s_add_u32 s40, s40, 4096
    buffer_load_dwordx4 v[80:83], v1, s[8:11], s40 offen offset:0 sc1
    buffer_load_dwordx4 v[84:87], v1, s[8:11], s40 offen offset:1024 sc1
    buffer_load_dwordx4 v[88:91], v1, s[8:11], s40 offen offset:2048 sc1
    buffer_load_dwordx4 v[92:95], v1, s[8:11], s40 offen offset:3072 sc1
    s_waitcnt vmcnt(19) lgkmcnt(4)
    v_mfma_f32_16x16x32_bf16 v[128:131], v[96:99], v[16:19], 0
    ds_read_b128 v[120:123], v4 offset:6144
    v_mfma_f32_16x16x32_bf16 v[132:135], v[100:103], v[16:19], 0
    ds_read_b128 v[124:127], v4 offset:7168
    s_waitcnt lgkmcnt(4)
    v_mfma_f32_16x16x32_bf16 v[136:139], v[104:107], v[16:19], 0
    ds_read_b128 v[96:99], v4 offset:8192
    v_mfma_f32_16x16x32_bf16 v[140:143], v[108:111], v[16:19], 0
    ds_read_b128 v[100:103], v4 offset:9216
    s_waitcnt vmcnt(18) lgkmcnt(4)
    v_mfma_f32_16x16x32_bf16 v[128:131], v[112:115], v[20:23], v[128:131]
    ds_read_b128 v[104:107], v4 offset:10240
    v_mfma_f32_16x16x32_bf16 v[132:135], v[116:119], v[20:23], v[132:135]
    ds_read_b128 v[108:111], v4 offset:11264
    s_waitcnt lgkmcnt(4)
    v_mfma_f32_16x16x32_bf16 v[136:139], v[120:123], v[20:23], v[136:139]
    ds_read_b128 v[112:115], v4 offset:12288
    v_mfma_f32_16x16x32_bf16 v[140:143], v[124:127], v[20:23], v[140:143]
    ds_read_b128 v[116:119], v4 offset:13312
    s_waitcnt vmcnt(17) lgkmcnt(4)
    v_mfma_f32_16x16x32_bf16 v[128:131], v[96:99], v[24:27], v[128:131]
    ds_read_b128 v[120:123], v4 offset:14336
    v_mfma_f32_16x16x32_bf16 v[132:135], v[100:103], v[24:27], v[132:135]
    ds_read_b128 v[124:127], v4 offset:15360
    s_waitcnt lgkmcnt(4)
    v_mfma_f32_16x16x32_bf16 v[136:139], v[104:107], v[24:27], v[136:139]
    ds_read_b128 v[96:99], v4 offset:16384
    v_mfma_f32_16x16x32_bf16 v[140:143], v[108:111], v[24:27], v[140:143]
    ds_read_b128 v[100:103], v4 offset:17408
    s_waitcnt vmcnt(16) lgkmcnt(4)
    v_mfma_f32_16x16x32_bf16 v[128:131], v[112:115], v[28:31], v[128:131]
    ds_read_b128 v[104:107], v4 offset:18432
    v_mfma_f32_16x16x32_bf16 v[132:135], v[116:119], v[28:31], v[132:135]
    ds_read_b128 v[108:111], v4 offset:19456
    s_waitcnt lgkmcnt(4)
    v_mfma_f32_16x16x32_bf16 v[136:139], v[120:123], v[28:31], v[136:139]
    ds_read_b128 v[112:115], v4 offset:20480
    v_mfma_f32_16x16x32_bf16 v[140:143], v[124:127], v[28:31], v[140:143]
    ds_read_b128 v[116:119], v4 offset:21504
    s_waitcnt vmcnt(15) lgkmcnt(4)
    v_mfma_f32_16x16x32_bf16 v[128:131], v[96:99], v[32:35], v[128:131]
    ds_read_b128 v[120:123], v4 offset:22528
    v_mfma_f32_16x16x32_bf16 v[132:135], v[100:103], v[32:35], v[132:135]
    ds_read_b128 v[124:127], v4 offset:23552
    s_waitcnt lgkmcnt(4)
    v_mfma_f32_16x16x32_bf16 v[136:139], v[104:107], v[32:35], v[136:139]
    ds_read_b128 v[96:99], v4 offset:24576
    v_mfma_f32_16x16x32_bf16 v[140:143], v[108:111], v[32:35], v[140:143]
    ds_read_b128 v[100:103], v4 offset:25600
    s_waitcnt vmcnt(14) lgkmcnt(4)
    v_mfma_f32_16x16x32_bf16 v[128:131], v[112:115], v[36:39], v[128:131]
    ds_read_b128 v[104:107], v4 offset:26624
    v_mfma_f32_16x16x32_bf16 v[132:135], v[116:119], v[36:39], v[132:135]
    ds_read_b128 v[108:111], v4 offset:27648
    s_waitcnt lgkmcnt(4)
    v_mfma_f32_16x16x32_bf16 v[136:139], v[120:123], v[36:39], v[136:139]
    ds_read_b128 v[112:115], v4 offset:28672
    v_mfma_f32_16x16x32_bf16 v[140:143], v[124:127], v[36:39], v[140:143]
    ds_read_b128 v[116:119], v4 offset:29696
    s_waitcnt vmcnt(13) lgkmcnt(4)
    v_mfma_f32_16x16x32_bf16 v[128:131], v[96:99], v[40:43], v[128:131]
    ds_read_b128 v[120:123], v4 offset:30720
    v_mfma_f32_16x16x32_bf16 v[132:135], v[100:103], v[40:43], v[132:135]
    ds_read_b128 v[124:127], v4 offset:31744
    s_waitcnt lgkmcnt(4)
    v_mfma_f32_16x16x32_bf16 v[136:139], v[104:107], v[40:43], v[136:139]
    ds_read_b128 v[96:99], v4 offset:32768
    v_mfma_f32_16x16x32_bf16 v[140:143], v[108:111], v[40:43], v[140:143]
    ds_read_b128 v[100:103], v4 offset:33792
    s_waitcnt vmcnt(12) lgkmcnt(4)
    v_mfma_f32_16x16x32_bf16 v[128:131], v[112:115], v[44:47], v[128:131]
    ds_read_b128 v[104:107], v4 offset:34816
    v_mfma_f32_16x16x32_bf16 v[132:135], v[116:119], v[44:47], v[132:135]
    ds_read_b128 v[108:111], v4 offset:35840
    s_waitcnt lgkmcnt(4)
    v_mfma_f32_16x16x32_bf16 v[136:139], v[120:123], v[44:47], v[136:139]
    ds_read_b128 v[112:115], v4 offset:36864
    v_mfma_f32_16x16x32_bf16 v[140:143], v[124:127], v[44:47], v[140:143]
    ds_read_b128 v[116:119], v4 offset:37888
    s_waitcnt vmcnt(11) lgkmcnt(4)
    v_mfma_f32_16x16x32_bf16 v[128:131], v[96:99], v[48:51], v[128:131]
    ds_read_b128 v[120:123], v4 offset:38912
    v_mfma_f32_16x16x32_bf16 v[132:135], v[100:103], v[48:51], v[132:135]
    ds_read_b128 v[124:127], v4 offset:39936
    s_waitcnt lgkmcnt(4)
    v_mfma_f32_16x16x32_bf16 v[136:139], v[104:107], v[48:51], v[136:139]
    ds_read_b128 v[96:99], v4 offset:40960
    v_mfma_f32_16x16x32_bf16 v[140:143], v[108:111], v[48:51], v[140:143]
    ds_read_b128 v[100:103], v4 offset:41984
    s_waitcnt vmcnt(10) lgkmcnt(4)
    v_mfma_f32_16x16x32_bf16 v[128:131], v[112:115], v[52:55], v[128:131]
    ds_read_b128 v[104:107], v4 offset:43008
    v_mfma_f32_16x16x32_bf16 v[132:135], v[116:119], v[52:55], v[132:135]
    ds_read_b128 v[108:111], v4 offset:44032
    s_waitcnt lgkmcnt(4)
    v_mfma_f32_16x16x32_bf16 v[136:139], v[120:123], v[52:55], v[136:139]
    ds_read_b128 v[112:115], v4 offset:45056
    v_mfma_f32_16x16x32_bf16 v[140:143], v[124:127], v[52:55], v[140:143]
    ds_read_b128 v[116:119], v4 offset:46080
    s_waitcnt vmcnt(9) lgkmcnt(4)
    v_mfma_f32_16x16x32_bf16 v[128:131], v[96:99], v[56:59], v[128:131]
    ds_read_b128 v[120:123], v4 offset:47104
    v_mfma_f32_16x16x32_bf16 v[132:135], v[100:103], v[56:59], v[132:135]
    ds_read_b128 v[124:127], v4 offset:48128
    s_waitcnt lgkmcnt(4)
    v_mfma_f32_16x16x32_bf16 v[136:139], v[104:107], v[56:59], v[136:139]
    ds_read_b128 v[96:99], v4 offset:49152
    v_mfma_f32_16x16x32_bf16 v[140:143], v[108:111], v[56:59], v[140:143]
    ds_read_b128 v[100:103], v4 offset:50176
    s_waitcnt vmcnt(8) lgkmcnt(4)
    v_mfma_f32_16x16x32_bf16 v[128:131], v[112:115], v[60:63], v[128:131]
    ds_read_b128 v[104:107], v4 offset:51200
    v_mfma_f32_16x16x32_bf16 v[132:135], v[116:119], v[60:63], v[132:135]
    ds_read_b128 v[108:111], v4 offset:52224
    s_waitcnt lgkmcnt(4)
    v_mfma_f32_16x16x32_bf16 v[136:139], v[120:123], v[60:63], v[136:139]
    ds_read_b128 v[112:115], v4 offset:53248
    v_mfma_f32_16x16x32_bf16 v[140:143], v[124:127], v[60:63], v[140:143]
    ds_read_b128 v[116:119], v4 offset:54272
    s_waitcnt vmcnt(7) lgkmcnt(4)
    v_mfma_f32_16x16x32_bf16 v[128:131], v[96:99], v[64:67], v[128:131]
    ds_read_b128 v[120:123], v4 offset:55296
    v_mfma_f32_16x16x32_bf16 v[132:135], v[100:103], v[64:67], v[132:135]
    ds_read_b128 v[124:127], v4 offset:56320
    s_waitcnt lgkmcnt(4)
    v_mfma_f32_16x16x32_bf16 v[136:139], v[104:107], v[64:67], v[136:139]
    ds_read_b128 v[96:99], v4 offset:57344
    v_mfma_f32_16x16x32_bf16 v[140:143], v[108:111], v[64:67], v[140:143]
    ds_read_b128 v[100:103], v4 offset:58368
    s_waitcnt vmcnt(6) lgkmcnt(4)
    v_mfma_f32_16x16x32_bf16 v[128:131], v[112:115], v[68:71], v[128:131]
    ds_read_b128 v[104:107], v4 offset:59392
    v_mfma_f32_16x16x32_bf16 v[132:135], v[116:119], v[68:71], v[132:135]
    ds_read_b128 v[108:111], v4 offset:60416
    s_waitcnt lgkmcnt(4)
    v_mfma_f32_16x16x32_bf16 v[136:139], v[120:123], v[68:71], v[136:139]
    ds_read_b128 v[112:115], v4 offset:61440
    v_mfma_f32_16x16x32_bf16 v[140:143], v[124:127], v[68:71], v[140:143]
    ds_read_b128 v[116:119], v4 offset:62464
    s_waitcnt vmcnt(5) lgkmcnt(4)
    v_mfma_f32_16x16x32_bf16 v[128:131], v[96:99], v[72:75], v[128:131]
    ds_read_b128 v[120:123], v4 offset:63488
    v_mfma_f32_16x16x32_bf16 v[132:135], v[100:103], v[72:75], v[132:135]
    ds_read_b128 v[124:127], v4 offset:64512
    s_waitcnt lgkmcnt(4)
    v_mfma_f32_16x16x32_bf16 v[136:139], v[104:107], v[72:75], v[136:139]
    ds_read_b128 v[96:99], v5 offset:0
    v_mfma_f32_16x16x32_bf16 v[140:143], v[108:111], v[72:75], v[140:143]
    ds_read_b128 v[100:103], v5 offset:1024
    s_waitcnt vmcnt(4) lgkmcnt(4)
    v_mfma_f32_16x16x32_bf16 v[128:131], v[112:115], v[76:79], v[128:131]
    ds_read_b128 v[104:107], v5 offset:2048
    v_mfma_f32_16x16x32_bf16 v[132:135], v[116:119], v[76:79], v[132:135]
    ds_read_b128 v[108:111], v5 offset:3072
    s_waitcnt lgkmcnt(4)
    v_mfma_f32_16x16x32_bf16 v[136:139], v[120:123], v[76:79], v[136:139]
    ds_read_b128 v[112:115], v5 offset:4096
    v_mfma_f32_16x16x32_bf16 v[140:143], v[124:127], v[76:79], v[140:143]
    ds_read_b128 v[116:119], v5 offset:5120
    s_waitcnt vmcnt(3) lgkmcnt(4)
    v_mfma_f32_16x16x32_bf16 v[128:131], v[96:99], v[80:83], v[128:131]
    ds_read_b128 v[120:123], v5 offset:6144
    v_mfma_f32_16x16x32_bf16 v[132:135], v[100:103], v[80:83], v[132:135]
    ds_read_b128 v[124:127], v5 offset:7168
    s_waitcnt lgkmcnt(4)
    v_mfma_f32_16x16x32_bf16 v[136:139], v[104:107], v[80:83], v[136:139]
    ds_read_b128 v[96:99], v5 offset:8192
    v_mfma_f32_16x16x32_bf16 v[140:143], v[108:111], v[80:83], v[140:143]
    ds_read_b128 v[100:103], v5 offset:9216
    s_waitcnt vmcnt(2) lgkmcnt(4)
    v_mfma_f32_16x16x32_bf16 v[128:131], v[112:115], v[84:87], v[128:131]
    ds_read_b128 v[104:107], v5 offset:10240
    v_mfma_f32_16x16x32_bf16 v[132:135], v[116:119], v[84:87], v[132:135]
    ds_read_b128 v[108:111], v5 offset:11264
    s_waitcnt lgkmcnt(4)
    v_mfma_f32_16x16x32_bf16 v[136:139], v[120:123], v[84:87], v[136:139]
    ds_read_b128 v[112:115], v5 offset:12288
    v_mfma_f32_16x16x32_bf16 v[140:143], v[124:127], v[84:87], v[140:143]
    ds_read_b128 v[116:119], v5 offset:13312
    s_waitcnt vmcnt(1) lgkmcnt(4)
    v_mfma_f32_16x16x32_bf16 v[128:131], v[96:99], v[88:91], v[128:131]
    ds_read_b128 v[120:123], v5 offset:14336
    v_mfma_f32_16x16x32_bf16 v[132:135], v[100:103], v[88:91], v[132:135]
    ds_read_b128 v[124:127], v5 offset:15360
    s_waitcnt lgkmcnt(4)
    v_mfma_f32_16x16x32_bf16 v[136:139], v[104:107], v[88:91], v[136:139]
    v_mfma_f32_16x16x32_bf16 v[140:143], v[108:111], v[88:91], v[140:143]
    s_waitcnt vmcnt(0) lgkmcnt(2)
    v_mfma_f32_16x16x32_bf16 v[128:131], v[112:115], v[92:95], v[128:131]
    v_mfma_f32_16x16x32_bf16 v[132:135], v[116:119], v[92:95], v[132:135]
    s_waitcnt lgkmcnt(0)
    v_mfma_f32_16x16x32_bf16 v[136:139], v[120:123], v[92:95], v[136:139]
    v_mfma_f32_16x16x32_bf16 v[140:143], v[124:127], v[92:95], v[140:143]
    v_cvt_pk_bf16_f32 v129, v128, v129
    v_lshlrev_b32 v128, 16, v129
    v_and_b32 v129, 0xffff0000, v129
    v_cvt_pk_bf16_f32 v131, v130, v131
    v_lshlrev_b32 v130, 16, v131
    v_and_b32 v131, 0xffff0000, v131
    v_cvt_pk_bf16_f32 v133, v132, v133
    v_lshlrev_b32 v132, 16, v133
    v_and_b32 v133, 0xffff0000, v133
    v_cvt_pk_bf16_f32 v135, v134, v135
    v_lshlrev_b32 v134, 16, v135
    v_and_b32 v135, 0xffff0000, v135
    v_mul_f32 v16, 0xbfb8aa3b, v128
    v_mul_f32 v17, 0xbfb8aa3b, v129
    v_mul_f32 v18, 0xbfb8aa3b, v130
    v_mul_f32 v19, 0xbfb8aa3b, v131
    v_mul_f32 v20, 0xbfb8aa3b, v132
    v_mul_f32 v21, 0xbfb8aa3b, v133
    v_mul_f32 v22, 0xbfb8aa3b, v134
    v_mul_f32 v23, 0xbfb8aa3b, v135
    v_exp_f32 v16, v16
    v_exp_f32 v17, v17
    v_exp_f32 v18, v18
    v_exp_f32 v19, v19
    v_exp_f32 v20, v20
    v_exp_f32 v21, v21
    v_exp_f32 v22, v22
    v_exp_f32 v23, v23
    v_add_f32 v16, 1.0, v16
    v_add_f32 v17, 1.0, v17
    v_add_f32 v18, 1.0, v18
    v_add_f32 v19, 1.0, v19
    v_add_f32 v20, 1.0, v20
    v_add_f32 v21, 1.0, v21
    v_add_f32 v22, 1.0, v22
    v_add_f32 v23, 1.0, v23
    v_rcp_f32 v16, v16
    v_rcp_f32 v17, v17
    v_rcp_f32 v18, v18
    v_rcp_f32 v19, v19
    v_rcp_f32 v20, v20
    v_rcp_f32 v21, v21
    v_rcp_f32 v22, v22
    v_rcp_f32 v23, v23
    v_pk_mul_f32 v[128:129], v[128:129], v[16:17]
    v_pk_mul_f32 v[130:131], v[130:131], v[18:19]
    v_pk_mul_f32 v[132:133], v[132:133], v[20:21]
    v_pk_mul_f32 v[134:135], v[134:135], v[22:23]
    v_cvt_pk_bf16_f32 v32, v128, v129
    v_cvt_pk_bf16_f32 v33, v130, v131
    v_cvt_pk_bf16_f32 v34, v132, v133
    v_cvt_pk_bf16_f32 v35, v134, v135
    buffer_store_dwordx4 v[32:35], v1, s[8:11], s44 offen offset:0 sc1
    v_cvt_pk_bf16_f32 v137, v136, v137
    v_lshlrev_b32 v136, 16, v137
    v_and_b32 v137, 0xffff0000, v137
    v_cvt_pk_bf16_f32 v139, v138, v139
    v_lshlrev_b32 v138, 16, v139
    v_and_b32 v139, 0xffff0000, v139
    v_cvt_pk_bf16_f32 v141, v140, v141
    v_lshlrev_b32 v140, 16, v141
    v_and_b32 v141, 0xffff0000, v141
    v_cvt_pk_bf16_f32 v143, v142, v143
    v_lshlrev_b32 v142, 16, v143
    v_and_b32 v143, 0xffff0000, v143
    v_mul_f32 v16, 0xbfb8aa3b, v136
    v_mul_f32 v17, 0xbfb8aa3b, v137
    v_mul_f32 v18, 0xbfb8aa3b, v138
    v_mul_f32 v19, 0xbfb8aa3b, v139
    v_mul_f32 v20, 0xbfb8aa3b, v140
    v_mul_f32 v21, 0xbfb8aa3b, v141
    v_mul_f32 v22, 0xbfb8aa3b, v142
    v_mul_f32 v23, 0xbfb8aa3b, v143
    v_exp_f32 v16, v16
    v_exp_f32 v17, v17
    v_exp_f32 v18, v18
    v_exp_f32 v19, v19
    v_exp_f32 v20, v20
    v_exp_f32 v21, v21
    v_exp_f32 v22, v22
    v_exp_f32 v23, v23
    v_add_f32 v16, 1.0, v16
    v_add_f32 v17, 1.0, v17
    v_add_f32 v18, 1.0, v18
    v_add_f32 v19, 1.0, v19
    v_add_f32 v20, 1.0, v20
    v_add_f32 v21, 1.0, v21
    v_add_f32 v22, 1.0, v22
    v_add_f32 v23, 1.0, v23
    v_rcp_f32 v16, v16
    v_rcp_f32 v17, v17
    v_rcp_f32 v18, v18
    v_rcp_f32 v19, v19
    v_rcp_f32 v20, v20
    v_rcp_f32 v21, v21
    v_rcp_f32 v22, v22
    v_rcp_f32 v23, v23
    v_pk_mul_f32 v[136:137], v[136:137], v[16:17]
    v_pk_mul_f32 v[138:139], v[138:139], v[18:19]
    v_pk_mul_f32 v[140:141], v[140:141], v[20:21]
    v_pk_mul_f32 v[142:143], v[142:143], v[22:23]
    v_cvt_pk_bf16_f32 v36, v136, v137
    v_cvt_pk_bf16_f32 v37, v138, v139
    v_cvt_pk_bf16_f32 v38, v140, v141
    v_cvt_pk_bf16_f32 v39, v142, v143
    buffer_store_dwordx4 v[36:39], v1, s[8:11], s44 offen offset:1024 sc1
    s_lshl_b32 s75, s45, 7
    s_add_u32 s75, s75, 2408448
    s_waitcnt vmcnt(0)
    v_mov_b32 v4, 0
    v_mov_b32 v5, 1
    s_mov_b64 exec, 1
    buffer_atomic_add v5, v4, s[8:11], s75 offen
    s_mov_b64 exec, -1
    s_add_u32 s76, s76, 1
    s_cmp_lt_u32 s76, 32
    s_cbranch_scc1 f1top_173
    s_branch main_end
g5_171:
    s_sub_u32 s77, s37, 16
    s_cmp_ge_u32 s37, 16
    s_cbranch_scc1 att_160
    s_mov_b32 s77, s37
rln_163:
    s_waitcnt vmcnt(0)
    s_mov_b32 s75, 2359296
    s_cmp_lg_u32 s36, 0
    s_cbranch_scc1 wd_177
    v_min_u32 v14, 0, v0
    v_mul_u32_u24 v14, 0, v14
wt_176:
    buffer_load_dword v15, v14, s[8:11], s75 offen sc1
    s_waitcnt vmcnt(0)
    v_cmp_gt_u32 vcc, 64, v15
    s_nop 0
    s_cbranch_vccz wd_177
    s_sleep 8
    s_sub_u32 s53, s53, 1
    s_cbranch_scc0 wt_176
    s_mov_b32 s53, 0
wd_177:
    s_barrier
    s_barrier
    s_and_b32 s76, s77, 1
    s_lshr_b32 s77, s77, 1
    s_lshl_b32 s72, s76, 4
    s_add_u32 s72, s72, s77
    v_lshlrev_b32 v1, 4, v0
    s_lshl_b32 s54, s36, 9
    v_lshrrev_b32 v2, 1, v0
    v_lshl_add_u32 v2, v2, 4, s54
    v_and_b32 v7, 1, v0
    v_mul_u32_u24 v3, 1280, v7
    v_lshrrev_b32 v8, 1, v2
    v_add_u32 v3, v3, v8
    v_bfe_u32 v8, v0, 4, 2
    v_lshlrev_b32 v4, 10, v8
    v_bfe_u32 v8, v0, 2, 2
    v_lshl_add_u32 v4, v8, 8, v4
    v_bfe_u32 v8, v0, 0, 1
    v_lshl_add_u32 v4, v8, 4, v4
    v_bfe_u32 v8, v0, 1, 1
    v_lshl_add_u32 v4, v8, 3, v4
    s_lshl_b32 s54, s36, 12
    v_add_u32 v4, s54, v4
    s_lshl_b32 s54, s36, 3
    v_lshl_add_u32 v10, v7, 2, s54
    v_lshlrev_b32 v11, 2, v7
    s_mov_b32 s54, 5120
    buffer_load_dwordx4 v[20:23], v2, s[8:11], s54 offen offset:0 sc1
    s_mov_b32 s54, 10240
    buffer_load_dwordx4 v[28:31], v2, s[8:11], s54 offen offset:0 sc1
    s_mov_b32 s54, 7680
    buffer_load_dwordx4 v[36:39], v2, s[8:11], s54 offen offset:0 sc1
    s_cmp_lg_u32 s36, 0
    s_cbranch_scc1 ln2s_179
    s_mov_b32 s54, 5120
    buffer_load_dwordx4 v[24:27], v2, s[8:11], s54 offen offset:2048 sc1
    s_mov_b32 s54, 10240
    buffer_load_dwordx4 v[32:35], v2, s[8:11], s54 offen offset:2048 sc1
    s_mov_b32 s54, 7680
    buffer_load_dwordx4 v[40:43], v2, s[8:11], s54 offen offset:2048 sc1
ln2s_179:
lntop_178:
    s_mul_i32 s44, s72, 2560
    buffer_load_dwordx2 v[12:13], v3, s[20:23], s44 offen offset:0
    s_cmp_lg_u32 s36, 0
    s_cbranch_scc1 ln2s_180
    buffer_load_dwordx2 v[14:15], v3, s[20:23], s44 offen offset:1024
ln2s_180:
    s_lshl_b32 s75, s76, 7
    s_add_u32 s75, s75, 2375680
    s_cmp_lg_u32 s36, 0
    s_cbranch_scc1 wd_182
    v_min_u32 v8, 0, v0
    v_mul_u32_u24 v8, 0, v8
wt_181:
    buffer_load_dword v9, v8, s[8:11], s75 offen sc1
    s_waitcnt vmcnt(0)
    v_cmp_gt_u32 vcc, 32, v9
    s_nop 0
    s_cbranch_vccz wd_182
    s_sleep 2
    s_sub_u32 s53, s53, 1
    s_cbranch_scc0 wt_181
    s_mov_b32 s53, 0
wd_182:
    s_barrier
    s_lshl_b32 s56, s44, 1
    s_lshl_b32 s55, s36, 10
    s_add_u32 s56, s56, s55
    s_add_u32 s54, s56, 134217728
    buffer_load_dwordx4 v[44:47], v1, s[8:11], s54 offen sc1
    s_add_u32 s54, s54, 5242880
    buffer_load_dwordx4 v[52:55], v1, s[8:11], s54 offen sc1
    s_add_u32 s54, s54, 5242880
    buffer_load_dwordx4 v[60:63], v1, s[8:11], s54 offen sc1
    s_add_u32 s54, s54, 5242880
    buffer_load_dwordx4 v[68:71], v1, s[8:11], s54 offen sc1
    s_add_u32 s54, s54, 5242880
    buffer_load_dwordx4 v[76:79], v1, s[8:11], s54 offen sc1
    s_add_u32 s54, s54, 5242880
    buffer_load_dwordx4 v[84:87], v1, s[8:11], s54 offen sc1
    s_add_u32 s54, s54, 5242880
    buffer_load_dwordx4 v[92:95], v1, s[8:11], s54 offen sc1
    s_add_u32 s54, s54, 5242880
    buffer_load_dwordx4 v[100:103], v1, s[8:11], s54 offen sc1
    s_cmp_lg_u32 s36, 0
    s_cbranch_scc1 ln2s_183
    s_add_u32 s54, s56, 134221824
    buffer_load_dwordx4 v[48:51], v1, s[8:11], s54 offen sc1
    s_add_u32 s54, s54, 5242880
    buffer_load_dwordx4 v[56:59], v1, s[8:11], s54 offen sc1
    s_add_u32 s54, s54, 5242880
    buffer_load_dwordx4 v[64:67], v1, s[8:11], s54 offen sc1
    s_add_u32 s54, s54, 5242880
    buffer_load_dwordx4 v[72:75], v1, s[8:11], s54 offen sc1
    s_add_u32 s54, s54, 5242880
    buffer_load_dwordx4 v[80:83], v1, s[8:11], s54 offen sc1
    s_add_u32 s54, s54, 5242880
    buffer_load_dwordx4 v[88:91], v1, s[8:11], s54 offen sc1
    s_add_u32 s54, s54, 5242880
    buffer_load_dwordx4 v[96:99], v1, s[8:11], s54 offen sc1
    s_add_u32 s54, s54, 5242880
    buffer_load_dwordx4 v[104:107], v1, s[8:11], s54 offen sc1
ln2s_183:
    s_add_u32 s55, s44, 12582912
    s_waitcnt vmcnt(0)
    v_pk_add_f32 v[44:45], v[44:45], v[52:53]
    v_pk_add_f32 v[44:45], v[44:45], v[60:61]
    v_pk_add_f32 v[44:45], v[44:45], v[68:69]
    v_pk_add_f32 v[44:45], v[44:45], v[76:77]
    v_pk_add_f32 v[44:45], v[44:45], v[84:85]
    v_pk_add_f32 v[44:45], v[44:45], v[92:93]
    v_pk_add_f32 v[44:45], v[44:45], v[100:101]
    v_pk_add_f32 v[46:47], v[46:47], v[54:55]
    v_pk_add_f32 v[46:47], v[46:47], v[62:63]
    v_pk_add_f32 v[46:47], v[46:47], v[70:71]
    v_pk_add_f32 v[46:47], v[46:47], v[78:79]
    v_pk_add_f32 v[46:47], v[46:47], v[86:87]
    v_pk_add_f32 v[46:47], v[46:47], v[94:95]
    v_pk_add_f32 v[46:47], v[46:47], v[102:103]
    v_cvt_pk_bf16_f32 v45, v44, v45
    v_lshlrev_b32 v44, 16, v45
    v_and_b32 v45, 0xffff0000, v45
    v_pk_mul_f32 v[44:45], v[44:45], v[20:21]
    v_cvt_pk_bf16_f32 v45, v44, v45
    v_lshlrev_b32 v44, 16, v45
    v_and_b32 v45, 0xffff0000, v45
    v_lshlrev_b32 v8, 16, v12
    v_and_b32 v9, 0xffff0000, v12
    v_pk_add_f32 v[44:45], v[44:45], v[8:9]
    v_cvt_pk_bf16_f32 v12, v44, v45
    v_lshlrev_b32 v44, 16, v12
    v_and_b32 v45, 0xffff0000, v12
    v_cvt_pk_bf16_f32 v47, v46, v47
    v_lshlrev_b32 v46, 16, v47
    v_and_b32 v47, 0xffff0000, v47
    v_pk_mul_f32 v[46:47], v[46:47], v[22:23]
    v_cvt_pk_bf16_f32 v47, v46, v47
    v_lshlrev_b32 v46, 16, v47
    v_and_b32 v47, 0xffff0000, v47
    v_lshlrev_b32 v8, 16, v13
    v_and_b32 v9, 0xffff0000, v13
    v_pk_add_f32 v[46:47], v[46:47], v[8:9]
    v_cvt_pk_bf16_f32 v13, v46, v47
    v_lshlrev_b32 v46, 16, v13
    v_and_b32 v47, 0xffff0000, v13
    buffer_store_dwordx2 v[12:13], v3, s[8:11], s55 offen offset:0 sc1
    v_pk_add_f32 v[8:9], v[44:45], v[46:47]
    v_add_f32 v5, v8, v9
    s_cmp_lg_u32 s36, 0
    s_cbranch_scc1 ln2s_184
    v_pk_add_f32 v[48:49], v[48:49], v[56:57]
    v_pk_add_f32 v[48:49], v[48:49], v[64:65]
    v_pk_add_f32 v[48:49], v[48:49], v[72:73]
    v_pk_add_f32 v[48:49], v[48:49], v[80:81]
    v_pk_add_f32 v[48:49], v[48:49], v[88:89]
    v_pk_add_f32 v[48:49], v[48:49], v[96:97]
    v_pk_add_f32 v[48:49], v[48:49], v[104:105]
    v_pk_add_f32 v[50:51], v[50:51], v[58:59]
    v_pk_add_f32 v[50:51], v[50:51], v[66:67]
    v_pk_add_f32 v[50:51], v[50:51], v[74:75]
    v_pk_add_f32 v[50:51], v[50:51], v[82:83]
    v_pk_add_f32 v[50:51], v[50:51], v[90:91]
    v_pk_add_f32 v[50:51], v[50:51], v[98:99]
    v_pk_add_f32 v[50:51], v[50:51], v[106:107]
    v_cvt_pk_bf16_f32 v49, v48, v49
    v_lshlrev_b32 v48, 16, v49
    v_and_b32 v49, 0xffff0000, v49
    v_pk_mul_f32 v[48:49], v[48:49], v[24:25]
    v_cvt_pk_bf16_f32 v49, v48, v49
    v_lshlrev_b32 v48, 16, v49
    v_and_b32 v49, 0xffff0000, v49
    v_lshlrev_b32 v8, 16, v14
    v_and_b32 v9, 0xffff0000, v14
    v_pk_add_f32 v[48:49], v[48:49], v[8:9]
    v_cvt_pk_bf16_f32 v14, v48, v49
    v_lshlrev_b32 v48, 16, v14
    v_and_b32 v49, 0xffff0000, v14
    v_cvt_pk_bf16_f32 v51, v50, v51
    v_lshlrev_b32 v50, 16, v51
    v_and_b32 v51, 0xffff0000, v51
    v_pk_mul_f32 v[50:51], v[50:51], v[26:27]
    v_cvt_pk_bf16_f32 v51, v50, v51
    v_lshlrev_b32 v50, 16, v51
    v_and_b32 v51, 0xffff0000, v51
    v_lshlrev_b32 v8, 16, v15
    v_and_b32 v9, 0xffff0000, v15
    v_pk_add_f32 v[50:51], v[50:51], v[8:9]
    v_cvt_pk_bf16_f32 v15, v50, v51
    v_lshlrev_b32 v50, 16, v15
    v_and_b32 v51, 0xffff0000, v15
    buffer_store_dwordx2 v[14:15], v3, s[8:11], s55 offen offset:1024 sc1
    v_pk_add_f32 v[8:9], v[48:49], v[50:51]
    v_add_f32 v5, v5, v8
    v_add_f32 v5, v5, v9
ln2s_184:
    s_nop 1
    v_add_f32 v5, v5, v5 row_ror:2
    s_nop 1
    v_add_f32 v5, v5, v5 row_ror:4
    s_nop 1
    v_add_f32 v5, v5, v5 row_ror:8
    v_mov_b32 v7, v5
    s_nop 1
    v_permlane16_swap_b32 v5, v7
    v_add_f32 v5, v5, v7
    v_mov_b32 v7, v5
    s_nop 1
    v_permlane32_swap_b32 v5, v7
    v_add_f32 v5, v5, v7
    ds_write_b32 v10, v5 offset:0
    s_waitcnt lgkmcnt(0)
    s_barrier
    ds_read_b32 v52, v11 offset:0
    ds_read_b32 v53, v11 offset:8
    ds_read_b32 v54, v11 offset:16
    ds_read_b32 v55, v11 offset:24
    s_waitcnt lgkmcnt(0)
    v_pk_add_f32 v[52:53], v[52:53], v[54:55]
    v_add_f32 v5, v52, v53
    v_mul_f32 v5, 0x3acccccd, v5
    v_mov_b32 v6, 0
    v_sub_f32 v8, v44, v5
    v_fmac_f32 v6, v8, v8
    v_sub_f32 v9, v45, v5
    v_fmac_f32 v6, v9, v9
    v_sub_f32 v8, v46, v5
    v_fmac_f32 v6, v8, v8
    v_sub_f32 v9, v47, v5
    v_fmac_f32 v6, v9, v9
    s_cmp_lg_u32 s36, 0
    s_cbranch_scc1 ln2s_185
    v_sub_f32 v8, v48, v5
    v_fmac_f32 v6, v8, v8
    v_sub_f32 v9, v49, v5
    v_fmac_f32 v6, v9, v9
    v_sub_f32 v8, v50, v5
    v_fmac_f32 v6, v8, v8
    v_sub_f32 v9, v51, v5
    v_fmac_f32 v6, v9, v9
ln2s_185:
    s_nop 1
    v_add_f32 v6, v6, v6 row_ror:2
    s_nop 1
    v_add_f32 v6, v6, v6 row_ror:4
    s_nop 1
    v_add_f32 v6, v6, v6 row_ror:8
    v_mov_b32 v7, v6
    s_nop 1
    v_permlane16_swap_b32 v6, v7
    v_add_f32 v6, v6, v7
    v_mov_b32 v7, v6
    s_nop 1
    v_permlane32_swap_b32 v6, v7
    v_add_f32 v6, v6, v7
    ds_write_b32 v10, v6 offset:32
    v_cvt_pk_bf16_f32 v18, v5, v5
    v_lshlrev_b32 v18, 16, v18
    v_pk_add_f32 v[44:45], v[44:45], v[18:19] op_sel_hi:[1,0] neg_lo:[0,1] neg_hi:[0,1]
    v_cvt_pk_bf16_f32 v45, v44, v45
    v_lshlrev_b32 v44, 16, v45
    v_and_b32 v45, 0xffff0000, v45
    v_pk_add_f32 v[46:47], v[46:47], v[18:19] op_sel_hi:[1,0] neg_lo:[0,1] neg_hi:[0,1]
    v_cvt_pk_bf16_f32 v47, v46, v47
    v_lshlrev_b32 v46, 16, v47
    v_and_b32 v47, 0xffff0000, v47
    s_cmp_lg_u32 s36, 0
    s_cbranch_scc1 ln2s_186
    v_pk_add_f32 v[48:49], v[48:49], v[18:19] op_sel_hi:[1,0] neg_lo:[0,1] neg_hi:[0,1]
    v_cvt_pk_bf16_f32 v49, v48, v49
    v_lshlrev_b32 v48, 16, v49
    v_and_b32 v49, 0xffff0000, v49
    v_pk_add_f32 v[50:51], v[50:51], v[18:19] op_sel_hi:[1,0] neg_lo:[0,1] neg_hi:[0,1]
    v_cvt_pk_bf16_f32 v51, v50, v51
    v_lshlrev_b32 v50, 16, v51
    v_and_b32 v51, 0xffff0000, v51
ln2s_186:
    s_lshr_b32 s54, s72, 3
    s_mul_i32 s54, s54, 20480
    s_and_b32 s55, s72, 7
    s_lshl_b32 s55, s55, 5
    s_add_u32 s54, s54, s55
    s_add_u32 s54, s54, 16777216
    s_waitcnt lgkmcnt(0)
    s_barrier
    ds_read_b32 v52, v11 offset:32
    ds_read_b32 v53, v11 offset:40
    ds_read_b32 v54, v11 offset:48
    ds_read_b32 v55, v11 offset:56
    s_waitcnt lgkmcnt(0)
    v_pk_add_f32 v[52:53], v[52:53], v[54:55]
    v_add_f32 v6, v52, v53
    v_mul_f32 v6, 0x3acccccd, v6
    v_cvt_pk_bf16_f32 v6, v6, v6
    v_lshlrev_b32 v6, 16, v6
    v_add_f32 v6, 0x3727c5ac, v6
    v_cvt_pk_bf16_f32 v6, v6, v6
    v_lshlrev_b32 v6, 16, v6
    v_sqrt_f32 v6, v6
    s_nop 0
    v_cvt_pk_bf16_f32 v6, v6, v6
    v_lshlrev_b32 v6, 16, v6
    v_rcp_f32 v8, v6
    s_nop 0
    v_pk_mul_f32 v[44:45], v[44:45], v[8:9] op_sel_hi:[1,0]
    v_cvt_pk_bf16_f32 v45, v44, v45
    v_lshlrev_b32 v44, 16, v45
    v_and_b32 v45, 0xffff0000, v45
    v_pk_mul_f32 v[44:45], v[44:45], v[28:29]
    v_cvt_pk_bf16_f32 v45, v44, v45
    v_lshlrev_b32 v44, 16, v45
    v_and_b32 v45, 0xffff0000, v45
    v_pk_add_f32 v[44:45], v[44:45], v[36:37]
    v_cvt_pk_bf16_f32 v56, v44, v45
    v_pk_mul_f32 v[46:47], v[46:47], v[8:9] op_sel_hi:[1,0]
    v_cvt_pk_bf16_f32 v47, v46, v47
    v_lshlrev_b32 v46, 16, v47
    v_and_b32 v47, 0xffff0000, v47
    v_pk_mul_f32 v[46:47], v[46:47], v[30:31]
    v_cvt_pk_bf16_f32 v47, v46, v47
    v_lshlrev_b32 v46, 16, v47
    v_and_b32 v47, 0xffff0000, v47
    v_pk_add_f32 v[46:47], v[46:47], v[38:39]
    v_cvt_pk_bf16_f32 v57, v46, v47
    buffer_store_dwordx2 v[56:57], v4, s[8:11], s54 offen sc1
    s_add_u32 s54, s54, 16384
    s_cmp_lg_u32 s36, 0
    s_cbranch_scc1 ln2s_187
    v_pk_mul_f32 v[48:49], v[48:49], v[8:9] op_sel_hi:[1,0]
    v_cvt_pk_bf16_f32 v49, v48, v49
    v_lshlrev_b32 v48, 16, v49
    v_and_b32 v49, 0xffff0000, v49
    v_pk_mul_f32 v[48:49], v[48:49], v[32:33]
    v_cvt_pk_bf16_f32 v49, v48, v49
    v_lshlrev_b32 v48, 16, v49
    v_and_b32 v49, 0xffff0000, v49
    v_pk_add_f32 v[48:49], v[48:49], v[40:41]
    v_cvt_pk_bf16_f32 v58, v48, v49
    v_pk_mul_f32 v[50:51], v[50:51], v[8:9] op_sel_hi:[1,0]
    v_cvt_pk_bf16_f32 v51, v50, v51
    v_lshlrev_b32 v50, 16, v51
    v_and_b32 v51, 0xffff0000, v51
    v_pk_mul_f32 v[50:51], v[50:51], v[34:35]
    v_cvt_pk_bf16_f32 v51, v50, v51
    v_lshlrev_b32 v50, 16, v51
    v_and_b32 v51, 0xffff0000, v51
    v_pk_add_f32 v[50:51], v[50:51], v[42:43]
    v_cvt_pk_bf16_f32 v59, v50, v51
    buffer_store_dwordx2 v[58:59], v4, s[8:11], s54 offen sc1
    s_add_u32 s54, s54, 16384
ln2s_187:
    s_lshr_b32 s75, s72, 3
    s_lshl_b32 s75, s75, 7
    s_add_u32 s75, s75, 2392064
    s_waitcnt vmcnt(0) lgkmcnt(0)
    s_barrier
    s_cmp_lg_u32 s36, 0
    s_cbranch_scc1 sg_188
    v_mov_b32 v8, 0
    v_mov_b32 v9, 1
    s_mov_b64 exec, 1
    buffer_atomic_add v9, v8, s[8:11], s75 offen
    s_mov_b64 exec, -1
sg_188:
    s_add_u32 s72, s72, 32
    s_add_u32 s76, s76, 2
    s_cmp_lt_u32 s76, 64
    s_cbranch_scc1 lntop_178
    s_branch main_end
rff2_162:
    s_lshl_b32 s54, s76, 2
    s_add_u32 s77, s54, s37
    s_sub_u32 s77, s77, 12
    s_cmp_ge_u32 s37, 28
    s_cbranch_scc1 att_160
    s_lshl_b32 s54, s76, 3
    s_add_u32 s77, s54, s37
    s_sub_u32 s77, s77, 4
    s_cmp_ge_u32 s37, 20
    s_cbranch_scc1 rln_163
    s_load_dwordx2 s[12:13], s[0:1], 72
    s_waitcnt lgkmcnt(0)
    s_and_b32 s13, s13, 0xffff
    s_mov_b32 s14, 2211840
    s_mov_b32 s15, 0x20000
    s_lshl_b32 s41, s37, 6
    v_lshrrev_b32 v3, 2, v0
    s_mov_b32 s55, 1280
    v_mul_lo_u32 v3, v3, s55
    v_lshrrev_b32 v2, 3, v0
    v_and_b32 v2, 2, v2
    v_xor_b32 v2, v2, v0
    v_and_b32 v2, 3, v2
    v_lshl_add_u32 v3, v2, 4, v3
    v_bfe_u32 v2, v0, 2, 4
    v_lshlrev_b32 v4, 6, v2
    v_bfe_u32 v2, v0, 4, 1
    v_lshl_add_u32 v4, v2, 5, v4
    v_bfe_u32 v2, v0, 0, 2
    v_lshl_add_u32 v4, v2, 3, v4
    v_xor_b32 v5, 32, v4
    s_mul_i32 s54, s36, 40960
    s_add_u32 s41, s41, s54
    s_mul_i32 s42, s36, 2048
    s_add_u32 m0, s42, 0
    s_add_u32 s54, s41, 0
    buffer_load_dwordx4 v3, s[12:15], s54 offen lds
    s_add_u32 m0, s42, 1024
    s_add_u32 s54, s41, 20480
    buffer_load_dwordx4 v3, s[12:15], s54 offen lds
    s_add_u32 m0, s42, 8192
    s_add_u32 s54, s41, 163840
    buffer_load_dwordx4 v3, s[12:15], s54 offen lds
    s_add_u32 m0, s42, 9216
    s_add_u32 s54, s41, 184320
    buffer_load_dwordx4 v3, s[12:15], s54 offen lds
    s_add_u32 m0, s42, 16384
    s_add_u32 s54, s41, 327680
    buffer_load_dwordx4 v3, s[12:15], s54 offen lds
    s_add_u32 m0, s42, 17408
    s_add_u32 s54, s41, 348160
    buffer_load_dwordx4 v3, s[12:15], s54 offen lds
    s_add_u32 m0, s42, 24576
    s_add_u32 s54, s41, 491520
    buffer_load_dwordx4 v3, s[12:15], s54 offen lds
    s_add_u32 m0, s42, 25600
    s_add_u32 s54, s41, 512000
    buffer_load_dwordx4 v3, s[12:15], s54 offen lds
    s_add_u32 m0, s42, 32768
    s_add_u32 s54, s41, 655360
    buffer_load_dwordx4 v3, s[12:15], s54 offen lds
    s_add_u32 m0, s42, 33792
    s_add_u32 s54, s41, 675840
    buffer_load_dwordx4 v3, s[12:15], s54 offen lds
    s_add_u32 m0, s42, 40960
    s_add_u32 s54, s41, 819200
    buffer_load_dwordx4 v3, s[12:15], s54 offen lds
    s_add_u32 m0, s42, 41984
    s_add_u32 s54, s41, 839680
    buffer_load_dwordx4 v3, s[12:15], s54 offen lds
    s_add_u32 m0, s42, 49152
    s_add_u32 s54, s41, 983040
    buffer_load_dwordx4 v3, s[12:15], s54 offen lds
    s_add_u32 m0, s42, 50176
    s_add_u32 s54, s41, 1003520
    buffer_load_dwordx4 v3, s[12:15], s54 offen lds
    s_add_u32 m0, s42, 57344
    s_add_u32 s54, s41, 1146880
    buffer_load_dwordx4 v3, s[12:15], s54 offen lds
    s_add_u32 m0, s42, 58368
    s_add_u32 s54, s41, 1167360
    buffer_load_dwordx4 v3, s[12:15], s54 offen lds
    s_add_u32 m0, s42, 65536
    s_add_u32 s54, s41, 1310720
    buffer_load_dwordx4 v3, s[12:15], s54 offen lds
    s_add_u32 m0, s42, 66560
    s_add_u32 s54, s41, 1331200
    buffer_load_dwordx4 v3, s[12:15], s54 offen lds
    s_add_u32 m0, s42, 73728
    s_add_u32 s54, s41, 1474560
    buffer_load_dwordx4 v3, s[12:15], s54 offen lds
    s_add_u32 m0, s42, 74752
    s_add_u32 s54, s41, 1495040
    buffer_load_dwordx4 v3, s[12:15], s54 offen lds
    s_add_u32 m0, s42, 81920
    s_add_u32 s54, s41, 1638400
    buffer_load_dwordx4 v3, s[12:15], s54 offen lds
    s_add_u32 m0, s42, 82944
    s_add_u32 s54, s41, 1658880
    buffer_load_dwordx4 v3, s[12:15], s54 offen lds
    s_add_u32 m0, s42, 90112
    s_add_u32 s54, s41, 1802240
    buffer_load_dwordx4 v3, s[12:15], s54 offen lds
    s_add_u32 m0, s42, 91136
    s_add_u32 s54, s41, 1822720
    buffer_load_dwordx4 v3, s[12:15], s54 offen lds
    s_add_u32 m0, s42, 98304
    s_add_u32 s54, s41, 1966080
    buffer_load_dwordx4 v3, s[12:15], s54 offen lds
    s_add_u32 m0, s42, 99328
    s_add_u32 s54, s41, 1986560
    buffer_load_dwordx4 v3, s[12:15], s54 offen lds
    s_add_u32 m0, s42, 106496
    s_add_u32 s54, s41, 2129920
    buffer_load_dwordx4 v3, s[12:15], s54 offen lds
    s_add_u32 m0, s42, 107520
    s_add_u32 s54, s41, 2150400
    buffer_load_dwordx4 v3, s[12:15], s54 offen lds
    s_waitcnt vmcnt(0)
    v_lshrrev_b32 v3, 2, v0
    s_mov_b32 s55, 16
    v_mul_lo_u32 v3, v3, s55
    v_lshrrev_b32 v2, 3, v0
    v_and_b32 v2, 2, v2
    v_xor_b32 v2, v2, v0
    v_and_b32 v2, 3, v2
    v_lshl_add_u32 v3, v2, 4, v3
    v_bfe_u32 v2, v0, 2, 4
    v_lshlrev_b32 v4, 6, v2
    v_bfe_u32 v2, v0, 4, 1
    v_lshl_add_u32 v4, v2, 5, v4
    v_bfe_u32 v2, v0, 0, 2
    v_lshl_add_u32 v4, v2, 3, v4
    v_xor_b32 v5, 32, v4
    s_mul_i32 s54, s36, 2048
    s_add_u32 s54, s54, 0
    v_add_u32 v4, s54, v4
    v_add_u32 v5, s54, v5
    v_lshlrev_b32 v6, 4, v0
    v_add_u32 v6, s54, v6
    s_mov_b32 s43, 14
cv_189:
    ds_read_b64_tr_b16 v[16:17], v4 offset:0
    ds_read_b64_tr_b16 v[18:19], v4 offset:1024
    ds_read_b64_tr_b16 v[20:21], v5 offset:0
    ds_read_b64_tr_b16 v[22:23], v5 offset:1024
    s_waitcnt lgkmcnt(0)
    ds_write_b128 v6, v[16:19] offset:0
    ds_write_b128 v6, v[20:23] offset:1024
    v_add_u32 v4, 8192, v4
    v_add_u32 v5, 8192, v5
    v_add_u32 v6, 8192, v6
    s_waitcnt lgkmcnt(0)
    s_sub_u32 s43, s43, 1
    s_cmp_lg_u32 s43, 0
    s_cbranch_scc1 cv_189
    s_mov_b32 s75, 2359296
    s_cmp_lg_u32 s36, 0
    s_cbranch_scc1 wd_191
    v_min_u32 v14, 0, v0
    v_mul_u32_u24 v14, 0, v14
wt_190:
    buffer_load_dword v15, v14, s[8:11], s75 offen sc1
    s_waitcnt vmcnt(0)
    v_cmp_gt_u32 vcc, 64, v15
    s_nop 0
    s_cbranch_vccz wd_191
    s_sleep 8
    s_sub_u32 s53, s53, 1
    s_cbranch_scc0 wt_190
    s_mov_b32 s53, 0
wd_191:
    s_barrier
    s_barrier
f2top_192:
    s_lshl_b32 s45, s76, 1
    s_and_b32 s54, s36, 1
    s_add_u32 s45, s45, s54
    s_lshr_b32 s56, s36, 1
    s_mul_i32 s40, s45, 55296
    s_mul_i32 s55, s56, 27648
    s_add_u32 s40, s40, s55
    s_add_u32 s40, s40, 20971520
    s_lshl_b32 s41, s55, 1
    s_lshl_b32 s55, s37, 1
    s_add_u32 s55, s55, s56
    s_lshl_b32 s55, s55, 5
    s_mul_i32 s44, s45, 20480
    s_add_u32 s44, s44, s55
    s_lshl_b32 s46, s55, 1
    s_add_u32 s46, s46, 12800
    v_lshlrev_b32 v1, 4, v0
    v_add_u32 v4, s41, v1
    v_add_u32 v5, 0x10000, v4
    v_add_u32 v6, 0x20000, v4
    ds_read_b128 v[124:127], v4 offset:0
    ds_read_b128 v[128:131], v4 offset:1024
    ds_read_b128 v[132:135], v4 offset:2048
    ds_read_b128 v[136:139], v4 offset:3072
    ds_read_b128 v[140:143], v4 offset:4096
    ds_read_b128 v[144:147], v4 offset:5120
    v_and_b32 v12, 15, v0
    v_mul_u32_u24 v12, 1280, v12
    v_bfe_u32 v2, v0, 4, 2
    v_lshl_add_u32 v12, v2, 3, v12
    v_bfe_u32 v2, v0, 4, 2
    v_lshlrev_b32 v13, 4, v2
    buffer_load_dwordx4 v[204:207], v13, s[8:11], s46 offen sc1
    s_lshl_b32 s54, s36, 10
    s_add_u32 s54, s54, 118784
    v_add_u32 v10, s54, v1
    v_xor_b32 v11, 2048, v10
    s_lshl_b32 s75, s76, 8
    s_add_u32 s75, s75, 2408448
    s_cmp_lg_u32 s36, 0
    s_cbranch_scc1 wd_194
    v_min_u32 v14, 1, v0
    v_mul_u32_u24 v14, 128, v14
wt_193:
    buffer_load_dword v15, v14, s[8:11], s75 offen sc1
    s_waitcnt vmcnt(0)
    v_cmp_gt_u32 vcc, 27, v15
    s_nop 0
    s_cbranch_vccz wd_194
    s_sleep 2
    s_sub_u32 s53, s53, 1
    s_cbranch_scc0 wt_193
    s_mov_b32 s53, 0
wd_194:
    s_barrier
    s_add_u32 s54, s44, 12582912
    buffer_load_dwordx2 v[200:201], v12, s[8:11], s54 offen sc1
    buffer_load_dwordx4 v[16:19], v1, s[8:11], s40 offen offset:0 sc1
    buffer_load_dwordx4 v[20:23], v1, s[8:11], s40 offen offset:1024 sc1
    buffer_load_dwordx4 v[24:27], v1, s[8:11], s40 offen offset:2048 sc1
    buffer_load_dwordx4 v[28:31], v1, s[8:11], s40 offen offset:3072 sc1
    s_add_u32 s40, s40, 4096
    buffer_load_dwordx4 v[32:35], v1, s[8:11], s40 offen offset:0 sc1
    buffer_load_dwordx4 v[36:39], v1, s[8:11], s40 offen offset:1024 sc1
    buffer_load_dwordx4 v[40:43], v1, s[8:11], s40 offen offset:2048 sc1
    buffer_load_dwordx4 v[44:47], v1, s[8:11], s40 offen offset:3072 sc1
    s_add_u32 s40, s40, 4096
    buffer_load_dwordx4 v[48:51], v1, s[8:11], s40 offen offset:0 sc1
    buffer_load_dwordx4 v[52:55], v1, s[8:11], s40 offen offset:1024 sc1
    buffer_load_dwordx4 v[56:59], v1, s[8:11], s40 offen offset:2048 sc1
    buffer_load_dwordx4 v[60:63], v1, s[8:11], s40 offen offset:3072 sc1
    s_add_u32 s40, s40, 4096
    buffer_load_dwordx4 v[64:67], v1, s[8:11], s40 offen offset:0 sc1
    buffer_load_dwordx4 v[68:71], v1, s[8:11], s40 offen offset:1024 sc1
    buffer_load_dwordx4 v[72:75], v1, s[8:11], s40 offen offset:2048 sc1
    buffer_load_dwordx4 v[76:79], v1, s[8:11], s40 offen offset:3072 sc1
    s_add_u32 s40, s40, 4096
    buffer_load_dwordx4 v[80:83], v1, s[8:11], s40 offen offset:0 sc1
    buffer_load_dwordx4 v[84:87], v1, s[8:11], s40 offen offset:1024 sc1
    buffer_load_dwordx4 v[88:91], v1, s[8:11], s40 offen offset:2048 sc1
    buffer_load_dwordx4 v[92:95], v1, s[8:11], s40 offen offset:3072 sc1
    s_add_u32 s40, s40, 4096
    buffer_load_dwordx4 v[96:99], v1, s[8:11], s40 offen offset:0 sc1
    buffer_load_dwordx4 v[100:103], v1, s[8:11], s40 offen offset:1024 sc1
    buffer_load_dwordx4 v[104:107], v1, s[8:11], s40 offen offset:2048 sc1
    buffer_load_dwordx4 v[108:111], v1, s[8:11], s40 offen offset:3072 sc1
    s_add_u32 s40, s40, 4096
    buffer_load_dwordx4 v[112:115], v1, s[8:11], s40 offen offset:0 sc1
    buffer_load_dwordx4 v[116:119], v1, s[8:11], s40 offen offset:1024 sc1
    buffer_load_dwordx4 v[120:123], v1, s[8:11], s40 offen offset:2048 sc1
    s_waitcnt vmcnt(26) lgkmcnt(4)
    v_mfma_f32_16x16x32_bf16 v[156:159], v[124:127], v[16:19], 0
    ds_read_b128 v[148:151], v4 offset:6144
    v_mfma_f32_16x16x32_bf16 v[160:163], v[128:131], v[16:19], 0
    ds_read_b128 v[152:155], v4 offset:7168
    s_waitcnt vmcnt(25) lgkmcnt(4)
    v_mfma_f32_16x16x32_bf16 v[156:159], v[132:135], v[20:23], v[156:159]
    ds_read_b128 v[124:127], v4 offset:8192
    v_mfma_f32_16x16x32_bf16 v[160:163], v[136:139], v[20:23], v[160:163]
    ds_read_b128 v[128:131], v4 offset:9216
    s_waitcnt vmcnt(24) lgkmcnt(4)
    v_mfma_f32_16x16x32_bf16 v[156:159], v[140:143], v[24:27], v[156:159]
    ds_read_b128 v[132:135], v4 offset:10240
    v_mfma_f32_16x16x32_bf16 v[160:163], v[144:147], v[24:27], v[160:163]
    ds_read_b128 v[136:139], v4 offset:11264
    s_waitcnt vmcnt(23) lgkmcnt(4)
    v_mfma_f32_16x16x32_bf16 v[156:159], v[148:151], v[28:31], v[156:159]
    ds_read_b128 v[140:143], v4 offset:12288
    v_mfma_f32_16x16x32_bf16 v[160:163], v[152:155], v[28:31], v[160:163]
    ds_read_b128 v[144:147], v4 offset:13312
    s_waitcnt vmcnt(22) lgkmcnt(4)
    v_mfma_f32_16x16x32_bf16 v[156:159], v[124:127], v[32:35], v[156:159]
    ds_read_b128 v[148:151], v4 offset:14336
    v_mfma_f32_16x16x32_bf16 v[160:163], v[128:131], v[32:35], v[160:163]
    ds_read_b128 v[152:155], v4 offset:15360
    s_waitcnt vmcnt(21) lgkmcnt(4)
    v_mfma_f32_16x16x32_bf16 v[156:159], v[132:135], v[36:39], v[156:159]
    ds_read_b128 v[124:127], v4 offset:16384
    v_mfma_f32_16x16x32_bf16 v[160:163], v[136:139], v[36:39], v[160:163]
    ds_read_b128 v[128:131], v4 offset:17408
    s_waitcnt vmcnt(20) lgkmcnt(4)
    v_mfma_f32_16x16x32_bf16 v[156:159], v[140:143], v[40:43], v[156:159]
    ds_read_b128 v[132:135], v4 offset:18432
    v_mfma_f32_16x16x32_bf16 v[160:163], v[144:147], v[40:43], v[160:163]
    ds_read_b128 v[136:139], v4 offset:19456
    s_waitcnt vmcnt(19) lgkmcnt(4)
    v_mfma_f32_16x16x32_bf16 v[156:159], v[148:151], v[44:47], v[156:159]
    ds_read_b128 v[140:143], v4 offset:20480
    v_mfma_f32_16x16x32_bf16 v[160:163], v[152:155], v[44:47], v[160:163]
    ds_read_b128 v[144:147], v4 offset:21504
    s_waitcnt vmcnt(18) lgkmcnt(4)
    v_mfma_f32_16x16x32_bf16 v[156:159], v[124:127], v[48:51], v[156:159]
    ds_read_b128 v[148:151], v4 offset:22528
    v_mfma_f32_16x16x32_bf16 v[160:163], v[128:131], v[48:51], v[160:163]
    ds_read_b128 v[152:155], v4 offset:23552
    s_waitcnt vmcnt(17) lgkmcnt(4)
    v_mfma_f32_16x16x32_bf16 v[156:159], v[132:135], v[52:55], v[156:159]
    ds_read_b128 v[124:127], v4 offset:24576
    v_mfma_f32_16x16x32_bf16 v[160:163], v[136:139], v[52:55], v[160:163]
    ds_read_b128 v[128:131], v4 offset:25600
    s_waitcnt vmcnt(16) lgkmcnt(4)
    v_mfma_f32_16x16x32_bf16 v[156:159], v[140:143], v[56:59], v[156:159]
    ds_read_b128 v[132:135], v4 offset:26624
    v_mfma_f32_16x16x32_bf16 v[160:163], v[144:147], v[56:59], v[160:163]
    ds_read_b128 v[136:139], v4 offset:27648
    s_waitcnt vmcnt(15) lgkmcnt(4)
    v_mfma_f32_16x16x32_bf16 v[156:159], v[148:151], v[60:63], v[156:159]
    ds_read_b128 v[140:143], v4 offset:28672
    v_mfma_f32_16x16x32_bf16 v[160:163], v[152:155], v[60:63], v[160:163]
    ds_read_b128 v[144:147], v4 offset:29696
    s_waitcnt vmcnt(14) lgkmcnt(4)
    v_mfma_f32_16x16x32_bf16 v[156:159], v[124:127], v[64:67], v[156:159]
    ds_read_b128 v[148:151], v4 offset:30720
    v_mfma_f32_16x16x32_bf16 v[160:163], v[128:131], v[64:67], v[160:163]
    ds_read_b128 v[152:155], v4 offset:31744
    s_waitcnt vmcnt(13) lgkmcnt(4)
    v_mfma_f32_16x16x32_bf16 v[156:159], v[132:135], v[68:71], v[156:159]
    ds_read_b128 v[124:127], v4 offset:32768
    v_mfma_f32_16x16x32_bf16 v[160:163], v[136:139], v[68:71], v[160:163]
    ds_read_b128 v[128:131], v4 offset:33792
    s_waitcnt vmcnt(12) lgkmcnt(4)
    v_mfma_f32_16x16x32_bf16 v[156:159], v[140:143], v[72:75], v[156:159]
    ds_read_b128 v[132:135], v4 offset:34816
    v_mfma_f32_16x16x32_bf16 v[160:163], v[144:147], v[72:75], v[160:163]
    ds_read_b128 v[136:139], v4 offset:35840
    s_waitcnt vmcnt(11) lgkmcnt(4)
    v_mfma_f32_16x16x32_bf16 v[156:159], v[148:151], v[76:79], v[156:159]
    ds_read_b128 v[140:143], v4 offset:36864
    v_mfma_f32_16x16x32_bf16 v[160:163], v[152:155], v[76:79], v[160:163]
    ds_read_b128 v[144:147], v4 offset:37888
    s_waitcnt vmcnt(10) lgkmcnt(4)
    v_mfma_f32_16x16x32_bf16 v[156:159], v[124:127], v[80:83], v[156:159]
    ds_read_b128 v[148:151], v4 offset:38912
    v_mfma_f32_16x16x32_bf16 v[160:163], v[128:131], v[80:83], v[160:163]
    ds_read_b128 v[152:155], v4 offset:39936
    s_waitcnt vmcnt(9) lgkmcnt(4)
    v_mfma_f32_16x16x32_bf16 v[156:159], v[132:135], v[84:87], v[156:159]
    ds_read_b128 v[124:127], v4 offset:40960
    v_mfma_f32_16x16x32_bf16 v[160:163], v[136:139], v[84:87], v[160:163]
    ds_read_b128 v[128:131], v4 offset:41984
    s_waitcnt vmcnt(8) lgkmcnt(4)
    v_mfma_f32_16x16x32_bf16 v[156:159], v[140:143], v[88:91], v[156:159]
    ds_read_b128 v[132:135], v4 offset:43008
    v_mfma_f32_16x16x32_bf16 v[160:163], v[144:147], v[88:91], v[160:163]
    ds_read_b128 v[136:139], v4 offset:44032
    s_waitcnt vmcnt(7) lgkmcnt(4)
    v_mfma_f32_16x16x32_bf16 v[156:159], v[148:151], v[92:95], v[156:159]
    ds_read_b128 v[140:143], v4 offset:45056
    v_mfma_f32_16x16x32_bf16 v[160:163], v[152:155], v[92:95], v[160:163]
    ds_read_b128 v[144:147], v4 offset:46080
    s_waitcnt vmcnt(6) lgkmcnt(4)
    v_mfma_f32_16x16x32_bf16 v[156:159], v[124:127], v[96:99], v[156:159]
    ds_read_b128 v[148:151], v4 offset:47104
    v_mfma_f32_16x16x32_bf16 v[160:163], v[128:131], v[96:99], v[160:163]
    ds_read_b128 v[152:155], v4 offset:48128
    s_waitcnt vmcnt(5) lgkmcnt(4)
    v_mfma_f32_16x16x32_bf16 v[156:159], v[132:135], v[100:103], v[156:159]
    ds_read_b128 v[124:127], v4 offset:49152
    v_mfma_f32_16x16x32_bf16 v[160:163], v[136:139], v[100:103], v[160:163]
    ds_read_b128 v[128:131], v4 offset:50176
    s_waitcnt vmcnt(4) lgkmcnt(4)
    v_mfma_f32_16x16x32_bf16 v[156:159], v[140:143], v[104:107], v[156:159]
    ds_read_b128 v[132:135], v4 offset:51200
    v_mfma_f32_16x16x32_bf16 v[160:163], v[144:147], v[104:107], v[160:163]
    ds_read_b128 v[136:139], v4 offset:52224
    s_waitcnt vmcnt(3) lgkmcnt(4)
    v_mfma_f32_16x16x32_bf16 v[156:159], v[148:151], v[108:111], v[156:159]
    ds_read_b128 v[140:143], v4 offset:53248
    v_mfma_f32_16x16x32_bf16 v[160:163], v[152:155], v[108:111], v[160:163]
    ds_read_b128 v[144:147], v4 offset:54272
    s_waitcnt vmcnt(2) lgkmcnt(4)
    v_mfma_f32_16x16x32_bf16 v[156:159], v[124:127], v[112:115], v[156:159]
    v_mfma_f32_16x16x32_bf16 v[160:163], v[128:131], v[112:115], v[160:163]
    s_waitcnt vmcnt(1) lgkmcnt(2)
    v_mfma_f32_16x16x32_bf16 v[156:159], v[132:135], v[116:119], v[156:159]
    v_mfma_f32_16x16x32_bf16 v[160:163], v[136:139], v[116:119], v[160:163]
    s_waitcnt vmcnt(0) lgkmcnt(0)
    v_mfma_f32_16x16x32_bf16 v[156:159], v[140:143], v[120:123], v[156:159]
    v_mfma_f32_16x16x32_bf16 v[160:163], v[144:147], v[120:123], v[160:163]
    s_cmp_ge_u32 s36, 2
    s_cbranch_scc1 f2h_195
    s_nop 5
    ds_write_b128 v10, v[160:163]
    s_branch f2j_196
f2h_195:
    s_nop 1
    ds_write_b128 v10, v[156:159]
    s_waitcnt lgkmcnt(0)
    s_nop 1
    v_mov_b64 v[156:157], v[160:161]
    v_mov_b64 v[158:159], v[162:163]
f2j_196:
    s_waitcnt lgkmcnt(0)
    s_barrier
    ds_read_b128 v[160:163], v11
    s_waitcnt lgkmcnt(0)
    v_pk_add_f32 v[156:157], v[156:157], v[160:161]
    v_cvt_pk_bf16_f32 v157, v156, v157
    v_lshlrev_b32 v156, 16, v157
    v_and_b32 v157, 0xffff0000, v157
    v_pk_mul_f32 v[156:157], v[156:157], v[204:205]
    v_cvt_pk_bf16_f32 v157, v156, v157
    v_lshlrev_b32 v156, 16, v157
    v_and_b32 v157, 0xffff0000, v157
    v_lshlrev_b32 v6, 16, v200
    v_and_b32 v7, 0xffff0000, v200
    v_pk_add_f32 v[156:157], v[156:157], v[6:7]
    v_cvt_pk_bf16_f32 v200, v156, v157
    v_pk_add_f32 v[158:159], v[158:159], v[162:163]
    v_cvt_pk_bf16_f32 v159, v158, v159
    v_lshlrev_b32 v158, 16, v159
    v_and_b32 v159, 0xffff0000, v159
    v_pk_mul_f32 v[158:159], v[158:159], v[206:207]
    v_cvt_pk_bf16_f32 v159, v158, v159
    v_lshlrev_b32 v158, 16, v159
    v_and_b32 v159, 0xffff0000, v159
    v_lshlrev_b32 v6, 16, v201
    v_and_b32 v7, 0xffff0000, v201
    v_pk_add_f32 v[158:159], v[158:159], v[6:7]
    v_cvt_pk_bf16_f32 v201, v158, v159
    buffer_store_dwordx2 v[200:201], v12, s[24:27], s44 offen
    s_add_u32 s76, s76, 2
    s_cmp_lt_u32 s76, 64
    s_cbranch_scc1 f2top_192
    s_branch main_end
att_160:
    v_lshlrev_b32 v1, 4, v0
    v_bfe_u32 v4, v0, 2, 4
    v_lshlrev_b32 v2, 4, v4
    v_bfe_u32 v4, v0, 0, 1
    v_lshl_add_u32 v2, v4, 3, v2
    v_bfe_u32 v4, v0, 0, 4
    v_lshlrev_b32 v3, 4, v4
    v_bfe_u32 v4, v0, 4, 1
    v_lshl_add_u32 v3, v4, 3, v3
    v_bfe_u32 v4, v0, 5, 1
    v_lshl_add_u32 v3, v4, 8, v3
    s_lshl_b32 s54, s36, 11
    v_add_u32 v2, s54, v2
    v_add_u32 v3, s54, v3
    v_and_b32 v4, 15, v0
    v_lshrrev_b32 v5, 4, v0
    v_lshlrev_b32 v5, 2, v5
    v_add_u32 v6, 0, v5
    v_cmp_le_u32 s[60:61], v6, v4
    v_add_u32 v6, 1, v5
    v_cmp_le_u32 s[62:63], v6, v4
    v_add_u32 v6, 2, v5
    v_cmp_le_u32 s[64:65], v6, v4
    v_add_u32 v6, 3, v5
    v_cmp_le_u32 s[66:67], v6, v4
    s_mov_b64 s[68:69], 0xffffffff
    s_not_b64 s[58:59], s[68:69]
    s_lshr_b32 s76, s77, 3
    s_and_b32 s77, s77, 7
    s_lshl_b32 s73, s77, 2
    s_add_u32 s73, s73, s36
    s_lshl_b32 s75, s73, 7
    s_add_u32 s75, s75, 2363392
    v_min_u32 v4, 15, v0
    v_mul_u32_u24 v4, 4, v4
wt_197:
    buffer_load_dword v5, v4, s[8:11], s75 offen sc1
    s_waitcnt vmcnt(0)
    v_cmp_gt_u32 vcc, 2, v5
    s_nop 0
    s_cbranch_vccz wd_198
    s_sleep 2
    s_sub_u32 s53, s53, 1
    s_cbranch_scc0 wt_197
    s_mov_b32 s53, 0
wd_198:
    s_lshr_b32 s75, s73, 1
    s_lshl_b32 s75, s75, 7
    s_add_u32 s75, s75, 2367488
    v_min_u32 v4, 15, v0
    v_mul_u32_u24 v4, 4, v4
wt_199:
    buffer_load_dword v5, v4, s[8:11], s75 offen sc1
    s_waitcnt vmcnt(0)
    v_cmp_gt_u32 vcc, 2, v5
    s_nop 0
    s_cbranch_vccz wd_200
    s_sleep 2
    s_sub_u32 s53, s53, 1
    s_cbranch_scc0 wt_199
    s_mov_b32 s53, 0
wd_200:
atop_201:
    s_lshl_b32 s54, s76, 5
    s_add_u32 s54, s54, s73
    s_lshl_b32 s55, s54, 13
    s_add_u32 s55, s55, 33554432
    s_mul_i32 s54, s73, 65
    s_add_u32 s54, s54, s76
    s_lshl_b32 s56, s54, 14
    s_add_u32 s56, s56, 50331648
    s_lshl_b32 s57, s54, 12
    s_add_u32 s57, s57, 88080384
    buffer_load_dwordx4 v[8:11], v1, s[8:11], s55 offen offset:0 sc1
    buffer_load_dwordx4 v[12:15], v1, s[8:11], s55 offen offset:1024 sc1
    buffer_load_dwordx4 v[16:19], v1, s[8:11], s55 offen offset:2048 sc1
    buffer_load_dwordx4 v[20:23], v1, s[8:11], s55 offen offset:3072 sc1
    s_add_u32 s55, s55, 4096
    buffer_load_dwordx4 v[24:27], v1, s[8:11], s55 offen offset:0 sc1
    buffer_load_dwordx4 v[28:31], v1, s[8:11], s55 offen offset:1024 sc1
    buffer_load_dwordx4 v[32:35], v1, s[8:11], s55 offen offset:2048 sc1
    buffer_load_dwordx4 v[36:39], v1, s[8:11], s55 offen offset:3072 sc1
    buffer_load_dwordx4 v[40:43], v1, s[8:11], s56 offen offset:0 sc1
    buffer_load_dwordx4 v[44:47], v1, s[8:11], s56 offen offset:1024 sc1
    buffer_load_dwordx4 v[48:51], v1, s[8:11], s56 offen offset:2048 sc1
    buffer_load_dwordx4 v[52:55], v1, s[8:11], s56 offen offset:3072 sc1
    s_add_u32 s56, s56, 4096
    buffer_load_dwordx4 v[56:59], v1, s[8:11], s56 offen offset:0 sc1
    buffer_load_dwordx4 v[60:63], v1, s[8:11], s56 offen offset:1024 sc1
    buffer_load_dwordx4 v[64:67], v1, s[8:11], s56 offen offset:2048 sc1
    buffer_load_dwordx4 v[68:71], v1, s[8:11], s56 offen offset:3072 sc1
    s_add_u32 s56, s56, 4096
    buffer_load_dwordx4 v[72:75], v1, s[8:11], s56 offen offset:0 sc1
    buffer_load_dwordx4 v[76:79], v1, s[8:11], s56 offen offset:1024 sc1
    buffer_load_dwordx4 v[80:83], v1, s[8:11], s56 offen offset:2048 sc1
    buffer_load_dwordx4 v[84:87], v1, s[8:11], s56 offen offset:3072 sc1
    s_add_u32 s56, s56, 4096
    buffer_load_dwordx4 v[88:91], v1, s[8:11], s56 offen offset:0 sc1
    buffer_load_dwordx4 v[92:95], v1, s[8:11], s56 offen offset:1024 sc1
    buffer_load_dwordx4 v[96:99], v1, s[8:11], s56 offen offset:2048 sc1
    buffer_load_dwordx4 v[100:103], v1, s[8:11], s56 offen offset:3072 sc1
    v_mov_b32 v6, 0xce6e6b28
    s_mov_b32 s44, 0x3db504f3
    s_mov_b32 s45, 1069066811
    s_waitcnt vmcnt(8)
    v_mfma_f32_16x16x32_bf16 v[140:143], v[40:43], v[8:11], 0
    v_mfma_f32_16x16x32_bf16 v[140:143], v[44:47], v[12:15], v[140:143]
    v_mfma_f32_16x16x32_bf16 v[140:143], v[48:51], v[16:19], v[140:143]
    v_mfma_f32_16x16x32_bf16 v[140:143], v[52:55], v[20:23], v[140:143]
    v_mfma_f32_16x16x32_bf16 v[152:155], v[40:43], v[24:27], 0
    v_mfma_f32_16x16x32_bf16 v[152:155], v[44:47], v[28:31], v[152:155]
    v_mfma_f32_16x16x32_bf16 v[152:155], v[48:51], v[32:35], v[152:155]
    v_mfma_f32_16x16x32_bf16 v[152:155], v[52:55], v[36:39], v[152:155]
    v_mfma_f32_16x16x32_bf16 v[156:159], v[56:59], v[24:27], 0
    v_mfma_f32_16x16x32_bf16 v[156:159], v[60:63], v[28:31], v[156:159]
    v_mfma_f32_16x16x32_bf16 v[156:159], v[64:67], v[32:35], v[156:159]
    v_mfma_f32_16x16x32_bf16 v[156:159], v[68:71], v[36:39], v[156:159]
    v_cvt_pk_bf16_f32 v141, v140, v141
    v_lshlrev_b32 v140, 16, v141
    v_and_b32 v141, 0xffff0000, v141
    v_mul_f32 v140, s44, v140
    v_mul_f32 v141, s44, v141
    v_cvt_pk_bf16_f32 v141, v140, v141
    v_lshlrev_b32 v140, 16, v141
    v_and_b32 v141, 0xffff0000, v141
    v_cvt_pk_bf16_f32 v143, v142, v143
    v_lshlrev_b32 v142, 16, v143
    v_and_b32 v143, 0xffff0000, v143
    v_mul_f32 v142, s44, v142
    v_mul_f32 v143, s44, v143
    v_cvt_pk_bf16_f32 v143, v142, v143
    v_lshlrev_b32 v142, 16, v143
    v_and_b32 v143, 0xffff0000, v143
    v_cndmask_b32 v140, v6, v140, s[60:61]
    v_cndmask_b32 v141, v6, v141, s[62:63]
    v_cndmask_b32 v142, v6, v142, s[64:65]
    v_cndmask_b32 v143, v6, v143, s[66:67]
    v_max3_f32 v176, v140, v141, v142
    v_max_f32 v176, v176, v143
    v_cvt_pk_bf16_f32 v153, v152, v153
    v_lshlrev_b32 v152, 16, v153
    v_and_b32 v153, 0xffff0000, v153
    v_mul_f32 v152, s44, v152
    v_mul_f32 v153, s44, v153
    v_cvt_pk_bf16_f32 v153, v152, v153
    v_lshlrev_b32 v152, 16, v153
    v_and_b32 v153, 0xffff0000, v153
    v_cvt_pk_bf16_f32 v155, v154, v155
    v_lshlrev_b32 v154, 16, v155
    v_and_b32 v155, 0xffff0000, v155
    v_mul_f32 v154, s44, v154
    v_mul_f32 v155, s44, v155
    v_cvt_pk_bf16_f32 v155, v154, v155
    v_lshlrev_b32 v154, 16, v155
    v_and_b32 v155, 0xffff0000, v155
    v_cvt_pk_bf16_f32 v157, v156, v157
    v_lshlrev_b32 v156, 16, v157
    v_and_b32 v157, 0xffff0000, v157
    v_mul_f32 v156, s44, v156
    v_mul_f32 v157, s44, v157
    v_cvt_pk_bf16_f32 v157, v156, v157
    v_lshlrev_b32 v156, 16, v157
    v_and_b32 v157, 0xffff0000, v157
    v_cvt_pk_bf16_f32 v159, v158, v159
    v_lshlrev_b32 v158, 16, v159
    v_and_b32 v159, 0xffff0000, v159
    v_mul_f32 v158, s44, v158
    v_mul_f32 v159, s44, v159
    v_cvt_pk_bf16_f32 v159, v158, v159
    v_lshlrev_b32 v158, 16, v159
    v_and_b32 v159, 0xffff0000, v159
    v_cndmask_b32 v156, v6, v156, s[60:61]
    v_cndmask_b32 v157, v6, v157, s[62:63]
    v_cndmask_b32 v158, v6, v158, s[64:65]
    v_cndmask_b32 v159, v6, v159, s[66:67]
    v_max3_f32 v177, v152, v153, v154
    v_max3_f32 v177, v177, v155, v156
    v_max3_f32 v177, v177, v157, v158
    v_max_f32 v177, v177, v159
    v_mov_b64 v[162:163], 0
kp_204:
    buffer_load_dword v4, off, s[8:11], s57 offset:3072 sc1
    s_waitcnt vmcnt(0)
    v_cmp_eq_u32 vcc, -1, v4
    s_nop 0
    s_cbranch_vccz kpd_205
    s_sleep 6
    s_sub_u32 s53, s53, 1
    s_cbranch_scc0 kp_204
    s_mov_b32 s53, 0
kpd_205:
km_202:
    buffer_load_dwordx4 v[120:123], v1, s[8:11], s57 offen offset:0 sc1
    buffer_load_dwordx4 v[124:127], v1, s[8:11], s57 offen offset:1024 sc1
    buffer_load_dwordx4 v[128:131], v1, s[8:11], s57 offen offset:2048 sc1
    buffer_load_dwordx4 v[132:135], v1, s[8:11], s57 offen offset:3072 sc1
    s_waitcnt vmcnt(0)
    v_max3_u32 v4, v120, v121, v122
    v_max3_u32 v4, v4, v123, v124
    v_max3_u32 v4, v4, v125, v126
    v_max3_u32 v4, v4, v127, v128
    v_max3_u32 v4, v4, v129, v130
    v_max3_u32 v4, v4, v131, v132
    v_max3_u32 v4, v4, v133, v134
    v_max_u32 v4, v4, v135
    v_cmp_eq_u32 vcc, -1, v4
    s_nop 0
    s_cbranch_vccz kmd_203
    s_sleep 2
    s_sub_u32 s53, s53, 1
    s_cbranch_scc0 km_202
    s_mov_b32 s53, 0
kmd_203:
    ds_write_b64 v3, v[122:123] offset:0
    ds_write_b64 v3, v[126:127] offset:512
    ds_write_b64 v3, v[130:131] offset:1024
    ds_write_b64 v3, v[134:135] offset:1536
    s_waitcnt lgkmcnt(0)
    ds_read_b64_tr_b16 v[104:105], v2 offset:0
    ds_read_b64_tr_b16 v[106:107], v2 offset:256
    ds_read_b64_tr_b16 v[108:109], v2 offset:512
    ds_read_b64_tr_b16 v[110:111], v2 offset:768
    ds_read_b64_tr_b16 v[112:113], v2 offset:1024
    ds_read_b64_tr_b16 v[114:115], v2 offset:1280
    ds_read_b64_tr_b16 v[116:117], v2 offset:1536
    ds_read_b64_tr_b16 v[118:119], v2 offset:1792
    s_waitcnt lgkmcnt(0)
    v_mfma_f32_16x16x32_bf16 v[136:139], v[104:107], v[8:11], 0
    v_mfma_f32_16x16x32_bf16 v[136:139], v[108:111], v[12:15], v[136:139]
    v_mfma_f32_16x16x32_bf16 v[136:139], v[112:115], v[16:19], v[136:139]
    v_mfma_f32_16x16x32_bf16 v[136:139], v[116:119], v[20:23], v[136:139]
    v_mfma_f32_16x16x32_bf16 v[148:151], v[104:107], v[24:27], 0
    v_mfma_f32_16x16x32_bf16 v[148:151], v[108:111], v[28:31], v[148:151]
    v_mfma_f32_16x16x32_bf16 v[148:151], v[112:115], v[32:35], v[148:151]
    v_mfma_f32_16x16x32_bf16 v[148:151], v[116:119], v[36:39], v[148:151]
    v_cvt_pk_bf16_f32 v137, v136, v137
    v_lshlrev_b32 v136, 16, v137
    v_and_b32 v137, 0xffff0000, v137
    v_mul_f32 v136, s44, v136
    v_mul_f32 v137, s44, v137
    v_cvt_pk_bf16_f32 v137, v136, v137
    v_lshlrev_b32 v136, 16, v137
    v_and_b32 v137, 0xffff0000, v137
    v_cvt_pk_bf16_f32 v139, v138, v139
    v_lshlrev_b32 v138, 16, v139
    v_and_b32 v139, 0xffff0000, v139
    v_mul_f32 v138, s44, v138
    v_mul_f32 v139, s44, v139
    v_cvt_pk_bf16_f32 v139, v138, v139
    v_lshlrev_b32 v138, 16, v139
    v_and_b32 v139, 0xffff0000, v139
    v_max3_f32 v176, v176, v136, v137
    v_max3_f32 v176, v176, v138, v139
    v_mov_b32 v5, v176
    s_nop 1
    v_permlane16_swap_b32 v176, v5
    v_max_f32 v176, v176, v5
    v_mov_b32 v5, v176
    s_nop 1
    v_permlane32_swap_b32 v176, v5
    v_max_f32 v176, v176, v5
    v_sub_f32 v136, v136, v176
    v_sub_f32 v137, v137, v176
    v_sub_f32 v138, v138, v176
    v_sub_f32 v139, v139, v176
    v_sub_f32 v140, v140, v176
    v_sub_f32 v141, v141, v176
    v_sub_f32 v142, v142, v176
    v_sub_f32 v143, v143, v176
    v_mul_f32 v136, s45, v136
    v_mul_f32 v137, s45, v137
    v_mul_f32 v138, s45, v138
    v_mul_f32 v139, s45, v139
    v_mul_f32 v140, s45, v140
    v_mul_f32 v141, s45, v141
    v_mul_f32 v142, s45, v142
    v_mul_f32 v143, s45, v143
    v_exp_f32 v136, v136
    v_exp_f32 v137, v137
    v_exp_f32 v138, v138
    v_exp_f32 v139, v139
    v_exp_f32 v140, v140
    v_exp_f32 v141, v141
    v_exp_f32 v142, v142
    v_exp_f32 v143, v143
    v_add_f32 v176, v136, v137
    v_add_f32 v5, v138, v139
    v_add_f32 v176, v176, v5
    v_cndmask_b32 v176, 0, v176, s[68:69]
    v_add_f32 v176, v176, v140
    v_add_f32 v176, v176, v141
    v_add_f32 v176, v176, v142
    v_add_f32 v176, v176, v143
    v_mov_b32 v5, v176
    s_nop 1
    v_permlane16_swap_b32 v176, v5
    v_add_f32 v176, v176, v5
    v_mov_b32 v5, v176
    s_nop 1
    v_permlane32_swap_b32 v176, v5
    v_add_f32 v176, v176, v5
    v_rcp_f32 v176, v176
    s_nop 0
    v_mul_f32 v136, v136, v176
    v_mul_f32 v137, v137, v176
    v_mul_f32 v138, v138, v176
    v_mul_f32 v139, v139, v176
    v_mul_f32 v140, v140, v176
    v_mul_f32 v141, v141, v176
    v_mul_f32 v142, v142, v176
    v_mul_f32 v143, v143, v176
    v_cvt_pk_bf16_f32 v136, v136, v137
    v_cvt_pk_bf16_f32 v137, v138, v139
    v_cndmask_b32 v164, 0, v136, s[68:69]
    v_cndmask_b32 v166, 0, v136, s[58:59]
    v_cndmask_b32 v165, 0, v137, s[68:69]
    v_cndmask_b32 v167, 0, v137, s[58:59]
    v_cvt_pk_bf16_f32 v160, v140, v141
    v_cvt_pk_bf16_f32 v161, v142, v143
    v_cvt_pk_bf16_f32 v149, v148, v149
    v_lshlrev_b32 v148, 16, v149
    v_and_b32 v149, 0xffff0000, v149
    v_mul_f32 v148, s44, v148
    v_mul_f32 v149, s44, v149
    v_cvt_pk_bf16_f32 v149, v148, v149
    v_lshlrev_b32 v148, 16, v149
    v_and_b32 v149, 0xffff0000, v149
    v_cvt_pk_bf16_f32 v151, v150, v151
    v_lshlrev_b32 v150, 16, v151
    v_and_b32 v151, 0xffff0000, v151
    v_mul_f32 v150, s44, v150
    v_mul_f32 v151, s44, v151
    v_cvt_pk_bf16_f32 v151, v150, v151
    v_lshlrev_b32 v150, 16, v151
    v_and_b32 v151, 0xffff0000, v151
    v_max3_f32 v177, v177, v148, v149
    v_max3_f32 v177, v177, v150, v151
    v_mov_b32 v5, v177
    s_nop 1
    v_permlane16_swap_b32 v177, v5
    v_max_f32 v177, v177, v5
    v_mov_b32 v5, v177
    s_nop 1
    v_permlane32_swap_b32 v177, v5
    v_max_f32 v177, v177, v5
    v_sub_f32 v148, v148, v177
    v_sub_f32 v149, v149, v177
    v_sub_f32 v150, v150, v177
    v_sub_f32 v151, v151, v177
    v_sub_f32 v152, v152, v177
    v_sub_f32 v153, v153, v177
    v_sub_f32 v154, v154, v177
    v_sub_f32 v155, v155, v177
    v_sub_f32 v156, v156, v177
    v_sub_f32 v157, v157, v177
    v_sub_f32 v158, v158, v177
    v_sub_f32 v159, v159, v177
    v_mul_f32 v148, s45, v148
    v_mul_f32 v149, s45, v149
    v_mul_f32 v150, s45, v150
    v_mul_f32 v151, s45, v151
    v_mul_f32 v152, s45, v152
    v_mul_f32 v153, s45, v153
    v_mul_f32 v154, s45, v154
    v_mul_f32 v155, s45, v155
    v_mul_f32 v156, s45, v156
    v_mul_f32 v157, s45, v157
    v_mul_f32 v158, s45, v158
    v_mul_f32 v159, s45, v159
    v_exp_f32 v148, v148
    v_exp_f32 v149, v149
    v_exp_f32 v150, v150
    v_exp_f32 v151, v151
    v_exp_f32 v152, v152
    v_exp_f32 v153, v153
    v_exp_f32 v154, v154
    v_exp_f32 v155, v155
    v_exp_f32 v156, v156
    v_exp_f32 v157, v157
    v_exp_f32 v158, v158
    v_exp_f32 v159, v159
    v_add_f32 v177, v148, v149
    v_add_f32 v5, v150, v151
    v_add_f32 v177, v177, v5
    v_cndmask_b32 v177, 0, v177, s[68:69]
    v_add_f32 v177, v177, v152
    v_add_f32 v177, v177, v153
    v_add_f32 v177, v177, v154
    v_add_f32 v177, v177, v155
    v_add_f32 v177, v177, v156
    v_add_f32 v177, v177, v157
    v_add_f32 v177, v177, v158
    v_add_f32 v177, v177, v159
    v_mov_b32 v5, v177
    s_nop 1
    v_permlane16_swap_b32 v177, v5
    v_add_f32 v177, v177, v5
    v_mov_b32 v5, v177
    s_nop 1
    v_permlane32_swap_b32 v177, v5
    v_add_f32 v177, v177, v5
    v_rcp_f32 v177, v177
    s_nop 0
    v_mul_f32 v148, v148, v177
    v_mul_f32 v149, v149, v177
    v_mul_f32 v150, v150, v177
    v_mul_f32 v151, v151, v177
    v_mul_f32 v152, v152, v177
    v_mul_f32 v153, v153, v177
    v_mul_f32 v154, v154, v177
    v_mul_f32 v155, v155, v177
    v_mul_f32 v156, v156, v177
    v_mul_f32 v157, v157, v177
    v_mul_f32 v158, v158, v177
    v_mul_f32 v159, v159, v177
    v_cvt_pk_bf16_f32 v148, v148, v149
    v_cvt_pk_bf16_f32 v149, v150, v151
    v_cndmask_b32 v172, 0, v148, s[68:69]
    v_cndmask_b32 v174, 0, v148, s[58:59]
    v_cndmask_b32 v173, 0, v149, s[68:69]
    v_cndmask_b32 v175, 0, v149, s[58:59]
    v_cvt_pk_bf16_f32 v168, v152, v153
    v_cvt_pk_bf16_f32 v169, v154, v155
    v_cvt_pk_bf16_f32 v170, v156, v157
    v_cvt_pk_bf16_f32 v171, v158, v159
    s_lshl_b32 s54, s76, 18
    s_lshl_b32 s55, s73, 12
    s_add_u32 s54, s54, s55
    s_add_u32 s54, s54, 117440512
    v_mfma_f32_16x16x32_bf16 v[8:11], v[72:75], v[160:163], 0
    v_mfma_f32_16x16x32_bf16 v[12:15], v[76:79], v[160:163], 0
    v_mfma_f32_16x16x32_bf16 v[16:19], v[80:83], v[160:163], 0
    v_mfma_f32_16x16x32_bf16 v[20:23], v[84:87], v[160:163], 0
    v_mfma_f32_16x16x32_bf16 v[24:27], v[88:91], v[160:163], 0
    v_mfma_f32_16x16x32_bf16 v[28:31], v[92:95], v[160:163], 0
    v_mfma_f32_16x16x32_bf16 v[32:35], v[96:99], v[160:163], 0
    v_mfma_f32_16x16x32_bf16 v[36:39], v[100:103], v[160:163], 0
    v_mfma_f32_16x16x16_bf16 v[8:11], v[120:121], v[164:165], v[8:11]
    v_mfma_f32_16x16x16_bf16 v[12:15], v[120:121], v[166:167], v[12:15]
    v_mfma_f32_16x16x16_bf16 v[16:19], v[124:125], v[164:165], v[16:19]
    v_mfma_f32_16x16x16_bf16 v[20:23], v[124:125], v[166:167], v[20:23]
    v_mfma_f32_16x16x16_bf16 v[24:27], v[128:129], v[164:165], v[24:27]
    v_mfma_f32_16x16x16_bf16 v[28:31], v[128:129], v[166:167], v[28:31]
    v_mfma_f32_16x16x16_bf16 v[32:35], v[132:133], v[164:165], v[32:35]
    v_mfma_f32_16x16x16_bf16 v[36:39], v[132:133], v[166:167], v[36:39]
    v_mfma_f32_16x16x32_bf16 v[40:43], v[72:75], v[168:171], 0
    v_mfma_f32_16x16x32_bf16 v[44:47], v[76:79], v[168:171], 0
    v_mfma_f32_16x16x32_bf16 v[48:51], v[80:83], v[168:171], 0
    v_mfma_f32_16x16x32_bf16 v[52:55], v[84:87], v[168:171], 0
    v_mfma_f32_16x16x32_bf16 v[56:59], v[88:91], v[168:171], 0
    v_mfma_f32_16x16x32_bf16 v[60:63], v[92:95], v[168:171], 0
    v_mfma_f32_16x16x32_bf16 v[64:67], v[96:99], v[168:171], 0
    v_mfma_f32_16x16x32_bf16 v[68:71], v[100:103], v[168:171], 0
    v_mfma_f32_16x16x16_bf16 v[40:43], v[120:121], v[172:173], v[40:43]
    v_mfma_f32_16x16x16_bf16 v[44:47], v[120:121], v[174:175], v[44:47]
    v_mfma_f32_16x16x16_bf16 v[48:51], v[124:125], v[172:173], v[48:51]
    v_mfma_f32_16x16x16_bf16 v[52:55], v[124:125], v[174:175], v[52:55]
    v_mfma_f32_16x16x16_bf16 v[56:59], v[128:129], v[172:173], v[56:59]
    v_mfma_f32_16x16x16_bf16 v[60:63], v[128:129], v[174:175], v[60:63]
    v_mfma_f32_16x16x16_bf16 v[64:67], v[132:133], v[172:173], v[64:67]
    v_mfma_f32_16x16x16_bf16 v[68:71], v[132:133], v[174:175], v[68:71]
    v_cvt_pk_bf16_f32 v136, v8, v9
    v_cvt_pk_bf16_f32 v137, v10, v11
    v_cvt_pk_bf16_f32 v138, v12, v13
    v_cvt_pk_bf16_f32 v139, v14, v15
    buffer_store_dwordx4 v[136:139], v1, s[8:11], s54 offen offset:0 sc1
    v_cvt_pk_bf16_f32 v140, v16, v17
    v_cvt_pk_bf16_f32 v141, v18, v19
    v_cvt_pk_bf16_f32 v142, v20, v21
    v_cvt_pk_bf16_f32 v143, v22, v23
    buffer_store_dwordx4 v[140:143], v1, s[8:11], s54 offen offset:1024 sc1
    v_cvt_pk_bf16_f32 v144, v24, v25
    v_cvt_pk_bf16_f32 v145, v26, v27
    v_cvt_pk_bf16_f32 v146, v28, v29
    v_cvt_pk_bf16_f32 v147, v30, v31
    buffer_store_dwordx4 v[144:147], v1, s[8:11], s54 offen offset:2048 sc1
    v_cvt_pk_bf16_f32 v148, v32, v33
    v_cvt_pk_bf16_f32 v149, v34, v35
    v_cvt_pk_bf16_f32 v150, v36, v37
    v_cvt_pk_bf16_f32 v151, v38, v39
    buffer_store_dwordx4 v[148:151], v1, s[8:11], s54 offen offset:3072 sc1
    s_add_u32 s54, s54, 131072
    v_cvt_pk_bf16_f32 v152, v40, v41
    v_cvt_pk_bf16_f32 v153, v42, v43
    v_cvt_pk_bf16_f32 v154, v44, v45
    v_cvt_pk_bf16_f32 v155, v46, v47
    buffer_store_dwordx4 v[152:155], v1, s[8:11], s54 offen offset:0 sc1
    v_cvt_pk_bf16_f32 v156, v48, v49
    v_cvt_pk_bf16_f32 v157, v50, v51
    v_cvt_pk_bf16_f32 v158, v52, v53
    v_cvt_pk_bf16_f32 v159, v54, v55
    buffer_store_dwordx4 v[156:159], v1, s[8:11], s54 offen offset:1024 sc1
    v_cvt_pk_bf16_f32 v136, v56, v57
    v_cvt_pk_bf16_f32 v137, v58, v59
    v_cvt_pk_bf16_f32 v138, v60, v61
    v_cvt_pk_bf16_f32 v139, v62, v63
    buffer_store_dwordx4 v[136:139], v1, s[8:11], s54 offen offset:2048 sc1
    v_cvt_pk_bf16_f32 v140, v64, v65
    v_cvt_pk_bf16_f32 v141, v66, v67
    v_cvt_pk_bf16_f32 v142, v68, v69
    v_cvt_pk_bf16_f32 v143, v70, v71
    buffer_store_dwordx4 v[140:143], v1, s[8:11], s54 offen offset:3072 sc1
    s_lshl_b32 s75, s76, 5
    s_lshl_b32 s54, s77, 2
    s_add_u32 s75, s75, s54
    s_add_u32 s75, s75, 2371584
    s_waitcnt vmcnt(0) lgkmcnt(0)
    s_barrier
    s_cmp_lg_u32 s36, 0
    s_cbranch_scc1 sg_206
    v_mov_b32 v4, 0
    v_mov_b32 v5, 1
    s_mov_b64 exec, 1
    buffer_store_dword v5, v4, s[8:11], s75 offen sc1
    s_mov_b64 exec, -1
sg_206:
    s_add_u32 s76, s76, 3
    s_cmp_lt_u32 s76, 64
    s_cbranch_scc1 atop_201
main_end:
    s_endpgm
.section .rodata,"a"
.p2align 6
.amdhsa_kernel adaLN_cond__memory_aug_recurrent_mem_tr__dense_activation_silu__prompt_kernel
  .amdhsa_next_free_vgpr 512
  .amdhsa_next_free_sgpr 102
  .amdhsa_accum_offset 256
  .amdhsa_group_segment_fixed_size 0
  .amdhsa_kernarg_size 120
  .amdhsa_user_sgpr_count 2
  .amdhsa_user_sgpr_kernarg_segment_ptr 1
  .amdhsa_system_sgpr_workgroup_id_x 1
.end_amdhsa_kernel
```
